```python
import torch

def _softmax(x, axis=-1):
    return torch.softmax(x, dim=axis)
def _gelu(x):
    return torch.nn.functional.gelu(x, approximate="tanh")
def _silu(x):
    return torch.nn.functional.silu(x)
def _sigmoid(x):
    return torch.sigmoid(x)
def _layernorm(x, axis=-1, eps=1e-5):
    m = x.mean(dim=axis, keepdim=True)
    v = x.var(dim=axis, keepdim=True, unbiased=False)
    return (x - m) / torch.sqrt(v + eps)
def _scatter_add(tgt, idx, src, axis=0):
    return tgt.clone().index_add_(axis, idx, src)
def _segment_sum(src, seg, n):
    out = torch.zeros((n,) + src.shape[1:], dtype=src.dtype)
    return out.index_add_(0, seg, src)
def _pad(x, pw):
    flat = tuple(v for pair in reversed(pw) for v in pair)
    return torch.nn.functional.pad(x, flat)

kernel_name = 'gated_mix__sliding_local_dilated__dense_activation_squared_relu__prompt'

def setup_inputs():

    _w = (lambda a: (lambda t: t.to(torch.bfloat16) if t.is_floating_point() else t)(torch.as_tensor(a)))
    def _A_setup():
        B, S, D = 1, 2048, 576
        return {
            "x": _w((lambda *s: torch.randn(*s, dtype=torch.bfloat16) * 0.05)(B, S, D)),
            "wqkv": _w((lambda *s: torch.randn(*s, dtype=torch.bfloat16) * 0.8)(D, 3 * D)),
            "wo": _w((lambda *s: torch.randn(*s, dtype=torch.bfloat16) * 0.05)(D, D)),
        }
    _A_in = _A_setup()

    def _B_setup():
        B, S, D, F = 1, 2048, 576, 4608
        return {
            "x": _w((lambda *s: torch.randn(*s, dtype=torch.bfloat16) * 0.05)(B, S, D)),
            "w1": _w((lambda *s: torch.randn(*s, dtype=torch.bfloat16) * 0.1)(D, F)),
            "b1": _w((lambda *s: torch.randn(*s, dtype=torch.bfloat16) * 0.1)(F)),
            "w2": _w((lambda *s: torch.randn(*s, dtype=torch.bfloat16) * 0.1)(F, D)),
            "b2": _w((lambda *s: torch.randn(*s, dtype=torch.bfloat16) * 0.2)(D)),
        }
    _B_in = _B_setup()

    return {
        "A_x": _A_in["x"],
        "A_wqkv": _A_in["wqkv"],
        "A_wo": _A_in["wo"],
        "B_x": _B_in["x"],
        "B_w1": _B_in["w1"],
        "B_b1": _B_in["b1"],
        "B_w2": _B_in["w2"],
        "B_b2": _B_in["b2"],
        "gate_w": _w((lambda *s: torch.randn(*s, dtype=torch.bfloat16) * 0.05)(576) * 16.0),
    }

def reference(A_x, A_wqkv, A_wo, B_x, B_w1, B_b1, B_w2, B_b2, gate_w):
    def _A_ref(x, wqkv, wo):
        B, S, D = x.shape
        H = 32; Dh = D // H
        W, dil = 8, 2
        qkv = (lambda x, *d: x.permute(*d))((x @ wqkv).reshape(B, S, 3, H, Dh), 2, 0, 3, 1, 4)
        q, k, v = qkv[0], qkv[1], qkv[2]
        scale = Dh ** -0.5
        pos = torch.arange(S)
        off = torch.arange(W) * dil
        idx = pos[:, None] - off[None, :]
        mask = idx >= 0
        idx_c = torch.where(mask, idx, 0).reshape(-1)
        kg = k[:, :, idx_c, :].reshape(B, H, S, W, Dh)
        vg = v[:, :, idx_c, :].reshape(B, H, S, W, Dh)
        logits = torch.einsum("bhsd,bhswd->bhsw", q, kg) * scale
        logits = torch.where(mask[None, None, :, :], logits, -1e9)
        attn = _softmax(logits, axis=-1)
        o = torch.einsum("bhsw,bhswd->bhsd", attn, vg)
        return (lambda x, *d: x.permute(*d))(o, 0, 2, 1, 3).reshape(B, S, D) @ wo

    def _B_ref(x, w1, b1, w2, b2):
        h = torch.einsum("bsd,df->bsf", x, w1) + b1
        zero = torch.zeros_like(h)
        r = torch.where(h > zero, h, zero)
        h = r * r
        out = torch.einsum("bsf,fd->bsd", h, w2) + b2
        return out

    x = A_x
    g = _sigmoid((x * gate_w).sum(-1, keepdims=True))
    a = _A_ref(x, A_wqkv, A_wo)
    b = _B_ref(x, B_w1, B_b1, B_w2, B_b2)
    return g * a + (1 - g) * b
```

```asm
; @launch grid=(256,1,1) block=(256,1,1) lds=163840
.amdgcn_target "amdgcn-amd-amdhsa--gfx950"
.text
.globl gated_mix__sliding_local_dilated__dense_activation_squared_relu__prompt_kernel
.p2align 12
.p2align 8
.type gated_mix__sliding_local_dilated__dense_activation_squared_relu__prompt_kernel,@function
gated_mix__sliding_local_dilated__dense_activation_squared_relu__prompt_kernel:
    s_cmp_ge_u32 s2, 256
    s_cbranch_scc1 L_exit
    s_load_dwordx16 s[4:19], s[0:1], 0
    s_load_dwordx8 s[20:27], s[0:1], 64
    v_lshrrev_b32 v1, 6, v0
    v_and_b32 v0, 63, v0
    v_readfirstlane_b32 s56, v1
    s_bfe_u32 s59, s2, 0x10002
    s_lshl_b32 s59, s59, 3
    s_bfe_u32 s57, s2, 0x30003
    s_add_u32 s57, s57, s59
    s_and_b32 s90, s2, 96
    s_bcnt1_i32_b32 s90, s90
    s_and_b32 s90, s90, 1
    s_and_b32 s59, s2, 5
    s_bcnt1_i32_b32 s59, s59
    s_and_b32 s59, s59, 1
    s_lshl1_add_u32 s90, s90, s59
    s_and_b32 s59, s2, 3
    s_lshr_b32 s60, s2, 6
    s_cbranch_scc1 L_ffn
L_att:
    s_add_u32 s58, s59, 12
    s_bfe_u32 s68, s2, 0x30003
    s_lshl_b32 s68, s68, 2
    s_add_u32 s68, s68, s56
    s_getpc_b64 s[82:83]
L_att_pc:
    s_add_u32 s82, s82, L_att_body-L_att_pc
    s_addc_u32 s83, s83, 0
    s_lshl_b32 s59, s68, 7
    v_min_u32 v39, 8, v0
    v_lshl_add_u32 v39, v39, 12, s59
    global_load_dword a255, v39, s[82:83]
    s_sub_u32 s67, s58, 12
    v_lshrrev_b32 v32, 3, v0
    v_and_b32 v33, 7, v0
    s_mul_i32 s63, s57, 147456
    s_and_b32 s69, s56, 1
    s_lshr_b32 s60, s56, 1
    s_mul_i32 s59, s69, 64
    s_add_u32 s59, s59, s60
    s_mul_i32 s59, s59, 1152
    s_add_u32 s59, s59, s63
    v_lshrrev_b32 v35, 1, v32
    v_xor_b32 v35, v33, v35
    v_lshlrev_b32 v35, 4, v35
    v_mul_u32_u24 v34, 2304, v32
    v_add3_u32 v1, v34, v35, s59
    v_xor_b32 v36, 64, v35
    s_add_u32 s59, s59, 17408
    v_add3_u32 v2, v34, v36, s59
    v_add_u32 v3, 34816, v1
    v_add_u32 v4, 34816, v2
    s_sub_u32 s59, s56, 16
    s_mul_i32 s59, s59, 1152
    s_add_u32 s59, s59, s63
    s_cmp_eq_u32 s57, 0
    s_cselect_b32 s62, 0, 2
    s_cmp_ge_u32 s56, s62
    s_cselect_b32 s59, 0x80000000, s59
    s_lshl_b32 s62, s69, 6
    v_xor_b32 v36, s62, v35
    v_add3_u32 v5, v34, v36, s59
    s_lshl_b32 s59, s69, 2
    v_and_or_b32 v38, v32, 2, s59
    v_xor_b32 v38, v33, v38
    s_mul_i32 s59, s56, 27648
    s_add_u32 s59, s59, 2048
    v_mul_u32_u24 v36, 3456, v32
    v_add_u32 v36, s59, v36
    v_lshl_add_u32 v6, v38, 4, v36
    v_subrev_u32 v7, 896, v6
    v_subrev_u32 v8, 1792, v6
    v_lshrrev_b32 v35, 1, v38
    v_subrev_u32 v37, s67, v35
    v_and_b32 v37, 256, v37
    v_add_u32 v6, v6, v37
    v_subrev_u32 v27, 896, v6
    v_mul_u32_u24 v37, 1152, v35
    v_add_u32 v35, 1, v35
    v_lshrrev_b32 v35, 2, v35
    v_lshl_add_u32 v36, v35, 31, v36
    v_and_b32 v35, 1, v38
    v_lshl_add_u32 v37, v35, 4, v37
    s_lshl_b32 s59, s67, 5
    s_sub_u32 s59, s59, 1792
    v_add3_u32 v9, v37, v36, s59
    s_lshl_b32 s64, s67, 8
    s_lshl_b32 s65, s56, 12
    s_mul_i32 s66, s56, 7168
    s_lshl_b32 s82, s56, 10
    s_bfe_u32 s85, s2, 0x10003
    s_mul_i32 s48, s85, 110592
    s_mov_b32 s30, 2359296
    s_mov_b32 s31, 0x20000
    s_mov_b32 s34, 1992704
    s_mov_b32 s35, 0x20000
    s_branch L_att_mid
L_ffn:
    s_mul_i32 s58, s59, 3
    s_add_u32 s58, s58, s60
    s_sub_u32 s58, s58, 1
    s_bfe_u32 s68, s2, 0x30003
    s_lshl_b32 s68, s68, 2
    s_add_u32 s68, s68, s56
    s_getpc_b64 s[82:83]
L_ffn_pc:
    s_add_u32 s82, s82, L_ffn_body-L_ffn_pc
    s_addc_u32 s83, s83, 0
    s_lshl_b32 s59, s68, 7
    v_min_u32 v38, 8, v0
    v_lshl_add_u32 v38, v38, 12, s59
    global_load_dword a255, v38, s[82:83]
    v_lshrrev_b32 v32, 3, v0
    v_and_b32 v33, 7, v0
    s_mul_i32 s59, s56, 36864
    v_mul_u32_u24 v34, 1152, v32
    v_add_u32 v34, s59, v34
    v_lshrrev_b32 v35, 1, v32
    v_xor_b32 v35, v33, v35
    v_lshlrev_b32 v35, 4, v35
    v_lshlrev_b32 v36, 1, v34
    v_subrev_u32 v36, s59, v36
    v_add_u32 v1, v36, v35
    v_xor_b32 v35, 64, v35
    v_add_u32 v2, v36, v35
    v_add_u32 v2, 128, v2
    v_add_u32 v3, 16384, v1
    v_add_u32 v4, 16384, v2
    s_and_b32 s69, s56, 1
    s_lshl_b32 s59, s69, 2
    v_and_or_b32 v35, v32, 2, s59
    v_xor_b32 v35, v33, v35
    s_mul_i32 s59, s56, 73728
    s_add_u32 s59, s59, 2048
    v_mul_u32_u24 v36, 9216, v32
    v_lshl_add_u32 v36, v35, 4, v36
    v_add_u32 v5, s59, v36
    v_subrev_u32 v6, 896, v5
    v_subrev_u32 v7, 1792, v5
    v_lshlrev_b32 v23, 4, v0
    s_mul_i32 s62, s57, 147456
    s_mul_i32 s63, s58, 768
    s_lshl_b32 s65, s56, 12
    s_mul_i32 s66, s56, 6144
    s_bfe_u32 s59, s2, 0x10004
    s_bfe_u32 s85, s2, 0x10003
    s_mul_i32 s60, s59, 3072
    s_sub_u32 s67, s66, s60
    s_add_u32 s67, s67, 3072
    s_add_u32 s66, s66, s60
    s_mul_i32 s59, s59, 384
    s_mul_i32 s60, s85, 294912
    s_add_u32 s48, s60, s59
    s_sub_u32 s49, s60, s59
    s_add_u32 s49, s49, 384
    s_mov_b32 s30, 2359296
    s_mov_b32 s31, 0x20000
    s_mov_b32 s34, 5310464
    s_mov_b32 s35, 0x20000
    s_mov_b32 s42, 9216
    s_mov_b32 s43, 0x20000
    s_branch L_ffn_mid
L_att_mid:
    s_waitcnt lgkmcnt(0)
    s_sub_u32 s32, s6, 2048
    s_subb_u32 s33, s7, 0
    s_mov_b64 s[28:29], s[4:5]
    s_add_u32 m0, s65, 114688
    s_xor_b32 s60, s90, 0
    s_lshl_b32 s60, s60, 7
    buffer_load_dwordx4 v1, s[28:31], s60 offen offset:0 lds
    buffer_load_dwordx4 v2, s[28:31], s60 offen offset:1024 lds
    buffer_load_dwordx4 v3, s[28:31], s60 offen offset:2048 lds
    buffer_load_dwordx4 v4, s[28:31], s60 offen offset:3072 lds
    s_add_u32 m0, s82, 131072
    s_nop 0
    buffer_load_dwordx4 v5, s[28:31], s60 offen lds
    s_xor_b32 s91, s90, 0
    s_mul_i32 s91, s91, 221184
    s_add_u32 s91, s91, s64
    s_add_u32 m0, s66, 0
    s_add_u32 s60, s91, s48
    buffer_load_dwordx4 v7, s[32:35], s60 offen offset:1024 lds
    buffer_load_dwordx4 v8, s[32:35], s60 offen offset:3072 lds
    buffer_load_dwordx4 v6, s[32:35], s60 offen offset:0 lds
    buffer_load_dwordx4 v27, s[32:35], s60 offen offset:2048 lds
    s_add_u32 m0, s66, 4096
    s_add_u32 s59, s60, 2304
    buffer_load_dwordx4 v9, s[32:35], s60 offen offset:2048 lds
    buffer_load_dwordx4 v6, s[32:35], s59 offen lds
    buffer_load_dwordx4 v7, s[32:35], s59 offen offset:1024 lds
    s_branch L_att_late
L_ffn_mid:
    s_waitcnt lgkmcnt(0)
    s_sub_u32 s32, s12, 2048
    s_subb_u32 s33, s13, 0
    s_mov_b64 s[28:29], s[4:5]
    s_add_u32 m0, s65, 98304
    s_xor_b32 s60, s90, 0
    s_lshl_b32 s60, s60, 7
    s_add_u32 s60, s60, s62
    buffer_load_dwordx4 v1, s[28:31], s60 offen offset:0 lds
    buffer_load_dwordx4 v2, s[28:31], s60 offen offset:1024 lds
    buffer_load_dwordx4 v3, s[28:31], s60 offen offset:2048 lds
    buffer_load_dwordx4 v4, s[28:31], s60 offen offset:3072 lds
    s_xor_b32 s91, s90, 0
    s_mul_i32 s91, s91, 589824
    s_add_u32 s91, s91, s63
    s_add_u32 m0, s66, 0
    s_add_u32 s60, s91, s48
    buffer_load_dwordx4 v5, s[32:35], s60 offen offset:0 lds
    buffer_load_dwordx4 v6, s[32:35], s60 offen offset:1024 lds
    buffer_load_dwordx4 v7, s[32:35], s60 offen offset:2048 lds
    s_add_u32 m0, s67, 0
    s_add_u32 s60, s91, s49
    buffer_load_dwordx4 v5, s[32:35], s60 offen offset:0 lds
    buffer_load_dwordx4 v6, s[32:35], s60 offen offset:1024 lds
    buffer_load_dwordx4 v7, s[32:35], s60 offen offset:2048 lds
    s_mov_b64 s[40:41], s[14:15]
    s_add_u32 m0, s65, 147456
    s_mov_b64 s[36:37], s[16:17]
    buffer_load_dwordx4 v23, s[40:43], s63 offen lds
    s_branch L_ffn_late
L_att_late:
    s_lshl_b32 s59, s56, 6
    v_add_u32 v42, s59, v0
    v_lshlrev_b32 v43, 1, v0
    s_lshl_b32 s59, s85, 6
    v_xor_b32 v43, s59, v43
    s_sub_u32 s49, 110592, s48
    s_mov_b64 s[40:41], s[20:21]
    s_mov_b32 s42, 1152
    s_mov_b32 s43, 0x20000
    s_add_u32 s59, s56, 0
    s_cmp_gt_u32 s59, 8
    s_subb_u32 s60, s59, 0
    s_xor_b32 s60, s60, s90
    s_cmp_eq_u32 s59, 8
    s_cselect_b32 s60, 8, s60
    s_lshl_b32 s60, s60, 7
    buffer_load_ushort v48, v43, s[40:43], s60 offen
    s_add_u32 s59, s56, 4
    s_cmp_gt_u32 s59, 8
    s_subb_u32 s60, s59, 0
    s_xor_b32 s60, s60, s90
    s_cmp_eq_u32 s59, 8
    s_cselect_b32 s60, 8, s60
    s_lshl_b32 s60, s60, 7
    buffer_load_ushort v50, v43, s[40:43], s60 offen
    s_add_u32 s59, s56, 8
    s_cmp_gt_u32 s59, 8
    s_subb_u32 s60, s59, 0
    s_xor_b32 s60, s60, s90
    s_cmp_eq_u32 s59, 8
    s_cselect_b32 s60, 8, s60
    s_lshl_b32 s60, s60, 7
    buffer_load_ushort v52, v43, s[40:43], s60 offen
    s_sub_u32 s36, s8, 2048
    s_subb_u32 s37, s9, 0
    s_mov_b32 s38, 665600
    s_mov_b32 s39, 0x20000
    s_mov_b64 s[44:45], s[26:27]
    s_mov_b32 s46, 167772160
    s_mov_b32 s47, 0x20000
    v_and_b32 v34, 3, v42
    v_lshlrev_b32 v34, 3, v34
    v_bfe_u32 v35, v42, 2, 1
    v_lshl_add_u32 v34, v35, 9, v34
    v_bfe_u32 v35, v42, 3, 4
    v_lshl_add_u32 v34, v35, 5, v34
    v_lshrrev_b32 v35, 7, v42
    v_lshl_add_u32 v34, v35, 10, v34
    v_add_u32 v43, 155648, v34
    v_and_b32 v36, 3, v32
    v_and_b32 v37, 3, v0
    v_lshlrev_b32 v37, 3, v37
    v_lshrrev_b32 v34, 4, v0
    v_bfe_u32 v35, v0, 2, 2
    v_xor_b32 v36, s56, v36
    v_lshl_add_u32 v36, v36, 5, v37
    v_lshl_add_u32 v36, v35, 7, v36
    v_mul_u32_u24 v10, 7168, v34
    v_add_u32 v10, v10, v36
    v_add_u32 v12, 6144, v10
    s_cmp_lt_u32 s56, s67
    s_cselect_b32 s59, 1024, 0
    s_sub_u32 s60, 1024, s59
    v_add_u32 v25, s60, v10
    v_add_u32 v10, s59, v10
    v_add_u32 v11, 0x10000, v10
    v_add_u32 v29, 0x10000, v25
    v_lshlrev_b32 v37, 5, v34
    v_lshl_add_u32 v37, v35, 3, v37
    v_add_u32 v37, 155648, v37
    s_cmp_eq_u32 s56, 3
    s_cselect_b64 vcc, -1, 0
    s_mov_b32 s62, 28672
    s_mov_b32 s83, -86016
    s_cselect_b32 s62, 128, s62
    s_cselect_b32 s83, 640, s83
    v_cndmask_b32 v12, v12, v37, vcc
    v_and_b32 v36, 15, v0
    v_lshrrev_b32 v37, 1, v36
    v_xor_b32 v37, v37, v34
    v_lshlrev_b32 v37, 4, v37
    v_lshl_add_u32 v13, v36, 7, v37
    v_add_u32 v13, 114688, v13
    s_lshl_b32 s59, s85, 6
    v_xor_b32 v13, s59, v13
    v_xor_b32 v14, 64, v13
    s_mul_i32 s69, s56, 3072
    s_mov_b64 exec, 0
    s_cmp_eq_u32 s56, 0
    s_cbranch_scc1 L_att_pad1
    s_cmp_eq_u32 s56, 1
    s_cbranch_scc1 L_att_pad2
    s_cmp_eq_u32 s56, 2
    s_cbranch_scc1 L_att_pad3
    s_branch L_att_pad4
L_att_ret0:
    s_mov_b64 exec, -1
    s_mov_b64 exec, 0
    s_cmp_eq_u32 s56, 0
    s_cbranch_scc1 L_att_pad5
    s_cmp_eq_u32 s56, 1
    s_cbranch_scc1 L_att_pad6
    s_cmp_eq_u32 s56, 2
    s_cbranch_scc1 L_att_pad7
    s_branch L_att_pad8
L_att_ret1:
    s_mov_b64 exec, -1
    s_branch L_att_body
L_ffn_late:
    s_mov_b64 s[44:45], s[26:27]
    s_mov_b32 s38, 5308416
    s_mov_b32 s39, 0x20000
    s_mov_b32 s46, 167772160
    s_mov_b32 s47, 0x20000
    s_sub_u32 s50, 295296, s49
    s_sub_u32 s51, 295296, s48
    s_mul_i32 s64, s58, 442368
    v_and_b32 v35, 6, v32
    v_xor_b32 v35, v33, v35
    v_lshl_add_u32 v8, v35, 4, v34
    v_and_b32 v32, 3, v32
    v_and_b32 v33, 3, v0
    v_lshlrev_b32 v33, 3, v33
    v_lshrrev_b32 v34, 4, v0
    v_bfe_u32 v35, v0, 2, 2
    s_lshl_b32 s59, s69, 1
    v_xor_b32 v12, s59, v32
    v_lshl_add_u32 v12, v12, 5, v33
    v_lshl_add_u32 v12, v35, 7, v12
    v_mul_u32_u24 v13, 6144, v34
    s_lshr_b32 s59, s56, 1
    s_lshl_b32 s59, s59, 10
    v_add3_u32 v12, v12, v13, s59
    v_xor_b32 v13, 32, v12
    v_add_u32 v14, 0x10000, v12
    v_add_u32 v15, 0x10000, v13
    v_xor_b32 v22, s56, v32
    v_lshl_add_u32 v22, v22, 5, v33
    v_lshrrev_b32 v35, 2, v0
    v_lshl_add_u32 v22, v35, 7, v22
    v_and_b32 v32, 15, v0
    v_lshrrev_b32 v33, 1, v32
    v_xor_b32 v33, v33, v34
    v_lshlrev_b32 v33, 4, v33
    v_lshl_add_u32 v16, v32, 7, v33
    v_add_u32 v16, 98304, v16
    s_lshl_b32 s59, s85, 6
    v_xor_b32 v16, s59, v16
    v_xor_b32 v17, 64, v16
    s_mul_i32 s59, s56, 4160
    s_add_u32 s59, s59, 147456
    v_lshl_add_u32 v39, v34, 3, s59
    s_branch L_ffn_body
L_exit:
    s_endpgm
.p2align 12
L_ffn_body:
L_ffn_pad0:
    s_cbranch_execz L_ffn_ret0
    s_add_u32 m0, s66, 24576
    s_add_u32 s60, s91, s50
    buffer_load_dwordx4 v5, s[32:35], s60 offen offset:0 lds
    buffer_load_dwordx4 v6, s[32:35], s60 offen offset:1024 lds
    buffer_load_dwordx4 v7, s[32:35], s60 offen offset:2048 lds
    s_add_u32 m0, s67, 24576
    s_add_u32 s60, s91, s51
    buffer_load_dwordx4 v5, s[32:35], s60 offen offset:0 lds
    buffer_load_dwordx4 v6, s[32:35], s60 offen offset:1024 lds
    buffer_load_dwordx4 v7, s[32:35], s60 offen offset:2048 lds
    s_add_u32 m0, s65, 114688
    s_xor_b32 s60, s90, 1
    s_lshl_b32 s60, s60, 7
    s_add_u32 s60, s60, s62
    buffer_load_dwordx4 v1, s[28:31], s60 offen offset:0 lds
    buffer_load_dwordx4 v2, s[28:31], s60 offen offset:1024 lds
    buffer_load_dwordx4 v3, s[28:31], s60 offen offset:2048 lds
    buffer_load_dwordx4 v4, s[28:31], s60 offen offset:3072 lds
    s_waitcnt vmcnt(10)
    ds_read_b64 v[244:245], v39 offset:0
    ds_read_b64 v[246:247], v39 offset:32
    ds_read_b64 v[248:249], v39 offset:256
    ds_read_b64 v[250:251], v39 offset:288
    ds_read_b64 v[252:253], v39 offset:512
    ds_read_b64 v[254:255], v39 offset:544
    s_barrier
    ds_read_b64_tr_b16 a[128:129], v12 offset:0
    ds_read_b64_tr_b16 a[130:131], v12 offset:512
    ds_read_b128 a[0:3], v16 offset:0
    ds_read_b128 a[4:7], v16 offset:2048
    ds_read_b128 a[8:11], v16 offset:4096
    ds_read_b128 a[12:15], v16 offset:6144
    ds_read_b128 a[16:19], v16 offset:8192
    ds_read_b128 a[20:23], v16 offset:10240
    ds_read_b128 a[24:27], v16 offset:12288
    ds_read_b128 a[28:31], v16 offset:14336
    ds_read_b64_tr_b16 a[132:133], v13 offset:0
    ds_read_b64_tr_b16 a[134:135], v13 offset:512
    ds_read_b64_tr_b16 a[160:161], v12 offset:2048
    ds_read_b64_tr_b16 a[162:163], v12 offset:2560
    ds_read_b64_tr_b16 a[164:165], v13 offset:2048
    ds_read_b64_tr_b16 a[166:167], v13 offset:2560
    ds_read_b64_tr_b16 a[192:193], v12 offset:4096
    ds_read_b64_tr_b16 a[194:195], v12 offset:4608
    ds_read_b64_tr_b16 a[196:197], v13 offset:4096
    ds_read_b64_tr_b16 a[198:199], v13 offset:4608
    s_waitcnt lgkmcnt(10)
    v_lshlrev_b32 v40, 16, v244
    v_and_b32 v41, 0xffff0000, v244
    v_lshlrev_b32 v42, 16, v245
    v_and_b32 v43, 0xffff0000, v245
    v_lshlrev_b32 v44, 16, v246
    v_and_b32 v45, 0xffff0000, v246
    v_lshlrev_b32 v46, 16, v247
    v_and_b32 v47, 0xffff0000, v247
    v_lshlrev_b32 v48, 16, v248
    v_and_b32 v49, 0xffff0000, v248
    v_lshlrev_b32_e64 v50, 16, v249
    v_and_b32 v51, 0xffff0000, v249
    v_lshlrev_b32 v52, 16, v250
    v_and_b32 v53, 0xffff0000, v250
    v_lshlrev_b32 v54, 16, v251
    v_and_b32 v55, 0xffff0000, v251
    v_lshlrev_b32_e64 v56, 16, v252
    v_and_b32 v57, 0xffff0000, v252
    v_lshlrev_b32_e64 v58, 16, v253
    v_and_b32 v59, 0xffff0000, v253
    v_lshlrev_b32_e64 v60, 16, v254
    v_and_b32 v61, 0xffff0000, v254
    v_lshlrev_b32_e64 v62, 16, v255
    v_and_b32 v63, 0xffff0000, v255
    v_mfma_f32_16x16x32_bf16 v[160:163], a[128:131], a[0:3], v[40:43]
    s_nop 0
    v_mfma_f32_16x16x32_bf16 v[164:167], a[128:131], a[4:7], v[40:43]
    s_xor_b32 s91, s90, 1
    s_mul_i32 s91, s91, 589824
    s_add_u32 s91, s91, s63
    v_mfma_f32_16x16x32_bf16 v[168:171], a[128:131], a[8:11], v[40:43]
    s_add_u32 m0, s66, 49152
    s_add_u32 s60, s91, s48
    v_mfma_f32_16x16x32_bf16 v[172:175], a[128:131], a[12:15], v[40:43]
    buffer_load_dwordx4 v5, s[32:35], s60 offen offset:0 lds
    v_mfma_f32_16x16x32_bf16 v[176:179], a[128:131], a[16:19], v[40:43]
    v_mfma_f32_16x16x32_bf16 v[180:183], a[128:131], a[20:23], v[40:43]
    v_mfma_f32_16x16x32_bf16 v[184:187], a[128:131], a[24:27], v[40:43]
    buffer_load_dwordx4 v6, s[32:35], s60 offen offset:1024 lds
    v_mfma_f32_16x16x32_bf16 v[188:191], a[128:131], a[28:31], v[40:43]
    s_waitcnt lgkmcnt(2)
    v_mfma_f32_16x16x32_bf16 v[92:95], a[132:135], a[28:31], v[44:47]
    s_nop 0
    v_mfma_f32_16x16x32_bf16 v[88:91], a[132:135], a[24:27], v[44:47]
    buffer_load_dwordx4 v7, s[32:35], s60 offen offset:2048 lds
    v_mfma_f32_16x16x32_bf16 v[84:87], a[132:135], a[20:23], v[44:47]
    s_add_u32 m0, s67, 49152
    s_add_u32 s60, s91, s49
    v_mfma_f32_16x16x32_bf16 v[80:83], a[132:135], a[16:19], v[44:47]
    s_nop 0
    v_mfma_f32_16x16x32_bf16 v[76:79], a[132:135], a[12:15], v[44:47]
    buffer_load_dwordx4 v5, s[32:35], s60 offen offset:0 lds
    v_mfma_f32_16x16x32_bf16 v[72:75], a[132:135], a[8:11], v[44:47]
    v_mfma_f32_16x16x32_bf16 v[68:71], a[132:135], a[4:7], v[44:47]
    v_mfma_f32_16x16x32_bf16 v[64:67], a[132:135], a[0:3], v[44:47]
    buffer_load_dwordx4 v6, s[32:35], s60 offen offset:1024 lds
    v_mfma_f32_16x16x32_bf16 v[192:195], a[160:163], a[0:3], v[48:51]
    v_mfma_f32_16x16x32_bf16 v[196:199], a[160:163], a[4:7], v[48:51]
    v_mfma_f32_16x16x32_bf16 v[200:203], a[160:163], a[8:11], v[48:51]
    buffer_load_dwordx4 v7, s[32:35], s60 offen offset:2048 lds
    v_mfma_f32_16x16x32_bf16 v[204:207], a[160:163], a[12:15], v[48:51]
    s_add_u32 m0, s65, 131072
    s_xor_b32 s60, s90, 2
    s_lshl_b32 s60, s60, 7
    v_mfma_f32_16x16x32_bf16 v[208:211], a[160:163], a[16:19], v[48:51]
    s_waitcnt lgkmcnt(0)
    s_waitcnt vmcnt(10)
    s_barrier
    s_add_u32 s60, s60, s62
    v_mfma_f32_16x16x32_bf16 v[212:215], a[160:163], a[20:23], v[48:51]
    buffer_load_dwordx4 v1, s[28:31], s60 offen offset:0 lds
    v_mfma_f32_16x16x32_bf16 v[216:219], a[160:163], a[24:27], v[48:51]
    ds_read_b64_tr_b16 a[136:137], v12 offset:24576
    v_mfma_f32_16x16x32_bf16 v[220:223], a[160:163], a[28:31], v[48:51]
    ds_read_b64_tr_b16 a[138:139], v12 offset:25088
    v_mfma_f32_16x16x32_bf16 v[124:127], a[164:167], a[28:31], v[52:55]
    buffer_load_dwordx4 v2, s[28:31], s60 offen offset:1024 lds
    v_mfma_f32_16x16x32_bf16 v[120:123], a[164:167], a[24:27], v[52:55]
    s_add_u32 m0, s66, 73728
    ds_read_b128 a[32:35], v17 offset:0
    s_add_u32 s60, s91, s50
    v_mfma_f32_16x16x32_bf16 v[116:119], a[164:167], a[20:23], v[52:55]
    s_nop 0
    ds_read_b128 a[36:39], v17 offset:2048
    v_mfma_f32_16x16x32_bf16 v[112:115], a[164:167], a[16:19], v[52:55]
    buffer_load_dwordx4 v5, s[32:35], s60 offen offset:0 lds
    v_mfma_f32_16x16x32_bf16 v[108:111], a[164:167], a[12:15], v[52:55]
    ds_read_b128 a[40:43], v17 offset:4096
    v_mfma_f32_16x16x32_bf16 v[104:107], a[164:167], a[8:11], v[52:55]
    ds_read_b128 a[44:47], v17 offset:6144
    v_mfma_f32_16x16x32_bf16 v[100:103], a[164:167], a[4:7], v[52:55]
    buffer_load_dwordx4 v6, s[32:35], s60 offen offset:1024 lds
    v_mfma_f32_16x16x32_bf16 v[96:99], a[164:167], a[0:3], v[52:55]
    ds_read_b128 a[48:51], v17 offset:8192
    v_mfma_f32_16x16x32_bf16 v[224:227], a[192:195], a[0:3], v[56:59]
    ds_read_b128 a[52:55], v17 offset:10240
    v_mfma_f32_16x16x32_bf16 v[228:231], a[192:195], a[4:7], v[56:59]
    buffer_load_dwordx4 v7, s[32:35], s60 offen offset:2048 lds
    v_mfma_f32_16x16x32_bf16 v[232:235], a[192:195], a[8:11], v[56:59]
    s_add_u32 m0, s67, 73728
    ds_read_b128 a[56:59], v17 offset:12288
    s_add_u32 s60, s91, s51
    v_mfma_f32_16x16x32_bf16 v[236:239], a[192:195], a[12:15], v[56:59]
    s_nop 0
    ds_read_b128 a[60:63], v17 offset:14336
    ds_read_b64_tr_b16 a[140:141], v13 offset:24576
    v_mfma_f32_16x16x32_bf16 v[240:243], a[192:195], a[16:19], v[56:59]
    buffer_load_dwordx4 v5, s[32:35], s60 offen offset:0 lds
    v_mfma_f32_16x16x32_bf16 v[244:247], a[192:195], a[20:23], v[56:59]
    s_mov_b32 s89, 0x12345
    ds_read_b64_tr_b16 a[142:143], v13 offset:25088
    ds_read_b64_tr_b16 a[168:169], v12 offset:26624
    v_mfma_f32_16x16x32_bf16 v[248:251], a[192:195], a[24:27], v[56:59]
    s_mov_b32 s89, 0x12345
    ds_read_b64_tr_b16 a[170:171], v12 offset:27136
    ds_read_b64_tr_b16 a[172:173], v13 offset:26624
    v_mfma_f32_16x16x32_bf16 v[252:255], a[192:195], a[28:31], v[56:59]
    buffer_load_dwordx4 v6, s[32:35], s60 offen offset:1024 lds
    v_mfma_f32_16x16x32_bf16 v[156:159], a[196:199], a[28:31], v[60:63]
    s_mov_b32 s89, 0x12345
    ds_read_b64_tr_b16 a[174:175], v13 offset:27136
    ds_read_b64_tr_b16 a[200:201], v12 offset:28672
    v_mfma_f32_16x16x32_bf16 v[152:155], a[196:199], a[24:27], v[60:63]
    s_mov_b32 s89, 0x12345
    ds_read_b64_tr_b16 a[202:203], v12 offset:29184
    ds_read_b64_tr_b16 a[204:205], v13 offset:28672
    v_mfma_f32_16x16x32_bf16 v[148:151], a[196:199], a[20:23], v[60:63]
    buffer_load_dwordx4 v7, s[32:35], s60 offen offset:2048 lds
    v_mfma_f32_16x16x32_bf16 v[144:147], a[196:199], a[16:19], v[60:63]
    s_add_u32 m0, s65, 131072
    ds_read_b64_tr_b16 a[206:207], v13 offset:29184
    s_xor_b32 s60, s90, 2
    v_mfma_f32_16x16x32_bf16 v[140:143], a[196:199], a[12:15], v[60:63]
    s_lshl_b32 s60, s60, 7
    s_add_u32 s60, s60, s62
    v_mfma_f32_16x16x32_bf16 v[136:139], a[196:199], a[8:11], v[60:63]
    buffer_load_dwordx4 v3, s[28:31], s60 offen offset:2048 lds
    v_mfma_f32_16x16x32_bf16 v[132:135], a[196:199], a[4:7], v[60:63]
    s_nop 0
    v_mfma_f32_16x16x32_bf16 v[128:131], a[196:199], a[0:3], v[60:63]
    s_waitcnt lgkmcnt(0)
    s_and_b32 s85, s57, 7
    s_lshl_b32 s85, s85, 7
    s_add_u32 s70, s85, s64
    s_add_u32 s85, s85, 128
    s_cmp_eq_u32 s85, 1152
    s_cselect_b32 s85, 0, s85
    s_add_u32 s71, s85, s64
    s_add_u32 s85, s85, 128
    s_cmp_eq_u32 s85, 1152
    s_cselect_b32 s85, 0, s85
    s_add_u32 s72, s85, s64
    s_add_u32 s85, s85, 128
    s_cmp_eq_u32 s85, 1152
    s_cselect_b32 s85, 0, s85
    s_add_u32 s73, s85, s64
    s_add_u32 s85, s85, 128
    s_cmp_eq_u32 s85, 1152
    s_cselect_b32 s85, 0, s85
    s_add_u32 s74, s85, s64
    s_add_u32 s85, s85, 128
    s_cmp_eq_u32 s85, 1152
    s_cselect_b32 s85, 0, s85
    s_add_u32 s75, s85, s64
    s_add_u32 s85, s85, 128
    s_cmp_eq_u32 s85, 1152
    s_cselect_b32 s85, 0, s85
    s_add_u32 s76, s85, s64
    s_add_u32 s85, s85, 128
    s_cmp_eq_u32 s85, 1152
    s_cselect_b32 s85, 0, s85
    s_add_u32 s77, s85, s64
    s_add_u32 s85, s85, 128
    s_cmp_eq_u32 s85, 1152
    s_cselect_b32 s85, 0, s85
    s_add_u32 s78, s85, s64
    v_mfma_f32_16x16x32_bf16 v[160:163], a[136:139], a[32:35], v[160:163]
    v_mfma_f32_16x16x32_bf16 v[164:167], a[136:139], a[36:39], v[164:167]
    v_mfma_f32_16x16x32_bf16 v[168:171], a[136:139], a[40:43], v[168:171]
    v_mfma_f32_16x16x32_bf16 v[172:175], a[136:139], a[44:47], v[172:175]
    buffer_load_dwordx4 v4, s[28:31], s60 offen offset:3072 lds
    v_mfma_f32_16x16x32_bf16 v[176:179], a[136:139], a[48:51], v[176:179]
    s_xor_b32 s91, s90, 2
    s_mul_i32 s91, s91, 589824
    s_add_u32 s91, s91, s63
    v_mfma_f32_16x16x32_bf16 v[180:183], a[136:139], a[52:55], v[180:183]
    s_add_u32 m0, s66, 0
    s_add_u32 s60, s91, s48
    v_mfma_f32_16x16x32_bf16 v[184:187], a[136:139], a[56:59], v[184:187]
    buffer_load_dwordx4 v5, s[32:35], s60 offen offset:0 lds
    v_mfma_f32_16x16x32_bf16 v[188:191], a[136:139], a[60:63], v[188:191]
    v_mfma_f32_16x16x32_bf16 v[92:95], a[140:143], a[60:63], v[92:95]
    s_waitcnt vmcnt(3)
    s_barrier
    v_mfma_f32_16x16x32_bf16 v[88:91], a[140:143], a[56:59], v[88:91]
    buffer_load_dwordx4 v6, s[32:35], s60 offen offset:1024 lds
    v_mfma_f32_16x16x32_bf16 v[84:87], a[140:143], a[52:55], v[84:87]
    s_mov_b32 s89, 0x12345
    ds_read_b64_tr_b16 a[144:145], v12 offset:49152
    ds_read_b64_tr_b16 a[146:147], v12 offset:49664
    v_mfma_f32_16x16x32_bf16 v[80:83], a[140:143], a[48:51], v[80:83]
    ds_read_b128 a[64:67], v16 offset:16384
    v_mfma_f32_16x16x32_bf16 v[76:79], a[140:143], a[44:47], v[76:79]
    buffer_load_dwordx4 v7, s[32:35], s60 offen offset:2048 lds
    v_mfma_f32_16x16x32_bf16 v[72:75], a[140:143], a[40:43], v[72:75]
    s_add_u32 m0, s67, 0
    ds_read_b128 a[68:71], v16 offset:18432
    s_add_u32 s60, s91, s49
    v_mfma_f32_16x16x32_bf16 v[68:71], a[140:143], a[36:39], v[68:71]
    ds_read_b128 a[72:75], v16 offset:20480
    v_mfma_f32_16x16x32_bf16 v[64:67], a[140:143], a[32:35], v[64:67]
    buffer_load_dwordx4 v5, s[32:35], s60 offen offset:0 lds
    v_mfma_f32_16x16x32_bf16 v[192:195], a[168:171], a[32:35], v[192:195]
    ds_read_b128 a[76:79], v16 offset:22528
    v_mfma_f32_16x16x32_bf16 v[196:199], a[168:171], a[36:39], v[196:199]
    ds_read_b128 a[80:83], v16 offset:24576
    v_mfma_f32_16x16x32_bf16 v[200:203], a[168:171], a[40:43], v[200:203]
    buffer_load_dwordx4 v6, s[32:35], s60 offen offset:1024 lds
    v_mfma_f32_16x16x32_bf16 v[204:207], a[168:171], a[44:47], v[204:207]
    ds_read_b128 a[84:87], v16 offset:26624
    v_mfma_f32_16x16x32_bf16 v[208:211], a[168:171], a[48:51], v[208:211]
    ds_read_b128 a[88:91], v16 offset:28672
    v_mfma_f32_16x16x32_bf16 v[212:215], a[168:171], a[52:55], v[212:215]
    s_mov_b32 s89, 0x12345
    ds_read_b128 a[92:95], v16 offset:30720
    ds_read_b64_tr_b16 a[148:149], v13 offset:49152
    v_mfma_f32_16x16x32_bf16 v[216:219], a[168:171], a[56:59], v[216:219]
    buffer_load_dwordx4 v7, s[32:35], s60 offen offset:2048 lds
    v_mfma_f32_16x16x32_bf16 v[220:223], a[168:171], a[60:63], v[220:223]
    s_add_u32 m0, s65, 147456
    ds_read_b64_tr_b16 a[150:151], v13 offset:49664
    ds_read_b64_tr_b16 a[176:177], v12 offset:51200
    v_mfma_f32_16x16x32_bf16 v[124:127], a[172:175], a[60:63], v[124:127]
    s_xor_b32 s60, s90, 3
    ds_read_b64_tr_b16 a[178:179], v12 offset:51712
    ds_read_b64_tr_b16 a[180:181], v13 offset:51200
    v_mfma_f32_16x16x32_bf16 v[120:123], a[172:175], a[56:59], v[120:123]
    s_lshl_b32 s60, s60, 7
    ds_read_b64_tr_b16 a[182:183], v13 offset:51712
    ds_read_b64_tr_b16 a[208:209], v12 offset:53248
    v_mfma_f32_16x16x32_bf16 v[116:119], a[172:175], a[52:55], v[116:119]
    s_add_u32 s60, s60, s62
    s_nop 0
    ds_read_b64_tr_b16 a[210:211], v12 offset:53760
    ds_read_b64_tr_b16 a[212:213], v13 offset:53248
    v_mfma_f32_16x16x32_bf16 v[112:115], a[172:175], a[48:51], v[112:115]
    buffer_load_dwordx4 v1, s[28:31], s60 offen offset:0 lds
    v_mfma_f32_16x16x32_bf16 v[108:111], a[172:175], a[44:47], v[108:111]
    s_mov_b32 s89, 0x12345
    ds_read_b64_tr_b16 a[214:215], v13 offset:53760
    ds_read_b64_tr_b16 a[152:153], v14 offset:8192
    v_mfma_f32_16x16x32_bf16 v[104:107], a[172:175], a[40:43], v[104:107]
    s_nop 0
    ds_read_b64_tr_b16 a[154:155], v14 offset:8704
    s_nop 0
    v_mfma_f32_16x16x32_bf16 v[100:103], a[172:175], a[36:39], v[100:103]
    buffer_load_dwordx4 v2, s[28:31], s60 offen offset:1024 lds
    v_mfma_f32_16x16x32_bf16 v[96:99], a[172:175], a[32:35], v[96:99]
    s_add_u32 m0, s66, 24576
    ds_read_b128 a[96:99], v17 offset:16384
    s_add_u32 s60, s91, s50
    v_mfma_f32_16x16x32_bf16 v[224:227], a[200:203], a[32:35], v[224:227]
    s_nop 0
    ds_read_b128 a[100:103], v17 offset:18432
    v_mfma_f32_16x16x32_bf16 v[228:231], a[200:203], a[36:39], v[228:231]
    buffer_load_dwordx4 v5, s[32:35], s60 offen offset:0 lds
    v_mfma_f32_16x16x32_bf16 v[232:235], a[200:203], a[40:43], v[232:235]
    s_nop 0
    ds_read_b128 a[104:107], v17 offset:20480
    v_mfma_f32_16x16x32_bf16 v[236:239], a[200:203], a[44:47], v[236:239]
    s_nop 0
    ds_read_b128 a[108:111], v17 offset:22528
    v_mfma_f32_16x16x32_bf16 v[240:243], a[200:203], a[48:51], v[240:243]
    s_mov_b32 s89, 0x12345
    ds_read_b128 a[112:115], v17 offset:24576
    ds_read_b128 a[116:119], v17 offset:26624
    v_mfma_f32_16x16x32_bf16 v[244:247], a[200:203], a[52:55], v[244:247]
    ds_read_b128 a[120:123], v17 offset:28672
    v_mfma_f32_16x16x32_bf16 v[248:251], a[200:203], a[56:59], v[248:251]
    s_mov_b32 s89, 0x12345
    ds_read_b128 a[124:127], v17 offset:30720
    ds_read_b64_tr_b16 a[156:157], v15 offset:8192
    v_mfma_f32_16x16x32_bf16 v[252:255], a[200:203], a[60:63], v[252:255]
    buffer_load_dwordx4 v6, s[32:35], s60 offen offset:1024 lds
    v_mfma_f32_16x16x32_bf16 v[156:159], a[204:207], a[60:63], v[156:159]
    s_mov_b32 s89, 0x12345
    ds_read_b64_tr_b16 a[158:159], v15 offset:8704
    ds_read_b64_tr_b16 a[184:185], v14 offset:10240
    v_mfma_f32_16x16x32_bf16 v[152:155], a[204:207], a[56:59], v[152:155]
    s_mov_b32 s89, 0x12345
    ds_read_b64_tr_b16 a[186:187], v14 offset:10752
    ds_read_b64_tr_b16 a[188:189], v15 offset:10240
    v_mfma_f32_16x16x32_bf16 v[148:151], a[204:207], a[52:55], v[148:151]
    buffer_load_dwordx4 v7, s[32:35], s60 offen offset:2048 lds
    v_mfma_f32_16x16x32_bf16 v[144:147], a[204:207], a[48:51], v[144:147]
    s_add_u32 m0, s67, 24576
    ds_read_b64_tr_b16 a[190:191], v15 offset:10752
    ds_read_b64_tr_b16 a[216:217], v14 offset:12288
    v_mfma_f32_16x16x32_bf16 v[140:143], a[204:207], a[44:47], v[140:143]
    s_add_u32 s60, s91, s51
    ds_read_b64_tr_b16 a[218:219], v14 offset:12800
    ds_read_b64_tr_b16 a[220:221], v15 offset:12288
    s_nop 0
    v_mfma_f32_16x16x32_bf16 v[136:139], a[204:207], a[40:43], v[136:139]
    buffer_load_dwordx4 v5, s[32:35], s60 offen offset:0 lds
    v_mfma_f32_16x16x32_bf16 v[132:135], a[204:207], a[36:39], v[132:135]
    ds_read_b64_tr_b16 a[222:223], v15 offset:12800
    v_mfma_f32_16x16x32_bf16 v[128:131], a[204:207], a[32:35], v[128:131]
    s_waitcnt lgkmcnt(0)
    buffer_load_dwordx4 v6, s[32:35], s60 offen offset:1024 lds
    buffer_load_dwordx4 v7, s[32:35], s60 offen offset:2048 lds
    s_sub_u32 s85, 0, s26
    s_and_b32 s85, s85, 2097151
    s_lshl_b32 s80, s57, 23
    s_add_u32 s80, s80, s85
    s_mov_b32 s81, 0x10000
    s_lshl_b32 s3, s57, 2
    s_lshr_b32 s84, 1, s56
    s_lshl_b32 s99, s84, 4
    s_lshl_b32 s100, s84, 10
    s_mul_i32 s101, s84, 0x410
    s_mov_b32 s96, 1
    v_bfe_u32 v24, v0, 2, 2
    v_lshlrev_b32 v24, 8, v24
    v_lshrrev_b32_e64 v28, 4, v0
    v_lshl_add_u32 v24, v28, 6, v24
    v_and_b32_e64 v26, 3, v0
    v_lshl_add_u32 v24, v26, 4, v24
    v_and_b32 v26, 15, v0
    v_mul_u32_u24 v28, 32768, v28
    v_lshl_add_u32 v28, v26, 4, v28
    s_lshl_b32 s85, s58, 8
    v_add_u32_e64 v28, s85, v28
    s_mul_i32 s85, s58, 32768
    v_add_u32_e64 v24, s85, v24
    s_mov_b32 vcc_lo, s84
    s_mov_b32 vcc_hi, 0
    s_add_u32 s94, s24, s3
    s_addc_u32 s95, s25, 0
    v_mfma_f32_16x16x32_bf16 v[160:163], a[144:147], a[64:67], v[160:163]
    s_waitcnt vmcnt(8)
    s_barrier
    v_mfma_f32_16x16x32_bf16 v[160:163], a[152:155], a[96:99], v[160:163]
    s_add_u32 m0, s65, 147456
    s_xor_b32 s60, s90, 3
    s_lshl_b32 s60, s60, 7
    v_mfma_f32_16x16x32_bf16 v[164:167], a[152:155], a[100:103], v[164:167]
    s_add_u32 s60, s60, s62
    ds_read_b64_tr_b16 a[128:129], v12 offset:0
    v_mfma_f32_16x16x32_bf16 v[164:167], a[144:147], a[68:71], v[164:167]
    buffer_load_dwordx4 v3, s[28:31], s60 offen offset:2048 lds
    v_mfma_f32_16x16x32_bf16 v[168:171], a[144:147], a[72:75], v[168:171]
    s_nop 0
    ds_read_b64_tr_b16 a[130:131], v12 offset:512
    v_mfma_f32_16x16x32_bf16 v[168:171], a[152:155], a[104:107], v[168:171]
    v_mfma_f32_16x16x32_bf16 v[172:175], a[152:155], a[108:111], v[172:175]
    buffer_load_dwordx4 v4, s[28:31], s60 offen offset:3072 lds
    v_mfma_f32_16x16x32_bf16 v[172:175], a[144:147], a[76:79], v[172:175]
    s_xor_b32 s91, s90, 3
    ds_read_b128 a[0:3], v16 offset:32768
    s_mul_i32 s91, s91, 589824
    v_mfma_f32_16x16x32_bf16 v[176:179], a[144:147], a[80:83], v[176:179]
    s_add_u32 s91, s91, s63
    ds_read_b128 a[4:7], v16 offset:34816
    s_add_u32 m0, s66, 49152
    v_mfma_f32_16x16x32_bf16 v[176:179], a[152:155], a[112:115], v[176:179]
    s_add_u32 s60, s91, s48
    v_mfma_f32_16x16x32_bf16 v[180:183], a[152:155], a[116:119], v[180:183]
    buffer_load_dwordx4 v5, s[32:35], s60 offen offset:0 lds
    v_mfma_f32_16x16x32_bf16 v[180:183], a[144:147], a[84:87], v[180:183]
    s_nop 0
    ds_read_b128 a[8:11], v16 offset:36864
    v_mfma_f32_16x16x32_bf16 v[184:187], a[144:147], a[88:91], v[184:187]
    ds_read_b128 a[12:15], v16 offset:38912
    v_mfma_f32_16x16x32_bf16 v[184:187], a[152:155], a[120:123], v[184:187]
    buffer_load_dwordx4 v6, s[32:35], s60 offen offset:1024 lds
    v_mfma_f32_16x16x32_bf16 v[188:191], a[152:155], a[124:127], v[188:191]
    s_nop 0
    ds_read_b128 a[16:19], v16 offset:40960
    v_mfma_f32_16x16x32_bf16 v[188:191], a[144:147], a[92:95], v[188:191]
    s_nop 0
    v_mfma_f32_16x16x32_bf16 v[92:95], a[148:151], a[92:95], v[92:95]
    buffer_load_dwordx4 v7, s[32:35], s60 offen offset:2048 lds
    v_mfma_f32_16x16x32_bf16 v[92:95], a[156:159], a[124:127], v[92:95]
    s_add_u32 m0, s67, 49152
    ds_read_b128 a[20:23], v16 offset:43008
    s_add_u32 s60, s91, s49
    v_mfma_f32_16x16x32_bf16 v[88:91], a[156:159], a[120:123], v[88:91]
    s_nop 0
    ds_read_b128 a[24:27], v16 offset:45056
    v_mfma_f32_16x16x32_bf16 v[88:91], a[148:151], a[88:91], v[88:91]
    buffer_load_dwordx4 v5, s[32:35], s60 offen offset:0 lds
    v_mfma_f32_16x16x32_bf16 v[84:87], a[148:151], a[84:87], v[84:87]
    s_nop 0
    ds_read_b128 a[28:31], v16 offset:47104
    v_mfma_f32_16x16x32_bf16 v[84:87], a[156:159], a[116:119], v[84:87]
    s_nop 0
    v_mfma_f32_16x16x32_bf16 v[80:83], a[156:159], a[112:115], v[80:83]
    buffer_load_dwordx4 v6, s[32:35], s60 offen offset:1024 lds
    v_mfma_f32_16x16x32_bf16 v[80:83], a[148:151], a[80:83], v[80:83]
    s_nop 0
    ds_read_b64_tr_b16 a[132:133], v13 offset:0
    v_mfma_f32_16x16x32_bf16 v[76:79], a[148:151], a[76:79], v[76:79]
    s_nop 0
    ds_read_b64_tr_b16 a[134:135], v13 offset:512
    v_mfma_f32_16x16x32_bf16 v[76:79], a[156:159], a[108:111], v[76:79]
    buffer_load_dwordx4 v7, s[32:35], s60 offen offset:2048 lds
    v_mfma_f32_16x16x32_bf16 v[72:75], a[156:159], a[104:107], v[72:75]
    s_add_u32 m0, s65, 98304
    ds_read_b64_tr_b16 a[160:161], v12 offset:2048
    s_xor_b32 s60, s90, 4
    v_mfma_f32_16x16x32_bf16 v[72:75], a[148:151], a[72:75], v[72:75]
    s_lshl_b32 s60, s60, 7
    s_add_u32 s60, s60, s62
    v_mfma_f32_16x16x32_bf16 v[68:71], a[148:151], a[68:71], v[68:71]
    buffer_load_dwordx4 v1, s[28:31], s60 offen offset:0 lds
    v_mfma_f32_16x16x32_bf16 v[68:71], a[156:159], a[100:103], v[68:71]
    s_nop 0
    ds_read_b64_tr_b16 a[162:163], v12 offset:2560
    v_mfma_f32_16x16x32_bf16 v[64:67], a[156:159], a[96:99], v[64:67]
    ds_read_b64_tr_b16 a[164:165], v13 offset:2048
    v_mfma_f32_16x16x32_bf16 v[64:67], a[148:151], a[64:67], v[64:67]
    buffer_load_dwordx4 v2, s[28:31], s60 offen offset:1024 lds
    v_mfma_f32_16x16x32_bf16 v[192:195], a[176:179], a[64:67], v[192:195]
    s_add_u32 m0, s66, 73728
    ds_read_b64_tr_b16 a[166:167], v13 offset:2560
    s_add_u32 s60, s91, s50
    v_mfma_f32_16x16x32_bf16 v[192:195], a[184:187], a[96:99], v[192:195]
    s_nop 0
    v_mfma_f32_16x16x32_bf16 v[196:199], a[184:187], a[100:103], v[196:199]
    buffer_load_dwordx4 v5, s[32:35], s60 offen offset:0 lds
    v_mfma_f32_16x16x32_bf16 v[196:199], a[176:179], a[68:71], v[196:199]
    ds_read_b64_tr_b16 a[192:193], v12 offset:4096
    v_mfma_f32_16x16x32_bf16 v[200:203], a[176:179], a[72:75], v[200:203]
    ds_read_b64_tr_b16 a[194:195], v12 offset:4608
    v_mfma_f32_16x16x32_bf16 v[200:203], a[184:187], a[104:107], v[200:203]
    buffer_load_dwordx4 v6, s[32:35], s60 offen offset:1024 lds
    v_mfma_f32_16x16x32_bf16 v[204:207], a[184:187], a[108:111], v[204:207]
    ds_read_b64_tr_b16 a[196:197], v13 offset:4096
    v_mfma_f32_16x16x32_bf16 v[204:207], a[176:179], a[76:79], v[204:207]
    v_mfma_f32_16x16x32_bf16 v[208:211], a[176:179], a[80:83], v[208:211]
    buffer_load_dwordx4 v7, s[32:35], s60 offen offset:2048 lds
    v_mfma_f32_16x16x32_bf16 v[208:211], a[184:187], a[112:115], v[208:211]
    s_add_u32 m0, s67, 73728
    ds_read_b64_tr_b16 a[198:199], v13 offset:4608
    s_add_u32 s60, s91, s51
    v_mfma_f32_16x16x32_bf16 v[212:215], a[184:187], a[116:119], v[212:215]
    s_nop 0
    v_mfma_f32_16x16x32_bf16 v[212:215], a[176:179], a[84:87], v[212:215]
    buffer_load_dwordx4 v5, s[32:35], s60 offen offset:0 lds
    v_mfma_f32_16x16x32_bf16 v[216:219], a[176:179], a[88:91], v[216:219]
    v_mfma_f32_16x16x32_bf16 v[216:219], a[184:187], a[120:123], v[216:219]
    v_mfma_f32_16x16x32_bf16 v[220:223], a[184:187], a[124:127], v[220:223]
    buffer_load_dwordx4 v6, s[32:35], s60 offen offset:1024 lds
    v_mfma_f32_16x16x32_bf16 v[220:223], a[176:179], a[92:95], v[220:223]
    s_waitcnt lgkmcnt(0)
    s_mov_b64 exec, 0
    s_cmp_eq_u32 s56, 0
    s_cbranch_scc1 L_ffn_pad1
    s_cmp_eq_u32 s56, 1
    s_cbranch_scc1 L_ffn_pad2
    s_cmp_eq_u32 s56, 2
    s_cbranch_scc1 L_ffn_pad3
    s_branch L_ffn_pad4
L_ffn_ret0:
    s_mov_b64 exec, -1
    v_mfma_f32_16x16x32_bf16 v[124:127], a[180:183], a[92:95], v[124:127]
    s_waitcnt vmcnt(15)
    s_barrier
    v_mfma_f32_16x16x32_bf16 v[124:127], a[188:191], a[124:127], v[124:127]
    v_mfma_f32_16x16x32_bf16 v[120:123], a[188:191], a[120:123], v[120:123]
    ds_read_b64_tr_b16 a[136:137], v12 offset:24576
    v_mfma_f32_16x16x32_bf16 v[120:123], a[180:183], a[88:91], v[120:123]
    buffer_load_dwordx4 v7, s[32:35], s60 offen offset:2048 lds
    v_mfma_f32_16x16x32_bf16 v[116:119], a[180:183], a[84:87], v[116:119]
    s_nop 0
    ds_read_b64_tr_b16 a[138:139], v12 offset:25088
    v_mfma_f32_16x16x32_bf16 v[116:119], a[188:191], a[116:119], v[116:119]
    s_add_u32 m0, s65, 98304
    s_xor_b32 s60, s90, 4
    s_lshl_b32 s60, s60, 7
    v_mfma_f32_16x16x32_bf16 v[112:115], a[188:191], a[112:115], v[112:115]
    s_add_u32 s60, s60, s62
    ds_read_b128 a[32:35], v17 offset:32768
    v_mfma_f32_16x16x32_bf16 v[112:115], a[180:183], a[80:83], v[112:115]
    buffer_load_dwordx4 v3, s[28:31], s60 offen offset:2048 lds
    v_mfma_f32_16x16x32_bf16 v[108:111], a[180:183], a[76:79], v[108:111]
    ds_read_b128 a[36:39], v17 offset:34816
    v_mfma_f32_16x16x32_bf16 v[108:111], a[188:191], a[108:111], v[108:111]
    v_mfma_f32_16x16x32_bf16 v[104:107], a[188:191], a[104:107], v[104:107]
    ds_read_b128 a[40:43], v17 offset:36864
    v_mfma_f32_16x16x32_bf16 v[104:107], a[180:183], a[72:75], v[104:107]
    buffer_load_dwordx4 v4, s[28:31], s60 offen offset:3072 lds
    v_mfma_f32_16x16x32_bf16 v[100:103], a[180:183], a[68:71], v[100:103]
    s_nop 0
    ds_read_b128 a[44:47], v17 offset:38912
    v_mfma_f32_16x16x32_bf16 v[100:103], a[188:191], a[100:103], v[100:103]
    s_xor_b32 s91, s90, 4
    s_mul_i32 s91, s91, 589824
    s_add_u32 s91, s91, s63
    v_mfma_f32_16x16x32_bf16 v[96:99], a[188:191], a[96:99], v[96:99]
    s_add_u32 m0, s66, 0
    ds_read_b128 a[48:51], v17 offset:40960
    s_add_u32 s60, s91, s48
    v_mfma_f32_16x16x32_bf16 v[96:99], a[180:183], a[64:67], v[96:99]
    buffer_load_dwordx4 v5, s[32:35], s60 offen offset:0 lds
    v_mfma_f32_16x16x32_bf16 v[224:227], a[208:211], a[64:67], v[224:227]
    s_nop 0
    ds_read_b128 a[52:55], v17 offset:43008
    v_mfma_f32_16x16x32_bf16 v[224:227], a[216:219], a[96:99], v[224:227]
    v_mfma_f32_16x16x32_bf16 v[228:231], a[216:219], a[100:103], v[228:231]
    ds_read_b128 a[56:59], v17 offset:45056
    v_mfma_f32_16x16x32_bf16 v[228:231], a[208:211], a[68:71], v[228:231]
    buffer_load_dwordx4 v6, s[32:35], s60 offen offset:1024 lds
    v_mfma_f32_16x16x32_bf16 v[232:235], a[208:211], a[72:75], v[232:235]
    ds_read_b128 a[60:63], v17 offset:47104
    v_mfma_f32_16x16x32_bf16 v[232:235], a[216:219], a[104:107], v[232:235]
    s_nop 0
    v_mfma_f32_16x16x32_bf16 v[236:239], a[216:219], a[108:111], v[236:239]
    s_nop 0
    ds_read_b64_tr_b16 a[140:141], v13 offset:24576
    v_mfma_f32_16x16x32_bf16 v[236:239], a[208:211], a[76:79], v[236:239]
    buffer_load_dwordx4 v7, s[32:35], s60 offen offset:2048 lds
    v_mfma_f32_16x16x32_bf16 v[240:243], a[208:211], a[80:83], v[240:243]
    ds_read_b64_tr_b16 a[142:143], v13 offset:25088
    v_mfma_f32_16x16x32_bf16 v[240:243], a[216:219], a[112:115], v[240:243]
    s_add_u32 m0, s67, 0
    s_add_u32 s60, s91, s49
    v_mfma_f32_16x16x32_bf16 v[244:247], a[216:219], a[116:119], v[244:247]
    ds_read_b64_tr_b16 a[168:169], v12 offset:26624
    v_mfma_f32_16x16x32_bf16 v[244:247], a[208:211], a[84:87], v[244:247]
    buffer_load_dwordx4 v5, s[32:35], s60 offen offset:0 lds
    v_mfma_f32_16x16x32_bf16 v[248:251], a[208:211], a[88:91], v[248:251]
    ds_read_b64_tr_b16 a[170:171], v12 offset:27136
    v_mfma_f32_16x16x32_bf16 v[248:251], a[216:219], a[120:123], v[248:251]
    s_nop 0
    v_mfma_f32_16x16x32_bf16 v[252:255], a[216:219], a[124:127], v[252:255]
    s_nop 0
    ds_read_b64_tr_b16 a[172:173], v13 offset:26624
L_ffn_pad1:
    s_cbranch_execz L_ffn_ret0
    v_mfma_f32_16x16x32_bf16 v[252:255], a[208:211], a[92:95], v[252:255]
    buffer_load_dwordx4 v6, s[32:35], s60 offen offset:1024 lds
    v_mfma_f32_16x16x32_bf16 v[156:159], a[212:215], a[92:95], v[156:159]
    s_nop 0
    ds_read_b64_tr_b16 a[174:175], v13 offset:27136
    v_mfma_f32_16x16x32_bf16 v[156:159], a[220:223], a[124:127], v[156:159]
    s_nop 0
    v_mfma_f32_16x16x32_bf16 v[152:155], a[220:223], a[120:123], v[152:155]
    s_nop 0
    ds_read_b64_tr_b16 a[200:201], v12 offset:28672
    v_mfma_f32_16x16x32_bf16 v[152:155], a[212:215], a[88:91], v[152:155]
    buffer_load_dwordx4 v7, s[32:35], s60 offen offset:2048 lds
    v_mfma_f32_16x16x32_bf16 v[148:151], a[212:215], a[84:87], v[148:151]
    s_nop 0
    ds_read_b64_tr_b16 a[202:203], v12 offset:29184
    v_mfma_f32_16x16x32_bf16 v[148:151], a[220:223], a[116:119], v[148:151]
    s_add_u32 m0, s65, 114688
    s_xor_b32 s60, s90, 5
    s_lshl_b32 s60, s60, 7
    v_mfma_f32_16x16x32_bf16 v[144:147], a[220:223], a[112:115], v[144:147]
    s_add_u32 s60, s60, s62
    ds_read_b64_tr_b16 a[204:205], v13 offset:28672
    v_mfma_f32_16x16x32_bf16 v[144:147], a[212:215], a[80:83], v[144:147]
    buffer_load_dwordx4 v1, s[28:31], s60 offen offset:0 lds
    v_mfma_f32_16x16x32_bf16 v[140:143], a[212:215], a[76:79], v[140:143]
    ds_read_b64_tr_b16 a[206:207], v13 offset:29184
    v_mfma_f32_16x16x32_bf16 v[140:143], a[220:223], a[108:111], v[140:143]
    v_mfma_f32_16x16x32_bf16 v[136:139], a[220:223], a[104:107], v[136:139]
    v_mfma_f32_16x16x32_bf16 v[136:139], a[212:215], a[72:75], v[136:139]
    buffer_load_dwordx4 v2, s[28:31], s60 offen offset:1024 lds
    v_mfma_f32_16x16x32_bf16 v[132:135], a[212:215], a[68:71], v[132:135]
    v_mfma_f32_16x16x32_bf16 v[132:135], a[220:223], a[100:103], v[132:135]
    v_mfma_f32_16x16x32_bf16 v[128:131], a[220:223], a[96:99], v[128:131]
    v_mfma_f32_16x16x32_bf16 v[128:131], a[212:215], a[64:67], v[128:131]
    s_waitcnt lgkmcnt(0)
    s_mov_b64 exec, 0
    s_cmp_eq_u32 s56, 0
    s_cbranch_scc1 L_ffn_pad5
    s_cmp_eq_u32 s56, 1
    s_cbranch_scc1 L_ffn_pad6
    s_cmp_eq_u32 s56, 2
    s_cbranch_scc1 L_ffn_pad7
    s_branch L_ffn_pad8
L_ffn_ret1:
    s_mov_b64 exec, -1
    v_mfma_f32_16x16x32_bf16 v[160:163], a[128:131], a[0:3], v[160:163]
    s_waitcnt vmcnt(18)
    s_barrier
    v_mfma_f32_16x16x32_bf16 v[160:163], a[136:139], a[32:35], v[160:163]
    s_add_u32 m0, s66, 24576
    s_add_u32 s60, s91, s50
    v_mfma_f32_16x16x32_bf16 v[164:167], a[136:139], a[36:39], v[164:167]
    s_nop 0
    ds_read_b64_tr_b16 a[144:145], v12 offset:49152
    v_mfma_f32_16x16x32_bf16 v[164:167], a[128:131], a[4:7], v[164:167]
    buffer_load_dwordx4 v5, s[32:35], s60 offen offset:0 lds
    v_mfma_f32_16x16x32_bf16 v[168:171], a[128:131], a[8:11], v[168:171]
    ds_read_b64_tr_b16 a[146:147], v12 offset:49664
    v_mfma_f32_16x16x32_bf16 v[168:171], a[136:139], a[40:43], v[168:171]
    v_mfma_f32_16x16x32_bf16 v[172:175], a[136:139], a[44:47], v[172:175]
    ds_read_b128 a[64:67], v16 offset:49152
    v_mfma_f32_16x16x32_bf16 v[172:175], a[128:131], a[12:15], v[172:175]
    v_mfma_f32_16x16x32_bf16 v[176:179], a[128:131], a[16:19], v[176:179]
    buffer_load_dwordx4 v6, s[32:35], s60 offen offset:1024 lds
    v_mfma_f32_16x16x32_bf16 v[176:179], a[136:139], a[48:51], v[176:179]
    ds_read_b128 a[68:71], v16 offset:51200
    v_mfma_f32_16x16x32_bf16 v[180:183], a[136:139], a[52:55], v[180:183]
    ds_read_b128 a[72:75], v16 offset:53248
    v_mfma_f32_16x16x32_bf16 v[180:183], a[128:131], a[20:23], v[180:183]
    v_mfma_f32_16x16x32_bf16 v[184:187], a[128:131], a[24:27], v[184:187]
    ds_read_b128 a[76:79], v16 offset:55296
    v_mfma_f32_16x16x32_bf16 v[184:187], a[136:139], a[56:59], v[184:187]
    v_mfma_f32_16x16x32_bf16 v[188:191], a[136:139], a[60:63], v[188:191]
    buffer_load_dwordx4 v7, s[32:35], s60 offen offset:2048 lds
    v_mfma_f32_16x16x32_bf16 v[188:191], a[128:131], a[28:31], v[188:191]
    ds_read_b128 a[80:83], v16 offset:57344
    v_mfma_f32_16x16x32_bf16 v[92:95], a[132:135], a[28:31], v[92:95]
    ds_read_b128 a[84:87], v16 offset:59392
    v_mfma_f32_16x16x32_bf16 v[92:95], a[140:143], a[60:63], v[92:95]
    s_add_u32 m0, s67, 24576
    s_add_u32 s60, s91, s51
    v_mfma_f32_16x16x32_bf16 v[88:91], a[140:143], a[56:59], v[88:91]
    s_nop 0
    ds_read_b128 a[88:91], v16 offset:61440
    v_mfma_f32_16x16x32_bf16 v[88:91], a[132:135], a[24:27], v[88:91]
    buffer_load_dwordx4 v5, s[32:35], s60 offen offset:0 lds
    v_mfma_f32_16x16x32_bf16 v[84:87], a[132:135], a[20:23], v[84:87]
    ds_read_b128 a[92:95], v16 offset:63488
    v_mfma_f32_16x16x32_bf16 v[84:87], a[140:143], a[52:55], v[84:87]
    v_mfma_f32_16x16x32_bf16 v[80:83], a[140:143], a[48:51], v[80:83]
    ds_read_b64_tr_b16 a[148:149], v13 offset:49152
    v_mfma_f32_16x16x32_bf16 v[80:83], a[132:135], a[16:19], v[80:83]
    v_mfma_f32_16x16x32_bf16 v[76:79], a[132:135], a[12:15], v[76:79]
    ds_read_b64_tr_b16 a[150:151], v13 offset:49664
    v_mfma_f32_16x16x32_bf16 v[76:79], a[140:143], a[44:47], v[76:79]
    buffer_load_dwordx4 v6, s[32:35], s60 offen offset:1024 lds
    v_mfma_f32_16x16x32_bf16 v[72:75], a[140:143], a[40:43], v[72:75]
    ds_read_b64_tr_b16 a[176:177], v12 offset:51200
    v_mfma_f32_16x16x32_bf16 v[72:75], a[132:135], a[8:11], v[72:75]
    v_mfma_f32_16x16x32_bf16 v[68:71], a[132:135], a[4:7], v[68:71]
    s_nop 0
    ds_read_b64_tr_b16 a[178:179], v12 offset:51712
    v_mfma_f32_16x16x32_bf16 v[68:71], a[140:143], a[36:39], v[68:71]
    s_nop 0
    v_mfma_f32_16x16x32_bf16 v[64:67], a[140:143], a[32:35], v[64:67]
    buffer_load_dwordx4 v7, s[32:35], s60 offen offset:2048 lds
    v_mfma_f32_16x16x32_bf16 v[64:67], a[132:135], a[0:3], v[64:67]
    ds_read_b64_tr_b16 a[180:181], v13 offset:51200
    v_mfma_f32_16x16x32_bf16 v[192:195], a[160:163], a[0:3], v[192:195]
    s_nop 0
    ds_read_b64_tr_b16 a[182:183], v13 offset:51712
    v_mfma_f32_16x16x32_bf16 v[192:195], a[168:171], a[32:35], v[192:195]
    s_nop 0
    v_mfma_f32_16x16x32_bf16 v[196:199], a[168:171], a[36:39], v[196:199]
    s_add_u32 m0, s65, 114688
    ds_read_b64_tr_b16 a[208:209], v12 offset:53248
    s_xor_b32 s60, s90, 5
    v_mfma_f32_16x16x32_bf16 v[196:199], a[160:163], a[4:7], v[196:199]
    s_lshl_b32 s60, s60, 7
    s_add_u32 s60, s60, s62
    v_mfma_f32_16x16x32_bf16 v[200:203], a[160:163], a[8:11], v[200:203]
    buffer_load_dwordx4 v3, s[28:31], s60 offen offset:2048 lds
    v_mfma_f32_16x16x32_bf16 v[200:203], a[168:171], a[40:43], v[200:203]
    s_nop 0
    ds_read_b64_tr_b16 a[210:211], v12 offset:53760
    v_mfma_f32_16x16x32_bf16 v[204:207], a[168:171], a[44:47], v[204:207]
    ds_read_b64_tr_b16 a[212:213], v13 offset:53248
    v_mfma_f32_16x16x32_bf16 v[204:207], a[160:163], a[12:15], v[204:207]
    v_mfma_f32_16x16x32_bf16 v[208:211], a[160:163], a[16:19], v[208:211]
    ds_read_b64_tr_b16 a[214:215], v13 offset:53760
    v_mfma_f32_16x16x32_bf16 v[208:211], a[168:171], a[48:51], v[208:211]
    buffer_load_dwordx4 v4, s[28:31], s60 offen offset:3072 lds
    v_mfma_f32_16x16x32_bf16 v[212:215], a[168:171], a[52:55], v[212:215]
    s_nop 0
    v_mfma_f32_16x16x32_bf16 v[212:215], a[160:163], a[20:23], v[212:215]
    s_nop 0
    v_mfma_f32_16x16x32_bf16 v[216:219], a[160:163], a[24:27], v[216:219]
    s_nop 0
    v_mfma_f32_16x16x32_bf16 v[216:219], a[168:171], a[56:59], v[216:219]
    v_mfma_f32_16x16x32_bf16 v[220:223], a[168:171], a[60:63], v[220:223]
    s_nop 0
    v_mfma_f32_16x16x32_bf16 v[220:223], a[160:163], a[28:31], v[220:223]
    s_waitcnt lgkmcnt(0)
    v_add_u32 v9, 8192, v8
    v_add_u32 v10, 16384, v8
    v_add_u32 v11, 24576, v8
    s_lshl_b32 s85, s56, 13
    v_add_u32_e64 v18, s85, v23
    v_add_u32 v19, 0x10000, v18
    s_xor_b32 s85, s56, 1
    s_lshl_b32 s85, s85, 13
    v_add_u32_e64 v32, s85, v23
    v_add_u32 v33, 0x10000, v32
    s_xor_b32 s85, s56, 2
    s_lshl_b32 s85, s85, 13
    v_add_u32_e64 v34, s85, v23
    v_add_u32 v35, 0x10000, v34
    s_xor_b32 s85, s56, 3
    s_lshl_b32 s85, s85, 13
    v_add_u32_e64 v36, s85, v23
    v_add_u32 v37, 0x10000, v36
    v_mfma_f32_16x16x32_bf16 v[124:127], a[164:167], a[28:31], v[124:127]
    s_waitcnt vmcnt(18)
    s_barrier
    s_nop 0
    v_mfma_f32_16x16x32_bf16 v[124:127], a[172:175], a[60:63], v[124:127]
    s_xor_b32 s91, s90, 5
    s_mul_i32 s91, s91, 589824
    s_add_u32 s91, s91, s63
    v_mfma_f32_16x16x32_bf16 v[120:123], a[172:175], a[56:59], v[120:123]
    s_add_u32 m0, s66, 49152
    ds_read_b64_tr_b16 a[152:153], v14 offset:8192
    s_add_u32 s60, s91, s48
    v_mfma_f32_16x16x32_bf16 v[120:123], a[164:167], a[24:27], v[120:123]
    buffer_load_dwordx4 v5, s[32:35], s60 offen offset:0 lds
    v_mfma_f32_16x16x32_bf16 v[116:119], a[164:167], a[20:23], v[116:119]
    ds_read_b64_tr_b16 a[154:155], v14 offset:8704
    v_mfma_f32_16x16x32_bf16 v[116:119], a[172:175], a[52:55], v[116:119]
    v_mfma_f32_16x16x32_bf16 v[112:115], a[172:175], a[48:51], v[112:115]
    ds_read_b128 a[96:99], v17 offset:49152
    v_mfma_f32_16x16x32_bf16 v[112:115], a[164:167], a[16:19], v[112:115]
    v_mfma_f32_16x16x32_bf16 v[108:111], a[164:167], a[12:15], v[108:111]
    buffer_load_dwordx4 v6, s[32:35], s60 offen offset:1024 lds
    v_mfma_f32_16x16x32_bf16 v[108:111], a[172:175], a[44:47], v[108:111]
    ds_read_b128 a[100:103], v17 offset:51200
    v_mfma_f32_16x16x32_bf16 v[104:107], a[172:175], a[40:43], v[104:107]
    ds_read_b128 a[104:107], v17 offset:53248
    v_mfma_f32_16x16x32_bf16 v[104:107], a[164:167], a[8:11], v[104:107]
    v_mfma_f32_16x16x32_bf16 v[100:103], a[164:167], a[4:7], v[100:103]
    ds_read_b128 a[108:111], v17 offset:55296
    v_mfma_f32_16x16x32_bf16 v[100:103], a[172:175], a[36:39], v[100:103]
    v_mfma_f32_16x16x32_bf16 v[96:99], a[172:175], a[32:35], v[96:99]
    buffer_load_dwordx4 v7, s[32:35], s60 offen offset:2048 lds
    v_mfma_f32_16x16x32_bf16 v[96:99], a[164:167], a[0:3], v[96:99]
    ds_read_b128 a[112:115], v17 offset:57344
    v_mfma_f32_16x16x32_bf16 v[224:227], a[192:195], a[0:3], v[224:227]
    ds_read_b128 a[116:119], v17 offset:59392
    v_mfma_f32_16x16x32_bf16 v[224:227], a[200:203], a[32:35], v[224:227]
    s_add_u32 m0, s67, 49152
    s_add_u32 s60, s91, s49
    v_mfma_f32_16x16x32_bf16 v[228:231], a[200:203], a[36:39], v[228:231]
    s_nop 0
    ds_read_b128 a[120:123], v17 offset:61440
    v_mfma_f32_16x16x32_bf16 v[228:231], a[192:195], a[4:7], v[228:231]
    buffer_load_dwordx4 v5, s[32:35], s60 offen offset:0 lds
    v_mfma_f32_16x16x32_bf16 v[232:235], a[192:195], a[8:11], v[232:235]
    ds_read_b128 a[124:127], v17 offset:63488
    v_mfma_f32_16x16x32_bf16 v[232:235], a[200:203], a[40:43], v[232:235]
    v_mfma_f32_16x16x32_bf16 v[236:239], a[200:203], a[44:47], v[236:239]
    ds_read_b64_tr_b16 a[156:157], v15 offset:8192
    v_mfma_f32_16x16x32_bf16 v[236:239], a[192:195], a[12:15], v[236:239]
    v_mfma_f32_16x16x32_bf16 v[240:243], a[192:195], a[16:19], v[240:243]
    ds_read_b64_tr_b16 a[158:159], v15 offset:8704
    v_mfma_f32_16x16x32_bf16 v[240:243], a[200:203], a[48:51], v[240:243]
    buffer_load_dwordx4 v6, s[32:35], s60 offen offset:1024 lds
    v_mfma_f32_16x16x32_bf16 v[244:247], a[200:203], a[52:55], v[244:247]
    ds_read_b64_tr_b16 a[184:185], v14 offset:10240
    v_mfma_f32_16x16x32_bf16 v[244:247], a[192:195], a[20:23], v[244:247]
    v_mfma_f32_16x16x32_bf16 v[248:251], a[192:195], a[24:27], v[248:251]
    ds_read_b64_tr_b16 a[186:187], v14 offset:10752
    v_mfma_f32_16x16x32_bf16 v[248:251], a[200:203], a[56:59], v[248:251]
    v_mfma_f32_16x16x32_bf16 v[252:255], a[200:203], a[60:63], v[252:255]
    buffer_load_dwordx4 v7, s[32:35], s60 offen offset:2048 lds
    v_mfma_f32_16x16x32_bf16 v[252:255], a[192:195], a[28:31], v[252:255]
    ds_read_b64_tr_b16 a[188:189], v15 offset:10240
    v_mfma_f32_16x16x32_bf16 v[156:159], a[196:199], a[28:31], v[156:159]
    s_nop 0
    ds_read_b64_tr_b16 a[190:191], v15 offset:10752
    v_mfma_f32_16x16x32_bf16 v[156:159], a[204:207], a[60:63], v[156:159]
    s_nop 0
    v_mfma_f32_16x16x32_bf16 v[152:155], a[204:207], a[56:59], v[152:155]
    s_add_u32 m0, s65, 131072
    ds_read_b64_tr_b16 a[216:217], v14 offset:12288
    s_xor_b32 s60, s90, 6
    v_mfma_f32_16x16x32_bf16 v[152:155], a[196:199], a[24:27], v[152:155]
    s_lshl_b32 s60, s60, 7
    s_add_u32 s60, s60, s62
    v_mfma_f32_16x16x32_bf16 v[148:151], a[196:199], a[20:23], v[148:151]
    buffer_load_dwordx4 v1, s[28:31], s60 offen offset:0 lds
    v_mfma_f32_16x16x32_bf16 v[148:151], a[204:207], a[52:55], v[148:151]
    s_nop 0
    ds_read_b64_tr_b16 a[218:219], v14 offset:12800
    v_mfma_f32_16x16x32_bf16 v[144:147], a[204:207], a[48:51], v[144:147]
    ds_read_b64_tr_b16 a[220:221], v15 offset:12288
    v_mfma_f32_16x16x32_bf16 v[144:147], a[196:199], a[16:19], v[144:147]
    v_mfma_f32_16x16x32_bf16 v[140:143], a[196:199], a[12:15], v[140:143]
    ds_read_b64_tr_b16 a[222:223], v15 offset:12800
    v_mfma_f32_16x16x32_bf16 v[140:143], a[204:207], a[44:47], v[140:143]
    buffer_load_dwordx4 v2, s[28:31], s60 offen offset:1024 lds
    v_mfma_f32_16x16x32_bf16 v[136:139], a[204:207], a[40:43], v[136:139]
    v_mfma_f32_16x16x32_bf16 v[136:139], a[196:199], a[8:11], v[136:139]
    v_mfma_f32_16x16x32_bf16 v[132:135], a[196:199], a[4:7], v[132:135]
    v_mfma_f32_16x16x32_bf16 v[132:135], a[204:207], a[36:39], v[132:135]
    v_mfma_f32_16x16x32_bf16 v[128:131], a[204:207], a[32:35], v[128:131]
    v_mfma_f32_16x16x32_bf16 v[128:131], a[196:199], a[0:3], v[128:131]
    s_waitcnt lgkmcnt(0)
    v_mfma_f32_16x16x32_bf16 v[160:163], a[144:147], a[64:67], v[160:163]
    s_waitcnt vmcnt(18)
    s_barrier
    v_mfma_f32_16x16x32_bf16 v[160:163], a[152:155], a[96:99], v[160:163]
    s_add_u32 m0, s66, 73728
    s_add_u32 s60, s91, s50
    v_mfma_f32_16x16x32_bf16 v[164:167], a[152:155], a[100:103], v[164:167]
    ds_read_b64_tr_b16 a[128:129], v12 offset:0
    v_mfma_f32_16x16x32_bf16 v[164:167], a[144:147], a[68:71], v[164:167]
    buffer_load_dwordx4 v5, s[32:35], s60 offen offset:0 lds
    v_mfma_f32_16x16x32_bf16 v[168:171], a[144:147], a[72:75], v[168:171]
    ds_read_b64_tr_b16 a[130:131], v12 offset:512
    v_mfma_f32_16x16x32_bf16 v[168:171], a[152:155], a[104:107], v[168:171]
    v_mfma_f32_16x16x32_bf16 v[172:175], a[152:155], a[108:111], v[172:175]
    ds_read_b128 a[0:3], v16 offset:0
    v_mfma_f32_16x16x32_bf16 v[172:175], a[144:147], a[76:79], v[172:175]
    v_mfma_f32_16x16x32_bf16 v[176:179], a[144:147], a[80:83], v[176:179]
    buffer_load_dwordx4 v6, s[32:35], s60 offen offset:1024 lds
    v_mfma_f32_16x16x32_bf16 v[176:179], a[152:155], a[112:115], v[176:179]
    ds_read_b128 a[4:7], v16 offset:2048
    v_mfma_f32_16x16x32_bf16 v[180:183], a[152:155], a[116:119], v[180:183]
    ds_read_b128 a[8:11], v16 offset:4096
    v_mfma_f32_16x16x32_bf16 v[180:183], a[144:147], a[84:87], v[180:183]
    v_mfma_f32_16x16x32_bf16 v[184:187], a[144:147], a[88:91], v[184:187]
    ds_read_b128 a[12:15], v16 offset:6144
    v_mfma_f32_16x16x32_bf16 v[184:187], a[152:155], a[120:123], v[184:187]
    v_mfma_f32_16x16x32_bf16 v[188:191], a[152:155], a[124:127], v[188:191]
    buffer_load_dwordx4 v7, s[32:35], s60 offen offset:2048 lds
    v_mfma_f32_16x16x32_bf16 v[188:191], a[144:147], a[92:95], v[188:191]
    ds_read_b128 a[16:19], v16 offset:8192
    v_mfma_f32_16x16x32_bf16 v[92:95], a[148:151], a[92:95], v[92:95]
    s_nop 0
    ds_read_b128 a[20:23], v16 offset:10240
    v_mfma_f32_16x16x32_bf16 v[92:95], a[156:159], a[124:127], v[92:95]
    s_add_u32 m0, s67, 73728
    s_add_u32 s60, s91, s51
    v_mfma_f32_16x16x32_bf16 v[88:91], a[156:159], a[120:123], v[88:91]
    ds_read_b128 a[24:27], v16 offset:12288
    v_mfma_f32_16x16x32_bf16 v[88:91], a[148:151], a[88:91], v[88:91]
    buffer_load_dwordx4 v5, s[32:35], s60 offen offset:0 lds
    v_mfma_f32_16x16x32_bf16 v[84:87], a[148:151], a[84:87], v[84:87]
    ds_read_b128 a[28:31], v16 offset:14336
    v_mfma_f32_16x16x32_bf16 v[84:87], a[156:159], a[116:119], v[84:87]
    v_mfma_f32_16x16x32_bf16 v[80:83], a[156:159], a[112:115], v[80:83]
    ds_read_b64_tr_b16 a[132:133], v13 offset:0
    v_mfma_f32_16x16x32_bf16 v[80:83], a[148:151], a[80:83], v[80:83]
    v_mfma_f32_16x16x32_bf16 v[76:79], a[148:151], a[76:79], v[76:79]
    ds_read_b64_tr_b16 a[134:135], v13 offset:512
    v_mfma_f32_16x16x32_bf16 v[76:79], a[156:159], a[108:111], v[76:79]
    buffer_load_dwordx4 v6, s[32:35], s60 offen offset:1024 lds
    v_mfma_f32_16x16x32_bf16 v[72:75], a[156:159], a[104:107], v[72:75]
    ds_read_b64_tr_b16 a[160:161], v12 offset:2048
    v_mfma_f32_16x16x32_bf16 v[72:75], a[148:151], a[72:75], v[72:75]
    v_mfma_f32_16x16x32_bf16 v[68:71], a[148:151], a[68:71], v[68:71]
    ds_read_b64_tr_b16 a[162:163], v12 offset:2560
    v_mfma_f32_16x16x32_bf16 v[68:71], a[156:159], a[100:103], v[68:71]
    v_mfma_f32_16x16x32_bf16 v[64:67], a[156:159], a[96:99], v[64:67]
    buffer_load_dwordx4 v7, s[32:35], s60 offen offset:2048 lds
    v_mfma_f32_16x16x32_bf16 v[64:67], a[148:151], a[64:67], v[64:67]
    ds_read_b64_tr_b16 a[164:165], v13 offset:2048
    v_mfma_f32_16x16x32_bf16 v[192:195], a[176:179], a[64:67], v[192:195]
    ds_read_b64_tr_b16 a[166:167], v13 offset:2560
    v_mfma_f32_16x16x32_bf16 v[192:195], a[184:187], a[96:99], v[192:195]
    v_mfma_f32_16x16x32_bf16 v[196:199], a[184:187], a[100:103], v[196:199]
    s_add_u32 m0, s65, 131072
    ds_read_b64_tr_b16 a[192:193], v12 offset:4096
    s_xor_b32 s60, s90, 6
    v_mfma_f32_16x16x32_bf16 v[196:199], a[176:179], a[68:71], v[196:199]
    s_lshl_b32 s60, s60, 7
    s_add_u32 s60, s60, s62
    v_mfma_f32_16x16x32_bf16 v[200:203], a[176:179], a[72:75], v[200:203]
    buffer_load_dwordx4 v3, s[28:31], s60 offen offset:2048 lds
    v_mfma_f32_16x16x32_bf16 v[200:203], a[184:187], a[104:107], v[200:203]
    s_nop 0
    ds_read_b64_tr_b16 a[194:195], v12 offset:4608
    v_mfma_f32_16x16x32_bf16 v[204:207], a[184:187], a[108:111], v[204:207]
    ds_read_b64_tr_b16 a[196:197], v13 offset:4096
    v_mfma_f32_16x16x32_bf16 v[204:207], a[176:179], a[76:79], v[204:207]
    v_mfma_f32_16x16x32_bf16 v[208:211], a[176:179], a[80:83], v[208:211]
    ds_read_b64_tr_b16 a[198:199], v13 offset:4608
    v_mfma_f32_16x16x32_bf16 v[208:211], a[184:187], a[112:115], v[208:211]
    buffer_load_dwordx4 v4, s[28:31], s60 offen offset:3072 lds
    v_mfma_f32_16x16x32_bf16 v[212:215], a[184:187], a[116:119], v[212:215]
    v_mfma_f32_16x16x32_bf16 v[212:215], a[176:179], a[84:87], v[212:215]
    v_mfma_f32_16x16x32_bf16 v[216:219], a[176:179], a[88:91], v[216:219]
    v_mfma_f32_16x16x32_bf16 v[216:219], a[184:187], a[120:123], v[216:219]
    v_mfma_f32_16x16x32_bf16 v[220:223], a[184:187], a[124:127], v[220:223]
    s_nop 0
    v_mfma_f32_16x16x32_bf16 v[220:223], a[176:179], a[92:95], v[220:223]
    s_waitcnt lgkmcnt(0)
    v_mfma_f32_16x16x32_bf16 v[124:127], a[180:183], a[92:95], v[124:127]
    s_waitcnt vmcnt(18)
    s_barrier
    v_mfma_f32_16x16x32_bf16 v[124:127], a[188:191], a[124:127], v[124:127]
    s_xor_b32 s91, s90, 6
    s_mul_i32 s91, s91, 589824
    s_add_u32 s91, s91, s63
    v_mfma_f32_16x16x32_bf16 v[120:123], a[188:191], a[120:123], v[120:123]
    s_add_u32 m0, s66, 0
    ds_read_b64_tr_b16 a[136:137], v12 offset:24576
    s_add_u32 s60, s91, s48
    v_mfma_f32_16x16x32_bf16 v[120:123], a[180:183], a[88:91], v[120:123]
    buffer_load_dwordx4 v5, s[32:35], s60 offen offset:0 lds
    v_mfma_f32_16x16x32_bf16 v[116:119], a[180:183], a[84:87], v[116:119]
    ds_read_b64_tr_b16 a[138:139], v12 offset:25088
    v_mfma_f32_16x16x32_bf16 v[116:119], a[188:191], a[116:119], v[116:119]
    v_mfma_f32_16x16x32_bf16 v[112:115], a[188:191], a[112:115], v[112:115]
    ds_read_b128 a[32:35], v17 offset:0
    v_mfma_f32_16x16x32_bf16 v[112:115], a[180:183], a[80:83], v[112:115]
    v_mfma_f32_16x16x32_bf16 v[108:111], a[180:183], a[76:79], v[108:111]
    buffer_load_dwordx4 v6, s[32:35], s60 offen offset:1024 lds
    v_mfma_f32_16x16x32_bf16 v[108:111], a[188:191], a[108:111], v[108:111]
    ds_read_b128 a[36:39], v17 offset:2048
    v_mfma_f32_16x16x32_bf16 v[104:107], a[188:191], a[104:107], v[104:107]
    ds_read_b128 a[40:43], v17 offset:4096
    v_mfma_f32_16x16x32_bf16 v[104:107], a[180:183], a[72:75], v[104:107]
    v_mfma_f32_16x16x32_bf16 v[100:103], a[180:183], a[68:71], v[100:103]
    ds_read_b128 a[44:47], v17 offset:6144
    v_mfma_f32_16x16x32_bf16 v[100:103], a[188:191], a[100:103], v[100:103]
    v_mfma_f32_16x16x32_bf16 v[96:99], a[188:191], a[96:99], v[96:99]
    buffer_load_dwordx4 v7, s[32:35], s60 offen offset:2048 lds
    v_mfma_f32_16x16x32_bf16 v[96:99], a[180:183], a[64:67], v[96:99]
    ds_read_b128 a[48:51], v17 offset:8192
    v_mfma_f32_16x16x32_bf16 v[224:227], a[208:211], a[64:67], v[224:227]
    ds_read_b128 a[52:55], v17 offset:10240
    v_mfma_f32_16x16x32_bf16 v[224:227], a[216:219], a[96:99], v[224:227]
    s_add_u32 m0, s67, 0
    s_add_u32 s60, s91, s49
    v_mfma_f32_16x16x32_bf16 v[228:231], a[216:219], a[100:103], v[228:231]
    ds_read_b128 a[56:59], v17 offset:12288
    v_mfma_f32_16x16x32_bf16 v[228:231], a[208:211], a[68:71], v[228:231]
    buffer_load_dwordx4 v5, s[32:35], s60 offen offset:0 lds
    v_mfma_f32_16x16x32_bf16 v[232:235], a[208:211], a[72:75], v[232:235]
    ds_read_b128 a[60:63], v17 offset:14336
    v_mfma_f32_16x16x32_bf16 v[232:235], a[216:219], a[104:107], v[232:235]
    v_mfma_f32_16x16x32_bf16 v[236:239], a[216:219], a[108:111], v[236:239]
    ds_read_b64_tr_b16 a[140:141], v13 offset:24576
    v_mfma_f32_16x16x32_bf16 v[236:239], a[208:211], a[76:79], v[236:239]
    v_mfma_f32_16x16x32_bf16 v[240:243], a[208:211], a[80:83], v[240:243]
    ds_read_b64_tr_b16 a[142:143], v13 offset:25088
    v_mfma_f32_16x16x32_bf16 v[240:243], a[216:219], a[112:115], v[240:243]
    buffer_load_dwordx4 v6, s[32:35], s60 offen offset:1024 lds
    v_mfma_f32_16x16x32_bf16 v[244:247], a[216:219], a[116:119], v[244:247]
    ds_read_b64_tr_b16 a[168:169], v12 offset:26624
    v_mfma_f32_16x16x32_bf16 v[244:247], a[208:211], a[84:87], v[244:247]
    v_mfma_f32_16x16x32_bf16 v[248:251], a[208:211], a[88:91], v[248:251]
    ds_read_b64_tr_b16 a[170:171], v12 offset:27136
    v_mfma_f32_16x16x32_bf16 v[248:251], a[216:219], a[120:123], v[248:251]
    v_mfma_f32_16x16x32_bf16 v[252:255], a[216:219], a[124:127], v[252:255]
    buffer_load_dwordx4 v7, s[32:35], s60 offen offset:2048 lds
    v_mfma_f32_16x16x32_bf16 v[252:255], a[208:211], a[92:95], v[252:255]
    ds_read_b64_tr_b16 a[172:173], v13 offset:26624
    v_mfma_f32_16x16x32_bf16 v[156:159], a[212:215], a[92:95], v[156:159]
    ds_read_b64_tr_b16 a[174:175], v13 offset:27136
    v_mfma_f32_16x16x32_bf16 v[156:159], a[220:223], a[124:127], v[156:159]
    s_nop 0
    v_mfma_f32_16x16x32_bf16 v[152:155], a[220:223], a[120:123], v[152:155]
    s_add_u32 m0, s65, 147456
    ds_read_b64_tr_b16 a[200:201], v12 offset:28672
    s_xor_b32 s60, s90, 7
    v_mfma_f32_16x16x32_bf16 v[152:155], a[212:215], a[88:91], v[152:155]
    s_lshl_b32 s60, s60, 7
    s_add_u32 s60, s60, s62
    v_mfma_f32_16x16x32_bf16 v[148:151], a[212:215], a[84:87], v[148:151]
    buffer_load_dwordx4 v1, s[28:31], s60 offen offset:0 lds
    v_mfma_f32_16x16x32_bf16 v[148:151], a[220:223], a[116:119], v[148:151]
    ds_read_b64_tr_b16 a[202:203], v12 offset:29184
    v_mfma_f32_16x16x32_bf16 v[144:147], a[220:223], a[112:115], v[144:147]
    ds_read_b64_tr_b16 a[204:205], v13 offset:28672
    v_mfma_f32_16x16x32_bf16 v[144:147], a[212:215], a[80:83], v[144:147]
    v_mfma_f32_16x16x32_bf16 v[140:143], a[212:215], a[76:79], v[140:143]
    ds_read_b64_tr_b16 a[206:207], v13 offset:29184
    v_mfma_f32_16x16x32_bf16 v[140:143], a[220:223], a[108:111], v[140:143]
    buffer_load_dwordx4 v2, s[28:31], s60 offen offset:1024 lds
    v_mfma_f32_16x16x32_bf16 v[136:139], a[220:223], a[104:107], v[136:139]
    v_mfma_f32_16x16x32_bf16 v[136:139], a[212:215], a[72:75], v[136:139]
    v_mfma_f32_16x16x32_bf16 v[132:135], a[212:215], a[68:71], v[132:135]
    v_mfma_f32_16x16x32_bf16 v[132:135], a[220:223], a[100:103], v[132:135]
    v_mfma_f32_16x16x32_bf16 v[128:131], a[220:223], a[96:99], v[128:131]
    s_nop 0
    v_mfma_f32_16x16x32_bf16 v[128:131], a[212:215], a[64:67], v[128:131]
    s_waitcnt lgkmcnt(0)
    v_mfma_f32_16x16x32_bf16 v[160:163], a[128:131], a[0:3], v[160:163]
    s_waitcnt vmcnt(18)
    s_barrier
    v_mfma_f32_16x16x32_bf16 v[160:163], a[136:139], a[32:35], v[160:163]
    s_add_u32 m0, s66, 24576
    s_add_u32 s60, s91, s50
    v_mfma_f32_16x16x32_bf16 v[164:167], a[136:139], a[36:39], v[164:167]
    s_nop 0
    ds_read_b64_tr_b16 a[144:145], v12 offset:49152
    v_mfma_f32_16x16x32_bf16 v[164:167], a[128:131], a[4:7], v[164:167]
    buffer_load_dwordx4 v5, s[32:35], s60 offen offset:0 lds
    v_mfma_f32_16x16x32_bf16 v[168:171], a[128:131], a[8:11], v[168:171]
    ds_read_b64_tr_b16 a[146:147], v12 offset:49664
    v_mfma_f32_16x16x32_bf16 v[168:171], a[136:139], a[40:43], v[168:171]
    v_mfma_f32_16x16x32_bf16 v[172:175], a[136:139], a[44:47], v[172:175]
    ds_read_b128 a[64:67], v16 offset:16384
    v_mfma_f32_16x16x32_bf16 v[172:175], a[128:131], a[12:15], v[172:175]
    v_mfma_f32_16x16x32_bf16 v[176:179], a[128:131], a[16:19], v[176:179]
    buffer_load_dwordx4 v6, s[32:35], s60 offen offset:1024 lds
    v_mfma_f32_16x16x32_bf16 v[176:179], a[136:139], a[48:51], v[176:179]
    ds_read_b128 a[68:71], v16 offset:18432
    v_mfma_f32_16x16x32_bf16 v[180:183], a[136:139], a[52:55], v[180:183]
    ds_read_b128 a[72:75], v16 offset:20480
    v_mfma_f32_16x16x32_bf16 v[180:183], a[128:131], a[20:23], v[180:183]
    v_mfma_f32_16x16x32_bf16 v[184:187], a[128:131], a[24:27], v[184:187]
    ds_read_b128 a[76:79], v16 offset:22528
    v_mfma_f32_16x16x32_bf16 v[184:187], a[136:139], a[56:59], v[184:187]
    v_mfma_f32_16x16x32_bf16 v[188:191], a[136:139], a[60:63], v[188:191]
    buffer_load_dwordx4 v7, s[32:35], s60 offen offset:2048 lds
    v_mfma_f32_16x16x32_bf16 v[188:191], a[128:131], a[28:31], v[188:191]
    ds_read_b128 a[80:83], v16 offset:24576
    v_mfma_f32_16x16x32_bf16 v[92:95], a[132:135], a[28:31], v[92:95]
    ds_read_b128 a[84:87], v16 offset:26624
    v_mfma_f32_16x16x32_bf16 v[92:95], a[140:143], a[60:63], v[92:95]
    s_add_u32 m0, s67, 24576
    s_add_u32 s60, s91, s51
    v_mfma_f32_16x16x32_bf16 v[88:91], a[140:143], a[56:59], v[88:91]
    s_nop 0
    ds_read_b128 a[88:91], v16 offset:28672
    v_mfma_f32_16x16x32_bf16 v[88:91], a[132:135], a[24:27], v[88:91]
    buffer_load_dwordx4 v5, s[32:35], s60 offen offset:0 lds
    v_mfma_f32_16x16x32_bf16 v[84:87], a[132:135], a[20:23], v[84:87]
    ds_read_b128 a[92:95], v16 offset:30720
    v_mfma_f32_16x16x32_bf16 v[84:87], a[140:143], a[52:55], v[84:87]
    v_mfma_f32_16x16x32_bf16 v[80:83], a[140:143], a[48:51], v[80:83]
    ds_read_b64_tr_b16 a[148:149], v13 offset:49152
    v_mfma_f32_16x16x32_bf16 v[80:83], a[132:135], a[16:19], v[80:83]
    s_nop 0
    v_mfma_f32_16x16x32_bf16 v[76:79], a[132:135], a[12:15], v[76:79]
    s_nop 0
    ds_read_b64_tr_b16 a[150:151], v13 offset:49664
    v_mfma_f32_16x16x32_bf16 v[76:79], a[140:143], a[44:47], v[76:79]
    buffer_load_dwordx4 v6, s[32:35], s60 offen offset:1024 lds
    v_mfma_f32_16x16x32_bf16 v[72:75], a[140:143], a[40:43], v[72:75]
    ds_read_b64_tr_b16 a[176:177], v12 offset:51200
    v_mfma_f32_16x16x32_bf16 v[72:75], a[132:135], a[8:11], v[72:75]
    s_nop 0
    v_mfma_f32_16x16x32_bf16 v[68:71], a[132:135], a[4:7], v[68:71]
    s_nop 0
    ds_read_b64_tr_b16 a[178:179], v12 offset:51712
    v_mfma_f32_16x16x32_bf16 v[68:71], a[140:143], a[36:39], v[68:71]
    s_nop 0
    v_mfma_f32_16x16x32_bf16 v[64:67], a[140:143], a[32:35], v[64:67]
    buffer_load_dwordx4 v7, s[32:35], s60 offen offset:2048 lds
    v_mfma_f32_16x16x32_bf16 v[64:67], a[132:135], a[0:3], v[64:67]
    s_nop 0
    ds_read_b64_tr_b16 a[180:181], v13 offset:51200
    v_mfma_f32_16x16x32_bf16 v[192:195], a[160:163], a[0:3], v[192:195]
    ds_read_b64_tr_b16 a[182:183], v13 offset:51712
    v_mfma_f32_16x16x32_bf16 v[192:195], a[168:171], a[32:35], v[192:195]
    s_nop 0
    v_mfma_f32_16x16x32_bf16 v[196:199], a[168:171], a[36:39], v[196:199]
    s_add_u32 m0, s65, 147456
    ds_read_b64_tr_b16 a[208:209], v12 offset:53248
    s_xor_b32 s60, s90, 7
    v_mfma_f32_16x16x32_bf16 v[196:199], a[160:163], a[4:7], v[196:199]
    s_lshl_b32 s60, s60, 7
    s_add_u32 s60, s60, s62
    v_mfma_f32_16x16x32_bf16 v[200:203], a[160:163], a[8:11], v[200:203]
    buffer_load_dwordx4 v3, s[28:31], s60 offen offset:2048 lds
    v_mfma_f32_16x16x32_bf16 v[200:203], a[168:171], a[40:43], v[200:203]
    ds_read_b64_tr_b16 a[210:211], v12 offset:53760
    v_mfma_f32_16x16x32_bf16 v[204:207], a[168:171], a[44:47], v[204:207]
    ds_read_b64_tr_b16 a[212:213], v13 offset:53248
    v_mfma_f32_16x16x32_bf16 v[204:207], a[160:163], a[12:15], v[204:207]
    v_mfma_f32_16x16x32_bf16 v[208:211], a[160:163], a[16:19], v[208:211]
    ds_read_b64_tr_b16 a[214:215], v13 offset:53760
    v_mfma_f32_16x16x32_bf16 v[208:211], a[168:171], a[48:51], v[208:211]
    buffer_load_dwordx4 v4, s[28:31], s60 offen offset:3072 lds
    v_mfma_f32_16x16x32_bf16 v[212:215], a[168:171], a[52:55], v[212:215]
    v_mfma_f32_16x16x32_bf16 v[212:215], a[160:163], a[20:23], v[212:215]
    v_mfma_f32_16x16x32_bf16 v[216:219], a[160:163], a[24:27], v[216:219]
    v_mfma_f32_16x16x32_bf16 v[216:219], a[168:171], a[56:59], v[216:219]
    v_mfma_f32_16x16x32_bf16 v[220:223], a[168:171], a[60:63], v[220:223]
    v_mfma_f32_16x16x32_bf16 v[220:223], a[160:163], a[28:31], v[220:223]
    s_waitcnt lgkmcnt(0)
    v_mfma_f32_16x16x32_bf16 v[124:127], a[164:167], a[28:31], v[124:127]
    s_waitcnt vmcnt(18)
    s_barrier
    v_mfma_f32_16x16x32_bf16 v[124:127], a[172:175], a[60:63], v[124:127]
    s_xor_b32 s91, s90, 7
    s_mul_i32 s91, s91, 589824
    s_add_u32 s91, s91, s63
    v_mfma_f32_16x16x32_bf16 v[120:123], a[172:175], a[56:59], v[120:123]
    s_add_u32 m0, s66, 49152
    ds_read_b64_tr_b16 a[152:153], v14 offset:8192
    s_add_u32 s60, s91, s48
    v_mfma_f32_16x16x32_bf16 v[120:123], a[164:167], a[24:27], v[120:123]
    buffer_load_dwordx4 v5, s[32:35], s60 offen offset:0 lds
    v_mfma_f32_16x16x32_bf16 v[116:119], a[164:167], a[20:23], v[116:119]
    ds_read_b64_tr_b16 a[154:155], v14 offset:8704
    v_mfma_f32_16x16x32_bf16 v[116:119], a[172:175], a[52:55], v[116:119]
    v_mfma_f32_16x16x32_bf16 v[112:115], a[172:175], a[48:51], v[112:115]
    ds_read_b128 a[96:99], v17 offset:16384
    v_mfma_f32_16x16x32_bf16 v[112:115], a[164:167], a[16:19], v[112:115]
    v_mfma_f32_16x16x32_bf16 v[108:111], a[164:167], a[12:15], v[108:111]
    buffer_load_dwordx4 v6, s[32:35], s60 offen offset:1024 lds
    v_mfma_f32_16x16x32_bf16 v[108:111], a[172:175], a[44:47], v[108:111]
    ds_read_b128 a[100:103], v17 offset:18432
    v_mfma_f32_16x16x32_bf16 v[104:107], a[172:175], a[40:43], v[104:107]
    ds_read_b128 a[104:107], v17 offset:20480
    v_mfma_f32_16x16x32_bf16 v[104:107], a[164:167], a[8:11], v[104:107]
    v_mfma_f32_16x16x32_bf16 v[100:103], a[164:167], a[4:7], v[100:103]
    ds_read_b128 a[108:111], v17 offset:22528
    v_mfma_f32_16x16x32_bf16 v[100:103], a[172:175], a[36:39], v[100:103]
    v_mfma_f32_16x16x32_bf16 v[96:99], a[172:175], a[32:35], v[96:99]
    buffer_load_dwordx4 v7, s[32:35], s60 offen offset:2048 lds
L_ffn_pad2:
    s_cbranch_execz L_ffn_ret0
    v_mfma_f32_16x16x32_bf16 v[96:99], a[164:167], a[0:3], v[96:99]
    s_nop 0
    ds_read_b128 a[112:115], v17 offset:24576
    v_mfma_f32_16x16x32_bf16 v[224:227], a[192:195], a[0:3], v[224:227]
    s_nop 0
    ds_read_b128 a[116:119], v17 offset:26624
    v_mfma_f32_16x16x32_bf16 v[224:227], a[200:203], a[32:35], v[224:227]
    s_add_u32 m0, s67, 49152
    s_add_u32 s60, s91, s49
    v_mfma_f32_16x16x32_bf16 v[228:231], a[200:203], a[36:39], v[228:231]
    ds_read_b128 a[120:123], v17 offset:28672
    v_mfma_f32_16x16x32_bf16 v[228:231], a[192:195], a[4:7], v[228:231]
    buffer_load_dwordx4 v5, s[32:35], s60 offen offset:0 lds
    v_mfma_f32_16x16x32_bf16 v[232:235], a[192:195], a[8:11], v[232:235]
    ds_read_b128 a[124:127], v17 offset:30720
    v_mfma_f32_16x16x32_bf16 v[232:235], a[200:203], a[40:43], v[232:235]
    v_mfma_f32_16x16x32_bf16 v[236:239], a[200:203], a[44:47], v[236:239]
    ds_read_b64_tr_b16 a[156:157], v15 offset:8192
    v_mfma_f32_16x16x32_bf16 v[236:239], a[192:195], a[12:15], v[236:239]
    v_mfma_f32_16x16x32_bf16 v[240:243], a[192:195], a[16:19], v[240:243]
    ds_read_b64_tr_b16 a[158:159], v15 offset:8704
    v_mfma_f32_16x16x32_bf16 v[240:243], a[200:203], a[48:51], v[240:243]
    buffer_load_dwordx4 v6, s[32:35], s60 offen offset:1024 lds
    v_mfma_f32_16x16x32_bf16 v[244:247], a[200:203], a[52:55], v[244:247]
    ds_read_b64_tr_b16 a[184:185], v14 offset:10240
    v_mfma_f32_16x16x32_bf16 v[244:247], a[192:195], a[20:23], v[244:247]
    v_mfma_f32_16x16x32_bf16 v[248:251], a[192:195], a[24:27], v[248:251]
    ds_read_b64_tr_b16 a[186:187], v14 offset:10752
    v_mfma_f32_16x16x32_bf16 v[248:251], a[200:203], a[56:59], v[248:251]
    v_mfma_f32_16x16x32_bf16 v[252:255], a[200:203], a[60:63], v[252:255]
    buffer_load_dwordx4 v7, s[32:35], s60 offen offset:2048 lds
    v_mfma_f32_16x16x32_bf16 v[252:255], a[192:195], a[28:31], v[252:255]
    ds_read_b64_tr_b16 a[188:189], v15 offset:10240
    v_mfma_f32_16x16x32_bf16 v[156:159], a[196:199], a[28:31], v[156:159]
    ds_read_b64_tr_b16 a[190:191], v15 offset:10752
    v_mfma_f32_16x16x32_bf16 v[156:159], a[204:207], a[60:63], v[156:159]
    v_mfma_f32_16x16x32_bf16 v[152:155], a[204:207], a[56:59], v[152:155]
    s_add_u32 m0, s65, 98304
    ds_read_b64_tr_b16 a[216:217], v14 offset:12288
    s_add_u32 s60, s62, 1024
    v_mfma_f32_16x16x32_bf16 v[152:155], a[196:199], a[24:27], v[152:155]
    v_mfma_f32_16x16x32_bf16 v[148:151], a[196:199], a[20:23], v[148:151]
    buffer_load_dwordx4 v1, s[28:31], s60 offen offset:0 lds
    v_mfma_f32_16x16x32_bf16 v[148:151], a[204:207], a[52:55], v[148:151]
    ds_read_b64_tr_b16 a[218:219], v14 offset:12800
    v_mfma_f32_16x16x32_bf16 v[144:147], a[204:207], a[48:51], v[144:147]
    ds_read_b64_tr_b16 a[220:221], v15 offset:12288
    v_mfma_f32_16x16x32_bf16 v[144:147], a[196:199], a[16:19], v[144:147]
    v_mfma_f32_16x16x32_bf16 v[140:143], a[196:199], a[12:15], v[140:143]
    ds_read_b64_tr_b16 a[222:223], v15 offset:12800
    v_mfma_f32_16x16x32_bf16 v[140:143], a[204:207], a[44:47], v[140:143]
    buffer_load_dwordx4 v2, s[28:31], s60 offen offset:1024 lds
    v_mfma_f32_16x16x32_bf16 v[136:139], a[204:207], a[40:43], v[136:139]
    v_mfma_f32_16x16x32_bf16 v[136:139], a[196:199], a[8:11], v[136:139]
    v_mfma_f32_16x16x32_bf16 v[132:135], a[196:199], a[4:7], v[132:135]
    v_mfma_f32_16x16x32_bf16 v[132:135], a[204:207], a[36:39], v[132:135]
    v_mfma_f32_16x16x32_bf16 v[128:131], a[204:207], a[32:35], v[128:131]
    s_nop 0
    v_mfma_f32_16x16x32_bf16 v[128:131], a[196:199], a[0:3], v[128:131]
    s_waitcnt lgkmcnt(0)
    v_mfma_f32_16x16x32_bf16 v[160:163], a[144:147], a[64:67], v[160:163]
    s_waitcnt vmcnt(18)
    s_barrier
    v_mfma_f32_16x16x32_bf16 v[160:163], a[152:155], a[96:99], v[160:163]
    s_add_u32 m0, s66, 73728
    s_add_u32 s60, s91, s50
    v_mfma_f32_16x16x32_bf16 v[164:167], a[152:155], a[100:103], v[164:167]
    s_nop 0
    ds_read_b64_tr_b16 a[128:129], v12 offset:0
    v_mfma_f32_16x16x32_bf16 v[164:167], a[144:147], a[68:71], v[164:167]
    buffer_load_dwordx4 v5, s[32:35], s60 offen offset:0 lds
    v_mfma_f32_16x16x32_bf16 v[168:171], a[144:147], a[72:75], v[168:171]
    s_getpc_b64 s[10:11]
L_ffn_pc2:
    s_sub_u32 s10, s10, L_ffn_pc2-L_ffn_body
    s_subb_u32 s11, s11, 0
    v_mfma_f32_16x16x32_bf16 v[168:171], a[152:155], a[104:107], v[168:171]
    ds_read_b64_tr_b16 a[130:131], v12 offset:512
    v_mfma_f32_16x16x32_bf16 v[172:175], a[152:155], a[108:111], v[172:175]
    ds_read_b128 a[0:3], v16 offset:32768
    v_mfma_f32_16x16x32_bf16 v[172:175], a[144:147], a[76:79], v[172:175]
    global_load_dword a255, v38, s[10:11]
    v_mfma_f32_16x16x32_bf16 v[176:179], a[144:147], a[80:83], v[176:179]
    s_mul_i32 s85, s68, 13824
    ds_read_b128 a[4:7], v16 offset:34816
    v_min_u32_e64 v31, 11, v0
    v_mfma_f32_16x16x32_bf16 v[176:179], a[152:155], a[112:115], v[176:179]
    v_mul_u32_u24 v31, 1152, v31
    v_add_u32_e64 v31, s85, v31
    v_mfma_f32_16x16x32_bf16 v[180:183], a[152:155], a[116:119], v[180:183]
    ds_read_b128 a[8:11], v16 offset:36864
    v_mfma_f32_16x16x32_bf16 v[180:183], a[144:147], a[84:87], v[180:183]
    buffer_load_dwordx4 v6, s[32:35], s60 offen offset:1024 lds
    v_mfma_f32_16x16x32_bf16 v[184:187], a[144:147], a[88:91], v[184:187]
    ds_read_b128 a[12:15], v16 offset:38912
    v_mfma_f32_16x16x32_bf16 v[184:187], a[152:155], a[120:123], v[184:187]
    v_mfma_f32_16x16x32_bf16 v[188:191], a[152:155], a[124:127], v[188:191]
    ds_read_b128 a[16:19], v16 offset:40960
    v_mfma_f32_16x16x32_bf16 v[188:191], a[144:147], a[92:95], v[188:191]
    buffer_load_dwordx4 v7, s[32:35], s60 offen offset:2048 lds
    v_mfma_f32_16x16x32_bf16 v[92:95], a[148:151], a[92:95], v[92:95]
    ds_read_b128 a[20:23], v16 offset:43008
    v_mfma_f32_16x16x32_bf16 v[92:95], a[156:159], a[124:127], v[92:95]
    s_add_u32 m0, s67, 73728
    s_add_u32 s60, s91, s51
    v_mfma_f32_16x16x32_bf16 v[88:91], a[156:159], a[120:123], v[88:91]
    s_nop 0
    ds_read_b128 a[24:27], v16 offset:45056
    v_mfma_f32_16x16x32_bf16 v[88:91], a[148:151], a[88:91], v[88:91]
    buffer_load_dwordx4 v5, s[32:35], s60 offen offset:0 lds
    v_mfma_f32_16x16x32_bf16 v[84:87], a[148:151], a[84:87], v[84:87]
    ds_read_b128 a[28:31], v16 offset:47104
    v_mfma_f32_16x16x32_bf16 v[84:87], a[156:159], a[116:119], v[84:87]
    v_mfma_f32_16x16x32_bf16 v[80:83], a[156:159], a[112:115], v[80:83]
    ds_read_b64_tr_b16 a[132:133], v13 offset:0
    v_mfma_f32_16x16x32_bf16 v[80:83], a[148:151], a[80:83], v[80:83]
    v_mfma_f32_16x16x32_bf16 v[76:79], a[148:151], a[76:79], v[76:79]
    ds_read_b64_tr_b16 a[134:135], v13 offset:512
    v_mfma_f32_16x16x32_bf16 v[76:79], a[156:159], a[108:111], v[76:79]
    buffer_load_dwordx4 v6, s[32:35], s60 offen offset:1024 lds
    v_mfma_f32_16x16x32_bf16 v[72:75], a[156:159], a[104:107], v[72:75]
    ds_read_b64_tr_b16 a[160:161], v12 offset:2048
    v_mfma_f32_16x16x32_bf16 v[72:75], a[148:151], a[72:75], v[72:75]
    v_mfma_f32_16x16x32_bf16 v[68:71], a[148:151], a[68:71], v[68:71]
    ds_read_b64_tr_b16 a[162:163], v12 offset:2560
    v_mfma_f32_16x16x32_bf16 v[68:71], a[156:159], a[100:103], v[68:71]
    v_mfma_f32_16x16x32_bf16 v[64:67], a[156:159], a[96:99], v[64:67]
    buffer_load_dwordx4 v7, s[32:35], s60 offen offset:2048 lds
    v_mfma_f32_16x16x32_bf16 v[64:67], a[148:151], a[64:67], v[64:67]
    ds_read_b64_tr_b16 a[164:165], v13 offset:2048
    v_mfma_f32_16x16x32_bf16 v[192:195], a[176:179], a[64:67], v[192:195]
    ds_read_b64_tr_b16 a[166:167], v13 offset:2560
    v_mfma_f32_16x16x32_bf16 v[192:195], a[184:187], a[96:99], v[192:195]
    v_mfma_f32_16x16x32_bf16 v[196:199], a[184:187], a[100:103], v[196:199]
    s_add_u32 m0, s65, 98304
    ds_read_b64_tr_b16 a[192:193], v12 offset:4096
    s_add_u32 s60, s62, 1024
    v_mfma_f32_16x16x32_bf16 v[196:199], a[176:179], a[68:71], v[196:199]
    v_mfma_f32_16x16x32_bf16 v[200:203], a[176:179], a[72:75], v[200:203]
    buffer_load_dwordx4 v3, s[28:31], s60 offen offset:2048 lds
    v_mfma_f32_16x16x32_bf16 v[200:203], a[184:187], a[104:107], v[200:203]
    ds_read_b64_tr_b16 a[194:195], v12 offset:4608
    v_mfma_f32_16x16x32_bf16 v[204:207], a[184:187], a[108:111], v[204:207]
    ds_read_b64_tr_b16 a[196:197], v13 offset:4096
    v_mfma_f32_16x16x32_bf16 v[204:207], a[176:179], a[76:79], v[204:207]
    v_mfma_f32_16x16x32_bf16 v[208:211], a[176:179], a[80:83], v[208:211]
    ds_read_b64_tr_b16 a[198:199], v13 offset:4608
    v_mfma_f32_16x16x32_bf16 v[208:211], a[184:187], a[112:115], v[208:211]
    buffer_load_dwordx4 v4, s[28:31], s60 offen offset:3072 lds
    v_mfma_f32_16x16x32_bf16 v[212:215], a[184:187], a[116:119], v[212:215]
    v_mfma_f32_16x16x32_bf16 v[212:215], a[176:179], a[84:87], v[212:215]
    s_nop 0
    v_mfma_f32_16x16x32_bf16 v[216:219], a[176:179], a[88:91], v[216:219]
    v_mfma_f32_16x16x32_bf16 v[216:219], a[184:187], a[120:123], v[216:219]
    s_nop 0
    v_mfma_f32_16x16x32_bf16 v[220:223], a[184:187], a[124:127], v[220:223]
    s_nop 0
    v_mfma_f32_16x16x32_bf16 v[220:223], a[176:179], a[92:95], v[220:223]
    s_waitcnt lgkmcnt(0)
    v_mfma_f32_16x16x32_bf16 v[124:127], a[180:183], a[92:95], v[124:127]
    s_waitcnt vmcnt(19)
    s_barrier
    v_mfma_f32_16x16x32_bf16 v[124:127], a[188:191], a[124:127], v[124:127]
    s_add_u32 s91, s63, 4718592
    s_add_u32 m0, s66, 0
    s_add_u32 s60, s91, s48
    v_mfma_f32_16x16x32_bf16 v[120:123], a[188:191], a[120:123], v[120:123]
    ds_read_b64_tr_b16 a[136:137], v12 offset:24576
    v_mfma_f32_16x16x32_bf16 v[120:123], a[180:183], a[88:91], v[120:123]
    buffer_load_dwordx4 v5, s[32:35], s60 offen offset:0 lds
    v_mfma_f32_16x16x32_bf16 v[116:119], a[180:183], a[84:87], v[116:119]
    s_mov_b64 s[52:53], s[18:19]
    ds_read_b64_tr_b16 a[138:139], v12 offset:25088
    s_mov_b32 s54, 1152
    v_mfma_f32_16x16x32_bf16 v[116:119], a[188:191], a[116:119], v[116:119]
    s_mov_b32 s55, 0x20000
    v_lshlrev_b32_e64 v39, 7, v0
    v_mfma_f32_16x16x32_bf16 v[112:115], a[188:191], a[112:115], v[112:115]
    s_nop 0
    ds_read_b128 a[32:35], v17 offset:32768
    v_mfma_f32_16x16x32_bf16 v[112:115], a[180:183], a[80:83], v[112:115]
    buffer_load_dword a255, v39, s[52:55], 0 offen
    v_mfma_f32_16x16x32_bf16 v[108:111], a[180:183], a[76:79], v[108:111]
    ds_read_b128 a[36:39], v17 offset:34816
    v_mfma_f32_16x16x32_bf16 v[108:111], a[188:191], a[108:111], v[108:111]
    v_mfma_f32_16x16x32_bf16 v[104:107], a[188:191], a[104:107], v[104:107]
    ds_read_b128 a[40:43], v17 offset:36864
    v_mfma_f32_16x16x32_bf16 v[104:107], a[180:183], a[72:75], v[104:107]
    buffer_load_dwordx4 v6, s[32:35], s60 offen offset:1024 lds
    v_mfma_f32_16x16x32_bf16 v[100:103], a[180:183], a[68:71], v[100:103]
    ds_read_b128 a[44:47], v17 offset:38912
    v_mfma_f32_16x16x32_bf16 v[100:103], a[188:191], a[100:103], v[100:103]
    v_mfma_f32_16x16x32_bf16 v[96:99], a[188:191], a[96:99], v[96:99]
    ds_read_b128 a[48:51], v17 offset:40960
    v_mfma_f32_16x16x32_bf16 v[96:99], a[180:183], a[64:67], v[96:99]
    v_mfma_f32_16x16x32_bf16 v[224:227], a[208:211], a[64:67], v[224:227]
    ds_read_b128 a[52:55], v17 offset:43008
    v_mfma_f32_16x16x32_bf16 v[224:227], a[216:219], a[96:99], v[224:227]
    buffer_load_dwordx4 v7, s[32:35], s60 offen offset:2048 lds
    v_mfma_f32_16x16x32_bf16 v[228:231], a[216:219], a[100:103], v[228:231]
    ds_read_b128 a[56:59], v17 offset:45056
    v_mfma_f32_16x16x32_bf16 v[228:231], a[208:211], a[68:71], v[228:231]
    v_mfma_f32_16x16x32_bf16 v[232:235], a[208:211], a[72:75], v[232:235]
    ds_read_b128 a[60:63], v17 offset:47104
    v_mfma_f32_16x16x32_bf16 v[232:235], a[216:219], a[104:107], v[232:235]
    v_mfma_f32_16x16x32_bf16 v[236:239], a[216:219], a[108:111], v[236:239]
    ds_read_b64_tr_b16 a[140:141], v13 offset:24576
    v_mfma_f32_16x16x32_bf16 v[236:239], a[208:211], a[76:79], v[236:239]
    s_add_u32 m0, s67, 0
    s_add_u32 s60, s91, s49
    v_mfma_f32_16x16x32_bf16 v[240:243], a[208:211], a[80:83], v[240:243]
    ds_read_b64_tr_b16 a[142:143], v13 offset:25088
    v_mfma_f32_16x16x32_bf16 v[240:243], a[216:219], a[112:115], v[240:243]
    buffer_load_dwordx4 v5, s[32:35], s60 offen offset:0 lds
    v_mfma_f32_16x16x32_bf16 v[244:247], a[216:219], a[116:119], v[244:247]
    ds_read_b64_tr_b16 a[168:169], v12 offset:26624
    v_mfma_f32_16x16x32_bf16 v[244:247], a[208:211], a[84:87], v[244:247]
    v_mfma_f32_16x16x32_bf16 v[248:251], a[208:211], a[88:91], v[248:251]
    ds_read_b64_tr_b16 a[170:171], v12 offset:27136
    v_mfma_f32_16x16x32_bf16 v[248:251], a[216:219], a[120:123], v[248:251]
    v_mfma_f32_16x16x32_bf16 v[252:255], a[216:219], a[124:127], v[252:255]
    ds_read_b64_tr_b16 a[172:173], v13 offset:26624
    v_mfma_f32_16x16x32_bf16 v[252:255], a[208:211], a[92:95], v[252:255]
    v_mfma_f32_16x16x32_bf16 v[156:159], a[212:215], a[92:95], v[156:159]
    buffer_load_dwordx4 v6, s[32:35], s60 offen offset:1024 lds
    v_mfma_f32_16x16x32_bf16 v[156:159], a[220:223], a[124:127], v[156:159]
    ds_read_b64_tr_b16 a[174:175], v13 offset:27136
    v_mfma_f32_16x16x32_bf16 v[152:155], a[220:223], a[120:123], v[152:155]
    ds_read_b64_tr_b16 a[200:201], v12 offset:28672
    v_mfma_f32_16x16x32_bf16 v[152:155], a[212:215], a[88:91], v[152:155]
    v_mfma_f32_16x16x32_bf16 v[148:151], a[212:215], a[84:87], v[148:151]
    ds_read_b64_tr_b16 a[202:203], v12 offset:29184
    v_mfma_f32_16x16x32_bf16 v[148:151], a[220:223], a[116:119], v[148:151]
    v_mfma_f32_16x16x32_bf16 v[144:147], a[220:223], a[112:115], v[144:147]
    ds_read_b64_tr_b16 a[204:205], v13 offset:28672
    v_mfma_f32_16x16x32_bf16 v[144:147], a[212:215], a[80:83], v[144:147]
    buffer_load_dwordx4 v7, s[32:35], s60 offen offset:2048 lds
    v_mfma_f32_16x16x32_bf16 v[140:143], a[212:215], a[76:79], v[140:143]
    ds_read_b64_tr_b16 a[206:207], v13 offset:29184
    v_mfma_f32_16x16x32_bf16 v[140:143], a[220:223], a[108:111], v[140:143]
    v_mfma_f32_16x16x32_bf16 v[136:139], a[220:223], a[104:107], v[136:139]
    v_mfma_f32_16x16x32_bf16 v[136:139], a[212:215], a[72:75], v[136:139]
    v_mfma_f32_16x16x32_bf16 v[132:135], a[212:215], a[68:71], v[132:135]
    v_mfma_f32_16x16x32_bf16 v[132:135], a[220:223], a[100:103], v[132:135]
    v_mfma_f32_16x16x32_bf16 v[128:131], a[220:223], a[96:99], v[128:131]
    s_nop 0
    v_mfma_f32_16x16x32_bf16 v[128:131], a[212:215], a[64:67], v[128:131]
    s_waitcnt lgkmcnt(0)
    v_mfma_f32_16x16x32_bf16 v[160:163], a[128:131], a[0:3], v[160:163]
    s_waitcnt vmcnt(9)
    s_barrier
    v_mfma_f32_16x16x32_bf16 v[164:167], a[128:131], a[4:7], v[164:167]
    s_add_u32 m0, s66, 24576
    s_add_u32 s60, s91, s50
    v_mfma_f32_16x16x32_bf16 v[168:171], a[128:131], a[8:11], v[168:171]
    s_nop 0
    ds_read_b64_tr_b16 a[144:145], v12 offset:49152
    v_mfma_f32_16x16x32_bf16 v[172:175], a[128:131], a[12:15], v[172:175]
    buffer_load_dwordx4 v5, s[32:35], s60 offen offset:0 lds
    v_mfma_f32_16x16x32_bf16 v[176:179], a[128:131], a[16:19], v[176:179]
    ds_read_b64_tr_b16 a[146:147], v12 offset:49664
    v_mfma_f32_16x16x32_bf16 v[180:183], a[128:131], a[20:23], v[180:183]
    ds_read_b128 a[64:67], v16 offset:49152
    v_mfma_f32_16x16x32_bf16 v[184:187], a[128:131], a[24:27], v[184:187]
    ds_read_b128 a[68:71], v16 offset:51200
    v_mfma_f32_16x16x32_bf16 v[188:191], a[128:131], a[28:31], v[188:191]
    ds_read_b128 a[72:75], v16 offset:53248
    v_mfma_f32_16x16x32_bf16 v[92:95], a[132:135], a[28:31], v[92:95]
    buffer_load_dwordx4 v6, s[32:35], s60 offen offset:1024 lds
    v_mfma_f32_16x16x32_bf16 v[88:91], a[132:135], a[24:27], v[88:91]
    ds_read_b128 a[76:79], v16 offset:55296
    v_mfma_f32_16x16x32_bf16 v[84:87], a[132:135], a[20:23], v[84:87]
    ds_read_b128 a[80:83], v16 offset:57344
    v_mfma_f32_16x16x32_bf16 v[80:83], a[132:135], a[16:19], v[80:83]
    ds_read_b128 a[84:87], v16 offset:59392
    v_mfma_f32_16x16x32_bf16 v[76:79], a[132:135], a[12:15], v[76:79]
    ds_read_b128 a[88:91], v16 offset:61440
    v_mfma_f32_16x16x32_bf16 v[72:75], a[132:135], a[8:11], v[72:75]
    ds_read_b128 a[92:95], v16 offset:63488
    v_mfma_f32_16x16x32_bf16 v[68:71], a[132:135], a[4:7], v[68:71]
    buffer_load_dwordx4 v7, s[32:35], s60 offen offset:2048 lds
    v_mfma_f32_16x16x32_bf16 v[64:67], a[132:135], a[0:3], v[64:67]
    s_mov_b32 s89, 0x12345
    ds_read_b64_tr_b16 a[148:149], v13 offset:49152
    ds_read_b64_tr_b16 a[150:151], v13 offset:49664
    v_mfma_f32_16x16x32_bf16 v[192:195], a[160:163], a[0:3], v[192:195]
    s_mov_b32 s89, 0x12345
    ds_read_b64_tr_b16 a[176:177], v12 offset:51200
    ds_read_b64_tr_b16 a[178:179], v12 offset:51712
    v_mfma_f32_16x16x32_bf16 v[196:199], a[160:163], a[4:7], v[196:199]
    s_add_u32 m0, s67, 24576
    ds_read_b64_tr_b16 a[180:181], v13 offset:51200
    ds_read_b64_tr_b16 a[182:183], v13 offset:51712
    v_mfma_f32_16x16x32_bf16 v[200:203], a[160:163], a[8:11], v[200:203]
    s_add_u32 s60, s91, s51
    ds_read_b64_tr_b16 a[208:209], v12 offset:53248
    v_mfma_f32_16x16x32_bf16 v[204:207], a[160:163], a[12:15], v[204:207]
    buffer_load_dwordx4 v5, s[32:35], s60 offen offset:0 lds
    v_mfma_f32_16x16x32_bf16 v[208:211], a[160:163], a[16:19], v[208:211]
    s_nop 0
    ds_read_b64_tr_b16 a[210:211], v12 offset:53760
    ds_read_b64_tr_b16 a[212:213], v13 offset:53248
    v_mfma_f32_16x16x32_bf16 v[212:215], a[160:163], a[20:23], v[212:215]
    ds_read_b64_tr_b16 a[214:215], v13 offset:53760
    v_mfma_f32_16x16x32_bf16 v[216:219], a[160:163], a[24:27], v[216:219]
    v_mfma_f32_16x16x32_bf16 v[220:223], a[160:163], a[28:31], v[220:223]
    ds_read_b64_tr_b16 a[152:153], v14 offset:8192
    v_mfma_f32_16x16x32_bf16 v[124:127], a[164:167], a[28:31], v[124:127]
    ds_read_b64_tr_b16 a[154:155], v14 offset:8704
    v_mfma_f32_16x16x32_bf16 v[120:123], a[164:167], a[24:27], v[120:123]
    buffer_load_dwordx4 v6, s[32:35], s60 offen offset:1024 lds
    v_mfma_f32_16x16x32_bf16 v[116:119], a[164:167], a[20:23], v[116:119]
    ds_read_b128 a[96:99], v17 offset:49152
    v_mfma_f32_16x16x32_bf16 v[112:115], a[164:167], a[16:19], v[112:115]
    ds_read_b128 a[100:103], v17 offset:51200
    v_mfma_f32_16x16x32_bf16 v[108:111], a[164:167], a[12:15], v[108:111]
    ds_read_b128 a[104:107], v17 offset:53248
    v_mfma_f32_16x16x32_bf16 v[104:107], a[164:167], a[8:11], v[104:107]
    ds_read_b128 a[108:111], v17 offset:55296
    v_mfma_f32_16x16x32_bf16 v[100:103], a[164:167], a[4:7], v[100:103]
    buffer_load_dwordx4 v7, s[32:35], s60 offen offset:2048 lds
    v_mfma_f32_16x16x32_bf16 v[96:99], a[164:167], a[0:3], v[96:99]
    ds_read_b128 a[112:115], v17 offset:57344
    v_mfma_f32_16x16x32_bf16 v[224:227], a[192:195], a[0:3], v[224:227]
    ds_read_b128 a[116:119], v17 offset:59392
    v_mfma_f32_16x16x32_bf16 v[228:231], a[192:195], a[4:7], v[228:231]
    ds_read_b128 a[120:123], v17 offset:61440
    v_mfma_f32_16x16x32_bf16 v[232:235], a[192:195], a[8:11], v[232:235]
    s_add_u32 s60, s64, 1024
    ds_read_b128 a[124:127], v17 offset:63488
    v_mfma_f32_16x16x32_bf16 v[236:239], a[192:195], a[12:15], v[236:239]
    s_mov_b32 s89, 0x12345
    ds_read_b64_tr_b16 a[156:157], v15 offset:8192
    ds_read_b64_tr_b16 a[158:159], v15 offset:8704
    v_mfma_f32_16x16x32_bf16 v[240:243], a[192:195], a[16:19], v[240:243]
    buffer_load_dword a255, v31, s[36:39], s60 offen
    v_mfma_f32_16x16x32_bf16 v[244:247], a[192:195], a[20:23], v[244:247]
    s_mov_b32 s89, 0x12345
    ds_read_b64_tr_b16 a[184:185], v14 offset:10240
    ds_read_b64_tr_b16 a[186:187], v14 offset:10752
    v_mfma_f32_16x16x32_bf16 v[248:251], a[192:195], a[24:27], v[248:251]
    s_mov_b32 s89, 0x12345
    ds_read_b64_tr_b16 a[188:189], v15 offset:10240
    ds_read_b64_tr_b16 a[190:191], v15 offset:10752
    v_mfma_f32_16x16x32_bf16 v[252:255], a[192:195], a[28:31], v[252:255]
    s_add_u32 m0, s65, 114688
    ds_read_b64_tr_b16 a[216:217], v14 offset:12288
    s_add_u32 s60, s70, 0
    v_mfma_f32_16x16x32_bf16 v[156:159], a[196:199], a[28:31], v[156:159]
    s_nop 0
    ds_read_b64_tr_b16 a[218:219], v14 offset:12800
    v_mfma_f32_16x16x32_bf16 v[152:155], a[196:199], a[24:27], v[152:155]
    buffer_load_dwordx4 v8, s[36:39], s60 offen offset:0 lds
    v_mfma_f32_16x16x32_bf16 v[148:151], a[196:199], a[20:23], v[148:151]
    s_mov_b32 s89, 0x12345
    ds_read_b64_tr_b16 a[220:221], v15 offset:12288
    ds_read_b64_tr_b16 a[222:223], v15 offset:12800
    v_mfma_f32_16x16x32_bf16 v[144:147], a[196:199], a[16:19], v[144:147]
    v_mfma_f32_16x16x32_bf16 v[140:143], a[196:199], a[12:15], v[140:143]
    v_mfma_f32_16x16x32_bf16 v[136:139], a[196:199], a[8:11], v[136:139]
    v_mfma_f32_16x16x32_bf16 v[132:135], a[196:199], a[4:7], v[132:135]
    v_mfma_f32_16x16x32_bf16 v[128:131], a[196:199], a[0:3], v[128:131]
    s_waitcnt lgkmcnt(0)
    v_mfma_f32_16x16x32_bf16 v[160:163], a[136:139], a[32:35], v[160:163]
    s_waitcnt vmcnt(8)
    s_barrier
    v_mfma_f32_16x16x32_bf16 v[164:167], a[136:139], a[36:39], v[164:167]
    s_nop 0
    v_mfma_f32_16x16x32_bf16 v[168:171], a[136:139], a[40:43], v[168:171]
    ds_read_b64_tr_b16 a[128:129], v12 offset:0
    v_mfma_f32_16x16x32_bf16 v[172:175], a[136:139], a[44:47], v[172:175]
    buffer_load_dwordx4 v9, s[36:39], s60 offen offset:1024 lds
    v_mfma_f32_16x16x32_bf16 v[176:179], a[136:139], a[48:51], v[176:179]
    s_xor_b32 s85, s56, 1
    ds_read_b64_tr_b16 a[130:131], v12 offset:512
    s_lshl_b32 s85, s85, 12
    v_mfma_f32_16x16x32_bf16 v[180:183], a[136:139], a[52:55], v[180:183]
    v_add_u32_e64 v1, s85, v22
    v_add_u32 v2, 0x10000, v1
    v_mfma_f32_16x16x32_bf16 v[184:187], a[136:139], a[56:59], v[184:187]
    ds_read_b128 a[0:3], v16 offset:0
    v_add_u32 v3, 0x20000, v1
    v_mfma_f32_16x16x32_bf16 v[188:191], a[136:139], a[60:63], v[188:191]
    s_xor_b32 s85, s56, 2
    s_lshl_b32 s85, s85, 12
    v_add_u32_e64 v4, s85, v22
    v_mfma_f32_16x16x32_bf16 v[92:95], a[140:143], a[60:63], v[92:95]
    ds_read_b128 a[4:7], v16 offset:2048
    v_add_u32 v5, 0x10000, v4
    v_mfma_f32_16x16x32_bf16 v[88:91], a[140:143], a[56:59], v[88:91]
    buffer_load_dwordx4 v10, s[36:39], s60 offen offset:2048 lds
    v_mfma_f32_16x16x32_bf16 v[84:87], a[140:143], a[52:55], v[84:87]
    ds_read_b128 a[8:11], v16 offset:4096
    v_add_u32 v6, 0x20000, v4
    v_mfma_f32_16x16x32_bf16 v[80:83], a[140:143], a[48:51], v[80:83]
    s_xor_b32 s85, s56, 3
    s_lshl_b32 s85, s85, 12
    v_add_u32_e64 v7, s85, v22
    v_mfma_f32_16x16x32_bf16 v[76:79], a[140:143], a[44:47], v[76:79]
    ds_read_b128 a[12:15], v16 offset:6144
    v_add_u32 v27, 0x10000, v7
    v_mfma_f32_16x16x32_bf16 v[72:75], a[140:143], a[40:43], v[72:75]
    v_add_u32 v30, 0x20000, v7
    s_xor_b32 s85, s56, 0
    v_mfma_f32_16x16x32_bf16 v[68:71], a[140:143], a[36:39], v[68:71]
    s_lshl_b32 s85, s85, 12
    ds_read_b128 a[16:19], v16 offset:8192
    v_add_u32_e64 v22, s85, v22
    v_mfma_f32_16x16x32_bf16 v[64:67], a[140:143], a[32:35], v[64:67]
    buffer_load_dwordx4 v11, s[36:39], s60 offen offset:3072 lds
    v_mfma_f32_16x16x32_bf16 v[192:195], a[168:171], a[32:35], v[192:195]
    ds_read_b128 a[20:23], v16 offset:10240
    v_add_u32 v21, 0x10000, v22
    v_mfma_f32_16x16x32_bf16 v[196:199], a[168:171], a[36:39], v[196:199]
    v_add_u32 v26, 0x20000, v22
    s_mul_i32 s85, s56, 36864
    v_mfma_f32_16x16x32_bf16 v[200:203], a[168:171], a[40:43], v[200:203]
    ds_read_b128 a[24:27], v16 offset:12288
    v_and_b32_e64 v31, 31, v0
    v_mfma_f32_16x16x32_bf16 v[204:207], a[168:171], a[44:47], v[204:207]
    s_add_u32 m0, s65, 131072
    s_add_u32 s60, s70, 147456
    v_mul_u32_u24 v31, 1152, v31
    v_mfma_f32_16x16x32_bf16 v[208:211], a[168:171], a[48:51], v[208:211]
    ds_read_b128 a[28:31], v16 offset:14336
    v_add_u32_e64 v31, s85, v31
    v_mfma_f32_16x16x32_bf16 v[212:215], a[168:171], a[52:55], v[212:215]
    buffer_load_dwordx4 v8, s[36:39], s60 offen offset:0 lds
    v_mfma_f32_16x16x32_bf16 v[216:219], a[168:171], a[56:59], v[216:219]
    ds_read_b64_tr_b16 a[132:133], v13 offset:0
    v_mfma_f32_16x16x32_bf16 v[220:223], a[168:171], a[60:63], v[220:223]
    v_mfma_f32_16x16x32_bf16 v[124:127], a[172:175], a[60:63], v[124:127]
    ds_read_b64_tr_b16 a[134:135], v13 offset:512
    v_mfma_f32_16x16x32_bf16 v[120:123], a[172:175], a[56:59], v[120:123]
    v_mfma_f32_16x16x32_bf16 v[116:119], a[172:175], a[52:55], v[116:119]
    ds_read_b64_tr_b16 a[160:161], v12 offset:2048
    v_mfma_f32_16x16x32_bf16 v[112:115], a[172:175], a[48:51], v[112:115]
    v_mfma_f32_16x16x32_bf16 v[108:111], a[172:175], a[44:47], v[108:111]
    buffer_load_dwordx4 v9, s[36:39], s60 offen offset:1024 lds
    v_mfma_f32_16x16x32_bf16 v[104:107], a[172:175], a[40:43], v[104:107]
    ds_read_b64_tr_b16 a[162:163], v12 offset:2560
    v_mfma_f32_16x16x32_bf16 v[100:103], a[172:175], a[36:39], v[100:103]
    ds_read_b64_tr_b16 a[164:165], v13 offset:2048
    v_mfma_f32_16x16x32_bf16 v[96:99], a[172:175], a[32:35], v[96:99]
    v_mfma_f32_16x16x32_bf16 v[224:227], a[200:203], a[32:35], v[224:227]
    ds_read_b64_tr_b16 a[166:167], v13 offset:2560
    v_mfma_f32_16x16x32_bf16 v[228:231], a[200:203], a[36:39], v[228:231]
    v_mfma_f32_16x16x32_bf16 v[232:235], a[200:203], a[40:43], v[232:235]
    buffer_load_dwordx4 v10, s[36:39], s60 offen offset:2048 lds
    v_mfma_f32_16x16x32_bf16 v[236:239], a[200:203], a[44:47], v[236:239]
    ds_read_b64_tr_b16 a[192:193], v12 offset:4096
    v_mfma_f32_16x16x32_bf16 v[240:243], a[200:203], a[48:51], v[240:243]
    ds_read_b64_tr_b16 a[194:195], v12 offset:4608
    v_mfma_f32_16x16x32_bf16 v[244:247], a[200:203], a[52:55], v[244:247]
    v_mfma_f32_16x16x32_bf16 v[248:251], a[200:203], a[56:59], v[248:251]
    ds_read_b64_tr_b16 a[196:197], v13 offset:4096
    v_mfma_f32_16x16x32_bf16 v[252:255], a[200:203], a[60:63], v[252:255]
    v_mfma_f32_16x16x32_bf16 v[156:159], a[204:207], a[60:63], v[156:159]
    buffer_load_dwordx4 v11, s[36:39], s60 offen offset:3072 lds
    v_mfma_f32_16x16x32_bf16 v[152:155], a[204:207], a[56:59], v[152:155]
    ds_read_b64_tr_b16 a[198:199], v13 offset:4608
    v_mfma_f32_16x16x32_bf16 v[148:151], a[204:207], a[52:55], v[148:151]
    v_mfma_f32_16x16x32_bf16 v[144:147], a[204:207], a[48:51], v[144:147]
    v_mfma_f32_16x16x32_bf16 v[140:143], a[204:207], a[44:47], v[140:143]
    v_mfma_f32_16x16x32_bf16 v[136:139], a[204:207], a[40:43], v[136:139]
    v_mfma_f32_16x16x32_bf16 v[132:135], a[204:207], a[36:39], v[132:135]
    s_nop 0
    v_mfma_f32_16x16x32_bf16 v[128:131], a[204:207], a[32:35], v[128:131]
    s_waitcnt lgkmcnt(0)
    v_mfma_f32_16x16x32_bf16 v[160:163], a[144:147], a[64:67], v[160:163]
    s_waitcnt vmcnt(8)
    s_barrier
    v_mfma_f32_16x16x32_bf16 v[160:163], a[152:155], a[96:99], v[160:163]
    s_add_u32 m0, s65, 147456
    ds_read_b64_tr_b16 a[136:137], v12 offset:24576
    ds_read_b64_tr_b16 a[138:139], v12 offset:25088
    v_mfma_f32_16x16x32_bf16 v[160:163], a[128:131], a[0:3], v[160:163]
    ds_read_b64_tr_b16 a[140:141], v13 offset:24576
    v_mfma_f32_16x16x32_bf16 v[64:67], a[132:135], a[0:3], v[64:67]
    ds_read_b64_tr_b16 a[142:143], v13 offset:25088
    v_mfma_f32_16x16x32_bf16 v[64:67], a[156:159], a[96:99], v[64:67]
    s_add_u32 s60, s70, 294912
    ds_read_b128 a[32:35], v17 offset:0
    v_mfma_f32_16x16x32_bf16 v[64:67], a[148:151], a[64:67], v[64:67]
    ds_read_b128 a[36:39], v17 offset:2048
    v_mfma_f32_16x16x32_bf16 v[164:167], a[144:147], a[68:71], v[164:167]
    ds_read_b128 a[40:43], v17 offset:4096
    v_mfma_f32_16x16x32_bf16 v[164:167], a[152:155], a[100:103], v[164:167]
    buffer_load_dwordx4 v8, s[36:39], s60 offen offset:0 lds
    v_mfma_f32_16x16x32_bf16 v[164:167], a[128:131], a[4:7], v[164:167]
    ds_read_b128 a[44:47], v17 offset:6144
    v_mfma_f32_16x16x32_bf16 v[68:71], a[132:135], a[4:7], v[68:71]
    ds_read_b128 a[48:51], v17 offset:8192
    v_mfma_f32_16x16x32_bf16 v[68:71], a[156:159], a[100:103], v[68:71]
    ds_read_b128 a[52:55], v17 offset:10240
    v_mfma_f32_16x16x32_bf16 v[68:71], a[148:151], a[68:71], v[68:71]
    ds_read_b128 a[56:59], v17 offset:12288
    v_mfma_f32_16x16x32_bf16 v[168:171], a[144:147], a[72:75], v[168:171]
    s_nop 0
    ds_read_b128 a[60:63], v17 offset:14336
    ds_read_b64_tr_b16 a[168:169], v12 offset:26624
    v_mfma_f32_16x16x32_bf16 v[168:171], a[152:155], a[104:107], v[168:171]
    s_nop 0
    ds_read_b64_tr_b16 a[170:171], v12 offset:27136
    ds_read_b64_tr_b16 a[172:173], v13 offset:26624
    v_mfma_f32_16x16x32_bf16 v[168:171], a[128:131], a[8:11], v[168:171]
    s_mov_b32 s89, 0x12345
    ds_read_b64_tr_b16 a[174:175], v13 offset:27136
    ds_read_b64_tr_b16 a[200:201], v12 offset:28672
    v_mfma_f32_16x16x32_bf16 v[72:75], a[132:135], a[8:11], v[72:75]
    s_mov_b32 s89, 0x12345
    ds_read_b64_tr_b16 a[202:203], v12 offset:29184
    ds_read_b64_tr_b16 a[204:205], v13 offset:28672
    v_mfma_f32_16x16x32_bf16 v[72:75], a[156:159], a[104:107], v[72:75]
    buffer_load_dwordx4 v9, s[36:39], s60 offen offset:1024 lds
    v_mfma_f32_16x16x32_bf16 v[72:75], a[148:151], a[72:75], v[72:75]
    s_waitcnt lgkmcnt(4)
    ds_read_b64_tr_b16 a[206:207], v13 offset:29184
    v_mfma_f32_16x16x32_bf16 v[160:163], a[136:139], a[32:35], v[160:163]
    s_nop 0
    v_mfma_f32_16x16x32_bf16 v[64:67], a[140:143], a[32:35], v[64:67]
    v_mfma_f32_16x16x32_bf16 v[164:167], a[136:139], a[36:39], v[164:167]
    buffer_load_dwordx4 v10, s[36:39], s60 offen offset:2048 lds
    v_mfma_f32_16x16x32_bf16 v[68:71], a[140:143], a[36:39], v[68:71]
    s_waitcnt lgkmcnt(0)
    s_barrier
    v_mfma_f32_16x16x32_bf16 v[168:171], a[136:139], a[40:43], v[168:171]
    v_mfma_f32_16x16x32_bf16 v[72:75], a[140:143], a[40:43], v[72:75]
    v_mul_f32 v160, v160, |v160|
    v_mul_f32 v161, v161, |v161|
    v_mfma_f32_16x16x32_bf16 v[172:175], a[144:147], a[76:79], v[172:175]
    buffer_load_dwordx4 v11, s[36:39], s60 offen offset:3072 lds
    v_mfma_f32_16x16x32_bf16 v[172:175], a[152:155], a[108:111], v[172:175]
    s_add_u32 m0, s65, 98304
    s_add_u32 s60, s71, 0
    v_mul_f32 v162, v162, |v162|
    v_mfma_f32_16x16x32_bf16 v[172:175], a[128:131], a[12:15], v[172:175]
    s_nop 0
    v_mul_f32 v163, v163, |v163|
    v_mul_f32 v64, v64, |v64|
    v_mfma_f32_16x16x32_bf16 v[172:175], a[136:139], a[44:47], v[172:175]
    v_mul_f32 v65, v65, |v65|
L_ffn_pad3:
    s_cbranch_execz L_ffn_ret0
    v_mul_f32 v66, v66, |v66|
    v_mfma_f32_16x16x32_bf16 v[76:79], a[140:143], a[44:47], v[76:79]
    buffer_load_dwordx4 v8, s[36:39], s60 offen offset:0 lds
    s_nop 0
    v_mfma_f32_16x16x32_bf16 v[76:79], a[132:135], a[12:15], v[76:79]
    v_mul_f32 v67, v67, |v67|
    v_cvt_pk_bf16_f32 v160, v160, v161
    v_mfma_f32_16x16x32_bf16 v[76:79], a[156:159], a[108:111], v[76:79]
    v_cvt_pk_bf16_f32 v161, v162, v163
    v_cvt_pk_bf16_f32 v162, v64, v65
    v_mfma_f32_16x16x32_bf16 v[76:79], a[148:151], a[76:79], v[76:79]
    v_cvt_pk_bf16_f32 v163, v66, v67
    v_pk_max_i16 v160, v160, 0
    v_mfma_f32_16x16x32_bf16 v[176:179], a[144:147], a[80:83], v[176:179]
    buffer_load_dwordx4 v9, s[36:39], s60 offen offset:1024 lds
    v_mfma_f32_16x16x32_bf16 v[176:179], a[152:155], a[112:115], v[176:179]
    v_pk_max_i16 v161, v161, 0
    v_pk_max_i16 v162, v162, 0
    v_mfma_f32_16x16x32_bf16 v[176:179], a[128:131], a[16:19], v[176:179]
    v_pk_max_i16 v163, v163, 0
    v_mul_f32 v164, v164, |v164|
    v_mfma_f32_16x16x32_bf16 v[176:179], a[136:139], a[48:51], v[176:179]
    ds_write_b128 v18, v[160:163] offset:0
    v_mul_f32 v165, v165, |v165|
    v_mul_f32 v166, v166, |v166|
    v_mfma_f32_16x16x32_bf16 v[80:83], a[140:143], a[48:51], v[80:83]
    buffer_load_dwordx4 v10, s[36:39], s60 offen offset:2048 lds
    v_mul_f32 v167, v167, |v167|
    v_mfma_f32_16x16x32_bf16 v[80:83], a[132:135], a[16:19], v[80:83]
    v_mul_f32 v68, v68, |v68|
    v_mul_f32 v69, v69, |v69|
    v_mfma_f32_16x16x32_bf16 v[80:83], a[156:159], a[112:115], v[80:83]
    v_mul_f32 v70, v70, |v70|
    v_mul_f32 v71, v71, |v71|
    v_mfma_f32_16x16x32_bf16 v[80:83], a[148:151], a[80:83], v[80:83]
    v_cvt_pk_bf16_f32 v164, v164, v165
    v_cvt_pk_bf16_f32 v165, v166, v167
    v_mfma_f32_16x16x32_bf16 v[180:183], a[144:147], a[84:87], v[180:183]
    buffer_load_dwordx4 v11, s[36:39], s60 offen offset:3072 lds
    v_cvt_pk_bf16_f32 v166, v68, v69
    v_mfma_f32_16x16x32_bf16 v[180:183], a[152:155], a[116:119], v[180:183]
    v_cvt_pk_bf16_f32 v167, v70, v71
    v_pk_max_i16 v164, v164, 0
    v_mfma_f32_16x16x32_bf16 v[180:183], a[128:131], a[20:23], v[180:183]
    v_pk_max_i16 v165, v165, 0
    v_pk_max_i16 v166, v166, 0
    v_mfma_f32_16x16x32_bf16 v[180:183], a[136:139], a[52:55], v[180:183]
    v_pk_max_i16 v167, v167, 0
    v_mul_f32 v168, v168, |v168|
    v_mfma_f32_16x16x32_bf16 v[84:87], a[140:143], a[52:55], v[84:87]
    ds_write_b128 v18, v[164:167] offset:1024
    v_mul_f32 v169, v169, |v169|
    v_mfma_f32_16x16x32_bf16 v[84:87], a[132:135], a[20:23], v[84:87]
    v_mul_f32 v170, v170, |v170|
    v_mul_f32 v171, v171, |v171|
    v_mfma_f32_16x16x32_bf16 v[84:87], a[156:159], a[116:119], v[84:87]
    v_mul_f32 v72, v72, |v72|
    v_mul_f32 v73, v73, |v73|
    v_mfma_f32_16x16x32_bf16 v[84:87], a[148:151], a[84:87], v[84:87]
    v_mul_f32 v74, v74, |v74|
    v_mul_f32 v75, v75, |v75|
    v_mfma_f32_16x16x32_bf16 v[184:187], a[144:147], a[88:91], v[184:187]
    v_cvt_pk_bf16_f32 v168, v168, v169
    v_cvt_pk_bf16_f32 v169, v170, v171
    v_mfma_f32_16x16x32_bf16 v[184:187], a[152:155], a[120:123], v[184:187]
    v_cvt_pk_bf16_f32 v170, v72, v73
    v_cvt_pk_bf16_f32 v171, v74, v75
    v_mfma_f32_16x16x32_bf16 v[184:187], a[128:131], a[24:27], v[184:187]
    v_pk_max_i16 v168, v168, 0
    v_pk_max_i16 v169, v169, 0
    v_mfma_f32_16x16x32_bf16 v[184:187], a[136:139], a[56:59], v[184:187]
    v_pk_max_i16 v170, v170, 0
    v_pk_max_i16 v171, v171, 0
    v_mfma_f32_16x16x32_bf16 v[88:91], a[140:143], a[56:59], v[88:91]
    v_mul_f32 v172, v172, |v172|
    v_mul_f32 v173, v173, |v173|
    v_mfma_f32_16x16x32_bf16 v[88:91], a[132:135], a[24:27], v[88:91]
    ds_write_b128 v18, v[168:171] offset:2048
    v_mfma_f32_16x16x32_bf16 v[88:91], a[156:159], a[120:123], v[88:91]
    v_mul_f32 v174, v174, |v174|
    v_mul_f32 v175, v175, |v175|
    v_mfma_f32_16x16x32_bf16 v[88:91], a[148:151], a[88:91], v[88:91]
    v_mul_f32 v76, v76, |v76|
    v_mul_f32 v77, v77, |v77|
    v_mfma_f32_16x16x32_bf16 v[188:191], a[144:147], a[92:95], v[188:191]
    v_mul_f32 v78, v78, |v78|
    v_mul_f32 v79, v79, |v79|
    v_mfma_f32_16x16x32_bf16 v[188:191], a[152:155], a[124:127], v[188:191]
    v_cvt_pk_bf16_f32 v172, v172, v173
    v_cvt_pk_bf16_f32 v173, v174, v175
    v_mfma_f32_16x16x32_bf16 v[188:191], a[128:131], a[28:31], v[188:191]
    v_cvt_pk_bf16_f32 v174, v76, v77
    v_cvt_pk_bf16_f32 v175, v78, v79
    v_mfma_f32_16x16x32_bf16 v[188:191], a[136:139], a[60:63], v[188:191]
    v_pk_max_i16 v172, v172, 0
    v_pk_max_i16 v173, v173, 0
    v_mfma_f32_16x16x32_bf16 v[92:95], a[140:143], a[60:63], v[92:95]
    v_pk_max_i16 v174, v174, 0
    v_pk_max_i16 v175, v175, 0
    v_mfma_f32_16x16x32_bf16 v[92:95], a[132:135], a[28:31], v[92:95]
    v_mul_f32 v176, v176, |v176|
    v_mul_f32 v177, v177, |v177|
    v_mfma_f32_16x16x32_bf16 v[92:95], a[156:159], a[124:127], v[92:95]
    v_mul_f32 v178, v178, |v178|
    v_mul_f32 v179, v179, |v179|
    v_mfma_f32_16x16x32_bf16 v[92:95], a[148:151], a[92:95], v[92:95]
    ds_write_b128 v18, v[172:175] offset:3072
    v_mfma_f32_16x16x32_bf16 v[192:195], a[176:179], a[64:67], v[192:195]
    v_mul_f32 v80, v80, |v80|
    v_mul_f32 v81, v81, |v81|
    v_mfma_f32_16x16x32_bf16 v[192:195], a[184:187], a[96:99], v[192:195]
    v_mul_f32 v82, v82, |v82|
    v_mul_f32 v83, v83, |v83|
    v_mfma_f32_16x16x32_bf16 v[192:195], a[160:163], a[0:3], v[192:195]
    v_cvt_pk_bf16_f32 v176, v176, v177
    v_cvt_pk_bf16_f32 v177, v178, v179
    v_mfma_f32_16x16x32_bf16 v[192:195], a[168:171], a[32:35], v[192:195]
    v_cvt_pk_bf16_f32 v178, v80, v81
    v_cvt_pk_bf16_f32 v179, v82, v83
    v_mfma_f32_16x16x32_bf16 v[96:99], a[172:175], a[32:35], v[96:99]
    v_pk_max_i16 v176, v176, 0
    v_pk_max_i16 v177, v177, 0
    v_mfma_f32_16x16x32_bf16 v[96:99], a[164:167], a[0:3], v[96:99]
    v_pk_max_i16 v178, v178, 0
    v_pk_max_i16 v179, v179, 0
    v_mfma_f32_16x16x32_bf16 v[96:99], a[188:191], a[96:99], v[96:99]
    v_mul_f32 v180, v180, |v180|
    v_mul_f32 v181, v181, |v181|
    v_mfma_f32_16x16x32_bf16 v[96:99], a[180:183], a[64:67], v[96:99]
    v_mul_f32 v182, v182, |v182|
    v_mul_f32 v183, v183, |v183|
    v_mfma_f32_16x16x32_bf16 v[196:199], a[176:179], a[68:71], v[196:199]
    ds_write_b128 v18, v[176:179] offset:4096
    v_mfma_f32_16x16x32_bf16 v[196:199], a[184:187], a[100:103], v[196:199]
    v_mul_f32 v84, v84, |v84|
    v_mul_f32 v85, v85, |v85|
    v_mfma_f32_16x16x32_bf16 v[196:199], a[160:163], a[4:7], v[196:199]
    v_mul_f32 v86, v86, |v86|
    v_mul_f32 v87, v87, |v87|
    v_mfma_f32_16x16x32_bf16 v[196:199], a[168:171], a[36:39], v[196:199]
    v_cvt_pk_bf16_f32 v180, v180, v181
    v_cvt_pk_bf16_f32 v181, v182, v183
    v_mfma_f32_16x16x32_bf16 v[100:103], a[172:175], a[36:39], v[100:103]
    v_cvt_pk_bf16_f32 v182, v84, v85
    v_cvt_pk_bf16_f32 v183, v86, v87
    v_mfma_f32_16x16x32_bf16 v[100:103], a[164:167], a[4:7], v[100:103]
    v_pk_max_i16 v180, v180, 0
    v_pk_max_i16 v181, v181, 0
    v_mfma_f32_16x16x32_bf16 v[100:103], a[188:191], a[100:103], v[100:103]
    v_pk_max_i16 v182, v182, 0
    v_pk_max_i16 v183, v183, 0
    v_mfma_f32_16x16x32_bf16 v[100:103], a[180:183], a[68:71], v[100:103]
    v_mul_f32 v184, v184, |v184|
    v_mul_f32 v185, v185, |v185|
    v_mfma_f32_16x16x32_bf16 v[200:203], a[176:179], a[72:75], v[200:203]
    v_mul_f32 v186, v186, |v186|
    v_mul_f32 v187, v187, |v187|
    v_mfma_f32_16x16x32_bf16 v[200:203], a[184:187], a[104:107], v[200:203]
    ds_write_b128 v18, v[180:183] offset:5120
    v_mfma_f32_16x16x32_bf16 v[200:203], a[160:163], a[8:11], v[200:203]
    v_mul_f32 v88, v88, |v88|
    v_mul_f32 v89, v89, |v89|
    v_mfma_f32_16x16x32_bf16 v[200:203], a[168:171], a[40:43], v[200:203]
    v_mul_f32 v90, v90, |v90|
    v_mul_f32 v91, v91, |v91|
    v_mfma_f32_16x16x32_bf16 v[104:107], a[172:175], a[40:43], v[104:107]
    v_cvt_pk_bf16_f32 v184, v184, v185
    v_cvt_pk_bf16_f32 v185, v186, v187
    v_mfma_f32_16x16x32_bf16 v[104:107], a[164:167], a[8:11], v[104:107]
    v_cvt_pk_bf16_f32 v186, v88, v89
    v_cvt_pk_bf16_f32 v187, v90, v91
    v_mfma_f32_16x16x32_bf16 v[104:107], a[188:191], a[104:107], v[104:107]
    v_pk_max_i16 v184, v184, 0
    v_pk_max_i16 v185, v185, 0
    v_mfma_f32_16x16x32_bf16 v[104:107], a[180:183], a[72:75], v[104:107]
    v_pk_max_i16 v186, v186, 0
    v_pk_max_i16 v187, v187, 0
    v_mfma_f32_16x16x32_bf16 v[204:207], a[176:179], a[76:79], v[204:207]
    v_mul_f32 v188, v188, |v188|
    v_mul_f32 v189, v189, |v189|
    v_mfma_f32_16x16x32_bf16 v[204:207], a[184:187], a[108:111], v[204:207]
    v_mul_f32 v190, v190, |v190|
    v_mul_f32 v191, v191, |v191|
    v_mfma_f32_16x16x32_bf16 v[204:207], a[160:163], a[12:15], v[204:207]
    ds_write_b128 v18, v[184:187] offset:6144
    v_mfma_f32_16x16x32_bf16 v[204:207], a[168:171], a[44:47], v[204:207]
    v_mul_f32 v92, v92, |v92|
    v_mul_f32 v93, v93, |v93|
    v_mfma_f32_16x16x32_bf16 v[108:111], a[172:175], a[44:47], v[108:111]
    v_mul_f32 v94, v94, |v94|
    v_mul_f32 v95, v95, |v95|
    v_mfma_f32_16x16x32_bf16 v[108:111], a[164:167], a[12:15], v[108:111]
    v_cvt_pk_bf16_f32 v188, v188, v189
    v_cvt_pk_bf16_f32 v189, v190, v191
    v_mfma_f32_16x16x32_bf16 v[108:111], a[188:191], a[108:111], v[108:111]
    v_cvt_pk_bf16_f32 v190, v92, v93
    v_cvt_pk_bf16_f32 v191, v94, v95
    v_mfma_f32_16x16x32_bf16 v[108:111], a[180:183], a[76:79], v[108:111]
    v_pk_max_i16 v188, v188, 0
    v_pk_max_i16 v189, v189, 0
    v_mfma_f32_16x16x32_bf16 v[208:211], a[176:179], a[80:83], v[208:211]
    v_pk_max_i16 v190, v190, 0
    v_pk_max_i16 v191, v191, 0
    v_mfma_f32_16x16x32_bf16 v[208:211], a[184:187], a[112:115], v[208:211]
    v_mul_f32 v192, v192, |v192|
    v_mul_f32 v193, v193, |v193|
    v_mfma_f32_16x16x32_bf16 v[208:211], a[160:163], a[16:19], v[208:211]
    v_mul_f32 v194, v194, |v194|
    v_mul_f32 v195, v195, |v195|
    v_mfma_f32_16x16x32_bf16 v[208:211], a[168:171], a[48:51], v[208:211]
    v_mul_f32 v96, v96, |v96|
    v_mul_f32 v97, v97, |v97|
    v_mfma_f32_16x16x32_bf16 v[112:115], a[172:175], a[48:51], v[112:115]
    ds_write_b128 v18, v[188:191] offset:7168
    v_mfma_f32_16x16x32_bf16 v[112:115], a[164:167], a[16:19], v[112:115]
    v_mul_f32 v98, v98, |v98|
    v_mul_f32 v99, v99, |v99|
    v_mfma_f32_16x16x32_bf16 v[112:115], a[188:191], a[112:115], v[112:115]
    v_cvt_pk_bf16_f32 v192, v192, v193
    v_cvt_pk_bf16_f32 v193, v194, v195
    v_mfma_f32_16x16x32_bf16 v[112:115], a[180:183], a[80:83], v[112:115]
    v_cvt_pk_bf16_f32 v194, v96, v97
    v_cvt_pk_bf16_f32 v195, v98, v99
    v_mfma_f32_16x16x32_bf16 v[212:215], a[176:179], a[84:87], v[212:215]
    s_waitcnt lgkmcnt(0)
    s_waitcnt vmcnt(12)
    s_barrier
    v_mfma_f32_16x16x32_bf16 v[212:215], a[184:187], a[116:119], v[212:215]
    s_nop 0
    ds_read_b128 a[224:227], v32 offset:0
    v_pk_max_i16 v192, v192, 0
    v_mfma_f32_16x16x32_bf16 v[212:215], a[160:163], a[20:23], v[212:215]
    s_load_dword s97, s[94:95], 0x0
    v_pk_max_i16 v193, v193, 0
    v_pk_max_i16 v194, v194, 0
    v_mfma_f32_16x16x32_bf16 v[212:215], a[168:171], a[52:55], v[212:215]
    ds_read_b128 a[228:231], v32 offset:1024
    v_pk_max_i16 v195, v195, 0
    v_mfma_f32_16x16x32_bf16 v[116:119], a[172:175], a[52:55], v[116:119]
    ds_write_b128 v18, v[192:195] offset:32768
    v_mul_f32 v196, v196, |v196|
    v_mul_f32 v197, v197, |v197|
    v_mfma_f32_16x16x32_bf16 v[116:119], a[164:167], a[20:23], v[116:119]
    v_mul_f32 v198, v198, |v198|
    v_mul_f32 v199, v199, |v199|
    v_mfma_f32_16x16x32_bf16 v[116:119], a[188:191], a[116:119], v[116:119]
    v_mul_f32 v100, v100, |v100|
    v_mul_f32 v101, v101, |v101|
    v_mfma_f32_16x16x32_bf16 v[116:119], a[180:183], a[84:87], v[116:119]
    ds_read_b128 a[232:235], v32 offset:2048
    v_mul_f32 v102, v102, |v102|
    v_mul_f32 v103, v103, |v103|
    v_mfma_f32_16x16x32_bf16 v[216:219], a[176:179], a[88:91], v[216:219]
    ds_read_b128 a[236:239], v32 offset:3072
    v_cvt_pk_bf16_f32 v196, v196, v197
    v_cvt_pk_bf16_f32 v197, v198, v199
    v_mfma_f32_16x16x32_bf16 v[216:219], a[184:187], a[120:123], v[216:219]
    v_cvt_pk_bf16_f32 v198, v100, v101
    v_cvt_pk_bf16_f32 v199, v102, v103
    v_mfma_f32_16x16x32_bf16 v[216:219], a[160:163], a[24:27], v[216:219]
    v_pk_max_i16 v196, v196, 0
    v_pk_max_i16 v197, v197, 0
    v_mfma_f32_16x16x32_bf16 v[216:219], a[168:171], a[56:59], v[216:219]
    ds_read_b128 a[240:243], v32 offset:4096
    v_pk_max_i16 v198, v198, 0
    v_mfma_f32_16x16x32_bf16 v[120:123], a[172:175], a[56:59], v[120:123]
    v_pk_max_i16 v199, v199, 0
    v_mul_f32 v200, v200, |v200|
    v_mfma_f32_16x16x32_bf16 v[120:123], a[164:167], a[24:27], v[120:123]
    ds_write_b128 v18, v[196:199] offset:33792
    v_mul_f32 v201, v201, |v201|
    v_mul_f32 v202, v202, |v202|
    v_mfma_f32_16x16x32_bf16 v[120:123], a[188:191], a[120:123], v[120:123]
    v_mul_f32 v203, v203, |v203|
    v_mul_f32 v104, v104, |v104|
    v_mfma_f32_16x16x32_bf16 v[120:123], a[180:183], a[88:91], v[120:123]
    v_mul_f32 v105, v105, |v105|
    v_mul_f32 v106, v106, |v106|
    v_mfma_f32_16x16x32_bf16 v[220:223], a[176:179], a[92:95], v[220:223]
    ds_read_b128 a[244:247], v32 offset:5120
    v_mul_f32 v107, v107, |v107|
    v_cvt_pk_bf16_f32 v200, v200, v201
    v_mfma_f32_16x16x32_bf16 v[220:223], a[184:187], a[124:127], v[220:223]
    ds_read_b128 a[248:251], v32 offset:6144
    v_cvt_pk_bf16_f32 v201, v202, v203
    v_cvt_pk_bf16_f32 v202, v104, v105
    v_mfma_f32_16x16x32_bf16 v[220:223], a[160:163], a[28:31], v[220:223]
    ds_read_b128 a[252:255], v32 offset:7168
    v_cvt_pk_bf16_f32 v203, v106, v107
    v_pk_max_i16 v200, v200, 0
    v_mfma_f32_16x16x32_bf16 v[220:223], a[168:171], a[60:63], v[220:223]
    v_pk_max_i16 v201, v201, 0
    v_pk_max_i16 v202, v202, 0
    v_mfma_f32_16x16x32_bf16 v[124:127], a[172:175], a[60:63], v[124:127]
    v_pk_max_i16 v203, v203, 0
    v_mul_f32 v204, v204, |v204|
    v_mfma_f32_16x16x32_bf16 v[124:127], a[164:167], a[28:31], v[124:127]
    ds_write_b128 v18, v[200:203] offset:34816
    v_mul_f32 v205, v205, |v205|
    v_mfma_f32_16x16x32_bf16 v[124:127], a[188:191], a[124:127], v[124:127]
    v_mul_f32 v206, v206, |v206|
    v_mul_f32 v207, v207, |v207|
    v_mfma_f32_16x16x32_bf16 v[124:127], a[180:183], a[92:95], v[124:127]
    v_mul_f32 v108, v108, |v108|
    v_mul_f32 v109, v109, |v109|
    v_mfma_f32_16x16x32_bf16 v[224:227], a[208:211], a[64:67], v[224:227]
    ds_read_b128 a[128:131], v34 offset:0
    v_mul_f32 v110, v110, |v110|
    v_mul_f32 v111, v111, |v111|
    v_mfma_f32_16x16x32_bf16 v[224:227], a[216:219], a[96:99], v[224:227]
    ds_read_b128 a[160:163], v36 offset:0
    v_cvt_pk_bf16_f32 v204, v204, v205
    v_cvt_pk_bf16_f32 v205, v206, v207
    v_mfma_f32_16x16x32_bf16 v[224:227], a[192:195], a[0:3], v[224:227]
    ds_read_b128 a[164:167], v36 offset:1024
    v_cvt_pk_bf16_f32 v206, v108, v109
    v_cvt_pk_bf16_f32 v207, v110, v111
    v_mfma_f32_16x16x32_bf16 v[224:227], a[200:203], a[32:35], v[224:227]
    v_pk_max_i16 v204, v204, 0
    v_pk_max_i16 v205, v205, 0
    v_mfma_f32_16x16x32_bf16 v[128:131], a[204:207], a[32:35], v[128:131]
    ds_read_b128 a[132:135], v34 offset:1024
    v_pk_max_i16 v206, v206, 0
    v_mfma_f32_16x16x32_bf16 v[128:131], a[196:199], a[0:3], v[128:131]
    v_pk_max_i16 v207, v207, 0
    v_mul_f32 v208, v208, |v208|
    v_mfma_f32_16x16x32_bf16 v[128:131], a[220:223], a[96:99], v[128:131]
    ds_write_b128 v18, v[204:207] offset:35840
    v_mul_f32 v209, v209, |v209|
    v_mul_f32 v210, v210, |v210|
    v_mfma_f32_16x16x32_bf16 v[128:131], a[212:215], a[64:67], v[128:131]
    v_mul_f32 v211, v211, |v211|
    v_mul_f32 v112, v112, |v112|
    v_mfma_f32_16x16x32_bf16 v[228:231], a[208:211], a[68:71], v[228:231]
    v_mul_f32 v113, v113, |v113|
    v_mul_f32 v114, v114, |v114|
    v_mfma_f32_16x16x32_bf16 v[228:231], a[216:219], a[100:103], v[228:231]
    ds_read_b128 a[136:139], v34 offset:2048
    v_mul_f32 v115, v115, |v115|
    v_cvt_pk_bf16_f32 v208, v208, v209
    v_mfma_f32_16x16x32_bf16 v[228:231], a[192:195], a[4:7], v[228:231]
    ds_read_b128 a[168:171], v36 offset:2048
    v_cvt_pk_bf16_f32 v209, v210, v211
    v_cvt_pk_bf16_f32 v210, v112, v113
    v_mfma_f32_16x16x32_bf16 v[228:231], a[200:203], a[36:39], v[228:231]
    v_cvt_pk_bf16_f32 v211, v114, v115
    v_pk_max_i16 v208, v208, 0
    v_mfma_f32_16x16x32_bf16 v[132:135], a[204:207], a[36:39], v[132:135]
    ds_read_b128 a[172:175], v36 offset:3072
    v_pk_max_i16 v209, v209, 0
    v_pk_max_i16 v210, v210, 0
    v_mfma_f32_16x16x32_bf16 v[132:135], a[196:199], a[4:7], v[132:135]
    v_pk_max_i16 v211, v211, 0
    v_mul_f32 v212, v212, |v212|
    v_mfma_f32_16x16x32_bf16 v[132:135], a[220:223], a[100:103], v[132:135]
    ds_write_b128 v18, v[208:211] offset:36864
    v_mul_f32 v213, v213, |v213|
    v_mfma_f32_16x16x32_bf16 v[132:135], a[212:215], a[68:71], v[132:135]
    v_mul_f32 v214, v214, |v214|
    v_mul_f32 v215, v215, |v215|
    v_mfma_f32_16x16x32_bf16 v[232:235], a[208:211], a[72:75], v[232:235]
    v_mul_f32 v116, v116, |v116|
    v_mul_f32 v117, v117, |v117|
    v_mfma_f32_16x16x32_bf16 v[232:235], a[216:219], a[104:107], v[232:235]
    ds_read_b128 a[140:143], v34 offset:3072
    v_mul_f32 v118, v118, |v118|
    v_mul_f32 v119, v119, |v119|
    v_mfma_f32_16x16x32_bf16 v[232:235], a[192:195], a[8:11], v[232:235]
    ds_read_b128 a[144:147], v34 offset:4096
    v_cvt_pk_bf16_f32 v212, v212, v213
    v_cvt_pk_bf16_f32 v213, v214, v215
    v_mfma_f32_16x16x32_bf16 v[232:235], a[200:203], a[40:43], v[232:235]
    ds_read_b128 a[176:179], v36 offset:4096
    v_cvt_pk_bf16_f32 v214, v116, v117
    v_cvt_pk_bf16_f32 v215, v118, v119
    v_mfma_f32_16x16x32_bf16 v[136:139], a[204:207], a[40:43], v[136:139]
    v_pk_max_i16 v212, v212, 0
    v_pk_max_i16 v213, v213, 0
    v_mfma_f32_16x16x32_bf16 v[136:139], a[196:199], a[8:11], v[136:139]
    v_pk_max_i16 v214, v214, 0
    v_pk_max_i16 v215, v215, 0
    v_mfma_f32_16x16x32_bf16 v[136:139], a[220:223], a[104:107], v[136:139]
    ds_read_b128 a[180:183], v36 offset:5120
    v_mul_f32 v216, v216, |v216|
    v_mfma_f32_16x16x32_bf16 v[136:139], a[212:215], a[72:75], v[136:139]
    ds_write_b128 v18, v[212:215] offset:37888
    v_mul_f32 v217, v217, |v217|
    v_mul_f32 v218, v218, |v218|
    v_mfma_f32_16x16x32_bf16 v[236:239], a[208:211], a[76:79], v[236:239]
    v_mul_f32 v219, v219, |v219|
    v_mul_f32 v120, v120, |v120|
    v_mfma_f32_16x16x32_bf16 v[236:239], a[216:219], a[108:111], v[236:239]
    v_mul_f32 v121, v121, |v121|
    v_mul_f32 v122, v122, |v122|
    v_mfma_f32_16x16x32_bf16 v[236:239], a[192:195], a[12:15], v[236:239]
    ds_read_b128 a[148:151], v34 offset:5120
    v_mul_f32 v123, v123, |v123|
    v_cvt_pk_bf16_f32 v216, v216, v217
    v_mfma_f32_16x16x32_bf16 v[236:239], a[200:203], a[44:47], v[236:239]
    ds_read_b128 a[152:155], v34 offset:6144
    v_cvt_pk_bf16_f32 v217, v218, v219
    v_cvt_pk_bf16_f32 v218, v120, v121
    v_mfma_f32_16x16x32_bf16 v[140:143], a[204:207], a[44:47], v[140:143]
    v_cvt_pk_bf16_f32 v219, v122, v123
    v_pk_max_i16 v216, v216, 0
    v_mfma_f32_16x16x32_bf16 v[140:143], a[196:199], a[12:15], v[140:143]
    ds_read_b128 a[184:187], v36 offset:6144
    v_pk_max_i16 v217, v217, 0
    v_pk_max_i16 v218, v218, 0
    v_mfma_f32_16x16x32_bf16 v[140:143], a[220:223], a[108:111], v[140:143]
    v_pk_max_i16 v219, v219, 0
    v_mul_f32 v220, v220, |v220|
    v_mfma_f32_16x16x32_bf16 v[140:143], a[212:215], a[76:79], v[140:143]
    ds_write_b128 v18, v[216:219] offset:38912
    v_mul_f32 v221, v221, |v221|
    v_mfma_f32_16x16x32_bf16 v[240:243], a[208:211], a[80:83], v[240:243]
    v_mul_f32 v222, v222, |v222|
    v_mul_f32 v223, v223, |v223|
    v_mfma_f32_16x16x32_bf16 v[240:243], a[216:219], a[112:115], v[240:243]
    v_mul_f32 v124, v124, |v124|
    v_mul_f32 v125, v125, |v125|
    v_mfma_f32_16x16x32_bf16 v[240:243], a[192:195], a[16:19], v[240:243]
    ds_read_b128 a[188:191], v36 offset:7168
    v_mul_f32 v126, v126, |v126|
    v_mul_f32 v127, v127, |v127|
    v_mfma_f32_16x16x32_bf16 v[240:243], a[200:203], a[48:51], v[240:243]
    ds_read_b128 a[156:159], v34 offset:7168
    v_cvt_pk_bf16_f32 v220, v220, v221
    v_cvt_pk_bf16_f32 v221, v222, v223
    v_mfma_f32_16x16x32_bf16 v[144:147], a[204:207], a[48:51], v[144:147]
    v_cvt_pk_bf16_f32 v222, v124, v125
    v_cvt_pk_bf16_f32 v223, v126, v127
    v_mfma_f32_16x16x32_bf16 v[144:147], a[196:199], a[16:19], v[144:147]
    v_pk_max_i16 v220, v220, 0
    v_pk_max_i16 v221, v221, 0
    v_mfma_f32_16x16x32_bf16 v[144:147], a[220:223], a[112:115], v[144:147]
    ds_read_b64_tr_b16 v[44:45], v21 offset:49152
    v_pk_max_i16 v222, v222, 0
    v_mfma_f32_16x16x32_bf16 v[144:147], a[212:215], a[80:83], v[144:147]
    v_pk_max_i16 v223, v223, 0
    v_mul_f32 v224, v224, |v224|
    v_mul_f32 v225, v225, |v225|
    v_mfma_f32_16x16x32_bf16 v[244:247], a[208:211], a[84:87], v[244:247]
    ds_write_b128 v18, v[220:223] offset:39936
    v_mul_f32 v226, v226, |v226|
    v_mul_f32 v227, v227, |v227|
    v_mfma_f32_16x16x32_bf16 v[244:247], a[216:219], a[116:119], v[244:247]
    v_mul_f32 v128, v128, |v128|
    v_mul_f32 v129, v129, |v129|
    v_mfma_f32_16x16x32_bf16 v[244:247], a[192:195], a[20:23], v[244:247]
    v_mul_f32 v130, v130, |v130|
    v_mul_f32 v131, v131, |v131|
    v_mfma_f32_16x16x32_bf16 v[244:247], a[200:203], a[52:55], v[244:247]
    ds_read_b64_tr_b16 v[46:47], v21 offset:51200
    v_cvt_pk_bf16_f32 v224, v224, v225
    v_cvt_pk_bf16_f32 v225, v226, v227
    v_mfma_f32_16x16x32_bf16 v[148:151], a[204:207], a[52:55], v[148:151]
    s_waitcnt lgkmcnt(0)
    s_andn2_b32 s89, 15, s97
    s_cbranch_scc1 L_ffn_spin0
L_ffn_spin0r:
    v_cvt_pk_bf16_f32 v226, v128, v129
    v_cvt_pk_bf16_f32 v227, v130, v131
    v_mfma_f32_16x16x32_bf16 v[148:151], a[196:199], a[20:23], v[148:151]
    s_barrier
    ds_read_b128 a[0:3], v32 offset:32768
    v_pk_max_i16 v224, v224, 0
    v_pk_max_i16 v225, v225, 0
    v_mfma_f32_16x16x32_bf16 v[148:151], a[220:223], a[116:119], v[148:151]
    s_lshr_b32 s85, s56, 1
    ds_read_b64_tr_b16 v[48:49], v2 offset:49152
    v_pk_max_i16 v226, v226, 0
    v_pk_max_i16 v227, v227, 0
    s_nop 0
    v_mul_f32 v228, v228, |v228|
    v_mfma_f32_16x16x32_bf16 v[148:151], a[212:215], a[84:87], v[148:151]
    ds_write_b128 v19, v[224:227] offset:0
    v_mul_f32 v229, v229, |v229|
    v_mul_f32 v230, v230, |v230|
    v_mfma_f32_16x16x32_bf16 v[248:251], a[208:211], a[88:91], v[248:251]
    s_mul_i32 s85, s85, 8192
    v_mul_f32 v231, v231, |v231|
    v_mul_f32 v132, v132, |v132|
    v_mfma_f32_16x16x32_bf16 v[248:251], a[216:219], a[120:123], v[248:251]
    v_mul_f32 v133, v133, |v133|
    v_mul_f32 v134, v134, |v134|
    v_mfma_f32_16x16x32_bf16 v[248:251], a[192:195], a[24:27], v[248:251]
    s_lshl_b32 s3, s56, 12
    ds_read_b64_tr_b16 v[50:51], v2 offset:51200
    ds_read_b128 a[4:7], v32 offset:33792
    s_nop 0
    v_mul_f32 v135, v135, |v135|
    v_cvt_pk_bf16_f32 v228, v228, v229
    v_mfma_f32_16x16x32_bf16 v[248:251], a[200:203], a[56:59], v[248:251]
    ds_read_b128 a[8:11], v32 offset:34816
    v_cvt_pk_bf16_f32 v229, v230, v231
    v_cvt_pk_bf16_f32 v230, v132, v133
    v_mfma_f32_16x16x32_bf16 v[152:155], a[204:207], a[56:59], v[152:155]
    s_add_u32 s3, s3, s85
    s_nop 0
    ds_read_b128 a[12:15], v32 offset:35840
    v_cvt_pk_bf16_f32 v231, v134, v135
    v_pk_max_i16 v228, v228, 0
    v_mfma_f32_16x16x32_bf16 v[152:155], a[196:199], a[24:27], v[152:155]
    s_nop 0
    v_pk_max_i16 v229, v229, 0
    v_pk_max_i16 v230, v230, 0
    v_mfma_f32_16x16x32_bf16 v[152:155], a[220:223], a[120:123], v[152:155]
    s_add_u32 s3, s3, s80
    ds_read_b64_tr_b16 v[52:53], v5 offset:49152
    v_pk_max_i16 v231, v231, 0
    v_mul_f32 v232, v232, |v232|
    v_mul_f32 v233, v233, |v233|
    v_mfma_f32_16x16x32_bf16 v[152:155], a[212:215], a[88:91], v[152:155]
    ds_write_b128 v19, v[228:231] offset:1024
    v_mul_f32 v234, v234, |v234|
    v_mul_f32 v235, v235, |v235|
    v_mfma_f32_16x16x32_bf16 v[252:255], a[208:211], a[92:95], v[252:255]
    s_bfe_u32 s85, s97, 0x10004
    v_mul_f32 v136, v136, |v136|
    v_mul_f32 v137, v137, |v137|
L_ffn_pad4:
    s_cbranch_execz L_ffn_ret0
    v_mfma_f32_16x16x32_bf16 v[252:255], a[216:219], a[124:127], v[252:255]
    s_nop 0
    v_mul_f32 v138, v138, |v138|
    v_mul_f32 v139, v139, |v139|
    v_mfma_f32_16x16x32_bf16 v[252:255], a[192:195], a[28:31], v[252:255]
    s_lshl_b32 s85, s85, 13
    ds_read_b64_tr_b16 v[54:55], v5 offset:51200
    ds_read_b128 a[16:19], v32 offset:36864
    s_nop 0
    v_cvt_pk_bf16_f32 v232, v232, v233
    v_cvt_pk_bf16_f32 v233, v234, v235
    v_mfma_f32_16x16x32_bf16 v[252:255], a[200:203], a[60:63], v[252:255]
    ds_read_b128 a[20:23], v32 offset:37888
    v_cvt_pk_bf16_f32 v234, v136, v137
    v_cvt_pk_bf16_f32 v235, v138, v139
    v_mfma_f32_16x16x32_bf16 v[156:159], a[204:207], a[60:63], v[156:159]
    s_add_u32 s79, s85, s80
    s_nop 0
    ds_read_b128 a[24:27], v32 offset:38912
    v_pk_max_i16 v232, v232, 0
    v_pk_max_i16 v233, v233, 0
    v_mfma_f32_16x16x32_bf16 v[156:159], a[196:199], a[28:31], v[156:159]
    v_pk_max_i16 v234, v234, 0
    v_pk_max_i16 v235, v235, 0
    v_mul_f32 v236, v236, |v236|
    v_mfma_f32_16x16x32_bf16 v[156:159], a[220:223], a[124:127], v[156:159]
    s_add_u32 s79, s79, 1572864
    ds_write_b128 v19, v[232:235] offset:2048
    v_mul_f32 v237, v237, |v237|
    v_mul_f32 v238, v238, |v238|
    v_mfma_f32_16x16x32_bf16 v[156:159], a[212:215], a[92:95], v[156:159]
    v_mul_f32 v239, v239, |v239|
    v_mul_f32 v140, v140, |v140|
    v_mfma_f32_16x16x32_bf16 v[64:67], v[44:47], v[160:163], 0
    s_add_u32 s85, s85, s3
    v_mul_f32 v141, v141, |v141|
    v_mul_f32 v142, v142, |v142|
    s_waitcnt lgkmcnt(2)
    v_mfma_f32_16x16x32_bf16 v[64:67], v[48:51], a[224:227], v[64:67]
    ds_read_b64_tr_b16 v[56:57], v27 offset:49152
    v_mul_f32 v143, v143, |v143|
    v_cvt_pk_bf16_f32 v236, v236, v237
    v_mfma_f32_16x16x32_bf16 v[68:71], v[48:51], a[228:231], 0
    s_add_u32 s0, s85, 0
    ds_read_b128 a[28:31], v32 offset:39936
    v_cvt_pk_bf16_f32 v237, v238, v239
    v_cvt_pk_bf16_f32 v238, v140, v141
    v_mfma_f32_16x16x32_bf16 v[68:71], v[44:47], v[164:167], v[68:71]
    s_nop 0
    ds_read_b64_tr_b16 v[58:59], v27 offset:51200
    ds_read_b128 a[32:35], v34 offset:32768
    v_cvt_pk_bf16_f32 v239, v142, v143
    v_pk_max_i16 v236, v236, 0
    v_mfma_f32_16x16x32_bf16 v[72:75], v[44:47], v[168:171], 0
    s_bfe_u32 s85, s97, 0x10005
    ds_read_b128 a[192:195], v36 offset:32768
    v_pk_max_i16 v237, v237, 0
    v_pk_max_i16 v238, v238, 0
    v_mfma_f32_16x16x32_bf16 v[72:75], v[48:51], a[232:235], v[72:75]
    v_pk_max_i16 v239, v239, 0
    v_mul_f32 v240, v240, |v240|
    v_mul_f32 v241, v241, |v241|
    v_mfma_f32_16x16x32_bf16 v[76:79], v[48:51], a[236:239], 0
    s_lshl_b32 s85, s85, 13
    s_nop 0
    ds_write_b128 v19, v[236:239] offset:3072
    v_mul_f32 v242, v242, |v242|
    v_mul_f32 v243, v243, |v243|
    v_mfma_f32_16x16x32_bf16 v[76:79], v[44:47], v[172:175], v[76:79]
    v_mul_f32 v144, v144, |v144|
    v_mul_f32 v145, v145, |v145|
    v_mfma_f32_16x16x32_bf16 v[80:83], v[44:47], v[176:179], 0
    s_waitcnt vmcnt(8)
    s_barrier
    s_add_u32 s85, s85, s3
    v_mul_f32 v146, v146, |v146|
    v_mul_f32 v147, v147, |v147|
    v_mfma_f32_16x16x32_bf16 v[80:83], v[48:51], a[240:243], v[80:83]
    s_nop 0
    ds_read_b64_tr_b16 v[60:61], v26 offset:0
    ds_read_b128 a[196:199], v36 offset:33792
    v_cvt_pk_bf16_f32 v240, v240, v241
    v_cvt_pk_bf16_f32 v241, v242, v243
    v_mfma_f32_16x16x32_bf16 v[84:87], v[48:51], a[244:247], 0
    s_add_u32 s1, s85, 2097152
    ds_read_b128 a[36:39], v34 offset:33792
    v_cvt_pk_bf16_f32 v242, v144, v145
    v_cvt_pk_bf16_f32 v243, v146, v147
    v_mfma_f32_16x16x32_bf16 v[84:87], v[44:47], v[180:183], v[84:87]
    ds_read_b64_tr_b16 v[62:63], v26 offset:2048
    v_pk_max_i16 v240, v240, 0
    v_pk_max_i16 v241, v241, 0
    v_mfma_f32_16x16x32_bf16 v[88:91], v[44:47], v[184:187], 0
    s_bfe_u32 s85, s97, 0x10006
    ds_read_b128 a[40:43], v34 offset:34816
    v_pk_max_i16 v242, v242, 0
    v_pk_max_i16 v243, v243, 0
    v_mul_f32 v244, v244, |v244|
    v_mfma_f32_16x16x32_bf16 v[88:91], v[48:51], a[248:251], v[88:91]
    ds_write_b128 v19, v[240:243] offset:4096
    v_mul_f32 v245, v245, |v245|
    v_mul_f32 v246, v246, |v246|
    v_mfma_f32_16x16x32_bf16 v[92:95], v[48:51], a[252:255], 0
    s_lshl_b32 s85, s85, 13
    v_mul_f32 v247, v247, |v247|
    v_mul_f32 v148, v148, |v148|
    v_mfma_f32_16x16x32_bf16 v[92:95], v[44:47], v[188:191], v[92:95]
    s_waitcnt lgkmcnt(9)
    v_mul_f32 v149, v149, |v149|
    v_mul_f32 v150, v150, |v150|
    v_mfma_f32_16x16x32_bf16 v[64:67], v[52:55], a[128:131], v[64:67]
    s_add_u32 s85, s85, s3
    s_nop 0
    ds_read_b128 a[200:203], v36 offset:34816
    v_mul_f32 v151, v151, |v151|
    v_cvt_pk_bf16_f32 v244, v244, v245
    v_mfma_f32_16x16x32_bf16 v[64:67], v[56:59], a[160:163], v[64:67]
    ds_read_b64_tr_b16 v[44:45], v3 offset:0
    v_cvt_pk_bf16_f32 v245, v246, v247
    v_cvt_pk_bf16_f32 v246, v148, v149
    v_mfma_f32_16x16x32_bf16 v[68:71], v[56:59], a[164:167], v[68:71]
    s_add_u32 s61, s85, 4194304
    ds_read_b128 a[204:207], v36 offset:35840
    v_cvt_pk_bf16_f32 v247, v150, v151
    v_pk_max_i16 v244, v244, 0
    v_mfma_f32_16x16x32_bf16 v[68:71], v[52:55], a[132:135], v[68:71]
    ds_read_b64_tr_b16 v[46:47], v3 offset:2048
    v_pk_max_i16 v245, v245, 0
    v_pk_max_i16 v246, v246, 0
    v_mfma_f32_16x16x32_bf16 v[72:75], v[52:55], a[136:139], v[72:75]
    s_bfe_u32 s85, s97, 0x10007
    ds_read_b128 a[44:47], v34 offset:35840
    v_pk_max_i16 v247, v247, 0
    v_mul_f32 v248, v248, |v248|
    v_mul_f32 v249, v249, |v249|
    v_mfma_f32_16x16x32_bf16 v[72:75], v[56:59], a[168:171], v[72:75]
    ds_write_b128 v19, v[244:247] offset:5120
    v_mul_f32 v250, v250, |v250|
    v_mul_f32 v251, v251, |v251|
    v_mfma_f32_16x16x32_bf16 v[76:79], v[56:59], a[172:175], v[76:79]
    s_lshl_b32 s85, s85, 13
    s_nop 0
    v_mul_f32 v152, v152, |v152|
    v_mul_f32 v153, v153, |v153|
    v_mfma_f32_16x16x32_bf16 v[76:79], v[52:55], a[140:143], v[76:79]
    v_mul_f32 v154, v154, |v154|
    v_mul_f32 v155, v155, |v155|
    v_mfma_f32_16x16x32_bf16 v[80:83], v[52:55], a[144:147], v[80:83]
    s_add_u32 s4, s85, s80
    ds_read_b128 a[48:51], v34 offset:36864
    s_nop 0
    v_cvt_pk_bf16_f32 v248, v248, v249
    v_cvt_pk_bf16_f32 v249, v250, v251
    v_mfma_f32_16x16x32_bf16 v[80:83], v[56:59], a[176:179], v[80:83]
    s_mov_b32 s89, 0x12345
    ds_read_b64_tr_b16 v[48:49], v6 offset:0
    ds_read_b128 a[208:211], v36 offset:36864
    v_cvt_pk_bf16_f32 v250, v152, v153
    v_cvt_pk_bf16_f32 v251, v154, v155
    v_mfma_f32_16x16x32_bf16 v[84:87], v[56:59], a[180:183], v[84:87]
    s_add_u32 s4, s4, 6291456
    ds_read_b128 a[212:215], v36 offset:37888
    v_pk_max_i16 v248, v248, 0
    v_pk_max_i16 v249, v249, 0
    v_mfma_f32_16x16x32_bf16 v[84:87], v[52:55], a[148:151], v[84:87]
    ds_read_b64_tr_b16 v[50:51], v6 offset:2048
    v_pk_max_i16 v250, v250, 0
    v_pk_max_i16 v251, v251, 0
    v_mul_f32 v252, v252, |v252|
    v_mfma_f32_16x16x32_bf16 v[88:91], v[52:55], a[152:155], v[88:91]
    s_add_u32 s85, s85, s3
    s_nop 0
    ds_write_b128 v19, v[248:251] offset:6144
    v_mul_f32 v253, v253, |v253|
    v_mul_f32 v254, v254, |v254|
    v_mfma_f32_16x16x32_bf16 v[88:91], v[56:59], a[184:187], v[88:91]
    v_mul_f32 v255, v255, |v255|
    v_mul_f32 v156, v156, |v156|
    v_mfma_f32_16x16x32_bf16 v[92:95], v[56:59], a[188:191], v[92:95]
    s_add_u32 s5, s85, 6815744
    v_mul_f32 v157, v157, |v157|
    v_mul_f32 v158, v158, |v158|
    v_mfma_f32_16x16x32_bf16 v[92:95], v[52:55], a[156:159], v[92:95]
    s_waitcnt lgkmcnt(8)
    s_nop 0
    ds_read_b128 a[52:55], v34 offset:37888
    v_mul_f32 v159, v159, |v159|
    v_cvt_pk_bf16_f32 v252, v252, v253
    v_mfma_f32_16x16x32_bf16 v[64:67], v[60:63], v[192:195], v[64:67]
    s_add_u32 s92, s26, s79
    s_addc_u32 s93, s27, 0
    ds_read_b128 a[56:59], v34 offset:38912
    v_cvt_pk_bf16_f32 v253, v254, v255
    v_cvt_pk_bf16_f32 v254, v156, v157
    v_mfma_f32_16x16x32_bf16 v[64:67], v[44:47], a[0:3], v[64:67]
    ds_read_b64_tr_b16 v[52:53], v30 offset:0
    v_cvt_pk_bf16_f32 v255, v158, v159
    v_pk_max_i16 v252, v252, 0
    v_mfma_f32_16x16x32_bf16 v[68:71], v[44:47], a[4:7], v[68:71]
    ds_read_b128 a[216:219], v36 offset:38912
    v_pk_max_i16 v253, v253, 0
    v_pk_max_i16 v254, v254, 0
    v_mfma_f32_16x16x32_bf16 v[68:71], v[60:63], v[196:199], v[68:71]
    ds_read_b64_tr_b16 v[54:55], v30 offset:2048
    v_pk_max_i16 v255, v255, 0
    v_mfma_f32_16x16x32_bf16 v[72:75], v[60:63], v[200:203], v[72:75]
    ds_write_b128 v19, v[252:255] offset:7168
    v_mfma_f32_16x16x32_bf16 v[72:75], v[44:47], a[8:11], v[72:75]
    v_mfma_f32_16x16x32_bf16 v[76:79], v[44:47], a[12:15], v[76:79]
    v_mfma_f32_16x16x32_bf16 v[76:79], v[60:63], v[204:207], v[76:79]
    s_nop 0
    ds_read_b128 a[220:223], v36 offset:39936
    v_mfma_f32_16x16x32_bf16 v[80:83], v[60:63], v[208:211], v[80:83]
    s_waitcnt lgkmcnt(1)
    s_waitcnt vmcnt(4)
    s_barrier
    ds_read_b128 a[60:63], v34 offset:39936
    v_mfma_f32_16x16x32_bf16 v[80:83], v[44:47], a[16:19], v[80:83]
    ds_read_b64_tr_b16 v[56:57], v26 offset:16384
    v_mfma_f32_16x16x32_bf16 v[84:87], v[44:47], a[20:23], v[84:87]
    s_nop 0
    ds_read_b128 a[64:67], v33 offset:0
    v_mfma_f32_16x16x32_bf16 v[84:87], v[60:63], v[212:215], v[84:87]
    s_nop 0
    ds_read_b64_tr_b16 v[58:59], v26 offset:18432
    v_mfma_f32_16x16x32_bf16 v[88:91], v[60:63], v[216:219], v[88:91]
    s_add_u32 m0, s65, 114688
    ds_read_b128 a[68:71], v33 offset:1024
    s_add_u32 s60, s71, 147456
    v_mfma_f32_16x16x32_bf16 v[88:91], v[44:47], a[24:27], v[88:91]
    buffer_load_dwordx4 v8, s[36:39], s60 offen offset:0 lds
    v_mfma_f32_16x16x32_bf16 v[92:95], v[44:47], a[28:31], v[92:95]
    ds_read_b128 a[72:75], v33 offset:2048
    v_mfma_f32_16x16x32_bf16 v[92:95], v[60:63], v[220:223], v[92:95]
    s_nop 0
    ds_read_b128 a[76:79], v33 offset:3072
    v_mfma_f32_16x16x32_bf16 v[64:67], v[48:51], a[32:35], v[64:67]
    s_nop 0
    ds_read_b128 a[80:83], v33 offset:4096
    v_mfma_f32_16x16x32_bf16 v[64:67], v[52:55], a[192:195], v[64:67]
    buffer_load_dwordx4 v9, s[36:39], s60 offen offset:1024 lds
    v_mfma_f32_16x16x32_bf16 v[68:71], v[52:55], a[196:199], v[68:71]
    ds_read_b64_tr_b16 v[60:61], v3 offset:16384
    v_mfma_f32_16x16x32_bf16 v[68:71], v[48:51], a[36:39], v[68:71]
    s_mov_b32 s89, 0x12345
    ds_read_b64_tr_b16 v[62:63], v3 offset:18432
    ds_read_b128 a[84:87], v33 offset:5120
    v_mfma_f32_16x16x32_bf16 v[72:75], v[48:51], a[40:43], v[72:75]
    ds_read_b128 a[88:91], v33 offset:6144
    v_mfma_f32_16x16x32_bf16 v[72:75], v[52:55], a[200:203], v[72:75]
    buffer_load_dwordx4 v10, s[36:39], s60 offen offset:2048 lds
    v_mfma_f32_16x16x32_bf16 v[76:79], v[52:55], a[204:207], v[76:79]
    ds_read_b128 a[92:95], v33 offset:7168
    v_mfma_f32_16x16x32_bf16 v[76:79], v[48:51], a[44:47], v[76:79]
    ds_read_b128 a[96:99], v35 offset:0
    v_mfma_f32_16x16x32_bf16 v[80:83], v[48:51], a[48:51], v[80:83]
    ds_read_b128 v[128:131], v37 offset:0
    v_mfma_f32_16x16x32_bf16 v[80:83], v[52:55], a[208:211], v[80:83]
    buffer_load_dwordx4 v11, s[36:39], s60 offen offset:3072 lds
    v_mfma_f32_16x16x32_bf16 v[84:87], v[52:55], a[212:215], v[84:87]
    ds_read_b64_tr_b16 v[44:45], v6 offset:16384
    v_mfma_f32_16x16x32_bf16 v[84:87], v[48:51], a[52:55], v[84:87]
    s_nop 0
    ds_read_b64_tr_b16 v[46:47], v6 offset:18432
    ds_read_b128 v[132:135], v37 offset:1024
    v_mfma_f32_16x16x32_bf16 v[88:91], v[48:51], a[56:59], v[88:91]
    s_add_u32 m0, s65, 0
    ds_read_b128 a[100:103], v35 offset:1024
    s_add_u32 s60, s71, 294912
    v_mfma_f32_16x16x32_bf16 v[88:91], v[52:55], a[216:219], v[88:91]
    buffer_load_dwordx4 v8, s[36:39], s60 offen offset:0 lds
    s_waitcnt lgkmcnt(3)
    v_mfma_f32_16x16x32_bf16 v[92:95], v[52:55], a[220:223], v[92:95]
    ds_read_b128 a[104:107], v35 offset:2048
    v_mfma_f32_16x16x32_bf16 v[92:95], v[48:51], a[60:63], v[92:95]
    s_nop 0
    ds_read_b128 v[136:139], v37 offset:2048
    v_mfma_f32_16x16x32_bf16 v[64:67], v[56:59], v[224:227], v[64:67]
    ds_read_b128 v[140:143], v37 offset:3072
    v_mfma_f32_16x16x32_bf16 v[64:67], v[60:63], a[64:67], v[64:67]
    buffer_load_dwordx4 v9, s[36:39], s60 offen offset:1024 lds
    v_mfma_f32_16x16x32_bf16 v[68:71], v[60:63], a[68:71], v[68:71]
    ds_read_b64_tr_b16 v[48:49], v30 offset:16384
    v_mfma_f32_16x16x32_bf16 v[68:71], v[56:59], v[228:231], v[68:71]
    s_mov_b32 s89, 0x12345
    ds_read_b64_tr_b16 v[50:51], v30 offset:18432
    ds_read_b128 a[108:111], v35 offset:3072
    v_mfma_f32_16x16x32_bf16 v[72:75], v[56:59], v[232:235], v[72:75]
    ds_read_b128 a[112:115], v35 offset:4096
    v_mfma_f32_16x16x32_bf16 v[72:75], v[60:63], a[72:75], v[72:75]
    buffer_load_dwordx4 v10, s[36:39], s60 offen offset:2048 lds
    v_mfma_f32_16x16x32_bf16 v[76:79], v[60:63], a[76:79], v[76:79]
    ds_read_b128 v[144:147], v37 offset:4096
    v_mfma_f32_16x16x32_bf16 v[76:79], v[56:59], v[236:239], v[76:79]
    ds_read_b128 v[148:151], v37 offset:5120
    v_mfma_f32_16x16x32_bf16 v[80:83], v[56:59], v[240:243], v[80:83]
    s_waitcnt vmcnt(7)
    s_barrier
    ds_read_b128 a[116:119], v35 offset:5120
    v_mfma_f32_16x16x32_bf16 v[80:83], v[60:63], a[80:83], v[80:83]
    buffer_load_dwordx4 v11, s[36:39], s60 offen offset:3072 lds
    v_mfma_f32_16x16x32_bf16 v[84:87], v[60:63], a[84:87], v[84:87]
    ds_read_b64_tr_b16 v[52:53], v21 offset:32768
    v_mfma_f32_16x16x32_bf16 v[84:87], v[56:59], v[244:247], v[84:87]
    s_mov_b32 s89, 0x12345
    ds_read_b64_tr_b16 v[54:55], v21 offset:34816
    ds_read_b128 a[120:123], v35 offset:6144
    v_mfma_f32_16x16x32_bf16 v[88:91], v[56:59], v[248:251], v[88:91]
    s_add_u32 m0, s65, 16384
    ds_read_b128 v[152:155], v37 offset:6144
    s_add_u32 s60, s72, 0
    v_mfma_f32_16x16x32_bf16 v[88:91], v[60:63], a[88:91], v[88:91]
    buffer_load_dwordx4 v8, s[36:39], s60 offen offset:0 lds
    s_nop 0
    v_mfma_f32_16x16x32_bf16 v[92:95], v[60:63], a[92:95], v[92:95]
    s_nop 0
    ds_read_b128 v[156:159], v37 offset:7168
    v_mfma_f32_16x16x32_bf16 v[92:95], v[56:59], v[252:255], v[92:95]
    s_waitcnt lgkmcnt(10)
    ds_read_b128 a[124:127], v35 offset:7168
    v_mfma_f32_16x16x32_bf16 v[64:67], v[44:47], a[96:99], v[64:67]
    v_mfma_f32_16x16x32_bf16 v[64:67], v[48:51], v[128:131], v[64:67]
    buffer_load_dwordx4 v9, s[36:39], s60 offen offset:1024 lds
    v_mfma_f32_16x16x32_bf16 v[68:71], v[48:51], v[132:135], v[68:71]
    ds_read_b64_tr_b16 v[56:57], v2 offset:32768
    v_mfma_f32_16x16x32_bf16 v[68:71], v[44:47], a[100:103], v[68:71]
    ds_read_b64_tr_b16 v[58:59], v2 offset:34816
    v_mfma_f32_16x16x32_bf16 v[72:75], v[44:47], a[104:107], v[72:75]
    v_mfma_f32_16x16x32_bf16 v[72:75], v[48:51], v[136:139], v[72:75]
    buffer_load_dwordx4 v10, s[36:39], s60 offen offset:2048 lds
    v_mfma_f32_16x16x32_bf16 v[76:79], v[48:51], v[140:143], v[76:79]
    s_add_u32 s62, s0, 0
    s_waitcnt lgkmcnt(2)
    v_mfma_f32_16x16x32_bf16 v[76:79], v[44:47], a[108:111], v[76:79]
    v_cvt_pk_bf16_f32 v32, v64, v65
    v_cvt_pk_bf16_f32 v33, v66, v67
    v_mfma_f32_16x16x32_bf16 v[80:83], v[44:47], a[112:115], v[80:83]
    v_cvt_pk_bf16_f32 v34, v68, v69
    v_cvt_pk_bf16_f32 v35, v70, v71
    v_mfma_f32_16x16x32_bf16 v[80:83], v[48:51], v[144:147], v[80:83]
    buffer_store_dwordx4 v[32:35], v24, s[44:47], s62 offen offset:0 sc1
    v_mfma_f32_16x16x32_bf16 v[84:87], v[48:51], v[148:151], v[84:87]
    ds_read_b64_tr_b16 v[60:61], v5 offset:32768
    v_mfma_f32_16x16x32_bf16 v[84:87], v[44:47], a[116:119], v[84:87]
    ds_read_b64_tr_b16 v[62:63], v5 offset:34816
    v_mfma_f32_16x16x32_bf16 v[88:91], v[44:47], a[120:123], v[88:91]
    v_mfma_f32_16x16x32_bf16 v[88:91], v[48:51], v[152:155], v[88:91]
    buffer_load_dwordx4 v11, s[36:39], s60 offen offset:3072 lds
    v_mfma_f32_16x16x32_bf16 v[92:95], v[48:51], v[156:159], v[92:95]
    s_add_u32 m0, s65, 131072
    s_add_u32 s60, s72, 147456
    v_mfma_f32_16x16x32_bf16 v[92:95], v[44:47], a[124:127], v[92:95]
    s_waitcnt lgkmcnt(2)
    v_mfma_f32_16x16x32_bf16 v[96:99], v[52:55], v[160:163], 0
    s_nop 0
    v_mfma_f32_16x16x32_bf16 v[96:99], v[56:59], a[224:227], v[96:99]
    buffer_load_dwordx4 v8, s[36:39], s60 offen offset:0 lds
    v_mfma_f32_16x16x32_bf16 v[100:103], v[56:59], a[228:231], 0
    ds_read_b64_tr_b16 v[44:45], v27 offset:32768
    v_mfma_f32_16x16x32_bf16 v[100:103], v[52:55], v[164:167], v[100:103]
    ds_read_b64_tr_b16 v[46:47], v27 offset:34816
    v_mfma_f32_16x16x32_bf16 v[104:107], v[52:55], v[168:171], 0
    v_mfma_f32_16x16x32_bf16 v[104:107], v[56:59], a[232:235], v[104:107]
    buffer_load_dwordx4 v9, s[36:39], s60 offen offset:1024 lds
    v_mfma_f32_16x16x32_bf16 v[108:111], v[56:59], a[236:239], 0
    v_cvt_pk_bf16_f32 v36, v72, v73
    v_cvt_pk_bf16_f32 v37, v74, v75
    v_mfma_f32_16x16x32_bf16 v[108:111], v[52:55], v[172:175], v[108:111]
    v_cvt_pk_bf16_f32 v38, v76, v77
    v_cvt_pk_bf16_f32 v39, v78, v79
    v_mfma_f32_16x16x32_bf16 v[112:115], v[52:55], v[176:179], 0
    s_waitcnt vmcnt(11)
    s_barrier
    v_mfma_f32_16x16x32_bf16 v[112:115], v[56:59], a[240:243], v[112:115]
    buffer_store_dwordx4 v[36:39], v24, s[44:47], s62 offen offset:1024 sc1
    v_mfma_f32_16x16x32_bf16 v[116:119], v[56:59], a[244:247], 0
    ds_read_b64_tr_b16 v[48:49], v21 offset:49152
    v_mfma_f32_16x16x32_bf16 v[116:119], v[52:55], v[180:183], v[116:119]
    ds_read_b64_tr_b16 v[50:51], v21 offset:51200
    v_mfma_f32_16x16x32_bf16 v[120:123], v[52:55], v[184:187], 0
    v_mfma_f32_16x16x32_bf16 v[120:123], v[56:59], a[248:251], v[120:123]
    buffer_load_dwordx4 v10, s[36:39], s60 offen offset:2048 lds
    v_mfma_f32_16x16x32_bf16 v[124:127], v[56:59], a[252:255], 0
    v_mfma_f32_16x16x32_bf16 v[124:127], v[52:55], v[188:191], v[124:127]
    s_waitcnt lgkmcnt(2)
    v_mfma_f32_16x16x32_bf16 v[96:99], v[60:63], a[128:131], v[96:99]
    s_nop 0
    v_mfma_f32_16x16x32_bf16 v[96:99], v[44:47], a[160:163], v[96:99]
    buffer_load_dwordx4 v11, s[36:39], s60 offen offset:3072 lds
    v_mfma_f32_16x16x32_bf16 v[100:103], v[44:47], a[164:167], v[100:103]
    s_add_u32 m0, s65, 32768
    ds_read_b64_tr_b16 v[52:53], v2 offset:49152
    s_add_u32 s60, s72, 294912
    v_mfma_f32_16x16x32_bf16 v[100:103], v[60:63], a[132:135], v[100:103]
    ds_read_b64_tr_b16 v[54:55], v2 offset:51200
    v_cvt_pk_bf16_f32 v40, v80, v81
    v_mfma_f32_16x16x32_bf16 v[104:107], v[60:63], a[136:139], v[104:107]
    v_cvt_pk_bf16_f32 v41, v82, v83
    v_cvt_pk_bf16_f32 v42, v84, v85
    v_mfma_f32_16x16x32_bf16 v[104:107], v[44:47], a[168:171], v[104:107]
    buffer_load_dwordx4 v8, s[36:39], s60 offen offset:0 lds
    v_mfma_f32_16x16x32_bf16 v[108:111], v[44:47], a[172:175], v[108:111]
    v_cvt_pk_bf16_f32 v43, v86, v87
    v_mfma_f32_16x16x32_bf16 v[108:111], v[60:63], a[140:143], v[108:111]
    v_mfma_f32_16x16x32_bf16 v[112:115], v[60:63], a[144:147], v[112:115]
    v_mfma_f32_16x16x32_bf16 v[112:115], v[44:47], a[176:179], v[112:115]
    buffer_store_dwordx4 v[40:43], v24, s[44:47], s62 offen offset:2048 sc1
    v_mfma_f32_16x16x32_bf16 v[116:119], v[44:47], a[180:183], v[116:119]
    ds_read_b64_tr_b16 v[56:57], v5 offset:49152
    v_mfma_f32_16x16x32_bf16 v[116:119], v[60:63], a[148:151], v[116:119]
    ds_read_b64_tr_b16 v[58:59], v5 offset:51200
    v_mfma_f32_16x16x32_bf16 v[120:123], v[60:63], a[152:155], v[120:123]
    v_mfma_f32_16x16x32_bf16 v[120:123], v[44:47], a[184:187], v[120:123]
    buffer_load_dwordx4 v9, s[36:39], s60 offen offset:1024 lds
    v_mfma_f32_16x16x32_bf16 v[124:127], v[44:47], a[188:191], v[124:127]
    s_nop 0
    v_mfma_f32_16x16x32_bf16 v[124:127], v[60:63], a[156:159], v[124:127]
    s_waitcnt lgkmcnt(2)
    v_mfma_f32_16x16x32_bf16 v[96:99], v[48:51], v[192:195], v[96:99]
    v_mfma_f32_16x16x32_bf16 v[96:99], v[52:55], a[0:3], v[96:99]
    buffer_load_dwordx4 v10, s[36:39], s60 offen offset:2048 lds
    v_mfma_f32_16x16x32_bf16 v[100:103], v[52:55], a[4:7], v[100:103]
    ds_read_b64_tr_b16 v[60:61], v27 offset:49152
    v_cvt_pk_bf16_f32 v32, v88, v89
    v_mfma_f32_16x16x32_bf16 v[100:103], v[48:51], v[196:199], v[100:103]
    ds_read_b64_tr_b16 v[62:63], v27 offset:51200
    v_cvt_pk_bf16_f32 v33, v90, v91
    v_mfma_f32_16x16x32_bf16 v[104:107], v[48:51], v[200:203], v[104:107]
    v_cvt_pk_bf16_f32 v34, v92, v93
    v_cvt_pk_bf16_f32 v35, v94, v95
    v_mfma_f32_16x16x32_bf16 v[104:107], v[52:55], a[8:11], v[104:107]
    buffer_store_dwordx4 v[32:35], v24, s[44:47], s62 offen offset:3072 sc1
    v_mfma_f32_16x16x32_bf16 v[108:111], v[52:55], a[12:15], v[108:111]
    v_mfma_f32_16x16x32_bf16 v[108:111], v[48:51], v[204:207], v[108:111]
    v_mfma_f32_16x16x32_bf16 v[112:115], v[48:51], v[208:211], v[112:115]
    s_waitcnt vmcnt(15)
    s_barrier
    v_mfma_f32_16x16x32_bf16 v[112:115], v[52:55], a[16:19], v[112:115]
    buffer_load_dwordx4 v11, s[36:39], s60 offen offset:3072 lds
    v_mfma_f32_16x16x32_bf16 v[116:119], v[52:55], a[20:23], v[116:119]
    s_add_u32 m0, s65, 49152
    ds_read_b64_tr_b16 v[44:45], v22 offset:0
    s_add_u32 s60, s73, 0
    v_mfma_f32_16x16x32_bf16 v[116:119], v[48:51], v[212:215], v[116:119]
    s_nop 0
    ds_read_b64_tr_b16 v[46:47], v22 offset:2048
    v_mfma_f32_16x16x32_bf16 v[120:123], v[48:51], v[216:219], v[120:123]
    v_mfma_f32_16x16x32_bf16 v[120:123], v[52:55], a[24:27], v[120:123]
    buffer_load_dwordx4 v8, s[36:39], s60 offen offset:0 lds
    v_mfma_f32_16x16x32_bf16 v[124:127], v[52:55], a[28:31], v[124:127]
    v_mfma_f32_16x16x32_bf16 v[124:127], v[48:51], v[220:223], v[124:127]
    s_waitcnt lgkmcnt(2)
    v_mfma_f32_16x16x32_bf16 v[96:99], v[56:59], a[32:35], v[96:99]
    s_nop 0
    v_mfma_f32_16x16x32_bf16 v[96:99], v[60:63], a[192:195], v[96:99]
    buffer_load_dwordx4 v9, s[36:39], s60 offen offset:1024 lds
    v_mfma_f32_16x16x32_bf16 v[100:103], v[60:63], a[196:199], v[100:103]
    ds_read_b64_tr_b16 v[48:49], v1 offset:0
    v_mfma_f32_16x16x32_bf16 v[100:103], v[56:59], a[36:39], v[100:103]
    ds_read_b64_tr_b16 v[50:51], v1 offset:2048
    v_mfma_f32_16x16x32_bf16 v[104:107], v[56:59], a[40:43], v[104:107]
    v_mfma_f32_16x16x32_bf16 v[104:107], v[60:63], a[200:203], v[104:107]
    buffer_load_dwordx4 v10, s[36:39], s60 offen offset:2048 lds
    v_mfma_f32_16x16x32_bf16 v[108:111], v[60:63], a[204:207], v[108:111]
    v_mfma_f32_16x16x32_bf16 v[108:111], v[56:59], a[44:47], v[108:111]
    v_mfma_f32_16x16x32_bf16 v[112:115], v[56:59], a[48:51], v[112:115]
    v_mfma_f32_16x16x32_bf16 v[112:115], v[60:63], a[208:211], v[112:115]
    buffer_load_dwordx4 v11, s[36:39], s60 offen offset:3072 lds
    v_mfma_f32_16x16x32_bf16 v[116:119], v[60:63], a[212:215], v[116:119]
    s_add_u32 m0, s65, 147456
    ds_read_b64_tr_b16 v[52:53], v4 offset:0
    s_add_u32 s60, s73, 147456
    v_mfma_f32_16x16x32_bf16 v[116:119], v[56:59], a[52:55], v[116:119]
    ds_read_b64_tr_b16 v[54:55], v4 offset:2048
    v_mfma_f32_16x16x32_bf16 v[120:123], v[56:59], a[56:59], v[120:123]
    v_mfma_f32_16x16x32_bf16 v[120:123], v[60:63], a[216:219], v[120:123]
    buffer_load_dwordx4 v8, s[36:39], s60 offen offset:0 lds
    v_mfma_f32_16x16x32_bf16 v[124:127], v[60:63], a[220:223], v[124:127]
    v_mfma_f32_16x16x32_bf16 v[124:127], v[56:59], a[60:63], v[124:127]
    s_waitcnt lgkmcnt(2)
    v_mfma_f32_16x16x32_bf16 v[96:99], v[44:47], v[224:227], v[96:99]
    s_nop 0
    v_mfma_f32_16x16x32_bf16 v[96:99], v[48:51], a[64:67], v[96:99]
    buffer_load_dwordx4 v9, s[36:39], s60 offen offset:1024 lds
    v_mfma_f32_16x16x32_bf16 v[100:103], v[48:51], a[68:71], v[100:103]
    ds_read_b64_tr_b16 v[56:57], v7 offset:0
    v_mfma_f32_16x16x32_bf16 v[100:103], v[44:47], v[228:231], v[100:103]
    ds_read_b64_tr_b16 v[58:59], v7 offset:2048
    v_mfma_f32_16x16x32_bf16 v[104:107], v[44:47], v[232:235], v[104:107]
    v_mfma_f32_16x16x32_bf16 v[104:107], v[48:51], a[72:75], v[104:107]
    buffer_load_dwordx4 v10, s[36:39], s60 offen offset:2048 lds
    v_mfma_f32_16x16x32_bf16 v[108:111], v[48:51], a[76:79], v[108:111]
    v_mfma_f32_16x16x32_bf16 v[108:111], v[44:47], v[236:239], v[108:111]
    v_mfma_f32_16x16x32_bf16 v[112:115], v[44:47], v[240:243], v[112:115]
    s_waitcnt vmcnt(18)
    s_barrier
    v_mfma_f32_16x16x32_bf16 v[112:115], v[48:51], a[80:83], v[112:115]
    buffer_load_dwordx4 v11, s[36:39], s60 offen offset:3072 lds
    v_mfma_f32_16x16x32_bf16 v[116:119], v[48:51], a[84:87], v[116:119]
    ds_read_b64_tr_b16 v[60:61], v22 offset:16384
    v_mfma_f32_16x16x32_bf16 v[116:119], v[44:47], v[244:247], v[116:119]
    ds_read_b64_tr_b16 v[62:63], v22 offset:18432
    v_mfma_f32_16x16x32_bf16 v[120:123], v[44:47], v[248:251], v[120:123]
    s_add_u32 m0, s65, 65536
    s_add_u32 s60, s73, 294912
    v_mfma_f32_16x16x32_bf16 v[120:123], v[48:51], a[88:91], v[120:123]
    buffer_load_dwordx4 v8, s[36:39], s60 offen offset:0 lds
    v_mfma_f32_16x16x32_bf16 v[124:127], v[48:51], a[92:95], v[124:127]
    v_mfma_f32_16x16x32_bf16 v[124:127], v[44:47], v[252:255], v[124:127]
    s_waitcnt lgkmcnt(2)
    v_mfma_f32_16x16x32_bf16 v[96:99], v[52:55], a[96:99], v[96:99]
    v_mfma_f32_16x16x32_bf16 v[96:99], v[56:59], v[128:131], v[96:99]
    s_nop 0
    ds_read_b64_tr_b16 v[44:45], v1 offset:16384
    v_mfma_f32_16x16x32_bf16 v[100:103], v[56:59], v[132:135], v[100:103]
    v_mfma_f32_16x16x32_bf16 v[100:103], v[52:55], a[100:103], v[100:103]
    ds_read_b64_tr_b16 v[46:47], v1 offset:18432
    v_mfma_f32_16x16x32_bf16 v[104:107], v[52:55], a[104:107], v[104:107]
    v_mfma_f32_16x16x32_bf16 v[104:107], v[56:59], v[136:139], v[104:107]
    buffer_load_dwordx4 v9, s[36:39], s60 offen offset:1024 lds
    v_mfma_f32_16x16x32_bf16 v[108:111], v[56:59], v[140:143], v[108:111]
    s_add_u32 s62, s0, 524288
    v_mfma_f32_16x16x32_bf16 v[108:111], v[52:55], a[108:111], v[108:111]
    v_cvt_pk_bf16_f32 v36, v96, v97
    v_cvt_pk_bf16_f32 v37, v98, v99
    v_mfma_f32_16x16x32_bf16 v[112:115], v[52:55], a[112:115], v[112:115]
    v_cvt_pk_bf16_f32 v38, v100, v101
    v_cvt_pk_bf16_f32 v39, v102, v103
    v_mfma_f32_16x16x32_bf16 v[112:115], v[56:59], v[144:147], v[112:115]
    buffer_store_dwordx4 v[36:39], v24, s[44:47], s62 offen offset:0 sc1
    v_mfma_f32_16x16x32_bf16 v[116:119], v[56:59], v[148:151], v[116:119]
    ds_read_b64_tr_b16 v[48:49], v4 offset:16384
    v_mfma_f32_16x16x32_bf16 v[116:119], v[52:55], a[116:119], v[116:119]
    ds_read_b64_tr_b16 v[50:51], v4 offset:18432
    v_mfma_f32_16x16x32_bf16 v[120:123], v[52:55], a[120:123], v[120:123]
    v_mfma_f32_16x16x32_bf16 v[120:123], v[56:59], v[152:155], v[120:123]
    buffer_load_dwordx4 v10, s[36:39], s60 offen offset:2048 lds
    v_mfma_f32_16x16x32_bf16 v[124:127], v[56:59], v[156:159], v[124:127]
    v_mfma_f32_16x16x32_bf16 v[124:127], v[52:55], a[124:127], v[124:127]
    s_waitcnt lgkmcnt(2)
    v_mfma_f32_16x16x32_bf16 v[64:67], v[60:63], v[160:163], 0
    v_mfma_f32_16x16x32_bf16 v[64:67], v[44:47], a[224:227], v[64:67]
    s_nop 0
    ds_read_b64_tr_b16 v[52:53], v7 offset:16384
    v_mfma_f32_16x16x32_bf16 v[68:71], v[44:47], a[228:231], 0
    v_mfma_f32_16x16x32_bf16 v[68:71], v[60:63], v[164:167], v[68:71]
    ds_read_b64_tr_b16 v[54:55], v7 offset:18432
L_ffn_pad5:
    s_cbranch_execz L_ffn_ret1
    v_mfma_f32_16x16x32_bf16 v[72:75], v[60:63], v[168:171], 0
    s_nop 0
    v_mfma_f32_16x16x32_bf16 v[72:75], v[44:47], a[232:235], v[72:75]
    buffer_load_dwordx4 v11, s[36:39], s60 offen offset:3072 lds
    v_mfma_f32_16x16x32_bf16 v[76:79], v[44:47], a[236:239], 0
    v_mfma_f32_16x16x32_bf16 v[76:79], v[60:63], v[172:175], v[76:79]
    s_nop 0
    v_mfma_f32_16x16x32_bf16 v[80:83], v[60:63], v[176:179], 0
    s_waitcnt vmcnt(14)
    s_barrier
    v_mfma_f32_16x16x32_bf16 v[80:83], v[44:47], a[240:243], v[80:83]
    s_cbranch_vccz L_skip17
    s_atomic_add s96, s[92:93], 0x0
L_skip17:
    ds_read_b64_tr_b16 v[56:57], v26 offset:0
    v_mfma_f32_16x16x32_bf16 v[84:87], v[44:47], a[244:247], 0
    v_mfma_f32_16x16x32_bf16 v[84:87], v[60:63], v[180:183], v[84:87]
    s_nop 0
    ds_read_b64_tr_b16 v[58:59], v26 offset:2048
    v_mfma_f32_16x16x32_bf16 v[88:91], v[60:63], v[184:187], 0
    s_add_u32 m0, s65, 81920
    s_add_u32 s60, s74, 0
    v_mfma_f32_16x16x32_bf16 v[88:91], v[44:47], a[248:251], v[88:91]
    buffer_load_dwordx4 v8, s[36:39], s60 offen offset:0 lds
    v_mfma_f32_16x16x32_bf16 v[92:95], v[44:47], a[252:255], 0
    v_cvt_pk_bf16_f32 v40, v104, v105
    v_cvt_pk_bf16_f32 v41, v106, v107
    v_mfma_f32_16x16x32_bf16 v[92:95], v[60:63], v[188:191], v[92:95]
    s_waitcnt lgkmcnt(2)
    v_cvt_pk_bf16_f32 v42, v108, v109
    v_cvt_pk_bf16_f32 v43, v110, v111
    v_mfma_f32_16x16x32_bf16 v[64:67], v[48:51], a[128:131], v[64:67]
    s_nop 0
    v_mfma_f32_16x16x32_bf16 v[64:67], v[52:55], a[160:163], v[64:67]
    buffer_store_dwordx4 v[40:43], v24, s[44:47], s62 offen offset:1024 sc1
    v_mfma_f32_16x16x32_bf16 v[68:71], v[52:55], a[164:167], v[68:71]
    ds_read_b64_tr_b16 v[60:61], v3 offset:0
    v_mfma_f32_16x16x32_bf16 v[68:71], v[48:51], a[132:135], v[68:71]
    ds_read_b64_tr_b16 v[62:63], v3 offset:2048
    v_mfma_f32_16x16x32_bf16 v[72:75], v[48:51], a[136:139], v[72:75]
    v_mfma_f32_16x16x32_bf16 v[72:75], v[52:55], a[168:171], v[72:75]
    buffer_load_dwordx4 v9, s[36:39], s60 offen offset:1024 lds
    v_mfma_f32_16x16x32_bf16 v[76:79], v[52:55], a[172:175], v[76:79]
    v_mfma_f32_16x16x32_bf16 v[76:79], v[48:51], a[140:143], v[76:79]
    v_mfma_f32_16x16x32_bf16 v[80:83], v[48:51], a[144:147], v[80:83]
    v_mfma_f32_16x16x32_bf16 v[80:83], v[52:55], a[176:179], v[80:83]
    ds_read_b64_tr_b16 v[44:45], v6 offset:0
    v_mfma_f32_16x16x32_bf16 v[84:87], v[52:55], a[180:183], v[84:87]
    v_mfma_f32_16x16x32_bf16 v[84:87], v[48:51], a[148:151], v[84:87]
    ds_read_b64_tr_b16 v[46:47], v6 offset:2048
    v_mfma_f32_16x16x32_bf16 v[88:91], v[48:51], a[152:155], v[88:91]
    v_mfma_f32_16x16x32_bf16 v[88:91], v[52:55], a[184:187], v[88:91]
    buffer_load_dwordx4 v10, s[36:39], s60 offen offset:2048 lds
    v_mfma_f32_16x16x32_bf16 v[92:95], v[52:55], a[188:191], v[92:95]
    v_mfma_f32_16x16x32_bf16 v[92:95], v[48:51], a[156:159], v[92:95]
    s_waitcnt lgkmcnt(2)
    v_mfma_f32_16x16x32_bf16 v[64:67], v[56:59], v[192:195], v[64:67]
    s_nop 0
    v_mfma_f32_16x16x32_bf16 v[64:67], v[60:63], a[0:3], v[64:67]
    ds_read_b64_tr_b16 v[48:49], v30 offset:0
    v_mfma_f32_16x16x32_bf16 v[68:71], v[60:63], a[4:7], v[68:71]
    v_mfma_f32_16x16x32_bf16 v[68:71], v[56:59], v[196:199], v[68:71]
    ds_read_b64_tr_b16 v[50:51], v30 offset:2048
    v_cvt_pk_bf16_f32 v32, v112, v113
    v_mfma_f32_16x16x32_bf16 v[72:75], v[56:59], v[200:203], v[72:75]
    v_cvt_pk_bf16_f32 v33, v114, v115
    v_cvt_pk_bf16_f32 v34, v116, v117
    v_mfma_f32_16x16x32_bf16 v[72:75], v[60:63], a[8:11], v[72:75]
    buffer_load_dwordx4 v11, s[36:39], s60 offen offset:3072 lds
    v_mfma_f32_16x16x32_bf16 v[76:79], v[60:63], a[12:15], v[76:79]
    s_and_b32 s85, s57, 7
    v_cvt_pk_bf16_f32 v35, v118, v119
    v_lshrrev_b32 v31, 1, v0
    v_mfma_f32_16x16x32_bf16 v[76:79], v[56:59], v[204:207], v[76:79]
    v_min_u32_e64 v31, 9, v31
    v_add_u32_e64 v31, s85, v31
    v_mfma_f32_16x16x32_bf16 v[80:83], v[56:59], v[208:211], v[80:83]
    s_waitcnt vmcnt(18)
    s_barrier
    v_subrev_u32_e64 v16, 9, v31
    v_mfma_f32_16x16x32_bf16 v[80:83], v[60:63], a[16:19], v[80:83]
    buffer_store_dwordx4 v[32:35], v24, s[44:47], s62 offen offset:2048 sc1
    v_mfma_f32_16x16x32_bf16 v[84:87], v[60:63], a[20:23], v[84:87]
    ds_read_b64_tr_b16 v[52:53], v22 offset:32768
    v_min_u32_e64 v31, v31, v16
    v_mfma_f32_16x16x32_bf16 v[84:87], v[56:59], v[212:215], v[84:87]
    ds_read_b64_tr_b16 v[54:55], v22 offset:34816
    v_and_b32_e64 v16, 1, v0
    v_mfma_f32_16x16x32_bf16 v[88:91], v[56:59], v[216:219], v[88:91]
    s_add_u32 m0, s65, 98304
    s_add_u32 s60, s74, 147456
    v_lshlrev_b32_e64 v16, 4, v16
    v_mfma_f32_16x16x32_bf16 v[88:91], v[60:63], a[24:27], v[88:91]
    buffer_load_dwordx4 v8, s[36:39], s60 offen offset:0 lds
    v_mfma_f32_16x16x32_bf16 v[92:95], v[60:63], a[28:31], v[92:95]
    v_lshl_add_u32 v31, v31, 7, v16
    s_lshl_b32 s85, s56, 5
    v_mfma_f32_16x16x32_bf16 v[92:95], v[56:59], v[220:223], v[92:95]
    s_waitcnt lgkmcnt(2)
    v_add_u32_e64 v31, s85, v31
    v_mfma_f32_16x16x32_bf16 v[64:67], v[44:47], a[32:35], v[64:67]
    v_mfma_f32_16x16x32_bf16 v[64:67], v[48:51], a[192:195], v[64:67]
    ds_read_b64_tr_b16 v[56:57], v1 offset:32768
    v_mfma_f32_16x16x32_bf16 v[68:71], v[48:51], a[196:199], v[68:71]
    v_mfma_f32_16x16x32_bf16 v[68:71], v[44:47], a[36:39], v[68:71]
    ds_read_b64_tr_b16 v[58:59], v1 offset:34816
    v_mfma_f32_16x16x32_bf16 v[72:75], v[44:47], a[40:43], v[72:75]
    v_mfma_f32_16x16x32_bf16 v[72:75], v[48:51], a[200:203], v[72:75]
    buffer_load_dwordx4 v9, s[36:39], s60 offen offset:1024 lds
    v_mfma_f32_16x16x32_bf16 v[76:79], v[48:51], a[204:207], v[76:79]
    v_mfma_f32_16x16x32_bf16 v[76:79], v[44:47], a[44:47], v[76:79]
    v_mfma_f32_16x16x32_bf16 v[80:83], v[44:47], a[48:51], v[80:83]
    v_mfma_f32_16x16x32_bf16 v[80:83], v[48:51], a[208:211], v[80:83]
    ds_read_b64_tr_b16 v[60:61], v4 offset:32768
    v_cvt_pk_bf16_f32 v36, v120, v121
    v_mfma_f32_16x16x32_bf16 v[84:87], v[48:51], a[212:215], v[84:87]
    v_cvt_pk_bf16_f32 v37, v122, v123
    v_cvt_pk_bf16_f32 v38, v124, v125
    v_mfma_f32_16x16x32_bf16 v[84:87], v[44:47], a[52:55], v[84:87]
    ds_read_b64_tr_b16 v[62:63], v4 offset:34816
    v_cvt_pk_bf16_f32 v39, v126, v127
    v_mfma_f32_16x16x32_bf16 v[88:91], v[44:47], a[56:59], v[88:91]
    buffer_store_dwordx4 v[36:39], v24, s[44:47], s62 offen offset:3072 sc1
    v_mfma_f32_16x16x32_bf16 v[88:91], v[48:51], a[216:219], v[88:91]
    s_cbranch_vccz L_skip19
    s_mov_b32 s97, 0
    s_atomic_add s97, s[92:93], 0x0 glc
L_skip19:
    v_mfma_f32_16x16x32_bf16 v[92:95], v[48:51], a[220:223], v[92:95]
    s_nop 0
    v_mfma_f32_16x16x32_bf16 v[92:95], v[44:47], a[60:63], v[92:95]
    s_waitcnt lgkmcnt(2)
    v_mfma_f32_16x16x32_bf16 v[64:67], v[52:55], v[224:227], v[64:67]
    buffer_load_dwordx4 v10, s[36:39], s60 offen offset:2048 lds
    v_mfma_f32_16x16x32_bf16 v[64:67], v[56:59], a[64:67], v[64:67]
    ds_read_b64_tr_b16 v[44:45], v7 offset:32768
    v_mfma_f32_16x16x32_bf16 v[68:71], v[56:59], a[68:71], v[68:71]
    v_mfma_f32_16x16x32_bf16 v[68:71], v[52:55], v[228:231], v[68:71]
    ds_read_b64_tr_b16 v[46:47], v7 offset:34816
    v_mfma_f32_16x16x32_bf16 v[72:75], v[52:55], v[232:235], v[72:75]
    v_mfma_f32_16x16x32_bf16 v[72:75], v[56:59], a[72:75], v[72:75]
    buffer_load_dwordx4 v11, s[36:39], s60 offen offset:3072 lds
    v_mfma_f32_16x16x32_bf16 v[76:79], v[56:59], a[76:79], v[76:79]
    v_mfma_f32_16x16x32_bf16 v[76:79], v[52:55], v[236:239], v[76:79]
    v_mfma_f32_16x16x32_bf16 v[80:83], v[52:55], v[240:243], v[80:83]
    s_waitcnt vmcnt(20)
    s_barrier
    v_mfma_f32_16x16x32_bf16 v[80:83], v[56:59], a[80:83], v[80:83]
    ds_read_b64_tr_b16 v[48:49], v22 offset:49152
    v_mfma_f32_16x16x32_bf16 v[84:87], v[56:59], a[84:87], v[84:87]
    v_mfma_f32_16x16x32_bf16 v[84:87], v[52:55], v[244:247], v[84:87]
    ds_read_b64_tr_b16 v[50:51], v22 offset:51200
    v_mfma_f32_16x16x32_bf16 v[88:91], v[52:55], v[248:251], v[88:91]
    s_add_u32 m0, s65, 114688
    s_add_u32 s60, s74, 294912
    v_mfma_f32_16x16x32_bf16 v[88:91], v[56:59], a[88:91], v[88:91]
    buffer_load_dwordx4 v8, s[36:39], s60 offen offset:0 lds
    v_mfma_f32_16x16x32_bf16 v[92:95], v[56:59], a[92:95], v[92:95]
    v_mfma_f32_16x16x32_bf16 v[92:95], v[52:55], v[252:255], v[92:95]
    s_waitcnt lgkmcnt(2)
    v_mfma_f32_16x16x32_bf16 v[64:67], v[60:63], a[96:99], v[64:67]
    s_nop 0
    v_mfma_f32_16x16x32_bf16 v[64:67], v[44:47], v[128:131], v[64:67]
    ds_read_b64_tr_b16 v[52:53], v1 offset:49152
    v_mfma_f32_16x16x32_bf16 v[68:71], v[44:47], v[132:135], v[68:71]
    v_mfma_f32_16x16x32_bf16 v[68:71], v[60:63], a[100:103], v[68:71]
    ds_read_b64_tr_b16 v[54:55], v1 offset:51200
    v_mfma_f32_16x16x32_bf16 v[72:75], v[60:63], a[104:107], v[72:75]
    v_mfma_f32_16x16x32_bf16 v[72:75], v[44:47], v[136:139], v[72:75]
    buffer_load_dwordx4 v9, s[36:39], s60 offen offset:1024 lds
    v_mfma_f32_16x16x32_bf16 v[76:79], v[44:47], v[140:143], v[76:79]
    s_add_u32 s62, s0, 1048576
    v_mfma_f32_16x16x32_bf16 v[76:79], v[60:63], a[108:111], v[76:79]
    v_cvt_pk_bf16_f32 v40, v64, v65
    v_cvt_pk_bf16_f32 v41, v66, v67
    v_mfma_f32_16x16x32_bf16 v[80:83], v[60:63], a[112:115], v[80:83]
    v_cvt_pk_bf16_f32 v42, v68, v69
    v_cvt_pk_bf16_f32 v43, v70, v71
    v_mfma_f32_16x16x32_bf16 v[80:83], v[44:47], v[144:147], v[80:83]
    buffer_store_dwordx4 v[40:43], v24, s[44:47], s62 offen offset:0 sc1
    v_mfma_f32_16x16x32_bf16 v[84:87], v[44:47], v[148:151], v[84:87]
    ds_read_b64_tr_b16 v[56:57], v4 offset:49152
    v_mfma_f32_16x16x32_bf16 v[84:87], v[60:63], a[116:119], v[84:87]
    ds_read_b64_tr_b16 v[58:59], v4 offset:51200
    v_mfma_f32_16x16x32_bf16 v[88:91], v[60:63], a[120:123], v[88:91]
    v_mfma_f32_16x16x32_bf16 v[88:91], v[44:47], v[152:155], v[88:91]
    buffer_load_dwordx4 v10, s[36:39], s60 offen offset:2048 lds
    v_mfma_f32_16x16x32_bf16 v[92:95], v[44:47], v[156:159], v[92:95]
    s_nop 0
    v_mfma_f32_16x16x32_bf16 v[92:95], v[60:63], a[124:127], v[92:95]
    s_waitcnt lgkmcnt(2)
    v_mfma_f32_16x16x32_bf16 v[96:99], v[48:51], v[160:163], 0
    v_mfma_f32_16x16x32_bf16 v[96:99], v[52:55], a[224:227], v[96:99]
    ds_read_b64_tr_b16 v[60:61], v7 offset:49152
    v_mfma_f32_16x16x32_bf16 v[100:103], v[52:55], a[228:231], 0
    v_mfma_f32_16x16x32_bf16 v[100:103], v[48:51], v[164:167], v[100:103]
    ds_read_b64_tr_b16 v[62:63], v7 offset:51200
    v_mfma_f32_16x16x32_bf16 v[104:107], v[48:51], v[168:171], 0
    v_mfma_f32_16x16x32_bf16 v[104:107], v[52:55], a[232:235], v[104:107]
    buffer_load_dwordx4 v11, s[36:39], s60 offen offset:3072 lds
    v_mfma_f32_16x16x32_bf16 v[108:111], v[52:55], a[236:239], 0
    v_cvt_pk_bf16_f32 v32, v72, v73
    v_cvt_pk_bf16_f32 v33, v74, v75
    v_mfma_f32_16x16x32_bf16 v[108:111], v[48:51], v[172:175], v[108:111]
    s_waitcnt lgkmcnt(0)
    s_andn2_b32 s89, s99, s97
    s_cbranch_scc1 L_ffn_spin1
L_ffn_spin1r:
    v_mfma_f32_16x16x32_bf16 v[112:115], v[48:51], v[176:179], 0
    s_waitcnt vmcnt(7)
    s_barrier
    v_cvt_pk_bf16_f32 v34, v76, v77
    v_mfma_f32_16x16x32_bf16 v[112:115], v[52:55], a[240:243], v[112:115]
    s_cbranch_vccz L_skip18
    s_atomic_add s96, s[92:93], 0x100
L_skip18:
    ds_read_b64_tr_b16 v[44:45], v26 offset:16384
    v_mfma_f32_16x16x32_bf16 v[116:119], v[52:55], a[244:247], 0
    v_cvt_pk_bf16_f32 v35, v78, v79
    v_mfma_f32_16x16x32_bf16 v[116:119], v[48:51], v[180:183], v[116:119]
    buffer_store_dwordx4 v[32:35], v24, s[44:47], s62 offen offset:1024 sc1
    v_mfma_f32_16x16x32_bf16 v[120:123], v[48:51], v[184:187], 0
    s_add_u32 m0, s65, 16384
    ds_read_b64_tr_b16 v[46:47], v26 offset:18432
    s_add_u32 s60, s75, 0
    v_mfma_f32_16x16x32_bf16 v[120:123], v[52:55], a[248:251], v[120:123]
    v_mfma_f32_16x16x32_bf16 v[124:127], v[52:55], a[252:255], 0
    v_mfma_f32_16x16x32_bf16 v[124:127], v[48:51], v[188:191], v[124:127]
    s_nop 0
    v_mfma_f32_16x16x32_bf16 v[96:99], v[56:59], a[128:131], v[96:99]
    buffer_load_dwordx4 v8, s[36:39], s60 offen offset:0 lds
    v_mfma_f32_16x16x32_bf16 v[96:99], v[60:63], a[160:163], v[96:99]
    ds_read_b64_tr_b16 v[48:49], v3 offset:16384
    v_mfma_f32_16x16x32_bf16 v[100:103], v[60:63], a[164:167], v[100:103]
    v_mfma_f32_16x16x32_bf16 v[100:103], v[56:59], a[132:135], v[100:103]
    ds_read_b64_tr_b16 v[50:51], v3 offset:18432
    v_cvt_pk_bf16_f32 v36, v80, v81
    v_mfma_f32_16x16x32_bf16 v[104:107], v[56:59], a[136:139], v[104:107]
    buffer_load_dwordx4 v9, s[36:39], s60 offen offset:1024 lds
    v_mfma_f32_16x16x32_bf16 v[104:107], v[60:63], a[168:171], v[104:107]
    v_cvt_pk_bf16_f32 v37, v82, v83
    v_cvt_pk_bf16_f32 v38, v84, v85
    v_mfma_f32_16x16x32_bf16 v[108:111], v[60:63], a[172:175], v[108:111]
    v_cvt_pk_bf16_f32 v39, v86, v87
    v_mfma_f32_16x16x32_bf16 v[108:111], v[56:59], a[140:143], v[108:111]
    v_mfma_f32_16x16x32_bf16 v[112:115], v[56:59], a[144:147], v[112:115]
    buffer_store_dwordx4 v[36:39], v24, s[44:47], s62 offen offset:2048 sc1
    v_mfma_f32_16x16x32_bf16 v[112:115], v[60:63], a[176:179], v[112:115]
    ds_read_b64_tr_b16 v[52:53], v6 offset:16384
    v_mfma_f32_16x16x32_bf16 v[116:119], v[60:63], a[180:183], v[116:119]
    v_mfma_f32_16x16x32_bf16 v[116:119], v[56:59], a[148:151], v[116:119]
    ds_read_b64_tr_b16 v[54:55], v6 offset:18432
    v_mfma_f32_16x16x32_bf16 v[120:123], v[56:59], a[152:155], v[120:123]
    buffer_load_dwordx4 v10, s[36:39], s60 offen offset:2048 lds
    v_mfma_f32_16x16x32_bf16 v[120:123], v[60:63], a[184:187], v[120:123]
    v_mfma_f32_16x16x32_bf16 v[124:127], v[60:63], a[188:191], v[124:127]
    s_nop 0
    v_mfma_f32_16x16x32_bf16 v[124:127], v[56:59], a[156:159], v[124:127]
    s_waitcnt lgkmcnt(2)
    v_mfma_f32_16x16x32_bf16 v[96:99], v[44:47], v[192:195], v[96:99]
    buffer_load_dwordx4 v11, s[36:39], s60 offen offset:3072 lds
    v_mfma_f32_16x16x32_bf16 v[96:99], v[48:51], a[0:3], v[96:99]
    s_add_u32 m0, s65, 0
    ds_read_b64_tr_b16 v[56:57], v30 offset:16384
    v_cvt_pk_bf16_f32 v40, v88, v89
    v_mfma_f32_16x16x32_bf16 v[100:103], v[48:51], a[4:7], v[100:103]
    s_add_u32 s60, s0, 0
    v_cvt_pk_bf16_f32 v41, v90, v91
    v_cvt_pk_bf16_f32 v42, v92, v93
    v_mfma_f32_16x16x32_bf16 v[100:103], v[44:47], v[196:199], v[100:103]
    ds_read_b64_tr_b16 v[58:59], v30 offset:18432
    v_cvt_pk_bf16_f32 v43, v94, v95
    v_mfma_f32_16x16x32_bf16 v[104:107], v[44:47], v[200:203], v[104:107]
    buffer_store_dwordx4 v[40:43], v24, s[44:47], s62 offen offset:3072 sc1
    v_mfma_f32_16x16x32_bf16 v[104:107], v[48:51], a[8:11], v[104:107]
    v_mfma_f32_16x16x32_bf16 v[108:111], v[48:51], a[12:15], v[108:111]
    v_mfma_f32_16x16x32_bf16 v[108:111], v[44:47], v[204:207], v[108:111]
    s_nop 0
    v_mfma_f32_16x16x32_bf16 v[112:115], v[44:47], v[208:211], v[112:115]
    s_barrier
    v_mfma_f32_16x16x32_bf16 v[112:115], v[48:51], a[16:19], v[112:115]
    buffer_load_dwordx4 v28, s[44:47], s60 offen offset:0 sc1 lds
    v_mfma_f32_16x16x32_bf16 v[116:119], v[48:51], a[20:23], v[116:119]
    s_add_u32 s60, s0, 130048
    ds_read_b64_tr_b16 v[60:61], v21 offset:0
    v_mfma_f32_16x16x32_bf16 v[116:119], v[44:47], v[212:215], v[116:119]
    ds_read_b64_tr_b16 v[62:63], v21 offset:2048
    v_mfma_f32_16x16x32_bf16 v[120:123], v[44:47], v[216:219], v[120:123]
    v_mfma_f32_16x16x32_bf16 v[120:123], v[48:51], a[24:27], v[120:123]
    buffer_load_dwordx4 v28, s[44:47], s60 offen offset:1024 sc1 lds
    v_mfma_f32_16x16x32_bf16 v[124:127], v[48:51], a[28:31], v[124:127]
    s_add_u32 s60, s0, 260096
    v_mfma_f32_16x16x32_bf16 v[124:127], v[44:47], v[220:223], v[124:127]
    s_waitcnt lgkmcnt(2)
    v_mfma_f32_16x16x32_bf16 v[96:99], v[52:55], a[32:35], v[96:99]
    s_nop 0
    v_mfma_f32_16x16x32_bf16 v[96:99], v[56:59], a[192:195], v[96:99]
    buffer_load_dwordx4 v28, s[44:47], s60 offen offset:2048 sc1 lds
    v_mfma_f32_16x16x32_bf16 v[100:103], v[56:59], a[196:199], v[100:103]
    s_add_u32 m0, s65, 131072
    ds_read_b64_tr_b16 v[44:45], v2 offset:0
    s_add_u32 s60, s75, 147456
    v_mfma_f32_16x16x32_bf16 v[100:103], v[52:55], a[36:39], v[100:103]
    ds_read_b64_tr_b16 v[46:47], v2 offset:2048
    v_mfma_f32_16x16x32_bf16 v[104:107], v[52:55], a[40:43], v[104:107]
    v_mfma_f32_16x16x32_bf16 v[104:107], v[56:59], a[200:203], v[104:107]
    buffer_load_dwordx4 v8, s[36:39], s60 offen offset:0 lds
    v_mfma_f32_16x16x32_bf16 v[108:111], v[56:59], a[204:207], v[108:111]
    v_mfma_f32_16x16x32_bf16 v[108:111], v[52:55], a[44:47], v[108:111]
    v_mfma_f32_16x16x32_bf16 v[112:115], v[52:55], a[48:51], v[112:115]
    v_mfma_f32_16x16x32_bf16 v[112:115], v[56:59], a[208:211], v[112:115]
    buffer_load_dwordx4 v9, s[36:39], s60 offen offset:1024 lds
    v_mfma_f32_16x16x32_bf16 v[116:119], v[56:59], a[212:215], v[116:119]
    ds_read_b64_tr_b16 v[48:49], v5 offset:0
    v_mfma_f32_16x16x32_bf16 v[116:119], v[52:55], a[52:55], v[116:119]
    ds_read_b64_tr_b16 v[50:51], v5 offset:2048
    v_mfma_f32_16x16x32_bf16 v[120:123], v[52:55], a[56:59], v[120:123]
    s_cbranch_vccz L_skip21
    s_mov_b32 s98, 0
    s_atomic_add s98, s[92:93], 0x100 glc
L_skip21:
    v_mfma_f32_16x16x32_bf16 v[120:123], v[56:59], a[216:219], v[120:123]
    buffer_load_dwordx4 v10, s[36:39], s60 offen offset:2048 lds
    v_mfma_f32_16x16x32_bf16 v[124:127], v[56:59], a[220:223], v[124:127]
    s_nop 0
    v_mfma_f32_16x16x32_bf16 v[124:127], v[52:55], a[60:63], v[124:127]
    s_waitcnt lgkmcnt(2)
    v_mfma_f32_16x16x32_bf16 v[96:99], v[60:63], v[224:227], v[96:99]
    v_mfma_f32_16x16x32_bf16 v[96:99], v[44:47], a[64:67], v[96:99]
    ds_read_b64_tr_b16 v[52:53], v27 offset:0
    v_mfma_f32_16x16x32_bf16 v[100:103], v[44:47], a[68:71], v[100:103]
    v_mfma_f32_16x16x32_bf16 v[100:103], v[60:63], v[228:231], v[100:103]
    ds_read_b64_tr_b16 v[54:55], v27 offset:2048
    v_mfma_f32_16x16x32_bf16 v[104:107], v[60:63], v[232:235], v[104:107]
    v_mfma_f32_16x16x32_bf16 v[104:107], v[44:47], a[72:75], v[104:107]
    buffer_load_dwordx4 v11, s[36:39], s60 offen offset:3072 lds
    v_mfma_f32_16x16x32_bf16 v[108:111], v[44:47], a[76:79], v[108:111]
    v_mfma_f32_16x16x32_bf16 v[108:111], v[60:63], v[236:239], v[108:111]
    s_nop 0
    v_mfma_f32_16x16x32_bf16 v[112:115], v[60:63], v[240:243], v[112:115]
    s_barrier
    v_mfma_f32_16x16x32_bf16 v[112:115], v[44:47], a[80:83], v[112:115]
    ds_read_b64_tr_b16 v[56:57], v21 offset:16384
    v_mfma_f32_16x16x32_bf16 v[116:119], v[44:47], a[84:87], v[116:119]
    v_mfma_f32_16x16x32_bf16 v[116:119], v[60:63], v[244:247], v[116:119]
    ds_read_b64_tr_b16 v[58:59], v21 offset:18432
    v_mfma_f32_16x16x32_bf16 v[120:123], v[60:63], v[248:251], v[120:123]
    s_add_u32 m0, s65, 32768
    s_add_u32 s60, s75, 294912
    v_mfma_f32_16x16x32_bf16 v[120:123], v[44:47], a[88:91], v[120:123]
    buffer_load_dwordx4 v8, s[36:39], s60 offen offset:0 lds
    v_mfma_f32_16x16x32_bf16 v[124:127], v[44:47], a[92:95], v[124:127]
    v_mfma_f32_16x16x32_bf16 v[124:127], v[60:63], v[252:255], v[124:127]
    s_waitcnt lgkmcnt(2)
    v_mfma_f32_16x16x32_bf16 v[96:99], v[48:51], a[96:99], v[96:99]
    v_mfma_f32_16x16x32_bf16 v[96:99], v[52:55], v[128:131], v[96:99]
    s_nop 0
    ds_read_b64_tr_b16 v[60:61], v2 offset:16384
    v_mfma_f32_16x16x32_bf16 v[100:103], v[52:55], v[132:135], v[100:103]
    s_nop 0
    v_mfma_f32_16x16x32_bf16 v[100:103], v[48:51], a[100:103], v[100:103]
    s_nop 0
    ds_read_b64_tr_b16 v[62:63], v2 offset:18432
    v_mfma_f32_16x16x32_bf16 v[104:107], v[48:51], a[104:107], v[104:107]
    v_mfma_f32_16x16x32_bf16 v[104:107], v[52:55], v[136:139], v[104:107]
    buffer_load_dwordx4 v9, s[36:39], s60 offen offset:1024 lds
    v_mfma_f32_16x16x32_bf16 v[108:111], v[52:55], v[140:143], v[108:111]
    s_add_u32 s62, s1, 0
    v_mfma_f32_16x16x32_bf16 v[108:111], v[48:51], a[108:111], v[108:111]
    s_nop 0
    v_cvt_pk_bf16_f32 v32, v96, v97
    v_cvt_pk_bf16_f32 v33, v98, v99
    v_mfma_f32_16x16x32_bf16 v[112:115], v[48:51], a[112:115], v[112:115]
    v_cvt_pk_bf16_f32 v34, v100, v101
    v_cvt_pk_bf16_f32 v35, v102, v103
    v_mfma_f32_16x16x32_bf16 v[112:115], v[52:55], v[144:147], v[112:115]
    buffer_store_dwordx4 v[32:35], v24, s[44:47], s62 offen offset:0 sc1
    v_mfma_f32_16x16x32_bf16 v[116:119], v[52:55], v[148:151], v[116:119]
    ds_read_b64_tr_b16 v[44:45], v5 offset:16384
    v_mfma_f32_16x16x32_bf16 v[116:119], v[48:51], a[116:119], v[116:119]
    s_nop 0
    ds_read_b64_tr_b16 v[46:47], v5 offset:18432
    v_mfma_f32_16x16x32_bf16 v[120:123], v[48:51], a[120:123], v[120:123]
    s_nop 0
    v_mfma_f32_16x16x32_bf16 v[120:123], v[52:55], v[152:155], v[120:123]
    buffer_load_dwordx4 v10, s[36:39], s60 offen offset:2048 lds
    v_mfma_f32_16x16x32_bf16 v[124:127], v[52:55], v[156:159], v[124:127]
    s_nop 0
    v_mfma_f32_16x16x32_bf16 v[124:127], v[48:51], a[124:127], v[124:127]
    s_waitcnt lgkmcnt(2)
    v_mfma_f32_16x16x32_bf16 v[64:67], v[56:59], v[160:163], 0
    v_mfma_f32_16x16x32_bf16 v[64:67], v[60:63], a[224:227], v[64:67]
    ds_read_b64_tr_b16 v[48:49], v27 offset:16384
    v_mfma_f32_16x16x32_bf16 v[68:71], v[60:63], a[228:231], 0
    v_mfma_f32_16x16x32_bf16 v[68:71], v[56:59], v[164:167], v[68:71]
    ds_read_b64_tr_b16 v[50:51], v27 offset:18432
    v_mfma_f32_16x16x32_bf16 v[72:75], v[56:59], v[168:171], 0
    v_mfma_f32_16x16x32_bf16 v[72:75], v[60:63], a[232:235], v[72:75]
    buffer_load_dwordx4 v11, s[36:39], s60 offen offset:3072 lds
    v_mfma_f32_16x16x32_bf16 v[76:79], v[60:63], a[236:239], 0
    v_cvt_pk_bf16_f32 v36, v104, v105
    v_cvt_pk_bf16_f32 v37, v106, v107
    v_mfma_f32_16x16x32_bf16 v[76:79], v[56:59], v[172:175], v[76:79]
    s_waitcnt lgkmcnt(0)
    s_andn2_b32 s89, s99, s98
    s_cbranch_scc1 L_ffn_spin2
L_ffn_spin2r:
    v_mfma_f32_16x16x32_bf16 v[80:83], v[56:59], v[176:179], 0
    s_waitcnt vmcnt(12)
    s_barrier
    v_cvt_pk_bf16_f32 v38, v108, v109
    v_mfma_f32_16x16x32_bf16 v[80:83], v[60:63], a[240:243], v[80:83]
    s_cbranch_vccz L_skip20
    s_atomic_add s96, s[92:93], 0x200
L_skip20:
    ds_read_b64_tr_b16 v[52:53], v21 offset:32768
    v_mfma_f32_16x16x32_bf16 v[84:87], v[60:63], a[244:247], 0
    v_cvt_pk_bf16_f32 v39, v110, v111
    v_mfma_f32_16x16x32_bf16 v[84:87], v[56:59], v[180:183], v[84:87]
    buffer_store_dwordx4 v[36:39], v24, s[44:47], s62 offen offset:1024 sc1
    v_mfma_f32_16x16x32_bf16 v[88:91], v[56:59], v[184:187], 0
    s_add_u32 m0, s65, 147456
    ds_read_b64_tr_b16 v[54:55], v21 offset:34816
    s_add_u32 s60, s76, 0
    v_mfma_f32_16x16x32_bf16 v[88:91], v[60:63], a[248:251], v[88:91]
    v_mfma_f32_16x16x32_bf16 v[92:95], v[60:63], a[252:255], 0
    v_mfma_f32_16x16x32_bf16 v[92:95], v[56:59], v[188:191], v[92:95]
    s_nop 0
    v_mfma_f32_16x16x32_bf16 v[64:67], v[44:47], a[128:131], v[64:67]
    buffer_load_dwordx4 v8, s[36:39], s60 offen offset:0 lds
    v_mfma_f32_16x16x32_bf16 v[64:67], v[48:51], a[160:163], v[64:67]
    ds_read_b64_tr_b16 v[56:57], v2 offset:32768
    v_mfma_f32_16x16x32_bf16 v[68:71], v[48:51], a[164:167], v[68:71]
    v_mfma_f32_16x16x32_bf16 v[68:71], v[44:47], a[132:135], v[68:71]
    ds_read_b64_tr_b16 v[58:59], v2 offset:34816
    v_cvt_pk_bf16_f32 v40, v112, v113
    v_mfma_f32_16x16x32_bf16 v[72:75], v[44:47], a[136:139], v[72:75]
    buffer_load_dwordx4 v9, s[36:39], s60 offen offset:1024 lds
    v_mfma_f32_16x16x32_bf16 v[72:75], v[48:51], a[168:171], v[72:75]
    v_cvt_pk_bf16_f32 v41, v114, v115
    v_cvt_pk_bf16_f32 v42, v116, v117
    v_mfma_f32_16x16x32_bf16 v[76:79], v[48:51], a[172:175], v[76:79]
    v_cvt_pk_bf16_f32 v43, v118, v119
    v_mfma_f32_16x16x32_bf16 v[76:79], v[44:47], a[140:143], v[76:79]
    v_mfma_f32_16x16x32_bf16 v[80:83], v[44:47], a[144:147], v[80:83]
    buffer_store_dwordx4 v[40:43], v24, s[44:47], s62 offen offset:2048 sc1
    v_mfma_f32_16x16x32_bf16 v[80:83], v[48:51], a[176:179], v[80:83]
    ds_read_b64_tr_b16 v[60:61], v5 offset:32768
    v_mfma_f32_16x16x32_bf16 v[84:87], v[48:51], a[180:183], v[84:87]
    s_nop 0
    v_mfma_f32_16x16x32_bf16 v[84:87], v[44:47], a[148:151], v[84:87]
    s_nop 0
    ds_read_b64_tr_b16 v[62:63], v5 offset:34816
    v_mfma_f32_16x16x32_bf16 v[88:91], v[44:47], a[152:155], v[88:91]
    buffer_load_dwordx4 v10, s[36:39], s60 offen offset:2048 lds
    v_mfma_f32_16x16x32_bf16 v[88:91], v[48:51], a[184:187], v[88:91]
    v_mfma_f32_16x16x32_bf16 v[92:95], v[48:51], a[188:191], v[92:95]
    s_nop 0
    v_mfma_f32_16x16x32_bf16 v[92:95], v[44:47], a[156:159], v[92:95]
    s_waitcnt lgkmcnt(2)
    v_mfma_f32_16x16x32_bf16 v[64:67], v[52:55], v[192:195], v[64:67]
    buffer_load_dwordx4 v11, s[36:39], s60 offen offset:3072 lds
    v_mfma_f32_16x16x32_bf16 v[64:67], v[56:59], a[0:3], v[64:67]
    s_add_u32 m0, s65, 49152
    ds_read_b64_tr_b16 v[44:45], v27 offset:32768
    v_cvt_pk_bf16_f32 v32, v120, v121
    v_mfma_f32_16x16x32_bf16 v[68:71], v[56:59], a[4:7], v[68:71]
    s_add_u32 s60, s0, 524288
    v_cvt_pk_bf16_f32 v33, v122, v123
    v_cvt_pk_bf16_f32 v34, v124, v125
    v_mfma_f32_16x16x32_bf16 v[68:71], v[52:55], v[196:199], v[68:71]
    ds_read_b64_tr_b16 v[46:47], v27 offset:34816
    v_cvt_pk_bf16_f32 v35, v126, v127
    v_mfma_f32_16x16x32_bf16 v[72:75], v[52:55], v[200:203], v[72:75]
    buffer_store_dwordx4 v[32:35], v24, s[44:47], s62 offen offset:3072 sc1
    v_mfma_f32_16x16x32_bf16 v[72:75], v[56:59], a[8:11], v[72:75]
    v_mfma_f32_16x16x32_bf16 v[76:79], v[56:59], a[12:15], v[76:79]
    v_mfma_f32_16x16x32_bf16 v[76:79], v[52:55], v[204:207], v[76:79]
    s_nop 0
    v_mfma_f32_16x16x32_bf16 v[80:83], v[52:55], v[208:211], v[80:83]
    s_barrier
    v_mfma_f32_16x16x32_bf16 v[80:83], v[56:59], a[16:19], v[80:83]
    buffer_load_dwordx4 v28, s[44:47], s60 offen offset:0 sc1 lds
    v_mfma_f32_16x16x32_bf16 v[84:87], v[56:59], a[20:23], v[84:87]
    s_add_u32 s60, s0, 654336
    ds_read_b64_tr_b16 v[48:49], v21 offset:49152
    v_mfma_f32_16x16x32_bf16 v[84:87], v[52:55], v[212:215], v[84:87]
    s_nop 0
    ds_read_b64_tr_b16 v[50:51], v21 offset:51200
    v_mfma_f32_16x16x32_bf16 v[88:91], v[52:55], v[216:219], v[88:91]
    s_nop 0
    v_mfma_f32_16x16x32_bf16 v[88:91], v[56:59], a[24:27], v[88:91]
    buffer_load_dwordx4 v28, s[44:47], s60 offen offset:1024 sc1 lds
    v_mfma_f32_16x16x32_bf16 v[92:95], v[56:59], a[28:31], v[92:95]
    s_add_u32 s60, s0, 784384
    v_mfma_f32_16x16x32_bf16 v[92:95], v[52:55], v[220:223], v[92:95]
    s_waitcnt lgkmcnt(2)
    v_mfma_f32_16x16x32_bf16 v[64:67], v[60:63], a[32:35], v[64:67]
    s_nop 0
    v_mfma_f32_16x16x32_bf16 v[64:67], v[44:47], a[192:195], v[64:67]
    buffer_load_dwordx4 v28, s[44:47], s60 offen offset:2048 sc1 lds
    v_mfma_f32_16x16x32_bf16 v[68:71], v[44:47], a[196:199], v[68:71]
    s_add_u32 m0, s65, 65536
    ds_read_b64_tr_b16 v[52:53], v2 offset:49152
    s_add_u32 s60, s76, 147456
    v_mfma_f32_16x16x32_bf16 v[68:71], v[60:63], a[36:39], v[68:71]
    ds_read_b64_tr_b16 v[54:55], v2 offset:51200
    v_mfma_f32_16x16x32_bf16 v[72:75], v[60:63], a[40:43], v[72:75]
    v_mfma_f32_16x16x32_bf16 v[72:75], v[44:47], a[200:203], v[72:75]
    buffer_load_dwordx4 v8, s[36:39], s60 offen offset:0 lds
    v_mfma_f32_16x16x32_bf16 v[76:79], v[44:47], a[204:207], v[76:79]
    v_mfma_f32_16x16x32_bf16 v[76:79], v[60:63], a[44:47], v[76:79]
    v_mfma_f32_16x16x32_bf16 v[80:83], v[60:63], a[48:51], v[80:83]
    v_mfma_f32_16x16x32_bf16 v[80:83], v[44:47], a[208:211], v[80:83]
    buffer_load_dwordx4 v9, s[36:39], s60 offen offset:1024 lds
    v_mfma_f32_16x16x32_bf16 v[84:87], v[44:47], a[212:215], v[84:87]
    ds_read_b64_tr_b16 v[56:57], v5 offset:49152
    v_mfma_f32_16x16x32_bf16 v[84:87], v[60:63], a[52:55], v[84:87]
    ds_read_b64_tr_b16 v[58:59], v5 offset:51200
    v_mfma_f32_16x16x32_bf16 v[88:91], v[60:63], a[56:59], v[88:91]
    s_cbranch_vccz L_skip23
    s_mov_b32 s97, 0
    s_atomic_add s97, s[92:93], 0x200 glc
L_skip23:
    v_mfma_f32_16x16x32_bf16 v[88:91], v[44:47], a[216:219], v[88:91]
    buffer_load_dwordx4 v10, s[36:39], s60 offen offset:2048 lds
    v_mfma_f32_16x16x32_bf16 v[92:95], v[44:47], a[220:223], v[92:95]
    v_mfma_f32_16x16x32_bf16 v[92:95], v[60:63], a[60:63], v[92:95]
    s_waitcnt lgkmcnt(2)
    v_mfma_f32_16x16x32_bf16 v[64:67], v[48:51], v[224:227], v[64:67]
    v_mfma_f32_16x16x32_bf16 v[64:67], v[52:55], a[64:67], v[64:67]
    s_nop 0
    ds_read_b64_tr_b16 v[60:61], v27 offset:49152
    v_mfma_f32_16x16x32_bf16 v[68:71], v[52:55], a[68:71], v[68:71]
    v_mfma_f32_16x16x32_bf16 v[68:71], v[48:51], v[228:231], v[68:71]
    ds_read_b64_tr_b16 v[62:63], v27 offset:51200
    v_mfma_f32_16x16x32_bf16 v[72:75], v[48:51], v[232:235], v[72:75]
    v_mfma_f32_16x16x32_bf16 v[72:75], v[52:55], a[72:75], v[72:75]
    buffer_load_dwordx4 v11, s[36:39], s60 offen offset:3072 lds
    v_mfma_f32_16x16x32_bf16 v[76:79], v[52:55], a[76:79], v[76:79]
    v_mfma_f32_16x16x32_bf16 v[76:79], v[48:51], v[236:239], v[76:79]
    v_mfma_f32_16x16x32_bf16 v[80:83], v[48:51], v[240:243], v[80:83]
    s_barrier
    v_mfma_f32_16x16x32_bf16 v[80:83], v[52:55], a[80:83], v[80:83]
    s_nop 0
    ds_read_b64_tr_b16 v[44:45], v22 offset:16384
    v_mfma_f32_16x16x32_bf16 v[84:87], v[52:55], a[84:87], v[84:87]
    v_mfma_f32_16x16x32_bf16 v[84:87], v[48:51], v[244:247], v[84:87]
    ds_read_b64_tr_b16 v[46:47], v22 offset:18432
    v_mfma_f32_16x16x32_bf16 v[88:91], v[48:51], v[248:251], v[88:91]
    s_add_u32 m0, s65, 81920
    s_add_u32 s60, s76, 294912
    v_mfma_f32_16x16x32_bf16 v[88:91], v[52:55], a[88:91], v[88:91]
    buffer_load_dwordx4 v8, s[36:39], s60 offen offset:0 lds
    v_mfma_f32_16x16x32_bf16 v[92:95], v[52:55], a[92:95], v[92:95]
    s_nop 0
    v_mfma_f32_16x16x32_bf16 v[92:95], v[48:51], v[252:255], v[92:95]
    s_waitcnt lgkmcnt(2)
    v_mfma_f32_16x16x32_bf16 v[64:67], v[56:59], a[96:99], v[64:67]
    s_nop 0
    v_mfma_f32_16x16x32_bf16 v[64:67], v[60:63], v[128:131], v[64:67]
    s_nop 0
    ds_read_b64_tr_b16 v[48:49], v1 offset:16384
L_ffn_pad6:
    s_cbranch_execz L_ffn_ret1
    v_mfma_f32_16x16x32_bf16 v[68:71], v[60:63], v[132:135], v[68:71]
    v_mfma_f32_16x16x32_bf16 v[68:71], v[56:59], a[100:103], v[68:71]
    s_nop 0
    ds_read_b64_tr_b16 v[50:51], v1 offset:18432
    v_mfma_f32_16x16x32_bf16 v[72:75], v[56:59], a[104:107], v[72:75]
    v_mfma_f32_16x16x32_bf16 v[72:75], v[60:63], v[136:139], v[72:75]
    buffer_load_dwordx4 v9, s[36:39], s60 offen offset:1024 lds
    v_mfma_f32_16x16x32_bf16 v[76:79], v[60:63], v[140:143], v[76:79]
    s_add_u32 s62, s1, 524288
    v_mfma_f32_16x16x32_bf16 v[76:79], v[56:59], a[108:111], v[76:79]
    v_cvt_pk_bf16_f32 v36, v64, v65
    v_cvt_pk_bf16_f32 v37, v66, v67
    v_mfma_f32_16x16x32_bf16 v[80:83], v[56:59], a[112:115], v[80:83]
    v_cvt_pk_bf16_f32 v38, v68, v69
    v_cvt_pk_bf16_f32 v39, v70, v71
    v_mfma_f32_16x16x32_bf16 v[80:83], v[60:63], v[144:147], v[80:83]
    buffer_store_dwordx4 v[36:39], v24, s[44:47], s62 offen offset:0 sc1
    v_mfma_f32_16x16x32_bf16 v[84:87], v[60:63], v[148:151], v[84:87]
    ds_read_b64_tr_b16 v[52:53], v4 offset:16384
    v_mfma_f32_16x16x32_bf16 v[84:87], v[56:59], a[116:119], v[84:87]
    s_nop 0
    ds_read_b64_tr_b16 v[54:55], v4 offset:18432
    v_mfma_f32_16x16x32_bf16 v[88:91], v[56:59], a[120:123], v[88:91]
    s_nop 0
    v_mfma_f32_16x16x32_bf16 v[88:91], v[60:63], v[152:155], v[88:91]
    buffer_load_dwordx4 v10, s[36:39], s60 offen offset:2048 lds
    v_mfma_f32_16x16x32_bf16 v[92:95], v[60:63], v[156:159], v[92:95]
    s_nop 0
    v_mfma_f32_16x16x32_bf16 v[92:95], v[56:59], a[124:127], v[92:95]
    s_waitcnt lgkmcnt(2)
    v_mfma_f32_16x16x32_bf16 v[96:99], v[44:47], v[160:163], 0
    v_mfma_f32_16x16x32_bf16 v[96:99], v[48:51], a[224:227], v[96:99]
    ds_read_b64_tr_b16 v[56:57], v7 offset:16384
    v_mfma_f32_16x16x32_bf16 v[100:103], v[48:51], a[228:231], 0
    v_mfma_f32_16x16x32_bf16 v[100:103], v[44:47], v[164:167], v[100:103]
    ds_read_b64_tr_b16 v[58:59], v7 offset:18432
    v_mfma_f32_16x16x32_bf16 v[104:107], v[44:47], v[168:171], 0
    v_mfma_f32_16x16x32_bf16 v[104:107], v[48:51], a[232:235], v[104:107]
    buffer_load_dwordx4 v11, s[36:39], s60 offen offset:3072 lds
    v_mfma_f32_16x16x32_bf16 v[108:111], v[48:51], a[236:239], 0
    v_cvt_pk_bf16_f32 v40, v72, v73
    v_cvt_pk_bf16_f32 v41, v74, v75
    v_mfma_f32_16x16x32_bf16 v[108:111], v[44:47], v[172:175], v[108:111]
    s_waitcnt lgkmcnt(0)
    s_andn2_b32 s89, s99, s97
    s_cbranch_scc1 L_ffn_spin3
L_ffn_spin3r:
    v_mfma_f32_16x16x32_bf16 v[112:115], v[44:47], v[176:179], 0
    s_waitcnt vmcnt(12)
    s_barrier
    v_cvt_pk_bf16_f32 v42, v76, v77
    v_mfma_f32_16x16x32_bf16 v[112:115], v[48:51], a[240:243], v[112:115]
    s_cbranch_vccz L_skip22
    s_atomic_add s96, s[92:93], 0x300
L_skip22:
    ds_read_b64_tr_b16 v[60:61], v26 offset:0
    v_mfma_f32_16x16x32_bf16 v[116:119], v[48:51], a[244:247], 0
    v_cvt_pk_bf16_f32 v43, v78, v79
    v_mfma_f32_16x16x32_bf16 v[116:119], v[44:47], v[180:183], v[116:119]
    buffer_store_dwordx4 v[40:43], v24, s[44:47], s62 offen offset:1024 sc1
    v_mfma_f32_16x16x32_bf16 v[120:123], v[44:47], v[184:187], 0
    s_add_u32 m0, s65, 114688
    ds_read_b64_tr_b16 v[62:63], v26 offset:2048
    s_add_u32 s60, s77, 0
    v_mfma_f32_16x16x32_bf16 v[120:123], v[48:51], a[248:251], v[120:123]
    v_mfma_f32_16x16x32_bf16 v[124:127], v[48:51], a[252:255], 0
    v_mfma_f32_16x16x32_bf16 v[124:127], v[44:47], v[188:191], v[124:127]
    s_nop 0
    v_mfma_f32_16x16x32_bf16 v[96:99], v[52:55], a[128:131], v[96:99]
    buffer_load_dwordx4 v8, s[36:39], s60 offen offset:0 lds
    v_mfma_f32_16x16x32_bf16 v[96:99], v[56:59], a[160:163], v[96:99]
    ds_read_b64_tr_b16 v[44:45], v3 offset:0
    v_mfma_f32_16x16x32_bf16 v[100:103], v[56:59], a[164:167], v[100:103]
    v_mfma_f32_16x16x32_bf16 v[100:103], v[52:55], a[132:135], v[100:103]
    ds_read_b64_tr_b16 v[46:47], v3 offset:2048
    v_cvt_pk_bf16_f32 v32, v80, v81
    v_mfma_f32_16x16x32_bf16 v[104:107], v[52:55], a[136:139], v[104:107]
    buffer_load_dwordx4 v9, s[36:39], s60 offen offset:1024 lds
    v_mfma_f32_16x16x32_bf16 v[104:107], v[56:59], a[168:171], v[104:107]
    v_cvt_pk_bf16_f32 v33, v82, v83
    v_cvt_pk_bf16_f32 v34, v84, v85
    v_mfma_f32_16x16x32_bf16 v[108:111], v[56:59], a[172:175], v[108:111]
    v_cvt_pk_bf16_f32 v35, v86, v87
    v_mfma_f32_16x16x32_bf16 v[108:111], v[52:55], a[140:143], v[108:111]
    v_mfma_f32_16x16x32_bf16 v[112:115], v[52:55], a[144:147], v[112:115]
    buffer_store_dwordx4 v[32:35], v24, s[44:47], s62 offen offset:2048 sc1
    v_mfma_f32_16x16x32_bf16 v[112:115], v[56:59], a[176:179], v[112:115]
    ds_read_b64_tr_b16 v[48:49], v6 offset:0
    v_mfma_f32_16x16x32_bf16 v[116:119], v[56:59], a[180:183], v[116:119]
    s_nop 0
    v_mfma_f32_16x16x32_bf16 v[116:119], v[52:55], a[148:151], v[116:119]
    s_nop 0
    ds_read_b64_tr_b16 v[50:51], v6 offset:2048
    v_mfma_f32_16x16x32_bf16 v[120:123], v[52:55], a[152:155], v[120:123]
    buffer_load_dwordx4 v10, s[36:39], s60 offen offset:2048 lds
    v_mfma_f32_16x16x32_bf16 v[120:123], v[56:59], a[184:187], v[120:123]
    v_mfma_f32_16x16x32_bf16 v[124:127], v[56:59], a[188:191], v[124:127]
    s_nop 0
    v_mfma_f32_16x16x32_bf16 v[124:127], v[52:55], a[156:159], v[124:127]
    s_waitcnt lgkmcnt(2)
    v_mfma_f32_16x16x32_bf16 v[96:99], v[60:63], v[192:195], v[96:99]
    buffer_load_dwordx4 v11, s[36:39], s60 offen offset:3072 lds
    v_mfma_f32_16x16x32_bf16 v[96:99], v[44:47], a[0:3], v[96:99]
    s_add_u32 m0, s65, 98304
    ds_read_b64_tr_b16 v[52:53], v30 offset:0
    v_cvt_pk_bf16_f32 v36, v88, v89
    v_mfma_f32_16x16x32_bf16 v[100:103], v[44:47], a[4:7], v[100:103]
    s_add_u32 s60, s0, 1048576
    v_cvt_pk_bf16_f32 v37, v90, v91
    v_cvt_pk_bf16_f32 v38, v92, v93
    v_mfma_f32_16x16x32_bf16 v[100:103], v[60:63], v[196:199], v[100:103]
    s_mov_b64 s[48:49], s[22:23]
    ds_read_b64_tr_b16 v[54:55], v30 offset:2048
    v_cvt_pk_bf16_f32 v39, v94, v95
    s_nop 0
    v_mfma_f32_16x16x32_bf16 v[104:107], v[60:63], v[200:203], v[104:107]
    buffer_store_dwordx4 v[36:39], v24, s[44:47], s62 offen offset:3072 sc1
    v_mfma_f32_16x16x32_bf16 v[104:107], v[44:47], a[8:11], v[104:107]
    s_mov_b32 s50, 2359296
    s_mov_b32 s51, 0x20000
    s_mul_i32 s68, s57, 147456
    v_mfma_f32_16x16x32_bf16 v[108:111], v[44:47], a[12:15], v[108:111]
    s_lshl_b32 s82, s56, 5
    s_add_u32 s68, s68, s82
    s_lshr_b32 s82, s58, 2
    v_mfma_f32_16x16x32_bf16 v[108:111], v[60:63], v[204:207], v[108:111]
    s_lshl_b32 s82, s82, 5
    v_mfma_f32_16x16x32_bf16 v[112:115], v[60:63], v[208:211], v[112:115]
    s_barrier
    s_and_b32 s83, s58, 1
    v_mfma_f32_16x16x32_bf16 v[112:115], v[44:47], a[16:19], v[112:115]
    buffer_load_dwordx4 v28, s[44:47], s60 offen offset:0 sc1 lds
    v_mfma_f32_16x16x32_bf16 v[116:119], v[44:47], a[20:23], v[116:119]
    s_add_u32 s60, s0, 1178624
    ds_read_b64_tr_b16 v[56:57], v22 offset:32768
    s_lshl_b32 s83, s83, 3
    v_mfma_f32_16x16x32_bf16 v[116:119], v[60:63], v[212:215], v[116:119]
    s_add_u32 s82, s82, s83
    ds_read_b64_tr_b16 v[58:59], v22 offset:34816
    s_bfe_u32 s83, s58, 0x10001
    v_mfma_f32_16x16x32_bf16 v[120:123], v[60:63], v[216:219], v[120:123]
    s_add_u32 s82, s82, s83
    s_nop 0
    v_mfma_f32_16x16x32_bf16 v[120:123], v[44:47], a[24:27], v[120:123]
    buffer_load_dwordx4 v28, s[44:47], s60 offen offset:1024 sc1 lds
    v_mfma_f32_16x16x32_bf16 v[124:127], v[44:47], a[28:31], v[124:127]
    s_add_u32 s60, s0, 1308672
    v_bfe_u32 v12, v0, 4, 1
    v_lshl_add_u32 v12, v12, 4, s82
    v_mfma_f32_16x16x32_bf16 v[124:127], v[60:63], v[220:223], v[124:127]
    s_waitcnt lgkmcnt(2)
    v_and_b32 v13, 3, v0
    v_mfma_f32_16x16x32_bf16 v[96:99], v[48:51], a[32:35], v[96:99]
    v_lshl_add_u32 v13, v13, 1, v12
    v_mfma_f32_16x16x32_bf16 v[96:99], v[52:55], a[192:195], v[96:99]
    buffer_load_dwordx4 v28, s[44:47], s60 offen offset:2048 sc1 lds
    v_mfma_f32_16x16x32_bf16 v[100:103], v[52:55], a[196:199], v[100:103]
    s_add_u32 m0, s65, 16384
    ds_read_b64_tr_b16 v[60:61], v1 offset:32768
    s_add_u32 s60, s77, 147456
    v_mfma_f32_16x16x32_bf16 v[100:103], v[48:51], a[36:39], v[100:103]
    ds_read_b64_tr_b16 v[62:63], v1 offset:34816
    v_lshlrev_b32_e64 v29, 2, v13
    v_mfma_f32_16x16x32_bf16 v[104:107], v[48:51], a[40:43], v[104:107]
    v_bfe_u32 v18, v0, 1, 3
    v_and_b32_e64 v19, 1, v0
    v_mfma_f32_16x16x32_bf16 v[104:107], v[52:55], a[200:203], v[104:107]
    buffer_load_dwordx4 v8, s[36:39], s60 offen offset:0 lds
    v_mfma_f32_16x16x32_bf16 v[108:111], v[52:55], a[204:207], v[108:111]
    v_lshlrev_b32 v19, 4, v19
    s_movk_i32 s83, 0x3f80
    v_mfma_f32_16x16x32_bf16 v[108:111], v[48:51], a[44:47], v[108:111]
    v_lshlrev_b32 v19, v19, s83
    s_add_u32 s83, s79, 65536
    v_mfma_f32_16x16x32_bf16 v[112:115], v[48:51], a[48:51], v[112:115]
    v_cmp_eq_u32 s[8:9], 0, v18
    v_mfma_f32_16x16x32_bf16 v[112:115], v[52:55], a[208:211], v[112:115]
    buffer_load_dwordx4 v9, s[36:39], s60 offen offset:1024 lds
    v_mfma_f32_16x16x32_bf16 v[116:119], v[52:55], a[212:215], v[116:119]
    ds_read_b64_tr_b16 v[44:45], v4 offset:32768
    v_cmp_eq_u32 s[10:11], 1, v18
    v_mfma_f32_16x16x32_bf16 v[116:119], v[48:51], a[52:55], v[116:119]
    ds_read_b64_tr_b16 v[46:47], v4 offset:34816
    v_cmp_eq_u32 s[12:13], 2, v18
    v_mfma_f32_16x16x32_bf16 v[120:123], v[48:51], a[56:59], v[120:123]
    s_cbranch_vccz L_skip25
    s_mov_b32 s98, 0
    s_atomic_add s98, s[92:93], 0x300 glc
L_skip25:
    v_cmp_eq_u32 s[14:15], 3, v18
    v_mfma_f32_16x16x32_bf16 v[120:123], v[52:55], a[216:219], v[120:123]
    buffer_load_dwordx4 v10, s[36:39], s60 offen offset:2048 lds
    v_mfma_f32_16x16x32_bf16 v[124:127], v[52:55], a[220:223], v[124:127]
    v_cndmask_b32 v12, 0, v19, s[8:9]
    v_cndmask_b32 v13, 0, v19, s[10:11]
    v_mfma_f32_16x16x32_bf16 v[124:127], v[48:51], a[60:63], v[124:127]
    s_waitcnt lgkmcnt(2)
    v_cndmask_b32 v14, 0, v19, s[12:13]
    v_cndmask_b32 v15, 0, v19, s[14:15]
    v_mfma_f32_16x16x32_bf16 v[96:99], v[56:59], v[224:227], v[96:99]
    s_nop 0
    v_cmp_eq_u32 s[8:9], 4, v18
    v_mfma_f32_16x16x32_bf16 v[96:99], v[60:63], a[64:67], v[96:99]
    ds_read_b64_tr_b16 v[48:49], v7 offset:32768
    v_cmp_eq_u32 s[10:11], 5, v18
    v_mfma_f32_16x16x32_bf16 v[100:103], v[60:63], a[68:71], v[100:103]
    v_cmp_eq_u32 s[12:13], 6, v18
    v_mfma_f32_16x16x32_bf16 v[100:103], v[56:59], v[228:231], v[100:103]
    ds_read_b64_tr_b16 v[50:51], v7 offset:34816
    v_cmp_eq_u32 s[14:15], 7, v18
    v_mfma_f32_16x16x32_bf16 v[104:107], v[56:59], v[232:235], v[104:107]
    v_cndmask_b32 v16, 0, v19, s[8:9]
    v_mfma_f32_16x16x32_bf16 v[104:107], v[60:63], a[72:75], v[104:107]
    buffer_load_dwordx4 v11, s[36:39], s60 offen offset:3072 lds
    v_mfma_f32_16x16x32_bf16 v[108:111], v[60:63], a[76:79], v[108:111]
    v_cndmask_b32 v17, 0, v19, s[10:11]
    v_cndmask_b32 v18, 0, v19, s[12:13]
    v_mfma_f32_16x16x32_bf16 v[108:111], v[56:59], v[236:239], v[108:111]
    s_nop 0
    v_cndmask_b32 v19, 0, v19, s[14:15]
    v_mfma_f32_16x16x32_bf16 v[112:115], v[56:59], v[240:243], v[112:115]
    s_barrier
    v_mfma_f32_16x16x32_bf16 v[112:115], v[60:63], a[80:83], v[112:115]
    ds_read_b64_tr_b16 v[52:53], v26 offset:16384
    v_mfma_f32_16x16x32_bf16 v[116:119], v[60:63], a[84:87], v[116:119]
    v_mfma_f32_16x16x32_bf16 v[116:119], v[56:59], v[244:247], v[116:119]
    ds_read_b64_tr_b16 v[54:55], v26 offset:18432
    v_mfma_f32_16x16x32_bf16 v[120:123], v[56:59], v[248:251], v[120:123]
    s_add_u32 m0, s65, 131072
    s_add_u32 s60, s77, 294912
    v_mfma_f32_16x16x32_bf16 v[120:123], v[60:63], a[88:91], v[120:123]
    buffer_load_dwordx4 v8, s[36:39], s60 offen offset:0 lds
    v_mfma_f32_16x16x32_bf16 v[124:127], v[60:63], a[92:95], v[124:127]
    v_mfma_f32_16x16x32_bf16 v[124:127], v[56:59], v[252:255], v[124:127]
    s_waitcnt lgkmcnt(2)
    v_mfma_f32_16x16x32_bf16 v[96:99], v[44:47], a[96:99], v[96:99]
    v_mfma_f32_16x16x32_bf16 v[96:99], v[48:51], v[128:131], v[96:99]
    s_nop 0
    ds_read_b64_tr_b16 v[56:57], v3 offset:16384
    v_mfma_f32_16x16x32_bf16 v[100:103], v[48:51], v[132:135], v[100:103]
    s_nop 0
    v_mfma_f32_16x16x32_bf16 v[100:103], v[44:47], a[100:103], v[100:103]
    s_nop 0
    ds_read_b64_tr_b16 v[58:59], v3 offset:18432
    v_mfma_f32_16x16x32_bf16 v[104:107], v[44:47], a[104:107], v[104:107]
    v_mfma_f32_16x16x32_bf16 v[104:107], v[48:51], v[136:139], v[104:107]
    buffer_load_dwordx4 v9, s[36:39], s60 offen offset:1024 lds
    v_mfma_f32_16x16x32_bf16 v[108:111], v[48:51], v[140:143], v[108:111]
    s_add_u32 s62, s1, 1048576
    v_mfma_f32_16x16x32_bf16 v[108:111], v[44:47], a[108:111], v[108:111]
    v_cvt_pk_bf16_f32 v40, v96, v97
    v_cvt_pk_bf16_f32 v41, v98, v99
    v_mfma_f32_16x16x32_bf16 v[112:115], v[44:47], a[112:115], v[112:115]
    v_cvt_pk_bf16_f32 v42, v100, v101
    v_cvt_pk_bf16_f32 v43, v102, v103
    v_mfma_f32_16x16x32_bf16 v[112:115], v[48:51], v[144:147], v[112:115]
    buffer_store_dwordx4 v[40:43], v24, s[44:47], s62 offen offset:0 sc1
    v_mfma_f32_16x16x32_bf16 v[116:119], v[48:51], v[148:151], v[116:119]
    ds_read_b64_tr_b16 v[60:61], v6 offset:16384
    v_mfma_f32_16x16x32_bf16 v[116:119], v[44:47], a[116:119], v[116:119]
    s_nop 0
    ds_read_b64_tr_b16 v[62:63], v6 offset:18432
    v_mfma_f32_16x16x32_bf16 v[120:123], v[44:47], a[120:123], v[120:123]
    s_nop 0
    v_mfma_f32_16x16x32_bf16 v[120:123], v[48:51], v[152:155], v[120:123]
    buffer_load_dwordx4 v10, s[36:39], s60 offen offset:2048 lds
    v_mfma_f32_16x16x32_bf16 v[124:127], v[48:51], v[156:159], v[124:127]
    s_nop 0
    v_mfma_f32_16x16x32_bf16 v[124:127], v[44:47], a[124:127], v[124:127]
    s_waitcnt lgkmcnt(2)
    v_mfma_f32_16x16x32_bf16 v[64:67], v[52:55], v[160:163], 0
    v_mfma_f32_16x16x32_bf16 v[64:67], v[56:59], a[224:227], v[64:67]
    ds_read_b64_tr_b16 v[44:45], v30 offset:16384
    v_mfma_f32_16x16x32_bf16 v[68:71], v[56:59], a[228:231], 0
    v_mfma_f32_16x16x32_bf16 v[68:71], v[52:55], v[164:167], v[68:71]
    ds_read_b64_tr_b16 v[46:47], v30 offset:18432
    v_mfma_f32_16x16x32_bf16 v[72:75], v[52:55], v[168:171], 0
    v_mfma_f32_16x16x32_bf16 v[72:75], v[56:59], a[232:235], v[72:75]
    buffer_load_dwordx4 v11, s[36:39], s60 offen offset:3072 lds
    v_mfma_f32_16x16x32_bf16 v[76:79], v[56:59], a[236:239], 0
    v_cvt_pk_bf16_f32 v32, v104, v105
    v_cvt_pk_bf16_f32 v33, v106, v107
    v_mfma_f32_16x16x32_bf16 v[76:79], v[52:55], v[172:175], v[76:79]
    s_waitcnt lgkmcnt(0)
    s_andn2_b32 s89, s99, s98
    s_cbranch_scc1 L_ffn_spin4
L_ffn_spin4r:
    v_mfma_f32_16x16x32_bf16 v[80:83], v[52:55], v[176:179], 0
    s_waitcnt vmcnt(12)
    s_barrier
    v_cvt_pk_bf16_f32 v34, v108, v109
    v_mfma_f32_16x16x32_bf16 v[80:83], v[56:59], a[240:243], v[80:83]
    s_cbranch_vccz L_skip24
    s_atomic_add s96, s[92:93], 0x400
L_skip24:
    ds_read_b64_tr_b16 v[48:49], v21 offset:0
    v_mfma_f32_16x16x32_bf16 v[84:87], v[56:59], a[244:247], 0
    v_cvt_pk_bf16_f32 v35, v110, v111
    v_mfma_f32_16x16x32_bf16 v[84:87], v[52:55], v[180:183], v[84:87]
    buffer_store_dwordx4 v[32:35], v24, s[44:47], s62 offen offset:1024 sc1
    v_mfma_f32_16x16x32_bf16 v[88:91], v[52:55], v[184:187], 0
    s_add_u32 m0, s65, 32768
    ds_read_b64_tr_b16 v[50:51], v21 offset:2048
    s_add_u32 s60, s1, 0
    v_mfma_f32_16x16x32_bf16 v[88:91], v[56:59], a[248:251], v[88:91]
    v_mfma_f32_16x16x32_bf16 v[92:95], v[56:59], a[252:255], 0
    v_mfma_f32_16x16x32_bf16 v[92:95], v[52:55], v[188:191], v[92:95]
    s_nop 0
    v_mfma_f32_16x16x32_bf16 v[64:67], v[60:63], a[128:131], v[64:67]
    buffer_load_dwordx4 v28, s[44:47], s60 offen offset:0 sc1 lds
    v_mfma_f32_16x16x32_bf16 v[64:67], v[44:47], a[160:163], v[64:67]
    ds_read_b64_tr_b16 v[52:53], v2 offset:0
    v_mfma_f32_16x16x32_bf16 v[68:71], v[44:47], a[164:167], v[68:71]
    v_mfma_f32_16x16x32_bf16 v[68:71], v[60:63], a[132:135], v[68:71]
    ds_read_b64_tr_b16 v[54:55], v2 offset:2048
    v_cvt_pk_bf16_f32 v36, v112, v113
    v_mfma_f32_16x16x32_bf16 v[72:75], v[60:63], a[136:139], v[72:75]
    v_cvt_pk_bf16_f32 v37, v114, v115
    v_cvt_pk_bf16_f32 v38, v116, v117
    v_mfma_f32_16x16x32_bf16 v[72:75], v[44:47], a[168:171], v[72:75]
    v_cvt_pk_bf16_f32 v39, v118, v119
    v_mfma_f32_16x16x32_bf16 v[76:79], v[44:47], a[172:175], v[76:79]
    buffer_store_dwordx4 v[36:39], v24, s[44:47], s62 offen offset:2048 sc1
    v_mfma_f32_16x16x32_bf16 v[76:79], v[60:63], a[140:143], v[76:79]
    s_add_u32 s60, s1, 130048
    v_mfma_f32_16x16x32_bf16 v[80:83], v[60:63], a[144:147], v[80:83]
    v_mfma_f32_16x16x32_bf16 v[80:83], v[44:47], a[176:179], v[80:83]
    ds_read_b64_tr_b16 v[56:57], v5 offset:0
    v_mfma_f32_16x16x32_bf16 v[84:87], v[44:47], a[180:183], v[84:87]
    buffer_load_dwordx4 v28, s[44:47], s60 offen offset:1024 sc1 lds
    v_mfma_f32_16x16x32_bf16 v[84:87], v[60:63], a[148:151], v[84:87]
    ds_read_b64_tr_b16 v[58:59], v5 offset:2048
    v_mfma_f32_16x16x32_bf16 v[88:91], v[60:63], a[152:155], v[88:91]
    v_mfma_f32_16x16x32_bf16 v[88:91], v[44:47], a[184:187], v[88:91]
    v_mfma_f32_16x16x32_bf16 v[92:95], v[44:47], a[188:191], v[92:95]
    v_mfma_f32_16x16x32_bf16 v[92:95], v[60:63], a[156:159], v[92:95]
    s_waitcnt lgkmcnt(2)
    v_mfma_f32_16x16x32_bf16 v[64:67], v[48:51], v[192:195], v[64:67]
    s_nop 0
    v_mfma_f32_16x16x32_bf16 v[64:67], v[52:55], a[0:3], v[64:67]
    s_add_u32 s60, s1, 260096
    ds_read_b64_tr_b16 v[60:61], v27 offset:0
    v_cvt_pk_bf16_f32 v40, v120, v121
    v_mfma_f32_16x16x32_bf16 v[68:71], v[52:55], a[4:7], v[68:71]
    buffer_load_dwordx4 v28, s[44:47], s60 offen offset:2048 sc1 lds
    v_mfma_f32_16x16x32_bf16 v[68:71], v[48:51], v[196:199], v[68:71]
    ds_read_b64_tr_b16 v[62:63], v27 offset:2048
    v_cvt_pk_bf16_f32 v41, v122, v123
    v_mfma_f32_16x16x32_bf16 v[72:75], v[48:51], v[200:203], v[72:75]
    v_cvt_pk_bf16_f32 v42, v124, v125
    v_cvt_pk_bf16_f32 v43, v126, v127
    v_mfma_f32_16x16x32_bf16 v[72:75], v[52:55], a[8:11], v[72:75]
    v_mfma_f32_16x16x32_bf16 v[76:79], v[52:55], a[12:15], v[76:79]
    buffer_store_dwordx4 v[40:43], v24, s[44:47], s62 offen offset:3072 sc1
    v_mfma_f32_16x16x32_bf16 v[76:79], v[48:51], v[204:207], v[76:79]
    s_nop 0
    v_mfma_f32_16x16x32_bf16 v[80:83], v[48:51], v[208:211], v[80:83]
    s_barrier
    v_mfma_f32_16x16x32_bf16 v[80:83], v[52:55], a[16:19], v[80:83]
    ds_read_b64_tr_b16 v[44:45], v21 offset:16384
    v_mfma_f32_16x16x32_bf16 v[84:87], v[52:55], a[20:23], v[84:87]
    v_mfma_f32_16x16x32_bf16 v[84:87], v[48:51], v[212:215], v[84:87]
    s_nop 0
    ds_read_b64_tr_b16 v[46:47], v21 offset:18432
    v_mfma_f32_16x16x32_bf16 v[88:91], v[48:51], v[216:219], v[88:91]
    s_add_u32 m0, s65, 147456
    s_add_u32 s60, s78, 0
    v_mfma_f32_16x16x32_bf16 v[88:91], v[52:55], a[24:27], v[88:91]
    buffer_load_dwordx4 v8, s[36:39], s60 offen offset:0 lds
    v_mfma_f32_16x16x32_bf16 v[92:95], v[52:55], a[28:31], v[92:95]
    v_mfma_f32_16x16x32_bf16 v[92:95], v[48:51], v[220:223], v[92:95]
    s_waitcnt lgkmcnt(2)
    v_mfma_f32_16x16x32_bf16 v[64:67], v[56:59], a[32:35], v[64:67]
    v_mfma_f32_16x16x32_bf16 v[64:67], v[60:63], a[192:195], v[64:67]
    s_nop 0
    ds_read_b64_tr_b16 v[48:49], v2 offset:16384
    v_mfma_f32_16x16x32_bf16 v[68:71], v[60:63], a[196:199], v[68:71]
    v_mfma_f32_16x16x32_bf16 v[68:71], v[56:59], a[36:39], v[68:71]
    ds_read_b64_tr_b16 v[50:51], v2 offset:18432
    v_mfma_f32_16x16x32_bf16 v[72:75], v[56:59], a[40:43], v[72:75]
    v_mfma_f32_16x16x32_bf16 v[72:75], v[60:63], a[200:203], v[72:75]
    buffer_load_dwordx4 v9, s[36:39], s60 offen offset:1024 lds
    v_mfma_f32_16x16x32_bf16 v[76:79], v[60:63], a[204:207], v[76:79]
    v_mfma_f32_16x16x32_bf16 v[76:79], v[56:59], a[44:47], v[76:79]
    v_mfma_f32_16x16x32_bf16 v[80:83], v[56:59], a[48:51], v[80:83]
    v_mfma_f32_16x16x32_bf16 v[80:83], v[60:63], a[208:211], v[80:83]
    ds_read_b64_tr_b16 v[52:53], v5 offset:16384
    v_mfma_f32_16x16x32_bf16 v[84:87], v[60:63], a[212:215], v[84:87]
    v_mfma_f32_16x16x32_bf16 v[84:87], v[56:59], a[52:55], v[84:87]
    ds_read_b64_tr_b16 v[54:55], v5 offset:18432
    v_mfma_f32_16x16x32_bf16 v[88:91], v[56:59], a[56:59], v[88:91]
    s_cbranch_vccz L_skip27
    s_mov_b32 s97, 0
    s_atomic_add s97, s[92:93], 0x400 glc
L_skip27:
    v_mfma_f32_16x16x32_bf16 v[88:91], v[60:63], a[216:219], v[88:91]
    buffer_load_dwordx4 v10, s[36:39], s60 offen offset:2048 lds
    v_mfma_f32_16x16x32_bf16 v[92:95], v[60:63], a[220:223], v[92:95]
    v_mfma_f32_16x16x32_bf16 v[92:95], v[56:59], a[60:63], v[92:95]
    s_waitcnt lgkmcnt(2)
    v_mfma_f32_16x16x32_bf16 v[64:67], v[44:47], v[224:227], v[64:67]
    v_mfma_f32_16x16x32_bf16 v[64:67], v[48:51], a[64:67], v[64:67]
    s_nop 0
    ds_read_b64_tr_b16 v[56:57], v27 offset:16384
    v_mfma_f32_16x16x32_bf16 v[68:71], v[48:51], a[68:71], v[68:71]
    v_mfma_f32_16x16x32_bf16 v[68:71], v[44:47], v[228:231], v[68:71]
    ds_read_b64_tr_b16 v[58:59], v27 offset:18432
    v_mfma_f32_16x16x32_bf16 v[72:75], v[44:47], v[232:235], v[72:75]
    v_mfma_f32_16x16x32_bf16 v[72:75], v[48:51], a[72:75], v[72:75]
    buffer_load_dwordx4 v11, s[36:39], s60 offen offset:3072 lds
    v_mfma_f32_16x16x32_bf16 v[76:79], v[48:51], a[76:79], v[76:79]
    v_mfma_f32_16x16x32_bf16 v[76:79], v[44:47], v[236:239], v[76:79]
    v_mfma_f32_16x16x32_bf16 v[80:83], v[44:47], v[240:243], v[80:83]
    s_barrier
    v_mfma_f32_16x16x32_bf16 v[80:83], v[48:51], a[80:83], v[80:83]
    s_nop 0
    ds_read_b64_tr_b16 v[60:61], v21 offset:49152
    v_mfma_f32_16x16x32_bf16 v[84:87], v[48:51], a[84:87], v[84:87]
    v_mfma_f32_16x16x32_bf16 v[84:87], v[44:47], v[244:247], v[84:87]
    ds_read_b64_tr_b16 v[62:63], v21 offset:51200
    v_mfma_f32_16x16x32_bf16 v[88:91], v[44:47], v[248:251], v[88:91]
    s_add_u32 m0, s65, 65536
    s_add_u32 s60, s78, 147456
    v_mfma_f32_16x16x32_bf16 v[88:91], v[48:51], a[88:91], v[88:91]
    buffer_load_dwordx4 v8, s[36:39], s60 offen offset:0 lds
    v_mfma_f32_16x16x32_bf16 v[92:95], v[48:51], a[92:95], v[92:95]
    s_nop 0
    v_mfma_f32_16x16x32_bf16 v[92:95], v[44:47], v[252:255], v[92:95]
    s_waitcnt lgkmcnt(2)
    v_mfma_f32_16x16x32_bf16 v[64:67], v[52:55], a[96:99], v[64:67]
    s_nop 0
    v_mfma_f32_16x16x32_bf16 v[64:67], v[56:59], v[128:131], v[64:67]
    s_nop 0
    ds_read_b64_tr_b16 v[44:45], v2 offset:49152
    v_mfma_f32_16x16x32_bf16 v[68:71], v[56:59], v[132:135], v[68:71]
    s_nop 0
    v_mfma_f32_16x16x32_bf16 v[68:71], v[52:55], a[100:103], v[68:71]
    s_nop 0
    ds_read_b64_tr_b16 v[46:47], v2 offset:51200
    v_mfma_f32_16x16x32_bf16 v[72:75], v[52:55], a[104:107], v[72:75]
    v_mfma_f32_16x16x32_bf16 v[72:75], v[56:59], v[136:139], v[72:75]
    buffer_load_dwordx4 v9, s[36:39], s60 offen offset:1024 lds
    v_mfma_f32_16x16x32_bf16 v[76:79], v[56:59], v[140:143], v[76:79]
    s_add_u32 s62, s61, 0
    v_mfma_f32_16x16x32_bf16 v[76:79], v[52:55], a[108:111], v[76:79]
    s_nop 0
    v_cvt_pk_bf16_f32 v32, v64, v65
    v_cvt_pk_bf16_f32 v33, v66, v67
    v_mfma_f32_16x16x32_bf16 v[80:83], v[52:55], a[112:115], v[80:83]
    v_cvt_pk_bf16_f32 v34, v68, v69
    v_cvt_pk_bf16_f32 v35, v70, v71
    v_mfma_f32_16x16x32_bf16 v[80:83], v[56:59], v[144:147], v[80:83]
    buffer_store_dwordx4 v[32:35], v24, s[44:47], s62 offen offset:0 sc1
    v_mfma_f32_16x16x32_bf16 v[84:87], v[56:59], v[148:151], v[84:87]
    ds_read_b64_tr_b16 v[48:49], v5 offset:49152
    v_mfma_f32_16x16x32_bf16 v[84:87], v[52:55], a[116:119], v[84:87]
    s_nop 0
    ds_read_b64_tr_b16 v[50:51], v5 offset:51200
    v_mfma_f32_16x16x32_bf16 v[88:91], v[52:55], a[120:123], v[88:91]
    s_nop 0
    v_mfma_f32_16x16x32_bf16 v[88:91], v[56:59], v[152:155], v[88:91]
    buffer_load_dwordx4 v10, s[36:39], s60 offen offset:2048 lds
    v_mfma_f32_16x16x32_bf16 v[92:95], v[56:59], v[156:159], v[92:95]
    s_nop 0
    v_mfma_f32_16x16x32_bf16 v[92:95], v[52:55], a[124:127], v[92:95]
    s_waitcnt lgkmcnt(2)
    v_mfma_f32_16x16x32_bf16 v[96:99], v[60:63], v[160:163], 0
    v_mfma_f32_16x16x32_bf16 v[96:99], v[44:47], a[224:227], v[96:99]
    ds_read_b64_tr_b16 v[52:53], v27 offset:49152
    v_mfma_f32_16x16x32_bf16 v[100:103], v[44:47], a[228:231], 0
    v_mfma_f32_16x16x32_bf16 v[100:103], v[60:63], v[164:167], v[100:103]
    ds_read_b64_tr_b16 v[54:55], v27 offset:51200
    v_mfma_f32_16x16x32_bf16 v[104:107], v[60:63], v[168:171], 0
    v_mfma_f32_16x16x32_bf16 v[104:107], v[44:47], a[232:235], v[104:107]
    buffer_load_dwordx4 v11, s[36:39], s60 offen offset:3072 lds
    v_mfma_f32_16x16x32_bf16 v[108:111], v[44:47], a[236:239], 0
    v_cvt_pk_bf16_f32 v36, v72, v73
    v_cvt_pk_bf16_f32 v37, v74, v75
    v_mfma_f32_16x16x32_bf16 v[108:111], v[60:63], v[172:175], v[108:111]
    s_waitcnt lgkmcnt(0)
    s_andn2_b32 s89, s99, s97
    s_cbranch_scc1 L_ffn_spin5
L_ffn_spin5r:
    v_mfma_f32_16x16x32_bf16 v[112:115], v[60:63], v[176:179], 0
    s_waitcnt vmcnt(9)
    s_barrier
    v_cvt_pk_bf16_f32 v38, v76, v77
    v_mfma_f32_16x16x32_bf16 v[112:115], v[44:47], a[240:243], v[112:115]
    s_cbranch_vccz L_skip26
    s_atomic_add s96, s[92:93], 0x500
L_skip26:
    ds_read_b64_tr_b16 v[56:57], v22 offset:16384
    v_mfma_f32_16x16x32_bf16 v[116:119], v[44:47], a[244:247], 0
    v_cvt_pk_bf16_f32 v39, v78, v79
    v_mfma_f32_16x16x32_bf16 v[116:119], v[60:63], v[180:183], v[116:119]
    buffer_store_dwordx4 v[36:39], v24, s[44:47], s62 offen offset:1024 sc1
    v_mfma_f32_16x16x32_bf16 v[120:123], v[60:63], v[184:187], 0
    s_add_u32 m0, s65, 81920
    ds_read_b64_tr_b16 v[58:59], v22 offset:18432
    s_add_u32 s60, s1, 524288
    v_mfma_f32_16x16x32_bf16 v[120:123], v[44:47], a[248:251], v[120:123]
    s_cbranch_vccz L_skip28
    s_mov_b32 s66, 0
    s_atomic_add s66, s[92:93], 0x900 glc
L_skip28:
    v_mfma_f32_16x16x32_bf16 v[124:127], v[44:47], a[252:255], 0
    v_mfma_f32_16x16x32_bf16 v[124:127], v[60:63], v[188:191], v[124:127]
    v_mfma_f32_16x16x32_bf16 v[96:99], v[48:51], a[128:131], v[96:99]
    buffer_load_dwordx4 v28, s[44:47], s60 offen offset:0 sc1 lds
    v_mfma_f32_16x16x32_bf16 v[96:99], v[52:55], a[160:163], v[96:99]
    ds_read_b64_tr_b16 v[60:61], v1 offset:16384
    v_mfma_f32_16x16x32_bf16 v[100:103], v[52:55], a[164:167], v[100:103]
    v_mfma_f32_16x16x32_bf16 v[100:103], v[48:51], a[132:135], v[100:103]
    ds_read_b64_tr_b16 v[62:63], v1 offset:18432
    v_cvt_pk_bf16_f32 v40, v80, v81
    v_mfma_f32_16x16x32_bf16 v[104:107], v[48:51], a[136:139], v[104:107]
    v_cvt_pk_bf16_f32 v41, v82, v83
    v_cvt_pk_bf16_f32 v42, v84, v85
    v_mfma_f32_16x16x32_bf16 v[104:107], v[52:55], a[168:171], v[104:107]
    v_cvt_pk_bf16_f32 v43, v86, v87
    v_mfma_f32_16x16x32_bf16 v[108:111], v[52:55], a[172:175], v[108:111]
    buffer_store_dwordx4 v[40:43], v24, s[44:47], s62 offen offset:2048 sc1
    v_mfma_f32_16x16x32_bf16 v[108:111], v[48:51], a[140:143], v[108:111]
    s_add_u32 s60, s1, 654336
    v_mfma_f32_16x16x32_bf16 v[112:115], v[48:51], a[144:147], v[112:115]
    v_mfma_f32_16x16x32_bf16 v[112:115], v[52:55], a[176:179], v[112:115]
    ds_read_b64_tr_b16 v[44:45], v4 offset:16384
    v_mfma_f32_16x16x32_bf16 v[116:119], v[52:55], a[180:183], v[116:119]
    buffer_load_dwordx4 v28, s[44:47], s60 offen offset:1024 sc1 lds
    v_mfma_f32_16x16x32_bf16 v[116:119], v[48:51], a[148:151], v[116:119]
    ds_read_b64_tr_b16 v[46:47], v4 offset:18432
    v_mfma_f32_16x16x32_bf16 v[120:123], v[48:51], a[152:155], v[120:123]
    v_mfma_f32_16x16x32_bf16 v[120:123], v[52:55], a[184:187], v[120:123]
    v_mfma_f32_16x16x32_bf16 v[124:127], v[52:55], a[188:191], v[124:127]
    v_mfma_f32_16x16x32_bf16 v[124:127], v[48:51], a[156:159], v[124:127]
    s_waitcnt lgkmcnt(2)
    v_mfma_f32_16x16x32_bf16 v[96:99], v[56:59], v[192:195], v[96:99]
    s_nop 0
    v_mfma_f32_16x16x32_bf16 v[96:99], v[60:63], a[0:3], v[96:99]
    s_add_u32 s60, s1, 784384
    ds_read_b64_tr_b16 v[48:49], v7 offset:16384
    v_cvt_pk_bf16_f32 v32, v88, v89
    v_mfma_f32_16x16x32_bf16 v[100:103], v[60:63], a[4:7], v[100:103]
    buffer_load_dwordx4 v28, s[44:47], s60 offen offset:2048 sc1 lds
    v_mfma_f32_16x16x32_bf16 v[100:103], v[56:59], v[196:199], v[100:103]
    ds_read_b64_tr_b16 v[50:51], v7 offset:18432
    v_cvt_pk_bf16_f32 v33, v90, v91
    v_mfma_f32_16x16x32_bf16 v[104:107], v[56:59], v[200:203], v[104:107]
    v_cvt_pk_bf16_f32 v34, v92, v93
    v_cvt_pk_bf16_f32 v35, v94, v95
    v_mfma_f32_16x16x32_bf16 v[104:107], v[60:63], a[8:11], v[104:107]
    v_mfma_f32_16x16x32_bf16 v[108:111], v[60:63], a[12:15], v[108:111]
    buffer_store_dwordx4 v[32:35], v24, s[44:47], s62 offen offset:3072 sc1
    v_mfma_f32_16x16x32_bf16 v[108:111], v[56:59], v[204:207], v[108:111]
    s_waitcnt lgkmcnt(0)
    s_andn2_b32 s89, s100, s66
    s_cbranch_scc1 L_ffn_spin6
L_ffn_spin6r:
    v_mfma_f32_16x16x32_bf16 v[112:115], v[56:59], v[208:211], v[112:115]
    s_barrier
    v_mfma_f32_16x16x32_bf16 v[112:115], v[60:63], a[16:19], v[112:115]
    ds_read_b64_tr_b16 v[52:53], v26 offset:0
    v_mfma_f32_16x16x32_bf16 v[116:119], v[60:63], a[20:23], v[116:119]
    v_mfma_f32_16x16x32_bf16 v[116:119], v[56:59], v[212:215], v[116:119]
    ds_read_b64_tr_b16 v[54:55], v26 offset:2048
    v_mfma_f32_16x16x32_bf16 v[120:123], v[56:59], v[216:219], v[120:123]
    s_add_u32 m0, s65, 114688
    s_add_u32 s60, s78, 294912
    v_mfma_f32_16x16x32_bf16 v[120:123], v[60:63], a[24:27], v[120:123]
L_ffn_pad7:
    s_cbranch_execz L_ffn_ret1
    buffer_load_dwordx4 v8, s[36:39], s60 offen offset:0 lds
    v_mfma_f32_16x16x32_bf16 v[124:127], v[60:63], a[28:31], v[124:127]
    v_mfma_f32_16x16x32_bf16 v[124:127], v[56:59], v[220:223], v[124:127]
    s_nop 0
    v_mfma_f32_16x16x32_bf16 v[96:99], v[44:47], a[32:35], v[96:99]
    v_mfma_f32_16x16x32_bf16 v[96:99], v[48:51], a[192:195], v[96:99]
    ds_read_b64_tr_b16 v[56:57], v3 offset:0
    v_mfma_f32_16x16x32_bf16 v[100:103], v[48:51], a[196:199], v[100:103]
    buffer_load_dwordx4 v9, s[36:39], s60 offen offset:1024 lds
    v_mfma_f32_16x16x32_bf16 v[100:103], v[44:47], a[36:39], v[100:103]
    ds_read_b64_tr_b16 v[58:59], v3 offset:2048
    v_mfma_f32_16x16x32_bf16 v[104:107], v[44:47], a[40:43], v[104:107]
    v_mfma_f32_16x16x32_bf16 v[104:107], v[48:51], a[200:203], v[104:107]
    v_mfma_f32_16x16x32_bf16 v[108:111], v[48:51], a[204:207], v[108:111]
    v_mfma_f32_16x16x32_bf16 v[108:111], v[44:47], a[44:47], v[108:111]
    buffer_load_dwordx4 v10, s[36:39], s60 offen offset:2048 lds
    v_mfma_f32_16x16x32_bf16 v[112:115], v[44:47], a[48:51], v[112:115]
    v_mfma_f32_16x16x32_bf16 v[112:115], v[48:51], a[208:211], v[112:115]
    ds_read_b64_tr_b16 v[60:61], v6 offset:0
    v_mfma_f32_16x16x32_bf16 v[116:119], v[48:51], a[212:215], v[116:119]
    v_mfma_f32_16x16x32_bf16 v[116:119], v[44:47], a[52:55], v[116:119]
    ds_read_b64_tr_b16 v[62:63], v6 offset:2048
    v_mfma_f32_16x16x32_bf16 v[120:123], v[44:47], a[56:59], v[120:123]
    s_cbranch_vccz L_skip30
    s_mov_b32 s98, 0
    s_atomic_add s98, s[92:93], 0x500 glc
L_skip30:
    v_mfma_f32_16x16x32_bf16 v[120:123], v[48:51], a[216:219], v[120:123]
    buffer_load_dwordx4 v11, s[36:39], s60 offen offset:3072 lds
    v_mfma_f32_16x16x32_bf16 v[124:127], v[48:51], a[220:223], v[124:127]
    s_nop 0
    v_mfma_f32_16x16x32_bf16 v[124:127], v[44:47], a[60:63], v[124:127]
    s_waitcnt lgkmcnt(2)
    v_mfma_f32_16x16x32_bf16 v[96:99], v[52:55], v[224:227], v[96:99]
    v_mfma_f32_16x16x32_bf16 v[96:99], v[56:59], a[64:67], v[96:99]
    s_add_u32 m0, s65, 3072
    ds_read_b64_tr_b16 v[44:45], v30 offset:0
    v_mfma_f32_16x16x32_bf16 v[100:103], v[56:59], a[68:71], v[100:103]
    buffer_load_dwordx4 v31, s[52:55], 0 offen lds
    v_mfma_f32_16x16x32_bf16 v[100:103], v[52:55], v[228:231], v[100:103]
    ds_read_b64_tr_b16 v[46:47], v30 offset:2048
    v_mfma_f32_16x16x32_bf16 v[104:107], v[52:55], v[232:235], v[104:107]
    v_mfma_f32_16x16x32_bf16 v[104:107], v[56:59], a[72:75], v[104:107]
    v_mfma_f32_16x16x32_bf16 v[108:111], v[56:59], a[76:79], v[108:111]
    v_mfma_f32_16x16x32_bf16 v[108:111], v[52:55], v[236:239], v[108:111]
    buffer_load_dword v25, v29, s[44:47], s83 offen sc1
    v_mfma_f32_16x16x32_bf16 v[112:115], v[52:55], v[240:243], v[112:115]
    s_waitcnt vmcnt(17)
    s_barrier
    v_mfma_f32_16x16x32_bf16 v[112:115], v[56:59], a[80:83], v[112:115]
    ds_read_b64_tr_b16 v[48:49], v26 offset:16384
    v_mfma_f32_16x16x32_bf16 v[116:119], v[56:59], a[84:87], v[116:119]
    v_mfma_f32_16x16x32_bf16 v[116:119], v[52:55], v[244:247], v[116:119]
    ds_read_b64_tr_b16 v[50:51], v26 offset:18432
    v_mfma_f32_16x16x32_bf16 v[120:123], v[52:55], v[248:251], v[120:123]
    v_mfma_f32_16x16x32_bf16 v[120:123], v[56:59], a[88:91], v[120:123]
    v_mfma_f32_16x16x32_bf16 v[124:127], v[56:59], a[92:95], v[124:127]
    v_mfma_f32_16x16x32_bf16 v[124:127], v[52:55], v[252:255], v[124:127]
    s_waitcnt lgkmcnt(2)
    v_mfma_f32_16x16x32_bf16 v[96:99], v[60:63], a[96:99], v[96:99]
    s_nop 0
    v_mfma_f32_16x16x32_bf16 v[96:99], v[44:47], v[128:131], v[96:99]
    ds_read_b64_tr_b16 v[52:53], v3 offset:16384
    v_mfma_f32_16x16x32_bf16 v[100:103], v[44:47], v[132:135], v[100:103]
    v_mfma_f32_16x16x32_bf16 v[100:103], v[60:63], a[100:103], v[100:103]
    ds_read_b64_tr_b16 v[54:55], v3 offset:18432
    v_mfma_f32_16x16x32_bf16 v[104:107], v[60:63], a[104:107], v[104:107]
    v_mfma_f32_16x16x32_bf16 v[104:107], v[44:47], v[136:139], v[104:107]
    s_add_u32 s62, s61, 524288
    v_mfma_f32_16x16x32_bf16 v[108:111], v[44:47], v[140:143], v[108:111]
    v_mfma_f32_16x16x32_bf16 v[108:111], v[60:63], a[108:111], v[108:111]
    v_cvt_pk_bf16_f32 v36, v96, v97
    v_cvt_pk_bf16_f32 v37, v98, v99
    v_mfma_f32_16x16x32_bf16 v[112:115], v[60:63], a[112:115], v[112:115]
    v_cvt_pk_bf16_f32 v38, v100, v101
    v_cvt_pk_bf16_f32 v39, v102, v103
    v_mfma_f32_16x16x32_bf16 v[112:115], v[44:47], v[144:147], v[112:115]
    buffer_store_dwordx4 v[36:39], v24, s[44:47], s62 offen offset:0 sc1
    v_mfma_f32_16x16x32_bf16 v[116:119], v[44:47], v[148:151], v[116:119]
    ds_read_b64_tr_b16 v[56:57], v6 offset:16384
    v_mfma_f32_16x16x32_bf16 v[116:119], v[60:63], a[116:119], v[116:119]
    ds_read_b64_tr_b16 v[58:59], v6 offset:18432
    v_mfma_f32_16x16x32_bf16 v[120:123], v[60:63], a[120:123], v[120:123]
    v_cvt_pk_bf16_f32 v40, v104, v105
    v_cvt_pk_bf16_f32 v41, v106, v107
    v_mfma_f32_16x16x32_bf16 v[120:123], v[44:47], v[152:155], v[120:123]
    v_cvt_pk_bf16_f32 v42, v108, v109
    v_cvt_pk_bf16_f32 v43, v110, v111
    v_mfma_f32_16x16x32_bf16 v[124:127], v[44:47], v[156:159], v[124:127]
    buffer_store_dwordx4 v[40:43], v24, s[44:47], s62 offen offset:1024 sc1
    v_mfma_f32_16x16x32_bf16 v[124:127], v[60:63], a[124:127], v[124:127]
    s_waitcnt lgkmcnt(2)
    v_mfma_f32_16x16x32_bf16 v[64:67], v[48:51], v[160:163], 0
    s_nop 0
    v_mfma_f32_16x16x32_bf16 v[64:67], v[52:55], a[224:227], v[64:67]
    ds_read_b64_tr_b16 v[60:61], v30 offset:16384
    v_cvt_pk_bf16_f32 v32, v112, v113
    v_mfma_f32_16x16x32_bf16 v[68:71], v[52:55], a[228:231], 0
    v_cvt_pk_bf16_f32 v33, v114, v115
    v_cvt_pk_bf16_f32 v34, v116, v117
    v_mfma_f32_16x16x32_bf16 v[68:71], v[48:51], v[164:167], v[68:71]
    ds_read_b64_tr_b16 v[62:63], v30 offset:18432
    v_cvt_pk_bf16_f32 v35, v118, v119
    v_mfma_f32_16x16x32_bf16 v[72:75], v[48:51], v[168:171], 0
    buffer_store_dwordx4 v[32:35], v24, s[44:47], s62 offen offset:2048 sc1
    v_mfma_f32_16x16x32_bf16 v[72:75], v[52:55], a[232:235], v[72:75]
    s_nop 0
    v_mfma_f32_16x16x32_bf16 v[76:79], v[52:55], a[236:239], 0
    s_nop 0
    v_cvt_pk_bf16_f32 v36, v120, v121
    v_cvt_pk_bf16_f32 v37, v122, v123
    v_mfma_f32_16x16x32_bf16 v[76:79], v[48:51], v[172:175], v[76:79]
    s_waitcnt lgkmcnt(0)
    s_andn2_b32 s89, s99, s98
    s_cbranch_scc1 L_ffn_spin7
L_ffn_spin7r:
    v_mfma_f32_16x16x32_bf16 v[80:83], v[48:51], v[176:179], 0
    s_waitcnt vmcnt(9)
    s_barrier
    v_cvt_pk_bf16_f32 v38, v124, v125
    v_mfma_f32_16x16x32_bf16 v[80:83], v[52:55], a[240:243], v[80:83]
    s_cbranch_vccz L_skip29
    s_atomic_add s96, s[92:93], 0x600
L_skip29:
    ds_read_b64_tr_b16 v[44:45], v21 offset:0
    v_mfma_f32_16x16x32_bf16 v[84:87], v[52:55], a[244:247], 0
    v_cvt_pk_bf16_f32 v39, v126, v127
    v_mfma_f32_16x16x32_bf16 v[84:87], v[48:51], v[180:183], v[84:87]
    buffer_store_dwordx4 v[36:39], v24, s[44:47], s62 offen offset:3072 sc1
    v_mfma_f32_16x16x32_bf16 v[88:91], v[48:51], v[184:187], 0
    ds_read_b64_tr_b16 v[46:47], v21 offset:2048
    v_mfma_f32_16x16x32_bf16 v[88:91], v[52:55], a[248:251], v[88:91]
    v_mfma_f32_16x16x32_bf16 v[92:95], v[52:55], a[252:255], 0
    v_mfma_f32_16x16x32_bf16 v[92:95], v[48:51], v[188:191], v[92:95]
    v_mfma_f32_16x16x32_bf16 v[64:67], v[56:59], a[128:131], v[64:67]
    v_mfma_f32_16x16x32_bf16 v[64:67], v[60:63], a[160:163], v[64:67]
    s_add_u32 s60, s1, 1048576
    ds_read_b64_tr_b16 v[48:49], v2 offset:0
    v_add_u32_e64 v160, s65, v23
    v_mfma_f32_16x16x32_bf16 v[68:71], v[60:63], a[164:167], v[68:71]
    buffer_load_dwordx4 a[224:227], v28, s[44:47], s60 offen sc1
    v_mfma_f32_16x16x32_bf16 v[68:71], v[56:59], a[132:135], v[68:71]
    ds_read_b64_tr_b16 v[50:51], v2 offset:2048
    v_add_u32 v161, 0x10000, v160
    v_mfma_f32_16x16x32_bf16 v[72:75], v[56:59], a[136:139], v[72:75]
    v_add_u32 v162, 0x20000, v160
    s_add_u32 s67, s65, 3072
    v_mfma_f32_16x16x32_bf16 v[72:75], v[60:63], a[168:171], v[72:75]
    v_lshrrev_b32_e64 v182, 5, v0
    v_bfe_u32 v183, v0, 2, 2
    v_mfma_f32_16x16x32_bf16 v[76:79], v[60:63], a[172:175], v[76:79]
    v_lshl_add_u32 v163, v183, 3, s67
    v_lshl_add_u32 v163, v182, 5, v163
    v_mfma_f32_16x16x32_bf16 v[76:79], v[56:59], a[140:143], v[76:79]
    s_lshl_b32 s67, s58, 8
    v_and_b32 v184, 15, v0
    v_lshl_add_u32 v184, v184, 4, s67
    v_mfma_f32_16x16x32_bf16 v[80:83], v[56:59], a[144:147], v[80:83]
    s_and_b32 s67, s57, 7
    v_lshrrev_b32 v185, 4, v0
    v_add_u32_e64 v186, s67, v185
    v_mfma_f32_16x16x32_bf16 v[80:83], v[60:63], a[176:179], v[80:83]
    ds_read_b64_tr_b16 v[52:53], v5 offset:0
    v_subrev_u32 v187, 9, v186
    v_mfma_f32_16x16x32_bf16 v[84:87], v[60:63], a[180:183], v[84:87]
    v_min_u32 v186, v186, v187
    v_lshl_add_u32 v165, v186, 15, v184
    v_mfma_f32_16x16x32_bf16 v[84:87], v[56:59], a[148:151], v[84:87]
    s_add_u32 s60, s1, 1179648
    ds_read_b64_tr_b16 v[54:55], v5 offset:2048
    v_add_u32_e64 v186, 4, v186
    v_mfma_f32_16x16x32_bf16 v[88:91], v[56:59], a[152:155], v[88:91]
    buffer_load_dwordx4 a[228:231], v28, s[44:47], s60 offen sc1
    v_mfma_f32_16x16x32_bf16 v[88:91], v[60:63], a[184:187], v[88:91]
    v_subrev_u32_e64 v187, 9, v186
    v_min_u32_e64 v186, v186, v187
    v_mfma_f32_16x16x32_bf16 v[92:95], v[60:63], a[188:191], v[92:95]
    v_lshl_add_u32 v166, v186, 15, v184
    v_add_u32_e64 v186, 4, v186
    v_mfma_f32_16x16x32_bf16 v[92:95], v[56:59], a[156:159], v[92:95]
    s_waitcnt lgkmcnt(2)
    v_subrev_u32 v187, 9, v186
    v_min_u32_e64 v186, v186, v187
    v_mfma_f32_16x16x32_bf16 v[64:67], v[44:47], v[192:195], v[64:67]
    v_lshl_add_u32 v167, v186, 15, v184
    v_min_u32 v187, 1, v185
    v_mfma_f32_16x16x32_bf16 v[64:67], v[48:51], a[0:3], v[64:67]
    s_waitcnt vmcnt(7)
    ds_read_b64_tr_b16 v[56:57], v27 offset:0
    v_lshl_add_u32 v167, v187, 31, v167
    v_mfma_f32_16x16x32_bf16 v[68:71], v[48:51], a[4:7], v[68:71]
    v_bfe_u32 v187, v0, 3, 1
    v_sub_u32_e64 v187, v185, v187
    v_mfma_f32_16x16x32_bf16 v[68:71], v[44:47], v[196:199], v[68:71]
    s_mov_b32 s89, 0x12345
    ds_read_b64_tr_b16 v[58:59], v27 offset:2048
    ds_read_b64 v[116:117], v163 offset:0
    v_mfma_f32_16x16x32_bf16 v[72:75], v[44:47], v[200:203], v[72:75]
    v_cmp_eq_u32 s[8:9], 0, v187
    v_cmp_eq_u32 s[10:11], 2, v187
    v_mfma_f32_16x16x32_bf16 v[72:75], v[48:51], a[8:11], v[72:75]
    ds_read_b64 v[118:119], v163 offset:64
    v_and_b32_e64 v188, 3, v0
    v_mfma_f32_16x16x32_bf16 v[76:79], v[48:51], a[12:15], v[76:79]
    s_add_u32 s60, s1, 1310720
    v_lshl_add_u32 v164, v188, 2, v183
    v_and_or_b32 v164, v0, 48, v164
    v_mfma_f32_16x16x32_bf16 v[76:79], v[44:47], v[204:207], v[76:79]
    buffer_load_dwordx4 a[232:235], v28, s[44:47], s60 offen sc1
    v_mfma_f32_16x16x32_bf16 v[80:83], v[44:47], v[208:211], v[80:83]
    s_barrier
    ds_read_b64 v[120:121], v163 offset:128
    v_mfma_f32_16x16x32_bf16 v[80:83], v[48:51], a[16:19], v[80:83]
    s_nop 0
    ds_read_b64_tr_b16 v[60:61], v21 offset:49152
    ds_read_b64 v[122:123], v163 offset:192
    v_mfma_f32_16x16x32_bf16 v[84:87], v[48:51], a[20:23], v[84:87]
    v_lshlrev_b32_e64 v164, 2, v164
    v_or_b32 v187, v12, v16
    v_mfma_f32_16x16x32_bf16 v[84:87], v[44:47], v[212:215], v[84:87]
    s_nop 0
    ds_read_b64_tr_b16 v[62:63], v21 offset:51200
    ds_read_b64 v[124:125], v163 offset:256
    v_mfma_f32_16x16x32_bf16 v[88:91], v[44:47], v[216:219], v[88:91]
    v_cndmask_b32 v168, 0, v187, s[8:9]
    v_cndmask_b32 v172, 0, v187, s[10:11]
    v_mfma_f32_16x16x32_bf16 v[88:91], v[48:51], a[24:27], v[88:91]
    v_or_b32_e64 v187, v13, v17
    v_cndmask_b32 v169, 0, v187, s[8:9]
    v_mfma_f32_16x16x32_bf16 v[92:95], v[48:51], a[28:31], v[92:95]
    v_cndmask_b32 v173, 0, v187, s[10:11]
    v_or_b32 v187, v14, v18
    v_mfma_f32_16x16x32_bf16 v[92:95], v[44:47], v[220:223], v[92:95]
    s_waitcnt lgkmcnt(7)
    ds_read_b128 a[128:131], v160 offset:0
    v_cndmask_b32 v170, 0, v187, s[8:9]
    v_mfma_f32_16x16x32_bf16 v[64:67], v[52:55], a[32:35], v[64:67]
    v_cndmask_b32 v174, 0, v187, s[10:11]
    v_or_b32_e64 v187, v15, v19
    v_mfma_f32_16x16x32_bf16 v[64:67], v[56:59], a[192:195], v[64:67]
    ds_read_b64_tr_b16 v[44:45], v2 offset:49152
    v_cndmask_b32 v171, 0, v187, s[8:9]
    v_mfma_f32_16x16x32_bf16 v[68:71], v[56:59], a[196:199], v[68:71]
    s_cbranch_vccz L_skip32
    s_mov_b32 s66, 0
    s_atomic_add s66, s[92:93], 0x600 glc
L_skip32:
    ds_read_b128 a[132:135], v160 offset:1024
    v_mfma_f32_16x16x32_bf16 v[68:71], v[52:55], a[36:39], v[68:71]
    ds_read_b64_tr_b16 v[46:47], v2 offset:51200
    v_cndmask_b32 v175, 0, v187, s[10:11]
    v_mfma_f32_16x16x32_bf16 v[72:75], v[52:55], a[40:43], v[72:75]
    ds_read_b128 a[136:139], v160 offset:2048
    v_mul_u32_u24 v184, 288, v29
    v_mfma_f32_16x16x32_bf16 v[72:75], v[56:59], a[200:203], v[72:75]
    ds_read_b128 a[140:143], v160 offset:49152
    v_lshl_add_u32 v184, v183, 3, v184
    v_mfma_f32_16x16x32_bf16 v[76:79], v[56:59], a[204:207], v[76:79]
    v_sub_u32 v187, v183, v188
    v_mul_i32_i24 v187, 2296, v187
    v_mfma_f32_16x16x32_bf16 v[76:79], v[52:55], a[44:47], v[76:79]
    ds_read_b128 a[144:147], v160 offset:50176
    v_add_u32 v185, v184, v187
    v_mfma_f32_16x16x32_bf16 v[80:83], v[52:55], a[48:51], v[80:83]
    v_lshl_add_u32 v184, v182, 31, v184
    v_add_u32_e64 v186, s67, v182
    v_mfma_f32_16x16x32_bf16 v[80:83], v[56:59], a[208:211], v[80:83]
    ds_read_b64_tr_b16 v[48:49], v5 offset:49152
    v_lshl_add_u32 v176, v186, 7, v185
    v_mfma_f32_16x16x32_bf16 v[84:87], v[56:59], a[212:215], v[84:87]
    ds_read_b128 a[148:151], v160 offset:51200
    v_add_u32 v186, 2, v186
    v_mfma_f32_16x16x32_bf16 v[84:87], v[52:55], a[52:55], v[84:87]
    ds_read_b64_tr_b16 v[50:51], v5 offset:51200
    v_subrev_u32 v187, 9, v186
    v_mfma_f32_16x16x32_bf16 v[88:91], v[52:55], a[56:59], v[88:91]
    ds_read_b128 a[152:155], v161 offset:32768
    v_min_u32_e64 v186, v186, v187
    v_mfma_f32_16x16x32_bf16 v[88:91], v[56:59], a[216:219], v[88:91]
    ds_read_b128 a[156:159], v161 offset:33792
    v_lshl_add_u32 v177, v186, 7, v185
    v_mfma_f32_16x16x32_bf16 v[92:95], v[56:59], a[220:223], v[92:95]
    v_add_u32_e64 v186, 2, v186
    v_subrev_u32_e64 v187, 9, v186
    v_mfma_f32_16x16x32_bf16 v[92:95], v[52:55], a[60:63], v[92:95]
    s_waitcnt lgkmcnt(8)
    ds_read_b128 a[160:163], v161 offset:34816
    v_min_u32 v186, v186, v187
    v_mfma_f32_16x16x32_bf16 v[64:67], v[60:63], v[224:227], v[64:67]
    v_lshl_add_u32 v178, v186, 7, v185
    v_add_u32_e64 v186, 2, v186
    v_mfma_f32_16x16x32_bf16 v[64:67], v[44:47], a[64:67], v[64:67]
    ds_read_b64_tr_b16 v[52:53], v27 offset:49152
    v_subrev_u32_e64 v187, 9, v186
    v_mfma_f32_16x16x32_bf16 v[68:71], v[44:47], a[68:71], v[68:71]
    ds_read_b128 a[164:167], v160 offset:32768
    v_min_u32_e64 v186, v186, v187
    v_mfma_f32_16x16x32_bf16 v[68:71], v[60:63], v[228:231], v[68:71]
    ds_read_b64_tr_b16 v[54:55], v27 offset:51200
    v_lshl_add_u32 v179, v186, 7, v185
    v_mfma_f32_16x16x32_bf16 v[72:75], v[60:63], v[232:235], v[72:75]
    ds_read_b128 a[168:171], v160 offset:33792
    v_add_u32_e64 v186, 2, v186
    v_mfma_f32_16x16x32_bf16 v[72:75], v[44:47], a[72:75], v[72:75]
    ds_read_b128 a[172:175], v160 offset:34816
    v_subrev_u32_e64 v187, 9, v186
    v_mfma_f32_16x16x32_bf16 v[76:79], v[44:47], a[76:79], v[76:79]
    v_min_u32_e64 v186, v186, v187
    v_lshl_add_u32 v180, v186, 7, v184
    v_mfma_f32_16x16x32_bf16 v[76:79], v[60:63], v[236:239], v[76:79]
    ds_read_b128 a[176:179], v161 offset:16384
    v_lshlrev_b32_e64 v96, 16, v116
    v_mfma_f32_16x16x32_bf16 v[80:83], v[60:63], v[240:243], v[80:83]
    v_and_b32 v97, 0xffff0000, v116
    v_lshlrev_b32_e64 v98, 16, v117
    v_mfma_f32_16x16x32_bf16 v[80:83], v[44:47], a[80:83], v[80:83]
    ds_read_b128 a[180:183], v161 offset:17408
    v_and_b32 v99, 0xffff0000, v117
    v_mfma_f32_16x16x32_bf16 v[84:87], v[44:47], a[84:87], v[84:87]
    v_lshlrev_b32_e64 v100, 16, v118
    v_and_b32 v101, 0xffff0000, v118
    v_mfma_f32_16x16x32_bf16 v[84:87], v[60:63], v[244:247], v[84:87]
    ds_read_b128 a[184:187], v161 offset:18432
    v_lshlrev_b32_e64 v102, 16, v119
    v_mfma_f32_16x16x32_bf16 v[88:91], v[60:63], v[248:251], v[88:91]
    v_and_b32 v103, 0xffff0000, v119
    v_lshlrev_b32 v104, 16, v120
    v_mfma_f32_16x16x32_bf16 v[88:91], v[44:47], a[88:91], v[88:91]
    v_and_b32 v105, 0xffff0000, v120
    v_lshlrev_b32 v106, 16, v121
    v_mfma_f32_16x16x32_bf16 v[92:95], v[44:47], a[92:95], v[92:95]
    v_and_b32 v107, 0xffff0000, v121
    v_lshlrev_b32 v108, 16, v122
    v_mfma_f32_16x16x32_bf16 v[92:95], v[60:63], v[252:255], v[92:95]
    s_waitcnt lgkmcnt(0)
    s_andn2_b32 s89, s99, s66
    s_cbranch_scc1 L_ffn_spin8
L_ffn_spin8r:
    v_mfma_f32_16x16x32_bf16 v[64:67], v[48:51], a[96:99], v[64:67]
    s_waitcnt vmcnt(3)
    s_barrier
    v_and_b32 v109, 0xffff0000, v122
    v_mfma_f32_16x16x32_bf16 v[64:67], v[52:55], v[128:131], v[64:67]
    s_cbranch_vccz L_skip31
    s_atomic_add s96, s[92:93], 0x700
L_skip31:
    v_lshlrev_b32 v110, 16, v123
    v_mfma_f32_16x16x32_bf16 v[68:71], v[52:55], v[132:135], v[68:71]
    v_and_b32 v111, 0xffff0000, v123
    v_lshlrev_b32_e64 v112, 16, v124
    v_mfma_f32_16x16x32_bf16 v[68:71], v[48:51], a[100:103], v[68:71]
    v_and_b32 v113, 0xffff0000, v124
    v_lshlrev_b32_e64 v114, 16, v125
    v_mfma_f32_16x16x32_bf16 v[72:75], v[48:51], a[104:107], v[72:75]
    v_and_b32 v115, 0xffff0000, v125
    v_mfma_f32_16x16x32_bf16 v[72:75], v[52:55], v[136:139], v[72:75]
    s_add_u32 s62, s61, 1048576
    v_mfma_f32_16x16x32_bf16 v[76:79], v[52:55], v[140:143], v[76:79]
    v_mfma_f32_16x16x32_bf16 v[76:79], v[48:51], a[108:111], v[76:79]
    v_cvt_pk_bf16_f32 v40, v64, v65
    v_cvt_pk_bf16_f32 v41, v66, v67
    v_mfma_f32_16x16x32_bf16 v[80:83], v[48:51], a[112:115], v[80:83]
    v_cvt_pk_bf16_f32 v42, v68, v69
    v_cvt_pk_bf16_f32 v43, v70, v71
    v_mfma_f32_16x16x32_bf16 v[80:83], v[52:55], v[144:147], v[80:83]
    buffer_store_dwordx4 v[40:43], v24, s[44:47], s62 offen offset:0 sc1
    v_mfma_f32_16x16x32_bf16 v[84:87], v[52:55], v[148:151], v[84:87]
    v_mfma_f32_16x16x32_bf16 v[84:87], v[48:51], a[116:119], v[84:87]
    v_cvt_pk_bf16_f32 v32, v72, v73
    v_cvt_pk_bf16_f32 v33, v74, v75
    v_mfma_f32_16x16x32_bf16 v[88:91], v[48:51], a[120:123], v[88:91]
    v_cvt_pk_bf16_f32 v34, v76, v77
    v_cvt_pk_bf16_f32 v35, v78, v79
    v_mfma_f32_16x16x32_bf16 v[88:91], v[52:55], v[152:155], v[88:91]
    buffer_store_dwordx4 v[32:35], v24, s[44:47], s62 offen offset:1024 sc1
    v_mfma_f32_16x16x32_bf16 v[92:95], v[52:55], v[156:159], v[92:95]
    v_mfma_f32_16x16x32_bf16 v[92:95], v[48:51], a[124:127], v[92:95]
    v_cvt_pk_bf16_f32 v36, v80, v81
    v_cvt_pk_bf16_f32 v37, v82, v83
    v_cvt_pk_bf16_f32 v38, v84, v85
    v_cvt_pk_bf16_f32 v39, v86, v87
    buffer_store_dwordx4 v[36:39], v24, s[44:47], s62 offen offset:2048 sc1
    v_cvt_pk_bf16_f32 v40, v88, v89
    v_cvt_pk_bf16_f32 v41, v90, v91
    s_nop 0
    v_cvt_pk_bf16_f32 v42, v92, v93
    v_cvt_pk_bf16_f32 v43, v94, v95
    buffer_store_dwordx4 v[40:43], v24, s[44:47], s62 offen offset:3072 sc1
    s_add_u32 s60, s61, 0
    buffer_load_dwordx4 a[236:239], v28, s[44:47], s60 offen sc1
    s_add_u32 s60, s61, 131072
    buffer_load_dwordx4 a[240:243], v28, s[44:47], s60 offen sc1
    s_add_u32 s60, s61, 262144
    buffer_load_dwordx4 a[244:247], v28, s[44:47], s60 offen sc1
    s_cbranch_vccz L_skip33
    s_mov_b32 s70, 0
    s_atomic_add s70, s[92:93], 0xa00 glc
L_skip33:
    v_mfma_f32_16x16x32_bf16 v[96:99], v[12:15], a[128:131], v[96:99]
    v_mfma_f32_16x16x32_bf16 v[96:99], v[12:15], a[132:135], v[96:99]
    v_mfma_f32_16x16x32_bf16 v[96:99], v[12:15], a[136:139], v[96:99]
    v_mfma_f32_16x16x32_bf16 v[96:99], v[16:19], a[140:143], v[96:99]
    v_mfma_f32_16x16x32_bf16 v[96:99], v[16:19], a[144:147], v[96:99]
    v_mfma_f32_16x16x32_bf16 v[96:99], v[16:19], a[148:151], v[96:99]
    v_mfma_f32_16x16x32_bf16 v[100:103], v[12:15], a[152:155], v[100:103]
    v_mfma_f32_16x16x32_bf16 v[100:103], v[12:15], a[156:159], v[100:103]
    v_mfma_f32_16x16x32_bf16 v[100:103], v[12:15], a[160:163], v[100:103]
    v_mfma_f32_16x16x32_bf16 v[100:103], v[16:19], a[164:167], v[100:103]
    v_mfma_f32_16x16x32_bf16 v[100:103], v[16:19], a[168:171], v[100:103]
    v_mfma_f32_16x16x32_bf16 v[100:103], v[16:19], a[172:175], v[100:103]
    v_mfma_f32_16x16x32_bf16 v[104:107], v[12:15], a[176:179], v[104:107]
    v_mfma_f32_16x16x32_bf16 v[104:107], v[12:15], a[180:183], v[104:107]
    v_mfma_f32_16x16x32_bf16 v[104:107], v[12:15], a[184:187], v[104:107]
    s_waitcnt vmcnt(9)
    v_mfma_f32_16x16x32_bf16 v[104:107], v[16:19], a[224:227], v[104:107]
    s_waitcnt vmcnt(8)
    v_mfma_f32_16x16x32_bf16 v[104:107], v[16:19], a[228:231], v[104:107]
    s_waitcnt vmcnt(7)
    v_mfma_f32_16x16x32_bf16 v[104:107], v[16:19], a[232:235], v[104:107]
    v_mul_f32 v96, v25, v96
    v_mul_f32 v97, v25, v97
    v_mul_f32 v98, v25, v98
    v_mul_f32 v99, v25, v99
    v_mul_f32 v100, v25, v100
    v_mul_f32 v101, v25, v101
    v_mul_f32 v102, v25, v102
    v_mul_f32 v103, v25, v103
    v_mul_f32 v104, v25, v104
    v_mul_f32 v105, v25, v105
    v_mul_f32 v106, v25, v106
    v_mul_f32 v107, v25, v107
    s_waitcnt lgkmcnt(0)
    s_waitcnt vmcnt(3)
    s_barrier
    s_cbranch_vccz L_skip34
    s_atomic_add s96, s[92:93], 0x800
L_skip34:
    s_andn2_b32 s89, s100, s70
    s_cbranch_scc1 L_ffn_spin9
L_ffn_spin9r:
    s_cbranch_vccz L_skip35
    s_mov_b32 s72, 0
    s_atomic_add s72, s[92:93], 0x700 glc
L_skip35:
    s_barrier
    buffer_load_dwordx4 a[36:39], v165, s[44:47], s5 offen sc1
    buffer_load_dwordx4 a[40:43], v166, s[44:47], s5 offen sc1
    buffer_load_dwordx4 a[44:47], v167, s[44:47], s5 offen sc1
    s_waitcnt vmcnt(5)
    v_mfma_f32_16x16x32_bf16 v[108:111], v[12:15], a[236:239], v[108:111]
    s_waitcnt vmcnt(4)
    v_mfma_f32_16x16x32_bf16 v[108:111], v[12:15], a[240:243], v[108:111]
    s_waitcnt vmcnt(3)
    s_nop 0
    v_mfma_f32_16x16x32_bf16 v[108:111], v[12:15], a[244:247], v[108:111]
    s_waitcnt lgkmcnt(0)
    s_andn2_b32 s89, s99, s72
    s_cbranch_scc1 L_ffn_spin10
L_ffn_spin10r:
    s_cbranch_vccz L_skip36
    s_mov_b32 s70, 0
    s_atomic_add s70, s[92:93], 0x800 glc
L_skip36:
    s_barrier
    s_add_u32 s60, s61, 524288
    buffer_load_dwordx4 a[12:15], v28, s[44:47], s60 offen sc1
    s_add_u32 s60, s61, 655360
    buffer_load_dwordx4 a[16:19], v28, s[44:47], s60 offen sc1
    s_add_u32 s60, s61, 786432
    buffer_load_dwordx4 a[20:23], v28, s[44:47], s60 offen sc1
    s_waitcnt vmcnt(5)
    v_mfma_f32_16x16x32_bf16 v[96:99], v[168:171], a[36:39], v[96:99]
    v_mfma_f32_16x16x32_bf16 v[100:103], v[172:175], a[36:39], v[100:103]
    s_waitcnt vmcnt(4)
    v_mfma_f32_16x16x32_bf16 v[104:107], v[168:171], a[40:43], v[104:107]
    s_waitcnt vmcnt(3)
    v_mfma_f32_16x16x32_bf16 v[116:119], v[168:171], a[44:47], 0
    s_nop 2
    v_cvt_pk_bf16_f32 v182, v96, v97
    v_cvt_pk_bf16_f32 v183, v98, v99
    v_cvt_pk_bf16_f32 v184, v100, v101
    v_cvt_pk_bf16_f32 v185, v102, v103
    v_cvt_pk_bf16_f32 v186, v104, v105
    v_cvt_pk_bf16_f32 v187, v106, v107
    ds_bpermute_b32 v182, v164, v182
    ds_bpermute_b32 v183, v164, v183
    ds_bpermute_b32 v184, v164, v184
    ds_bpermute_b32 v185, v164, v185
    ds_bpermute_b32 v186, v164, v186
    ds_bpermute_b32 v187, v164, v187
    s_waitcnt lgkmcnt(0)
    s_andn2_b32 s89, s99, s70
    s_cbranch_scc1 L_ffn_spin11
L_ffn_spin11r:
    s_barrier
    s_add_u32 s60, s61, 1048576
    buffer_load_dwordx4 a[24:27], v28, s[44:47], s60 offen sc1
    s_add_u32 s60, s61, 1179648
    buffer_load_dwordx4 a[28:31], v28, s[44:47], s60 offen sc1
    s_add_u32 s60, s61, 1310720
    buffer_load_dwordx4 a[32:35], v28, s[44:47], s60 offen sc1
    buffer_store_dwordx2 v[182:183], v176, s[48:51], s68 offen
    buffer_store_dwordx2 v[184:185], v177, s[48:51], s68 offen
    buffer_store_dwordx2 v[186:187], v178, s[48:51], s68 offen
    s_waitcnt vmcnt(8)
    v_mfma_f32_16x16x32_bf16 v[108:111], v[16:19], a[12:15], v[108:111]
    s_waitcnt vmcnt(7)
    v_mfma_f32_16x16x32_bf16 v[108:111], v[16:19], a[16:19], v[108:111]
    s_waitcnt vmcnt(6)
    v_mfma_f32_16x16x32_bf16 v[108:111], v[16:19], a[20:23], v[108:111]
    s_nop 7
    v_mul_f32 v108, v25, v108
    v_mul_f32 v109, v25, v109
    v_mul_f32 v110, v25, v110
    v_mul_f32 v111, v25, v111
    s_nop 1
    v_mfma_f32_16x16x32_bf16 v[108:111], v[172:175], a[40:43], v[108:111]
    s_nop 7
    v_cvt_pk_bf16_f32 v188, v108, v109
    v_cvt_pk_bf16_f32 v189, v110, v111
    ds_bpermute_b32 v188, v164, v188
    ds_bpermute_b32 v189, v164, v189
    s_waitcnt lgkmcnt(0)
    s_nop 0
    buffer_store_dwordx2 v[188:189], v179, s[48:51], s68 offen
    s_waitcnt vmcnt(6)
    v_mfma_f32_16x16x32_bf16 v[112:115], v[12:15], a[24:27], v[112:115]
    s_waitcnt vmcnt(5)
    v_mfma_f32_16x16x32_bf16 v[112:115], v[12:15], a[28:31], v[112:115]
    s_waitcnt vmcnt(4)
    v_mfma_f32_16x16x32_bf16 v[112:115], v[12:15], a[32:35], v[112:115]
    s_nop 7
    v_fma_f32 v112, v112, v25, v116
    v_fma_f32 v113, v113, v25, v117
    v_fma_f32 v114, v114, v25, v118
    v_fma_f32 v115, v115, v25, v119
    v_cvt_pk_bf16_f32 v190, v112, v113
    v_cvt_pk_bf16_f32 v191, v114, v115
    buffer_store_dwordx2 v[190:191], v180, s[48:51], s68 offen
    s_endpgm
L_ffn_spin0:
    v_mov_b32 v39, 0
    global_load_dword v39, v39, s[94:95] sc1
    s_waitcnt vmcnt(0)
    v_readfirstlane_b32 s97, v39
    s_sub_u32 s81, s81, 1
    s_waitcnt lgkmcnt(0)
    s_cmp_lt_i32 s81, 0
    s_cbranch_scc1 L_ffn_spin0r
    s_andn2_b32 s89, 15, s97
    s_cbranch_scc1 L_ffn_spin0
    s_branch L_ffn_spin0r
L_ffn_spin1:
    s_mov_b32 s97, 0
    s_atomic_add s97, s[92:93], 0x0 glc
    s_sub_u32 s81, s81, 1
    s_waitcnt lgkmcnt(0)
    s_cmp_lt_i32 s81, 0
    s_cbranch_scc1 L_ffn_spin1r
    s_andn2_b32 s89, s99, s97
    s_cbranch_scc1 L_ffn_spin1
    s_branch L_ffn_spin1r
L_ffn_spin2:
    s_mov_b32 s98, 0
    s_atomic_add s98, s[92:93], 0x100 glc
    s_sub_u32 s81, s81, 1
    s_waitcnt lgkmcnt(0)
    s_cmp_lt_i32 s81, 0
    s_cbranch_scc1 L_ffn_spin2r
    s_andn2_b32 s89, s99, s98
    s_cbranch_scc1 L_ffn_spin2
    s_branch L_ffn_spin2r
L_ffn_spin3:
    s_mov_b32 s97, 0
    s_atomic_add s97, s[92:93], 0x200 glc
    s_sub_u32 s81, s81, 1
    s_waitcnt lgkmcnt(0)
    s_cmp_lt_i32 s81, 0
    s_cbranch_scc1 L_ffn_spin3r
    s_andn2_b32 s89, s99, s97
    s_cbranch_scc1 L_ffn_spin3
    s_branch L_ffn_spin3r
L_ffn_spin4:
    s_mov_b32 s98, 0
    s_atomic_add s98, s[92:93], 0x300 glc
    s_sub_u32 s81, s81, 1
    s_waitcnt lgkmcnt(0)
    s_cmp_lt_i32 s81, 0
    s_cbranch_scc1 L_ffn_spin4r
    s_andn2_b32 s89, s99, s98
    s_cbranch_scc1 L_ffn_spin4
    s_branch L_ffn_spin4r
L_ffn_spin5:
    s_mov_b32 s97, 0
    s_atomic_add s97, s[92:93], 0x400 glc
    s_sub_u32 s81, s81, 1
    s_waitcnt lgkmcnt(0)
    s_cmp_lt_i32 s81, 0
    s_cbranch_scc1 L_ffn_spin5r
    s_andn2_b32 s89, s99, s97
    s_cbranch_scc1 L_ffn_spin5
    s_branch L_ffn_spin5r
L_ffn_spin6:
    s_mov_b32 s66, 0
    s_atomic_add s66, s[92:93], 0x900 glc
    s_sub_u32 s81, s81, 1
    s_waitcnt lgkmcnt(0)
    s_cmp_lt_i32 s81, 0
    s_cbranch_scc1 L_ffn_spin6r
    s_andn2_b32 s89, s100, s66
    s_cbranch_scc1 L_ffn_spin6
    s_branch L_ffn_spin6r
L_ffn_spin7:
    s_mov_b32 s98, 0
    s_atomic_add s98, s[92:93], 0x500 glc
    s_sub_u32 s81, s81, 1
    s_waitcnt lgkmcnt(0)
    s_cmp_lt_i32 s81, 0
    s_cbranch_scc1 L_ffn_spin7r
    s_andn2_b32 s89, s99, s98
    s_cbranch_scc1 L_ffn_spin7
    s_branch L_ffn_spin7r
L_ffn_spin8:
    s_mov_b32 s66, 0
    s_atomic_add s66, s[92:93], 0x600 glc
L_ffn_pad8:
    s_cbranch_execz L_ffn_ret1
    s_sub_u32 s81, s81, 1
    s_waitcnt lgkmcnt(0)
    s_cmp_lt_i32 s81, 0
    s_cbranch_scc1 L_ffn_spin8r
    s_andn2_b32 s89, s99, s66
    s_cbranch_scc1 L_ffn_spin8
    s_branch L_ffn_spin8r
L_ffn_spin9:
    s_mov_b32 s70, 0
    s_atomic_add s70, s[92:93], 0xa00 glc
    s_sub_u32 s81, s81, 1
    s_waitcnt lgkmcnt(0)
    s_cmp_lt_i32 s81, 0
    s_cbranch_scc1 L_ffn_spin9r
    s_andn2_b32 s89, s100, s70
    s_cbranch_scc1 L_ffn_spin9
    s_branch L_ffn_spin9r
L_ffn_spin10:
    s_mov_b32 s72, 0
    s_atomic_add s72, s[92:93], 0x700 glc
    s_sub_u32 s81, s81, 1
    s_waitcnt lgkmcnt(0)
    s_cmp_lt_i32 s81, 0
    s_cbranch_scc1 L_ffn_spin10r
    s_andn2_b32 s89, s99, s72
    s_cbranch_scc1 L_ffn_spin10
    s_branch L_ffn_spin10r
L_ffn_spin11:
    s_mov_b32 s70, 0
    s_atomic_add s70, s[92:93], 0x800 glc
    s_sub_u32 s81, s81, 1
    s_waitcnt lgkmcnt(0)
    s_cmp_lt_i32 s81, 0
    s_cbranch_scc1 L_ffn_spin11r
    s_andn2_b32 s89, s99, s70
    s_cbranch_scc1 L_ffn_spin11
    s_branch L_ffn_spin11r
.p2align 12
L_att_body:
L_att_pad0:
    s_cbranch_execz L_att_ret0
    s_add_u32 m0, s66, 28672
    s_add_u32 s60, s91, s49
    buffer_load_dwordx4 v7, s[32:35], s60 offen offset:1024 lds
    buffer_load_dwordx4 v8, s[32:35], s60 offen offset:3072 lds
    buffer_load_dwordx4 v6, s[32:35], s60 offen offset:0 lds
    buffer_load_dwordx4 v27, s[32:35], s60 offen offset:2048 lds
    s_add_u32 m0, s66, 32768
    s_add_u32 s59, s60, 2304
    buffer_load_dwordx4 v9, s[32:35], s60 offen offset:2048 lds
    buffer_load_dwordx4 v6, s[32:35], s59 offen lds
    buffer_load_dwordx4 v7, s[32:35], s59 offen offset:1024 lds
    s_add_u32 m0, s65, 135168
    s_xor_b32 s60, s90, 1
    s_lshl_b32 s60, s60, 7
    buffer_load_dwordx4 v1, s[28:31], s60 offen offset:0 lds
    buffer_load_dwordx4 v2, s[28:31], s60 offen offset:1024 lds
    buffer_load_dwordx4 v3, s[28:31], s60 offen offset:2048 lds
    s_waitcnt vmcnt(12)
    v_lshl_or_b32 v48, v48, 16, v48
    v_mov_b32_e64 v49, v48
    ds_write_b64 v43, v[48:49] offset:0
    s_waitcnt vmcnt(11)
    v_lshl_or_b32 v50, v50, 16, v50
    v_mov_b32 v51, v50
    ds_write_b64 v43, v[50:51] offset:2048
    s_waitcnt vmcnt(10)
    v_lshl_or_b32 v52, v52, 16, v52
    v_mov_b32_e64 v53, v52
    ds_write_b64 v43, v[52:53] offset:4096
    s_waitcnt lgkmcnt(0)
    s_barrier
    ds_read_b64_tr_b16 a[108:109], v10 offset:0
    ds_read_b64_tr_b16 a[110:111], v10 offset:512
    ds_read_b128 a[0:3], v13 offset:0
    ds_read_b128 a[4:7], v13 offset:2048
    ds_read_b128 a[8:11], v13 offset:4096
    ds_read_b128 a[12:15], v13 offset:6144
    ds_read_b128 a[16:19], v13 offset:8192
    ds_read_b128 a[20:23], v13 offset:10240
    ds_read_b128 a[24:27], v13 offset:12288
    ds_read_b128 a[28:31], v13 offset:14336
    ds_read_b128 a[32:35], v13 offset:16384
    ds_read_b64_tr_b16 a[112:113], v25 offset:0
    ds_read_b64_tr_b16 a[114:115], v25 offset:512
    ds_read_b64_tr_b16 a[116:117], v10 offset:2048
    ds_read_b64_tr_b16 a[118:119], v10 offset:2560
    ds_read_b64_tr_b16 a[120:121], v25 offset:2048
    ds_read_b64_tr_b16 a[122:123], v25 offset:2560
    ds_read_b64_tr_b16 a[124:125], v10 offset:4096
    ds_read_b64_tr_b16 a[126:127], v10 offset:4608
    ds_read_b64_tr_b16 a[128:129], v25 offset:4096
    ds_read_b64_tr_b16 a[130:131], v25 offset:4608
    ds_read_b64_tr_b16 a[132:133], v12
    ds_read_b64_tr_b16 a[134:135], v12 offset:512
    v_add_u32 v12, s62, v12
    s_waitcnt lgkmcnt(9)
    v_mfma_f32_16x16x32_bf16 v[48:51], a[108:111], a[0:3], 0
    v_mfma_f32_16x16x32_bf16 v[52:55], a[108:111], a[4:7], 0
    v_mfma_f32_16x16x32_bf16 v[56:59], a[108:111], a[8:11], 0
    v_mfma_f32_16x16x32_bf16 v[60:63], a[108:111], a[12:15], 0
    buffer_load_dwordx4 v4, s[28:31], s60 offen offset:3072 lds
    v_mfma_f32_16x16x32_bf16 v[64:67], a[108:111], a[16:19], 0
    s_add_u32 m0, s82, 151552
    v_mfma_f32_16x16x32_bf16 v[68:71], a[108:111], a[20:23], 0
    v_mfma_f32_16x16x32_bf16 v[72:75], a[108:111], a[24:27], 0
    buffer_load_dwordx4 v5, s[28:31], s60 offen lds
    v_mfma_f32_16x16x32_bf16 v[76:79], a[108:111], a[28:31], 0
    s_nop 0
    v_mfma_f32_16x16x32_bf16 v[108:111], a[112:115], a[28:31], 0
    s_xor_b32 s91, s90, 1
    s_mul_i32 s91, s91, 221184
    s_add_u32 s91, s91, s64
    v_mfma_f32_16x16x32_bf16 v[104:107], a[112:115], a[24:27], 0
    s_add_u32 m0, s66, 57344
    s_add_u32 s60, s91, s48
    v_mfma_f32_16x16x32_bf16 v[100:103], a[112:115], a[20:23], 0
    buffer_load_dwordx4 v7, s[32:35], s60 offen offset:1024 lds
    v_mfma_f32_16x16x32_bf16 v[96:99], a[112:115], a[16:19], 0
    v_mfma_f32_16x16x32_bf16 v[92:95], a[112:115], a[12:15], 0
    v_mfma_f32_16x16x32_bf16 v[88:91], a[112:115], a[8:11], 0
    buffer_load_dwordx4 v8, s[32:35], s60 offen offset:3072 lds
    v_mfma_f32_16x16x32_bf16 v[84:87], a[112:115], a[4:7], 0
    v_mfma_f32_16x16x32_bf16 v[80:83], a[112:115], a[0:3], 0
    s_waitcnt lgkmcnt(2)
    v_mfma_f32_16x16x32_bf16 v[112:115], a[116:119], a[0:3], 0
    s_nop 0
    v_mfma_f32_16x16x32_bf16 v[116:119], a[116:119], a[4:7], 0
    buffer_load_dwordx4 v6, s[32:35], s60 offen offset:0 lds
    v_mfma_f32_16x16x32_bf16 v[120:123], a[116:119], a[8:11], 0
    v_mfma_f32_16x16x32_bf16 v[124:127], a[116:119], a[12:15], 0
    s_nop 0
    v_mfma_f32_16x16x32_bf16 v[128:131], a[116:119], a[16:19], 0
    s_waitcnt lgkmcnt(0)
    s_waitcnt vmcnt(8)
    s_barrier
    v_mfma_f32_16x16x32_bf16 v[132:135], a[116:119], a[20:23], 0
    buffer_load_dwordx4 v27, s[32:35], s60 offen offset:2048 lds
    v_mfma_f32_16x16x32_bf16 v[136:139], a[116:119], a[24:27], 0
    s_add_u32 m0, s66, 61440
    ds_read_b64_tr_b16 a[136:137], v10 offset:28672
    s_add_u32 s59, s60, 2304
    v_mfma_f32_16x16x32_bf16 v[140:143], a[116:119], a[28:31], 0
    ds_read_b64_tr_b16 a[138:139], v10 offset:29184
    v_mfma_f32_16x16x32_bf16 v[144:147], a[116:119], a[32:35], 0
    buffer_load_dwordx4 v9, s[32:35], s60 offen offset:2048 lds
    v_mfma_f32_16x16x32_bf16 v[180:183], a[120:123], a[32:35], 0
    ds_read_b128 a[36:39], v14 offset:0
    v_mfma_f32_16x16x32_bf16 v[176:179], a[120:123], a[28:31], 0
    ds_read_b128 a[40:43], v14 offset:2048
    v_mfma_f32_16x16x32_bf16 v[172:175], a[120:123], a[24:27], 0
    buffer_load_dwordx4 v6, s[32:35], s59 offen lds
    v_mfma_f32_16x16x32_bf16 v[168:171], a[120:123], a[20:23], 0
    ds_read_b128 a[44:47], v14 offset:4096
    v_mfma_f32_16x16x32_bf16 v[164:167], a[120:123], a[16:19], 0
    ds_read_b128 a[48:51], v14 offset:6144
    v_mfma_f32_16x16x32_bf16 v[160:163], a[120:123], a[12:15], 0
    ds_read_b128 a[52:55], v14 offset:8192
    v_mfma_f32_16x16x32_bf16 v[156:159], a[120:123], a[8:11], 0
    buffer_load_dwordx4 v7, s[32:35], s59 offen offset:1024 lds
    v_mfma_f32_16x16x32_bf16 v[152:155], a[120:123], a[4:7], 0
    s_add_u32 m0, s66, 86016
    ds_read_b128 a[56:59], v14 offset:10240
    s_add_u32 s60, s91, s49
    v_mfma_f32_16x16x32_bf16 v[148:151], a[120:123], a[0:3], 0
    s_nop 0
    ds_read_b128 a[60:63], v14 offset:12288
    v_mfma_f32_16x16x32_bf16 v[184:187], a[124:127], a[0:3], 0
    buffer_load_dwordx4 v7, s[32:35], s60 offen offset:1024 lds
    v_mfma_f32_16x16x32_bf16 v[188:191], a[124:127], a[4:7], 0
    ds_read_b128 a[64:67], v14 offset:14336
    v_mfma_f32_16x16x32_bf16 v[192:195], a[124:127], a[8:11], 0
    ds_read_b128 a[68:71], v14 offset:16384
    v_mfma_f32_16x16x32_bf16 v[196:199], a[124:127], a[12:15], 0
    v_mfma_f32_16x16x32_bf16 v[200:203], a[124:127], a[16:19], 0
    buffer_load_dwordx4 v8, s[32:35], s60 offen offset:3072 lds
    v_mfma_f32_16x16x32_bf16 v[204:207], a[124:127], a[20:23], 0
    s_mov_b32 s89, 0x12345
    ds_read_b64_tr_b16 a[140:141], v25 offset:28672
    ds_read_b64_tr_b16 a[142:143], v25 offset:29184
    v_mfma_f32_16x16x32_bf16 v[208:211], a[124:127], a[24:27], 0
    ds_read_b64_tr_b16 a[144:145], v10 offset:30720
    v_mfma_f32_16x16x32_bf16 v[212:215], a[124:127], a[28:31], 0
    buffer_load_dwordx4 v6, s[32:35], s60 offen offset:0 lds
    v_mfma_f32_16x16x32_bf16 v[216:219], a[124:127], a[32:35], 0
    ds_read_b64_tr_b16 a[146:147], v10 offset:31232
    v_mfma_f32_16x16x32_bf16 v[252:255], a[128:131], a[32:35], 0
    ds_read_b64_tr_b16 a[148:149], v25 offset:30720
    v_mfma_f32_16x16x32_bf16 v[248:251], a[128:131], a[28:31], 0
    v_mfma_f32_16x16x32_bf16 v[244:247], a[128:131], a[24:27], 0
    buffer_load_dwordx4 v27, s[32:35], s60 offen offset:2048 lds
    v_mfma_f32_16x16x32_bf16 v[240:243], a[128:131], a[20:23], 0
    s_add_u32 m0, s66, 90112
    ds_read_b64_tr_b16 a[150:151], v25 offset:31232
    ds_read_b64_tr_b16 a[152:153], v10 offset:32768
    v_mfma_f32_16x16x32_bf16 v[236:239], a[128:131], a[16:19], 0
    s_add_u32 s59, s60, 2304
    v_mfma_f32_16x16x32_bf16 v[232:235], a[128:131], a[12:15], 0
    buffer_load_dwordx4 v9, s[32:35], s60 offen offset:2048 lds
    v_mfma_f32_16x16x32_bf16 v[228:231], a[128:131], a[8:11], 0
    s_mov_b32 s89, 0x12345
    ds_read_b64_tr_b16 a[154:155], v10 offset:33280
    ds_read_b64_tr_b16 a[156:157], v25 offset:32768
    v_mfma_f32_16x16x32_bf16 v[224:227], a[128:131], a[4:7], 0
    v_mfma_f32_16x16x32_bf16 v[220:223], a[128:131], a[0:3], 0
    ds_read_b64_tr_b16 a[158:159], v25 offset:33280
    v_mfma_f32_16x16x32_bf16 a[192:195], a[132:135], a[0:3], 0
    buffer_load_dwordx4 v6, s[32:35], s59 offen lds
    v_mfma_f32_16x16x32_bf16 a[196:199], a[132:135], a[4:7], 0
    ds_read_b64_tr_b16 a[160:161], v12
    v_mfma_f32_16x16x32_bf16 a[200:203], a[132:135], a[8:11], 0
    ds_read_b64_tr_b16 a[162:163], v12 offset:512
    v_mfma_f32_16x16x32_bf16 a[204:207], a[132:135], a[12:15], 0
    v_add_u32_e64 v12, s62, v12
    v_mfma_f32_16x16x32_bf16 a[208:211], a[132:135], a[16:19], 0
    buffer_load_dwordx4 v7, s[32:35], s59 offen offset:1024 lds
    v_mfma_f32_16x16x32_bf16 a[212:215], a[132:135], a[20:23], 0
    v_mfma_f32_16x16x32_bf16 a[216:219], a[132:135], a[24:27], 0
    s_nop 0
    v_mfma_f32_16x16x32_bf16 a[220:223], a[132:135], a[28:31], 0
    s_nop 0
    v_mfma_f32_16x16x32_bf16 a[224:227], a[132:135], a[32:35], 0
    s_waitcnt lgkmcnt(0)
    v_mfma_f32_16x16x32_bf16 v[48:51], a[136:139], a[36:39], v[48:51]
    s_nop 0
    v_mfma_f32_16x16x32_bf16 v[52:55], a[136:139], a[40:43], v[52:55]
    s_nop 0
    v_mfma_f32_16x16x32_bf16 v[56:59], a[136:139], a[44:47], v[56:59]
    s_nop 0
    v_mfma_f32_16x16x32_bf16 v[60:63], a[136:139], a[48:51], v[60:63]
    s_nop 0
    v_mfma_f32_16x16x32_bf16 v[64:67], a[136:139], a[52:55], v[64:67]
    s_sub_u32 s85, 0, s26
    s_and_b32 s85, s85, 2097151
    s_lshl_b32 s80, s57, 23
    v_mfma_f32_16x16x32_bf16 v[68:71], a[136:139], a[56:59], v[68:71]
    s_add_u32 s80, s80, s85
    s_mov_b32 s81, 0x10000
    s_lshl_b32 s3, s57, 2
    v_mfma_f32_16x16x32_bf16 v[72:75], a[136:139], a[60:63], v[72:75]
    s_lshr_b32 s84, 1, s56
    s_lshl_b32 s99, s84, 4
    s_lshl_b32 s100, s84, 10
    v_mfma_f32_16x16x32_bf16 v[76:79], a[136:139], a[64:67], v[76:79]
    s_mul_i32 s101, s84, 0x410
    s_mov_b32 s96, 256
    v_bfe_u32 v24, v0, 2, 2
    v_mfma_f32_16x16x32_bf16 v[108:111], a[140:143], a[64:67], v[108:111]
    s_waitcnt vmcnt(7)
    s_barrier
    v_lshlrev_b32_e64 v24, 8, v24
    v_mfma_f32_16x16x32_bf16 v[104:107], a[140:143], a[60:63], v[104:107]
    s_add_u32 m0, s65, 114688
    s_xor_b32 s60, s90, 2
    s_lshl_b32 s60, s60, 7
    v_mfma_f32_16x16x32_bf16 v[100:103], a[140:143], a[56:59], v[100:103]
    buffer_load_dwordx4 v1, s[28:31], s60 offen offset:0 lds
    v_mfma_f32_16x16x32_bf16 v[96:99], a[140:143], a[52:55], v[96:99]
    s_mov_b32 s89, 0x12345
    ds_read_b64_tr_b16 a[164:165], v10 offset:57344
    ds_read_b64_tr_b16 a[166:167], v10 offset:57856
    v_mfma_f32_16x16x32_bf16 v[92:95], a[140:143], a[48:51], v[92:95]
    v_lshrrev_b32_e64 v28, 4, v0
    v_lshl_add_u32 v24, v28, 6, v24
    v_mfma_f32_16x16x32_bf16 v[88:91], a[140:143], a[44:47], v[88:91]
    buffer_load_dwordx4 v2, s[28:31], s60 offen offset:1024 lds
    v_mfma_f32_16x16x32_bf16 v[84:87], a[140:143], a[40:43], v[84:87]
    ds_read_b128 a[72:75], v13 offset:20480
    v_and_b32_e64 v26, 3, v0
    v_mfma_f32_16x16x32_bf16 v[80:83], a[140:143], a[36:39], v[80:83]
    ds_read_b128 a[76:79], v13 offset:22528
    v_lshl_add_u32 v24, v26, 4, v24
    v_mfma_f32_16x16x32_bf16 v[112:115], a[144:147], a[36:39], v[112:115]
    buffer_load_dwordx4 v3, s[28:31], s60 offen offset:2048 lds
    v_mfma_f32_16x16x32_bf16 v[116:119], a[144:147], a[40:43], v[116:119]
    ds_read_b128 a[80:83], v13 offset:24576
    v_and_b32_e64 v26, 15, v0
    v_mfma_f32_16x16x32_bf16 v[120:123], a[144:147], a[44:47], v[120:123]
    v_mul_u32_u24 v28, 32768, v28
    v_mfma_f32_16x16x32_bf16 v[124:127], a[144:147], a[48:51], v[124:127]
    buffer_load_dwordx4 v4, s[28:31], s60 offen offset:3072 lds
    v_mfma_f32_16x16x32_bf16 v[128:131], a[144:147], a[52:55], v[128:131]
    s_add_u32 m0, s82, 131072
    ds_read_b128 a[84:87], v13 offset:26624
    v_mfma_f32_16x16x32_bf16 v[132:135], a[144:147], a[56:59], v[132:135]
    ds_read_b128 a[88:91], v13 offset:28672
    v_mfma_f32_16x16x32_bf16 v[136:139], a[144:147], a[60:63], v[136:139]
    buffer_load_dwordx4 v5, s[28:31], s60 offen lds
    v_mfma_f32_16x16x32_bf16 v[140:143], a[144:147], a[64:67], v[140:143]
    s_xor_b32 s91, s90, 2
    ds_read_b128 a[92:95], v13 offset:30720
    s_mul_i32 s91, s91, 221184
    v_mfma_f32_16x16x32_bf16 v[144:147], a[144:147], a[68:71], v[144:147]
    s_add_u32 s91, s91, s64
    s_add_u32 m0, s66, 0
    s_add_u32 s60, s91, s48
    v_mfma_f32_16x16x32_bf16 v[180:183], a[148:151], a[68:71], v[180:183]
    buffer_load_dwordx4 v7, s[32:35], s60 offen offset:1024 lds
    v_mfma_f32_16x16x32_bf16 v[176:179], a[148:151], a[64:67], v[176:179]
    ds_read_b128 a[96:99], v13 offset:32768
    v_mfma_f32_16x16x32_bf16 v[172:175], a[148:151], a[60:63], v[172:175]
    ds_read_b128 a[100:103], v13 offset:34816
    v_mfma_f32_16x16x32_bf16 v[168:171], a[148:151], a[56:59], v[168:171]
    buffer_load_dwordx4 v8, s[32:35], s60 offen offset:3072 lds
    v_mfma_f32_16x16x32_bf16 v[164:167], a[148:151], a[52:55], v[164:167]
    ds_read_b128 a[104:107], v13 offset:36864
    v_mfma_f32_16x16x32_bf16 v[160:163], a[148:151], a[48:51], v[160:163]
    v_mfma_f32_16x16x32_bf16 v[156:159], a[148:151], a[44:47], v[156:159]
    buffer_load_dwordx4 v6, s[32:35], s60 offen offset:0 lds
    v_mfma_f32_16x16x32_bf16 v[152:155], a[148:151], a[40:43], v[152:155]
    ds_read_b64_tr_b16 a[168:169], v25 offset:57344
    v_mfma_f32_16x16x32_bf16 v[148:151], a[148:151], a[36:39], v[148:151]
    ds_read_b64_tr_b16 a[170:171], v25 offset:57856
    v_mfma_f32_16x16x32_bf16 v[184:187], a[152:155], a[36:39], v[184:187]
    buffer_load_dwordx4 v27, s[32:35], s60 offen offset:2048 lds
    v_mfma_f32_16x16x32_bf16 v[188:191], a[152:155], a[40:43], v[188:191]
    s_add_u32 m0, s66, 4096
    ds_read_b64_tr_b16 a[172:173], v10 offset:59392
    s_add_u32 s59, s60, 2304
    v_mfma_f32_16x16x32_bf16 v[192:195], a[152:155], a[44:47], v[192:195]
    v_mfma_f32_16x16x32_bf16 v[196:199], a[152:155], a[48:51], v[196:199]
    buffer_load_dwordx4 v9, s[32:35], s60 offen offset:2048 lds
    v_mfma_f32_16x16x32_bf16 v[200:203], a[152:155], a[52:55], v[200:203]
    ds_read_b64_tr_b16 a[174:175], v10 offset:59904
    v_mfma_f32_16x16x32_bf16 v[204:207], a[152:155], a[56:59], v[204:207]
    ds_read_b64_tr_b16 a[176:177], v25 offset:59392
    v_mfma_f32_16x16x32_bf16 v[208:211], a[152:155], a[60:63], v[208:211]
    buffer_load_dwordx4 v6, s[32:35], s59 offen lds
    v_mfma_f32_16x16x32_bf16 v[212:215], a[152:155], a[64:67], v[212:215]
    ds_read_b64_tr_b16 a[178:179], v25 offset:59904
    v_mfma_f32_16x16x32_bf16 v[216:219], a[152:155], a[68:71], v[216:219]
    v_mfma_f32_16x16x32_bf16 v[252:255], a[156:159], a[68:71], v[252:255]
    buffer_load_dwordx4 v7, s[32:35], s59 offen offset:1024 lds
    v_mfma_f32_16x16x32_bf16 v[248:251], a[156:159], a[64:67], v[248:251]
    s_add_u32 m0, s66, 28672
    ds_read_b64_tr_b16 a[180:181], v10 offset:61440
    s_add_u32 s60, s91, s49
    v_mfma_f32_16x16x32_bf16 v[244:247], a[156:159], a[60:63], v[244:247]
    s_nop 0
    ds_read_b64_tr_b16 a[182:183], v10 offset:61952
    v_mfma_f32_16x16x32_bf16 v[240:243], a[156:159], a[56:59], v[240:243]
    buffer_load_dwordx4 v7, s[32:35], s60 offen offset:1024 lds
    v_mfma_f32_16x16x32_bf16 v[236:239], a[156:159], a[52:55], v[236:239]
    ds_read_b64_tr_b16 a[184:185], v25 offset:61440
    v_mfma_f32_16x16x32_bf16 v[232:235], a[156:159], a[48:51], v[232:235]
    v_mfma_f32_16x16x32_bf16 v[228:231], a[156:159], a[44:47], v[228:231]
    buffer_load_dwordx4 v8, s[32:35], s60 offen offset:3072 lds
    v_mfma_f32_16x16x32_bf16 v[224:227], a[156:159], a[40:43], v[224:227]
    ds_read_b64_tr_b16 a[186:187], v25 offset:61952
    v_mfma_f32_16x16x32_bf16 v[220:223], a[156:159], a[36:39], v[220:223]
    ds_read_b64_tr_b16 a[188:189], v12
    v_mfma_f32_16x16x32_bf16 a[192:195], a[160:163], a[36:39], a[192:195]
    buffer_load_dwordx4 v6, s[32:35], s60 offen offset:0 lds
    v_mfma_f32_16x16x32_bf16 a[196:199], a[160:163], a[40:43], a[196:199]
    ds_read_b64_tr_b16 a[190:191], v12 offset:512
    v_mfma_f32_16x16x32_bf16 a[200:203], a[160:163], a[44:47], a[200:203]
    v_mfma_f32_16x16x32_bf16 a[204:207], a[160:163], a[48:51], a[204:207]
    v_add_u32_e64 v12, s62, v12
    v_mfma_f32_16x16x32_bf16 a[208:211], a[160:163], a[52:55], a[208:211]
    buffer_load_dwordx4 v27, s[32:35], s60 offen offset:2048 lds
    v_mfma_f32_16x16x32_bf16 a[212:215], a[160:163], a[56:59], a[212:215]
    s_add_u32 m0, s66, 32768
    s_add_u32 s59, s60, 2304
    v_mfma_f32_16x16x32_bf16 a[216:219], a[160:163], a[60:63], a[216:219]
    s_nop 0
    v_mfma_f32_16x16x32_bf16 a[220:223], a[160:163], a[64:67], a[220:223]
    buffer_load_dwordx4 v9, s[32:35], s60 offen offset:2048 lds
    v_mfma_f32_16x16x32_bf16 a[224:227], a[160:163], a[68:71], a[224:227]
    s_waitcnt lgkmcnt(0)
    buffer_load_dwordx4 v6, s[32:35], s59 offen lds
    v_mfma_f32_16x16x32_bf16 v[48:51], a[164:167], a[72:75], v[48:51]
    s_waitcnt vmcnt(18)
    s_barrier
    v_mfma_f32_16x16x32_bf16 v[52:55], a[164:167], a[76:79], v[52:55]
    s_nop 0
    v_mfma_f32_16x16x32_bf16 v[56:59], a[164:167], a[80:83], v[56:59]
    s_nop 0
    ds_read_b64_tr_b16 a[108:109], v11 offset:20480
    v_mfma_f32_16x16x32_bf16 v[60:63], a[164:167], a[84:87], v[60:63]
    buffer_load_dwordx4 v7, s[32:35], s59 offen offset:1024 lds
    v_mfma_f32_16x16x32_bf16 v[64:67], a[164:167], a[88:91], v[64:67]
    s_min_u32 s85, s56, 1
    ds_read_b64_tr_b16 a[110:111], v11 offset:20992
    s_lshl_b32 s85, s85, 31
    v_mfma_f32_16x16x32_bf16 v[68:71], a[164:167], a[92:95], v[68:71]
    v_and_b32_e64 v42, 15, v0
    v_lshlrev_b32_e64 v42, 8, v42
    v_mfma_f32_16x16x32_bf16 v[72:75], a[164:167], a[96:99], v[72:75]
    ds_read_b128 a[0:3], v14 offset:20480
    v_bfe_u32 v43, v0, 4, 1
    v_mfma_f32_16x16x32_bf16 v[76:79], a[164:167], a[100:103], v[76:79]
    v_lshl_add_u32 v42, v43, 13, v42
    v_lshrrev_b32 v43, 5, v0
    v_mfma_f32_16x16x32_bf16 v[108:111], a[168:171], a[100:103], v[108:111]
    s_xor_b32 s91, s90, 3
    ds_read_b128 a[4:7], v14 offset:22528
    s_mul_i32 s91, s91, 221184
    v_mfma_f32_16x16x32_bf16 v[104:107], a[168:171], a[96:99], v[104:107]
    s_add_u32 s91, s91, s64
    s_add_u32 m0, s66, 57344
    s_add_u32 s60, s91, s48
    v_mfma_f32_16x16x32_bf16 v[100:103], a[168:171], a[92:95], v[100:103]
    buffer_load_dwordx4 v7, s[32:35], s60 offen offset:1024 lds
    v_mfma_f32_16x16x32_bf16 v[96:99], a[168:171], a[88:91], v[96:99]
    ds_read_b128 a[8:11], v14 offset:24576
    v_or_b32_e64 v43, s67, v43
    v_mfma_f32_16x16x32_bf16 v[92:95], a[168:171], a[84:87], v[92:95]
    ds_read_b128 a[12:15], v14 offset:26624
    v_min_u32_e64 v43, 1, v43
    v_mfma_f32_16x16x32_bf16 v[88:91], a[168:171], a[80:83], v[88:91]
    v_lshl_or_b32 v42, v43, 31, v42
    v_or_b32 v42, s85, v42
    v_mfma_f32_16x16x32_bf16 v[84:87], a[168:171], a[76:79], v[84:87]
    ds_read_b128 a[16:19], v14 offset:28672
    v_lshrrev_b32 v43, 3, v0
    v_mfma_f32_16x16x32_bf16 v[80:83], a[168:171], a[72:75], v[80:83]
    v_lshlrev_b32 v43, 12, v43
    v_and_b32 v44, 7, v0
    v_mfma_f32_16x16x32_bf16 v[112:115], a[172:175], a[72:75], v[112:115]
    ds_read_b128 a[20:23], v14 offset:30720
    v_lshl_add_u32 v43, v44, 3, v43
    v_mfma_f32_16x16x32_bf16 v[116:119], a[172:175], a[76:79], v[116:119]
    buffer_load_dwordx4 v8, s[32:35], s60 offen offset:3072 lds
    v_mfma_f32_16x16x32_bf16 v[120:123], a[172:175], a[80:83], v[120:123]
    ds_read_b128 a[24:27], v14 offset:32768
    v_or_b32 v43, s85, v43
    v_mfma_f32_16x16x32_bf16 v[124:127], a[172:175], a[84:87], v[124:127]
    v_mov_b32 v44, 4
    v_mov_b32_e64 v45, 4
    v_mfma_f32_16x16x32_bf16 v[128:131], a[172:175], a[88:91], v[128:131]
    s_add_u32 s85, s80, 1572864
    ds_read_b128 a[28:31], v14 offset:34816
    v_mfma_f32_16x16x32_bf16 v[132:135], a[172:175], a[92:95], v[132:135]
    buffer_store_dword v44, v42, s[44:47], s85 offen sc1
    v_mfma_f32_16x16x32_bf16 v[136:139], a[172:175], a[96:99], v[136:139]
    s_lshl_b32 s85, s67, 21
    ds_read_b128 a[32:35], v14 offset:36864
    s_add_u32 s85, s85, s80
    v_mfma_f32_16x16x32_bf16 v[140:143], a[172:175], a[100:103], v[140:143]
    s_add_u32 s85, s85, 1703936
    v_mfma_f32_16x16x32_bf16 v[144:147], a[172:175], a[104:107], v[144:147]
    ds_read_b64_tr_b16 a[112:113], v29 offset:20480
    v_mfma_f32_16x16x32_bf16 v[180:183], a[176:179], a[104:107], v[180:183]
    buffer_load_dwordx4 v6, s[32:35], s60 offen offset:0 lds
    v_mfma_f32_16x16x32_bf16 v[176:179], a[176:179], a[100:103], v[176:179]
    ds_read_b64_tr_b16 a[114:115], v29 offset:20992
    v_mfma_f32_16x16x32_bf16 v[172:175], a[176:179], a[96:99], v[172:175]
    v_mfma_f32_16x16x32_bf16 v[168:171], a[176:179], a[92:95], v[168:171]
    ds_read_b64_tr_b16 a[116:117], v11 offset:22528
    v_mfma_f32_16x16x32_bf16 v[164:167], a[176:179], a[88:91], v[164:167]
    buffer_store_dwordx2 v[44:45], v43, s[44:47], s85 offen sc1
    v_mfma_f32_16x16x32_bf16 v[160:163], a[176:179], a[84:87], v[160:163]
    s_add_u32 s16, s26, s85
    s_addc_u32 s17, s27, 0
    ds_read_b64_tr_b16 a[118:119], v11 offset:23040
    v_mfma_f32_16x16x32_bf16 v[156:159], a[176:179], a[80:83], v[156:159]
    s_mov_b32 s14, 0
    v_mfma_f32_16x16x32_bf16 v[152:155], a[176:179], a[76:79], v[152:155]
    s_nop 0
    ds_read_b64_tr_b16 a[120:121], v29 offset:22528
    v_mfma_f32_16x16x32_bf16 v[148:151], a[176:179], a[72:75], v[148:151]
    buffer_load_dwordx4 v27, s[32:35], s60 offen offset:2048 lds
    v_mfma_f32_16x16x32_bf16 v[184:187], a[180:183], a[72:75], v[184:187]
    ds_read_b64_tr_b16 a[122:123], v29 offset:23040
    v_mfma_f32_16x16x32_bf16 v[188:191], a[180:183], a[76:79], v[188:191]
    v_mfma_f32_16x16x32_bf16 v[192:195], a[180:183], a[80:83], v[192:195]
    s_add_u32 m0, s66, 61440
    ds_read_b64_tr_b16 a[124:125], v11 offset:24576
    s_add_u32 s59, s60, 2304
    v_mfma_f32_16x16x32_bf16 v[196:199], a[180:183], a[84:87], v[196:199]
    v_mfma_f32_16x16x32_bf16 v[200:203], a[180:183], a[88:91], v[200:203]
    buffer_load_dwordx4 v9, s[32:35], s60 offen offset:2048 lds
    v_mfma_f32_16x16x32_bf16 v[204:207], a[180:183], a[92:95], v[204:207]
    ds_read_b64_tr_b16 a[126:127], v11 offset:25088
    v_mfma_f32_16x16x32_bf16 v[208:211], a[180:183], a[96:99], v[208:211]
    ds_read_b64_tr_b16 a[128:129], v29 offset:24576
    v_mfma_f32_16x16x32_bf16 v[212:215], a[180:183], a[100:103], v[212:215]
    v_mfma_f32_16x16x32_bf16 v[216:219], a[180:183], a[104:107], v[216:219]
    ds_read_b64_tr_b16 a[130:131], v29 offset:25088
    v_mfma_f32_16x16x32_bf16 v[252:255], a[184:187], a[104:107], v[252:255]
    v_mfma_f32_16x16x32_bf16 v[248:251], a[184:187], a[100:103], v[248:251]
    ds_read_b64_tr_b16 a[132:133], v12
    v_mfma_f32_16x16x32_bf16 v[244:247], a[184:187], a[96:99], v[244:247]
    buffer_load_dwordx4 v6, s[32:35], s59 offen lds
    v_mfma_f32_16x16x32_bf16 v[240:243], a[184:187], a[92:95], v[240:243]
    ds_read_b64_tr_b16 a[134:135], v12 offset:512
    v_mfma_f32_16x16x32_bf16 v[236:239], a[184:187], a[88:91], v[236:239]
    v_mfma_f32_16x16x32_bf16 v[232:235], a[184:187], a[84:87], v[232:235]
    v_add_u32_e64 v12, s83, v12
    v_mfma_f32_16x16x32_bf16 v[228:231], a[184:187], a[80:83], v[228:231]
    v_mfma_f32_16x16x32_bf16 v[224:227], a[184:187], a[76:79], v[224:227]
    v_mfma_f32_16x16x32_bf16 v[220:223], a[184:187], a[72:75], v[220:223]
    v_mfma_f32_16x16x32_bf16 a[192:195], a[188:191], a[72:75], a[192:195]
    buffer_load_dwordx4 v7, s[32:35], s59 offen offset:1024 lds
    v_mfma_f32_16x16x32_bf16 a[196:199], a[188:191], a[76:79], a[196:199]
    v_mfma_f32_16x16x32_bf16 a[200:203], a[188:191], a[80:83], a[200:203]
    v_mfma_f32_16x16x32_bf16 a[204:207], a[188:191], a[84:87], a[204:207]
    v_mfma_f32_16x16x32_bf16 a[208:211], a[188:191], a[88:91], a[208:211]
    v_mfma_f32_16x16x32_bf16 a[212:215], a[188:191], a[92:95], a[212:215]
    v_mfma_f32_16x16x32_bf16 a[216:219], a[188:191], a[96:99], a[216:219]
    v_mfma_f32_16x16x32_bf16 a[220:223], a[188:191], a[100:103], a[220:223]
    s_nop 0
    v_mfma_f32_16x16x32_bf16 a[224:227], a[188:191], a[104:107], a[224:227]
    s_waitcnt lgkmcnt(0)
    v_mfma_f32_16x16x32_bf16 v[48:51], a[108:111], a[0:3], v[48:51]
    s_waitcnt vmcnt(16)
    s_barrier
    v_mfma_f32_16x16x32_bf16 v[52:55], a[108:111], a[4:7], v[52:55]
    s_add_u32 m0, s65, 135168
    s_xor_b32 s60, s90, 3
    s_lshl_b32 s60, s60, 7
    v_mfma_f32_16x16x32_bf16 v[56:59], a[108:111], a[8:11], v[56:59]
    ds_read_b64_tr_b16 a[136:137], v10 offset:0
    v_mfma_f32_16x16x32_bf16 v[60:63], a[108:111], a[12:15], v[60:63]
    buffer_load_dwordx4 v1, s[28:31], s60 offen offset:0 lds
    v_mfma_f32_16x16x32_bf16 v[64:67], a[108:111], a[16:19], v[64:67]
    ds_read_b64_tr_b16 a[138:139], v10 offset:512
    v_lshl_add_u32 v28, v26, 4, v28
    v_mfma_f32_16x16x32_bf16 v[68:71], a[108:111], a[20:23], v[68:71]
    s_lshl_b32 s85, s58, 8
    v_add_u32_e64 v28, s85, v28
    s_mul_i32 s85, s58, 32768
    v_mfma_f32_16x16x32_bf16 v[72:75], a[108:111], a[24:27], v[72:75]
    s_nop 0
    ds_read_b128 a[36:39], v13 offset:0
    v_add_u32_e64 v24, s85, v24
    v_mfma_f32_16x16x32_bf16 v[76:79], a[108:111], a[28:31], v[76:79]
    buffer_load_dwordx4 v2, s[28:31], s60 offen offset:1024 lds
    v_mfma_f32_16x16x32_bf16 v[108:111], a[112:115], a[28:31], v[108:111]
    s_mov_b32 vcc_lo, s84
    ds_read_b128 a[40:43], v13 offset:2048
    s_mov_b32 vcc_hi, 0
    v_mfma_f32_16x16x32_bf16 v[104:107], a[112:115], a[24:27], v[104:107]
    s_add_u32 s94, s24, s3
    s_addc_u32 s95, s25, 0
    v_mfma_f32_16x16x32_bf16 v[100:103], a[112:115], a[20:23], v[100:103]
    ds_read_b128 a[44:47], v13 offset:4096
    v_mfma_f32_16x16x32_bf16 v[96:99], a[112:115], a[16:19], v[96:99]
    v_mfma_f32_16x16x32_bf16 v[92:95], a[112:115], a[12:15], v[92:95]
    buffer_load_dwordx4 v3, s[28:31], s60 offen offset:2048 lds
    v_mfma_f32_16x16x32_bf16 v[88:91], a[112:115], a[8:11], v[88:91]
    ds_read_b128 a[48:51], v13 offset:6144
    v_mfma_f32_16x16x32_bf16 v[84:87], a[112:115], a[4:7], v[84:87]
    ds_read_b128 a[52:55], v13 offset:8192
    v_mfma_f32_16x16x32_bf16 v[80:83], a[112:115], a[0:3], v[80:83]
    v_mfma_f32_16x16x32_bf16 v[112:115], a[116:119], a[0:3], v[112:115]
    ds_read_b128 a[56:59], v13 offset:10240
    v_mfma_f32_16x16x32_bf16 v[116:119], a[116:119], a[4:7], v[116:119]
    buffer_load_dwordx4 v4, s[28:31], s60 offen offset:3072 lds
    v_mfma_f32_16x16x32_bf16 v[120:123], a[116:119], a[8:11], v[120:123]
    ds_read_b128 a[60:63], v13 offset:12288
    v_mfma_f32_16x16x32_bf16 v[124:127], a[116:119], a[12:15], v[124:127]
    s_add_u32 m0, s82, 151552
    v_mfma_f32_16x16x32_bf16 v[128:131], a[116:119], a[16:19], v[128:131]
    ds_read_b128 a[64:67], v13 offset:14336
    v_mfma_f32_16x16x32_bf16 v[132:135], a[116:119], a[20:23], v[132:135]
    buffer_load_dwordx4 v5, s[28:31], s60 offen lds
    v_mfma_f32_16x16x32_bf16 v[136:139], a[116:119], a[24:27], v[136:139]
    ds_read_b128 a[68:71], v13 offset:16384
    v_mfma_f32_16x16x32_bf16 v[140:143], a[116:119], a[28:31], v[140:143]
    v_mfma_f32_16x16x32_bf16 v[144:147], a[116:119], a[32:35], v[144:147]
    s_add_u32 m0, s66, 86016
    ds_read_b64_tr_b16 a[140:141], v25 offset:0
    s_add_u32 s60, s91, s49
    v_mfma_f32_16x16x32_bf16 v[180:183], a[120:123], a[32:35], v[180:183]
    s_nop 0
    v_mfma_f32_16x16x32_bf16 v[176:179], a[120:123], a[28:31], v[176:179]
    buffer_load_dwordx4 v7, s[32:35], s60 offen offset:1024 lds
    v_mfma_f32_16x16x32_bf16 v[172:175], a[120:123], a[24:27], v[172:175]
    ds_read_b64_tr_b16 a[142:143], v25 offset:512
    v_mfma_f32_16x16x32_bf16 v[168:171], a[120:123], a[20:23], v[168:171]
    ds_read_b64_tr_b16 a[144:145], v10 offset:2048
    v_mfma_f32_16x16x32_bf16 v[164:167], a[120:123], a[16:19], v[164:167]
    v_mfma_f32_16x16x32_bf16 v[160:163], a[120:123], a[12:15], v[160:163]
    ds_read_b64_tr_b16 a[146:147], v10 offset:2560
    v_mfma_f32_16x16x32_bf16 v[156:159], a[120:123], a[8:11], v[156:159]
    buffer_load_dwordx4 v8, s[32:35], s60 offen offset:3072 lds
    v_mfma_f32_16x16x32_bf16 v[152:155], a[120:123], a[4:7], v[152:155]
    ds_read_b64_tr_b16 a[148:149], v25 offset:2048
    v_mfma_f32_16x16x32_bf16 v[148:151], a[120:123], a[0:3], v[148:151]
    v_mfma_f32_16x16x32_bf16 v[184:187], a[124:127], a[0:3], v[184:187]
    ds_read_b64_tr_b16 a[150:151], v25 offset:2560
    v_mfma_f32_16x16x32_bf16 v[188:191], a[124:127], a[4:7], v[188:191]
    buffer_load_dwordx4 v6, s[32:35], s60 offen offset:0 lds
    v_mfma_f32_16x16x32_bf16 v[192:195], a[124:127], a[8:11], v[192:195]
    ds_read_b64_tr_b16 a[152:153], v10 offset:4096
    v_mfma_f32_16x16x32_bf16 v[196:199], a[124:127], a[12:15], v[196:199]
    v_mfma_f32_16x16x32_bf16 v[200:203], a[124:127], a[16:19], v[200:203]
    s_nop 0
    ds_read_b64_tr_b16 a[154:155], v10 offset:4608
    v_mfma_f32_16x16x32_bf16 v[204:207], a[124:127], a[20:23], v[204:207]
    s_nop 0
    v_mfma_f32_16x16x32_bf16 v[208:211], a[124:127], a[24:27], v[208:211]
    buffer_load_dwordx4 v27, s[32:35], s60 offen offset:2048 lds
    v_mfma_f32_16x16x32_bf16 v[212:215], a[124:127], a[28:31], v[212:215]
    ds_read_b64_tr_b16 a[156:157], v25 offset:4096
L_att_pad1:
    s_cbranch_execz L_att_ret0
    v_mfma_f32_16x16x32_bf16 v[216:219], a[124:127], a[32:35], v[216:219]
    s_nop 0
    ds_read_b64_tr_b16 a[158:159], v25 offset:4608
    v_mfma_f32_16x16x32_bf16 v[252:255], a[128:131], a[32:35], v[252:255]
    s_add_u32 m0, s66, 90112
    s_add_u32 s59, s60, 2304
    v_mfma_f32_16x16x32_bf16 v[248:251], a[128:131], a[28:31], v[248:251]
    ds_read_b64_tr_b16 a[160:161], v12
    v_mfma_f32_16x16x32_bf16 v[244:247], a[128:131], a[24:27], v[244:247]
    buffer_load_dwordx4 v9, s[32:35], s60 offen offset:2048 lds
    v_mfma_f32_16x16x32_bf16 v[240:243], a[128:131], a[20:23], v[240:243]
    ds_read_b64_tr_b16 a[162:163], v12 offset:512
    v_mfma_f32_16x16x32_bf16 v[236:239], a[128:131], a[16:19], v[236:239]
    v_mfma_f32_16x16x32_bf16 v[232:235], a[128:131], a[12:15], v[232:235]
    v_add_u32_e64 v12, s62, v12
    v_mfma_f32_16x16x32_bf16 v[228:231], a[128:131], a[8:11], v[228:231]
    buffer_load_dwordx4 v6, s[32:35], s59 offen lds
    v_mfma_f32_16x16x32_bf16 v[224:227], a[128:131], a[4:7], v[224:227]
    v_mfma_f32_16x16x32_bf16 v[220:223], a[128:131], a[0:3], v[220:223]
    v_mfma_f32_16x16x32_bf16 a[192:195], a[132:135], a[0:3], a[192:195]
    v_mfma_f32_16x16x32_bf16 a[196:199], a[132:135], a[4:7], a[196:199]
    v_mfma_f32_16x16x32_bf16 a[200:203], a[132:135], a[8:11], a[200:203]
    buffer_load_dwordx4 v7, s[32:35], s59 offen offset:1024 lds
    v_mfma_f32_16x16x32_bf16 a[204:207], a[132:135], a[12:15], a[204:207]
    v_mfma_f32_16x16x32_bf16 a[208:211], a[132:135], a[16:19], a[208:211]
    v_mfma_f32_16x16x32_bf16 a[212:215], a[132:135], a[20:23], a[212:215]
    v_mfma_f32_16x16x32_bf16 a[216:219], a[132:135], a[24:27], a[216:219]
    v_mfma_f32_16x16x32_bf16 a[220:223], a[132:135], a[28:31], a[220:223]
    s_nop 0
    v_mfma_f32_16x16x32_bf16 a[224:227], a[132:135], a[32:35], a[224:227]
    s_waitcnt lgkmcnt(0)
    v_mfma_f32_16x16x32_bf16 v[48:51], a[136:139], a[36:39], v[48:51]
    s_waitcnt vmcnt(16)
    s_barrier
    v_mfma_f32_16x16x32_bf16 v[52:55], a[136:139], a[40:43], v[52:55]
    s_xor_b32 s91, s90, 4
    s_mul_i32 s91, s91, 221184
    s_add_u32 s91, s91, s64
    v_mfma_f32_16x16x32_bf16 v[56:59], a[136:139], a[44:47], v[56:59]
    s_mov_b64 s[8:9], 0
    s_cbranch_vccz L_skip2
    s_load_dword s9, s[16:17], 0x3000 glc
    s_load_dword s8, s[16:17], 0x1000 glc
L_skip2:
    ds_read_b64_tr_b16 a[164:165], v10 offset:28672
    v_mfma_f32_16x16x32_bf16 v[60:63], a[136:139], a[48:51], v[60:63]
    s_add_u32 m0, s66, 0
    s_add_u32 s60, s91, s48
    v_mfma_f32_16x16x32_bf16 v[64:67], a[136:139], a[52:55], v[64:67]
    buffer_load_dwordx4 v7, s[32:35], s60 offen offset:1024 lds
    v_mfma_f32_16x16x32_bf16 v[68:71], a[136:139], a[56:59], v[68:71]
    ds_read_b64_tr_b16 a[166:167], v10 offset:29184
    v_mfma_f32_16x16x32_bf16 v[72:75], a[136:139], a[60:63], v[72:75]
    ds_read_b128 a[72:75], v14 offset:0
    v_mfma_f32_16x16x32_bf16 v[76:79], a[136:139], a[64:67], v[76:79]
    v_mfma_f32_16x16x32_bf16 v[108:111], a[140:143], a[64:67], v[108:111]
    ds_read_b128 a[76:79], v14 offset:2048
    v_mfma_f32_16x16x32_bf16 v[104:107], a[140:143], a[60:63], v[104:107]
    v_mfma_f32_16x16x32_bf16 v[100:103], a[140:143], a[56:59], v[100:103]
    ds_read_b128 a[80:83], v14 offset:4096
    v_mfma_f32_16x16x32_bf16 v[96:99], a[140:143], a[52:55], v[96:99]
    buffer_load_dwordx4 v8, s[32:35], s60 offen offset:3072 lds
    v_mfma_f32_16x16x32_bf16 v[92:95], a[140:143], a[48:51], v[92:95]
    ds_read_b128 a[84:87], v14 offset:6144
    v_mfma_f32_16x16x32_bf16 v[88:91], a[140:143], a[44:47], v[88:91]
    v_mfma_f32_16x16x32_bf16 v[84:87], a[140:143], a[40:43], v[84:87]
    ds_read_b128 a[88:91], v14 offset:8192
    v_mfma_f32_16x16x32_bf16 v[80:83], a[140:143], a[36:39], v[80:83]
    v_mfma_f32_16x16x32_bf16 v[112:115], a[144:147], a[36:39], v[112:115]
    ds_read_b128 a[92:95], v14 offset:10240
    v_mfma_f32_16x16x32_bf16 v[116:119], a[144:147], a[40:43], v[116:119]
    v_mfma_f32_16x16x32_bf16 v[120:123], a[144:147], a[44:47], v[120:123]
    ds_read_b128 a[96:99], v14 offset:12288
    v_mfma_f32_16x16x32_bf16 v[124:127], a[144:147], a[48:51], v[124:127]
    buffer_load_dwordx4 v6, s[32:35], s60 offen offset:0 lds
    v_mfma_f32_16x16x32_bf16 v[128:131], a[144:147], a[52:55], v[128:131]
    ds_read_b128 a[100:103], v14 offset:14336
    v_mfma_f32_16x16x32_bf16 v[132:135], a[144:147], a[56:59], v[132:135]
    v_mfma_f32_16x16x32_bf16 v[136:139], a[144:147], a[60:63], v[136:139]
    ds_read_b128 a[104:107], v14 offset:16384
    v_mfma_f32_16x16x32_bf16 v[140:143], a[144:147], a[64:67], v[140:143]
    v_mfma_f32_16x16x32_bf16 v[144:147], a[144:147], a[68:71], v[144:147]
    ds_read_b64_tr_b16 a[168:169], v25 offset:28672
    v_mfma_f32_16x16x32_bf16 v[180:183], a[148:151], a[68:71], v[180:183]
    v_mfma_f32_16x16x32_bf16 v[176:179], a[148:151], a[64:67], v[176:179]
    ds_read_b64_tr_b16 a[170:171], v25 offset:29184
    v_mfma_f32_16x16x32_bf16 v[172:175], a[148:151], a[60:63], v[172:175]
    buffer_load_dwordx4 v27, s[32:35], s60 offen offset:2048 lds
    v_mfma_f32_16x16x32_bf16 v[168:171], a[148:151], a[56:59], v[168:171]
    ds_read_b64_tr_b16 a[172:173], v10 offset:30720
    v_mfma_f32_16x16x32_bf16 v[164:167], a[148:151], a[52:55], v[164:167]
    v_mfma_f32_16x16x32_bf16 v[160:163], a[148:151], a[48:51], v[160:163]
    ds_read_b64_tr_b16 a[174:175], v10 offset:31232
    v_mfma_f32_16x16x32_bf16 v[156:159], a[148:151], a[44:47], v[156:159]
    v_mfma_f32_16x16x32_bf16 v[152:155], a[148:151], a[40:43], v[152:155]
    ds_read_b64_tr_b16 a[176:177], v25 offset:30720
    v_mfma_f32_16x16x32_bf16 v[148:151], a[148:151], a[36:39], v[148:151]
    s_add_u32 m0, s66, 4096
    s_add_u32 s59, s60, 2304
    v_mfma_f32_16x16x32_bf16 v[184:187], a[152:155], a[36:39], v[184:187]
    ds_read_b64_tr_b16 a[178:179], v25 offset:31232
    v_mfma_f32_16x16x32_bf16 v[188:191], a[152:155], a[40:43], v[188:191]
    buffer_load_dwordx4 v9, s[32:35], s60 offen offset:2048 lds
    v_mfma_f32_16x16x32_bf16 v[192:195], a[152:155], a[44:47], v[192:195]
    ds_read_b64_tr_b16 a[180:181], v10 offset:32768
    v_mfma_f32_16x16x32_bf16 v[196:199], a[152:155], a[48:51], v[196:199]
    v_mfma_f32_16x16x32_bf16 v[200:203], a[152:155], a[52:55], v[200:203]
    ds_read_b64_tr_b16 a[182:183], v10 offset:33280
    v_mfma_f32_16x16x32_bf16 v[204:207], a[152:155], a[56:59], v[204:207]
    v_mfma_f32_16x16x32_bf16 v[208:211], a[152:155], a[60:63], v[208:211]
    ds_read_b64_tr_b16 a[184:185], v25 offset:32768
    v_mfma_f32_16x16x32_bf16 v[212:215], a[152:155], a[64:67], v[212:215]
    v_mfma_f32_16x16x32_bf16 v[216:219], a[152:155], a[68:71], v[216:219]
    ds_read_b64_tr_b16 a[186:187], v25 offset:33280
    v_mfma_f32_16x16x32_bf16 v[252:255], a[156:159], a[68:71], v[252:255]
    buffer_load_dwordx4 v6, s[32:35], s59 offen lds
    v_mfma_f32_16x16x32_bf16 v[248:251], a[156:159], a[64:67], v[248:251]
    ds_read_b64_tr_b16 a[188:189], v12
    v_mfma_f32_16x16x32_bf16 v[244:247], a[156:159], a[60:63], v[244:247]
    v_mfma_f32_16x16x32_bf16 v[240:243], a[156:159], a[56:59], v[240:243]
    ds_read_b64_tr_b16 a[190:191], v12 offset:512
    v_mfma_f32_16x16x32_bf16 v[236:239], a[156:159], a[52:55], v[236:239]
    v_mfma_f32_16x16x32_bf16 v[232:235], a[156:159], a[48:51], v[232:235]
    v_add_u32_e64 v12, s62, v12
    v_mfma_f32_16x16x32_bf16 v[228:231], a[156:159], a[44:47], v[228:231]
    v_mfma_f32_16x16x32_bf16 v[224:227], a[156:159], a[40:43], v[224:227]
    v_mfma_f32_16x16x32_bf16 v[220:223], a[156:159], a[36:39], v[220:223]
    buffer_load_dwordx4 v7, s[32:35], s59 offen offset:1024 lds
    v_mfma_f32_16x16x32_bf16 a[192:195], a[160:163], a[36:39], a[192:195]
    v_mfma_f32_16x16x32_bf16 a[196:199], a[160:163], a[40:43], a[196:199]
    v_mfma_f32_16x16x32_bf16 a[200:203], a[160:163], a[44:47], a[200:203]
    v_mfma_f32_16x16x32_bf16 a[204:207], a[160:163], a[48:51], a[204:207]
    v_mfma_f32_16x16x32_bf16 a[208:211], a[160:163], a[52:55], a[208:211]
    v_mfma_f32_16x16x32_bf16 a[212:215], a[160:163], a[56:59], a[212:215]
    v_mfma_f32_16x16x32_bf16 a[216:219], a[160:163], a[60:63], a[216:219]
    v_mfma_f32_16x16x32_bf16 a[220:223], a[160:163], a[64:67], a[220:223]
    s_nop 0
    v_mfma_f32_16x16x32_bf16 a[224:227], a[160:163], a[68:71], a[224:227]
    s_waitcnt lgkmcnt(0)
    v_mfma_f32_16x16x32_bf16 v[48:51], a[164:167], a[72:75], v[48:51]
    s_waitcnt vmcnt(14)
    s_barrier
    v_mfma_f32_16x16x32_bf16 v[52:55], a[164:167], a[76:79], v[52:55]
    s_add_u32 m0, s65, 114688
    s_xor_b32 s60, s90, 4
    s_lshl_b32 s60, s60, 7
    v_mfma_f32_16x16x32_bf16 v[56:59], a[164:167], a[80:83], v[56:59]
    s_mov_b64 s[8:9], 0
    s_cbranch_vccz L_skip3
    s_load_dword s8, s[16:17], 0x0 glc
    s_load_dword s9, s[16:17], 0x2000 glc
L_skip3:
    ds_read_b64_tr_b16 a[108:109], v10 offset:57344
    v_mfma_f32_16x16x32_bf16 v[60:63], a[164:167], a[84:87], v[60:63]
    buffer_load_dwordx4 v1, s[28:31], s60 offen offset:0 lds
    v_mfma_f32_16x16x32_bf16 v[64:67], a[164:167], a[88:91], v[64:67]
    ds_read_b64_tr_b16 a[110:111], v10 offset:57856
    v_mfma_f32_16x16x32_bf16 v[68:71], a[164:167], a[92:95], v[68:71]
    v_mfma_f32_16x16x32_bf16 v[72:75], a[164:167], a[96:99], v[72:75]
    ds_read_b128 a[0:3], v13 offset:20480
    v_mfma_f32_16x16x32_bf16 v[76:79], a[164:167], a[100:103], v[76:79]
    buffer_load_dwordx4 v2, s[28:31], s60 offen offset:1024 lds
    v_mfma_f32_16x16x32_bf16 v[108:111], a[168:171], a[100:103], v[108:111]
    ds_read_b128 a[4:7], v13 offset:22528
    v_mfma_f32_16x16x32_bf16 v[104:107], a[168:171], a[96:99], v[104:107]
    v_mfma_f32_16x16x32_bf16 v[100:103], a[168:171], a[92:95], v[100:103]
    ds_read_b128 a[8:11], v13 offset:24576
    v_mfma_f32_16x16x32_bf16 v[96:99], a[168:171], a[88:91], v[96:99]
    v_mfma_f32_16x16x32_bf16 v[92:95], a[168:171], a[84:87], v[92:95]
    buffer_load_dwordx4 v3, s[28:31], s60 offen offset:2048 lds
    v_mfma_f32_16x16x32_bf16 v[88:91], a[168:171], a[80:83], v[88:91]
    s_nop 0
    ds_read_b128 a[12:15], v13 offset:26624
    v_mfma_f32_16x16x32_bf16 v[84:87], a[168:171], a[76:79], v[84:87]
    s_nop 0
    ds_read_b128 a[16:19], v13 offset:28672
    v_mfma_f32_16x16x32_bf16 v[80:83], a[168:171], a[72:75], v[80:83]
    v_mfma_f32_16x16x32_bf16 v[112:115], a[172:175], a[72:75], v[112:115]
    s_add_u32 s14, s14, s8
    s_sub_u32 s14, s14, s9
    ds_read_b128 a[20:23], v13 offset:30720
    v_mfma_f32_16x16x32_bf16 v[116:119], a[172:175], a[76:79], v[116:119]
    buffer_load_dwordx4 v4, s[28:31], s60 offen offset:3072 lds
    v_mfma_f32_16x16x32_bf16 v[120:123], a[172:175], a[80:83], v[120:123]
    ds_read_b128 a[24:27], v13 offset:32768
    v_mfma_f32_16x16x32_bf16 v[124:127], a[172:175], a[84:87], v[124:127]
    s_add_u32 s14, s14, s8
    s_sub_u32 s14, s14, s9
    s_add_u32 m0, s82, 131072
    v_mfma_f32_16x16x32_bf16 v[128:131], a[172:175], a[88:91], v[128:131]
    ds_read_b128 a[28:31], v13 offset:34816
    v_mfma_f32_16x16x32_bf16 v[132:135], a[172:175], a[92:95], v[132:135]
    buffer_load_dwordx4 v5, s[28:31], s60 offen lds
    v_mfma_f32_16x16x32_bf16 v[136:139], a[172:175], a[96:99], v[136:139]
    s_add_u32 s14, s14, s8
    s_sub_u32 s14, s14, s9
    ds_read_b128 a[32:35], v13 offset:36864
    v_mfma_f32_16x16x32_bf16 v[140:143], a[172:175], a[100:103], v[140:143]
    v_mfma_f32_16x16x32_bf16 v[144:147], a[172:175], a[104:107], v[144:147]
    s_add_u32 m0, s66, 28672
    ds_read_b64_tr_b16 a[112:113], v25 offset:57344
    s_add_u32 s60, s91, s49
    v_mfma_f32_16x16x32_bf16 v[180:183], a[176:179], a[104:107], v[180:183]
    s_add_u32 s14, s14, s8
    s_sub_u32 s14, s14, s9
    v_mfma_f32_16x16x32_bf16 v[176:179], a[176:179], a[100:103], v[176:179]
    buffer_load_dwordx4 v7, s[32:35], s60 offen offset:1024 lds
    v_mfma_f32_16x16x32_bf16 v[172:175], a[176:179], a[96:99], v[172:175]
    s_nop 0
    ds_read_b64_tr_b16 a[114:115], v25 offset:57856
    v_mfma_f32_16x16x32_bf16 v[168:171], a[176:179], a[92:95], v[168:171]
    s_add_u32 s14, s14, s8
    s_sub_u32 s14, s14, s9
    ds_read_b64_tr_b16 a[116:117], v10 offset:59392
    v_mfma_f32_16x16x32_bf16 v[164:167], a[176:179], a[88:91], v[164:167]
    v_mfma_f32_16x16x32_bf16 v[160:163], a[176:179], a[84:87], v[160:163]
    ds_read_b64_tr_b16 a[118:119], v10 offset:59904
    v_mfma_f32_16x16x32_bf16 v[156:159], a[176:179], a[80:83], v[156:159]
    buffer_load_dwordx4 v8, s[32:35], s60 offen offset:3072 lds
    v_mfma_f32_16x16x32_bf16 v[152:155], a[176:179], a[76:79], v[152:155]
    s_add_u32 s14, s14, s8
    s_sub_u32 s14, s14, s9
    ds_read_b64_tr_b16 a[120:121], v25 offset:59392
    v_mfma_f32_16x16x32_bf16 v[148:151], a[176:179], a[72:75], v[148:151]
    v_mfma_f32_16x16x32_bf16 v[184:187], a[180:183], a[72:75], v[184:187]
    s_add_u32 s14, s14, s8
    s_sub_u32 s14, s14, s9
    ds_read_b64_tr_b16 a[122:123], v25 offset:59904
    v_mfma_f32_16x16x32_bf16 v[188:191], a[180:183], a[76:79], v[188:191]
    buffer_load_dwordx4 v6, s[32:35], s60 offen offset:0 lds
    v_mfma_f32_16x16x32_bf16 v[192:195], a[180:183], a[80:83], v[192:195]
    ds_read_b64_tr_b16 a[124:125], v10 offset:61440
    v_mfma_f32_16x16x32_bf16 v[196:199], a[180:183], a[84:87], v[196:199]
    v_mfma_f32_16x16x32_bf16 v[200:203], a[180:183], a[88:91], v[200:203]
    ds_read_b64_tr_b16 a[126:127], v10 offset:61952
    v_mfma_f32_16x16x32_bf16 v[204:207], a[180:183], a[92:95], v[204:207]
    v_mfma_f32_16x16x32_bf16 v[208:211], a[180:183], a[96:99], v[208:211]
    buffer_load_dwordx4 v27, s[32:35], s60 offen offset:2048 lds
    v_mfma_f32_16x16x32_bf16 v[212:215], a[180:183], a[100:103], v[212:215]
    ds_read_b64_tr_b16 a[128:129], v25 offset:61440
    v_mfma_f32_16x16x32_bf16 v[216:219], a[180:183], a[104:107], v[216:219]
    ds_read_b64_tr_b16 a[130:131], v25 offset:61952
    v_mfma_f32_16x16x32_bf16 v[252:255], a[184:187], a[104:107], v[252:255]
    s_add_u32 m0, s66, 32768
    s_add_u32 s59, s60, 2304
    v_mfma_f32_16x16x32_bf16 v[248:251], a[184:187], a[100:103], v[248:251]
    ds_read_b64_tr_b16 a[132:133], v12
    v_mfma_f32_16x16x32_bf16 v[244:247], a[184:187], a[96:99], v[244:247]
    buffer_load_dwordx4 v9, s[32:35], s60 offen offset:2048 lds
    v_mfma_f32_16x16x32_bf16 v[240:243], a[184:187], a[92:95], v[240:243]
    ds_read_b64_tr_b16 a[134:135], v12 offset:512
    v_mfma_f32_16x16x32_bf16 v[236:239], a[184:187], a[88:91], v[236:239]
    v_mfma_f32_16x16x32_bf16 v[232:235], a[184:187], a[84:87], v[232:235]
    v_add_u32_e64 v12, s62, v12
    v_mfma_f32_16x16x32_bf16 v[228:231], a[184:187], a[80:83], v[228:231]
    buffer_load_dwordx4 v6, s[32:35], s59 offen lds
    v_mfma_f32_16x16x32_bf16 v[224:227], a[184:187], a[76:79], v[224:227]
    v_mfma_f32_16x16x32_bf16 v[220:223], a[184:187], a[72:75], v[220:223]
    v_mfma_f32_16x16x32_bf16 a[192:195], a[188:191], a[72:75], a[192:195]
    v_mfma_f32_16x16x32_bf16 a[196:199], a[188:191], a[76:79], a[196:199]
    s_nop 0
    v_mfma_f32_16x16x32_bf16 a[200:203], a[188:191], a[80:83], a[200:203]
    buffer_load_dwordx4 v7, s[32:35], s59 offen offset:1024 lds
    v_mfma_f32_16x16x32_bf16 a[204:207], a[188:191], a[84:87], a[204:207]
    s_nop 0
    v_mfma_f32_16x16x32_bf16 a[208:211], a[188:191], a[88:91], a[208:211]
    v_mfma_f32_16x16x32_bf16 a[212:215], a[188:191], a[92:95], a[212:215]
    s_nop 0
    v_mfma_f32_16x16x32_bf16 a[216:219], a[188:191], a[96:99], a[216:219]
    s_nop 0
    v_mfma_f32_16x16x32_bf16 a[220:223], a[188:191], a[100:103], a[220:223]
    s_nop 0
    v_mfma_f32_16x16x32_bf16 a[224:227], a[188:191], a[104:107], a[224:227]
    s_waitcnt lgkmcnt(0)
    v_mfma_f32_16x16x32_bf16 v[48:51], a[108:111], a[0:3], v[48:51]
    s_waitcnt vmcnt(19)
    s_barrier
    v_mfma_f32_16x16x32_bf16 v[52:55], a[108:111], a[4:7], v[52:55]
    s_xor_b32 s91, s90, 5
    s_mul_i32 s91, s91, 221184
    s_add_u32 s91, s91, s64
    v_mfma_f32_16x16x32_bf16 v[56:59], a[108:111], a[8:11], v[56:59]
    s_mov_b64 s[8:9], 0
    s_cbranch_vccz L_skip4
    s_load_dword s9, s[16:17], 0x3000 glc
    s_load_dword s8, s[16:17], 0x1000 glc
L_skip4:
    ds_read_b64_tr_b16 a[136:137], v11 offset:20480
    v_mfma_f32_16x16x32_bf16 v[60:63], a[108:111], a[12:15], v[60:63]
    s_add_u32 m0, s66, 57344
    s_add_u32 s60, s91, s48
    v_mfma_f32_16x16x32_bf16 v[64:67], a[108:111], a[16:19], v[64:67]
    buffer_load_dwordx4 v7, s[32:35], s60 offen offset:1024 lds
    v_mfma_f32_16x16x32_bf16 v[68:71], a[108:111], a[20:23], v[68:71]
    s_nop 0
    ds_read_b64_tr_b16 a[138:139], v11 offset:20992
    v_mfma_f32_16x16x32_bf16 v[72:75], a[108:111], a[24:27], v[72:75]
    ds_read_b128 a[36:39], v14 offset:20480
    v_mfma_f32_16x16x32_bf16 v[76:79], a[108:111], a[28:31], v[76:79]
    v_mfma_f32_16x16x32_bf16 v[108:111], a[112:115], a[28:31], v[108:111]
    ds_read_b128 a[40:43], v14 offset:22528
    v_mfma_f32_16x16x32_bf16 v[104:107], a[112:115], a[24:27], v[104:107]
    v_mfma_f32_16x16x32_bf16 v[100:103], a[112:115], a[20:23], v[100:103]
    ds_read_b128 a[44:47], v14 offset:24576
    v_mfma_f32_16x16x32_bf16 v[96:99], a[112:115], a[16:19], v[96:99]
    buffer_load_dwordx4 v8, s[32:35], s60 offen offset:3072 lds
    v_mfma_f32_16x16x32_bf16 v[92:95], a[112:115], a[12:15], v[92:95]
    ds_read_b128 a[48:51], v14 offset:26624
    v_mfma_f32_16x16x32_bf16 v[88:91], a[112:115], a[8:11], v[88:91]
    v_mfma_f32_16x16x32_bf16 v[84:87], a[112:115], a[4:7], v[84:87]
    ds_read_b128 a[52:55], v14 offset:28672
    v_mfma_f32_16x16x32_bf16 v[80:83], a[112:115], a[0:3], v[80:83]
    v_mfma_f32_16x16x32_bf16 v[112:115], a[116:119], a[0:3], v[112:115]
    s_sub_u32 s14, s14, s9
    s_add_u32 s14, s14, s8
    ds_read_b128 a[56:59], v14 offset:30720
    v_mfma_f32_16x16x32_bf16 v[116:119], a[116:119], a[4:7], v[116:119]
    v_mfma_f32_16x16x32_bf16 v[120:123], a[116:119], a[8:11], v[120:123]
    ds_read_b128 a[60:63], v14 offset:32768
    v_mfma_f32_16x16x32_bf16 v[124:127], a[116:119], a[12:15], v[124:127]
    buffer_load_dwordx4 v6, s[32:35], s60 offen offset:0 lds
    v_mfma_f32_16x16x32_bf16 v[128:131], a[116:119], a[16:19], v[128:131]
    s_sub_u32 s14, s14, s9
    s_add_u32 s14, s14, s8
    ds_read_b128 a[64:67], v14 offset:34816
    v_mfma_f32_16x16x32_bf16 v[132:135], a[116:119], a[20:23], v[132:135]
    v_mfma_f32_16x16x32_bf16 v[136:139], a[116:119], a[24:27], v[136:139]
    s_sub_u32 s14, s14, s9
    s_add_u32 s14, s14, s8
    ds_read_b128 a[68:71], v14 offset:36864
    v_mfma_f32_16x16x32_bf16 v[140:143], a[116:119], a[28:31], v[140:143]
    v_mfma_f32_16x16x32_bf16 v[144:147], a[116:119], a[32:35], v[144:147]
    ds_read_b64_tr_b16 a[140:141], v29 offset:20480
    v_mfma_f32_16x16x32_bf16 v[180:183], a[120:123], a[32:35], v[180:183]
    s_sub_u32 s14, s14, s9
    s_add_u32 s14, s14, s8
    v_mfma_f32_16x16x32_bf16 v[176:179], a[120:123], a[28:31], v[176:179]
    ds_read_b64_tr_b16 a[142:143], v29 offset:20992
    v_mfma_f32_16x16x32_bf16 v[172:175], a[120:123], a[24:27], v[172:175]
    buffer_load_dwordx4 v27, s[32:35], s60 offen offset:2048 lds
    v_mfma_f32_16x16x32_bf16 v[168:171], a[120:123], a[20:23], v[168:171]
    s_sub_u32 s14, s14, s9
    s_add_u32 s14, s14, s8
    ds_read_b64_tr_b16 a[144:145], v11 offset:22528
    v_mfma_f32_16x16x32_bf16 v[164:167], a[120:123], a[16:19], v[164:167]
    v_mfma_f32_16x16x32_bf16 v[160:163], a[120:123], a[12:15], v[160:163]
    ds_read_b64_tr_b16 a[146:147], v11 offset:23040
    v_mfma_f32_16x16x32_bf16 v[156:159], a[120:123], a[8:11], v[156:159]
    s_sub_u32 s14, s14, s9
    s_add_u32 s14, s14, s8
    v_mfma_f32_16x16x32_bf16 v[152:155], a[120:123], a[4:7], v[152:155]
    ds_read_b64_tr_b16 a[148:149], v29 offset:22528
    v_mfma_f32_16x16x32_bf16 v[148:151], a[120:123], a[0:3], v[148:151]
    s_add_u32 m0, s66, 61440
    s_add_u32 s59, s60, 2304
    v_mfma_f32_16x16x32_bf16 v[184:187], a[124:127], a[0:3], v[184:187]
    s_sub_u32 s14, s14, s9
    s_add_u32 s14, s14, s8
    ds_read_b64_tr_b16 a[150:151], v29 offset:23040
    v_mfma_f32_16x16x32_bf16 v[188:191], a[124:127], a[4:7], v[188:191]
    buffer_load_dwordx4 v9, s[32:35], s60 offen offset:2048 lds
    v_mfma_f32_16x16x32_bf16 v[192:195], a[124:127], a[8:11], v[192:195]
    ds_read_b64_tr_b16 a[152:153], v11 offset:24576
    v_mfma_f32_16x16x32_bf16 v[196:199], a[124:127], a[12:15], v[196:199]
    v_mfma_f32_16x16x32_bf16 v[200:203], a[124:127], a[16:19], v[200:203]
    ds_read_b64_tr_b16 a[154:155], v11 offset:25088
    v_mfma_f32_16x16x32_bf16 v[204:207], a[124:127], a[20:23], v[204:207]
    v_mfma_f32_16x16x32_bf16 v[208:211], a[124:127], a[24:27], v[208:211]
    ds_read_b64_tr_b16 a[156:157], v29 offset:24576
    v_mfma_f32_16x16x32_bf16 v[212:215], a[124:127], a[28:31], v[212:215]
    v_mfma_f32_16x16x32_bf16 v[216:219], a[124:127], a[32:35], v[216:219]
    ds_read_b64_tr_b16 a[158:159], v29 offset:25088
    v_mfma_f32_16x16x32_bf16 v[252:255], a[128:131], a[32:35], v[252:255]
    buffer_load_dwordx4 v6, s[32:35], s59 offen lds
    v_mfma_f32_16x16x32_bf16 v[248:251], a[128:131], a[28:31], v[248:251]
    ds_read_b64_tr_b16 a[160:161], v12
    v_mfma_f32_16x16x32_bf16 v[244:247], a[128:131], a[24:27], v[244:247]
    s_nop 0
    v_mfma_f32_16x16x32_bf16 v[240:243], a[128:131], a[20:23], v[240:243]
    s_nop 0
    ds_read_b64_tr_b16 a[162:163], v12 offset:512
    v_mfma_f32_16x16x32_bf16 v[236:239], a[128:131], a[16:19], v[236:239]
    v_mfma_f32_16x16x32_bf16 v[232:235], a[128:131], a[12:15], v[232:235]
    v_add_u32_e64 v12, s83, v12
    v_mfma_f32_16x16x32_bf16 v[228:231], a[128:131], a[8:11], v[228:231]
    v_mfma_f32_16x16x32_bf16 v[224:227], a[128:131], a[4:7], v[224:227]
    v_mfma_f32_16x16x32_bf16 v[220:223], a[128:131], a[0:3], v[220:223]
    buffer_load_dwordx4 v7, s[32:35], s59 offen offset:1024 lds
    v_mfma_f32_16x16x32_bf16 a[192:195], a[132:135], a[0:3], a[192:195]
    v_mfma_f32_16x16x32_bf16 a[196:199], a[132:135], a[4:7], a[196:199]
    v_mfma_f32_16x16x32_bf16 a[200:203], a[132:135], a[8:11], a[200:203]
    v_mfma_f32_16x16x32_bf16 a[204:207], a[132:135], a[12:15], a[204:207]
    v_mfma_f32_16x16x32_bf16 a[208:211], a[132:135], a[16:19], a[208:211]
    v_mfma_f32_16x16x32_bf16 a[212:215], a[132:135], a[20:23], a[212:215]
    v_mfma_f32_16x16x32_bf16 a[216:219], a[132:135], a[24:27], a[216:219]
    v_mfma_f32_16x16x32_bf16 a[220:223], a[132:135], a[28:31], a[220:223]
    s_nop 0
    v_mfma_f32_16x16x32_bf16 a[224:227], a[132:135], a[32:35], a[224:227]
    s_waitcnt lgkmcnt(0)
    v_mfma_f32_16x16x32_bf16 v[48:51], a[136:139], a[36:39], v[48:51]
    s_waitcnt vmcnt(14)
    s_barrier
    v_mfma_f32_16x16x32_bf16 v[52:55], a[136:139], a[40:43], v[52:55]
    s_add_u32 m0, s65, 135168
    s_xor_b32 s60, s90, 5
    s_lshl_b32 s60, s60, 7
    v_mfma_f32_16x16x32_bf16 v[56:59], a[136:139], a[44:47], v[56:59]
    s_mov_b64 s[8:9], 0
    s_cbranch_vccz L_skip5
    s_load_dword s8, s[16:17], 0x4000 glc
    s_load_dword s9, s[16:17], 0x6000 glc
L_skip5:
    ds_read_b64_tr_b16 a[164:165], v10 offset:0
    v_mfma_f32_16x16x32_bf16 v[60:63], a[136:139], a[48:51], v[60:63]
    buffer_load_dwordx4 v1, s[28:31], s60 offen offset:0 lds
    v_mfma_f32_16x16x32_bf16 v[64:67], a[136:139], a[52:55], v[64:67]
    ds_read_b64_tr_b16 a[166:167], v10 offset:512
    v_mfma_f32_16x16x32_bf16 v[68:71], a[136:139], a[56:59], v[68:71]
    v_mfma_f32_16x16x32_bf16 v[72:75], a[136:139], a[60:63], v[72:75]
    ds_read_b128 a[72:75], v13 offset:0
    v_mfma_f32_16x16x32_bf16 v[76:79], a[136:139], a[64:67], v[76:79]
    buffer_load_dwordx4 v2, s[28:31], s60 offen offset:1024 lds
    v_mfma_f32_16x16x32_bf16 v[108:111], a[140:143], a[64:67], v[108:111]
    ds_read_b128 a[76:79], v13 offset:2048
    v_mfma_f32_16x16x32_bf16 v[104:107], a[140:143], a[60:63], v[104:107]
    v_mfma_f32_16x16x32_bf16 v[100:103], a[140:143], a[56:59], v[100:103]
    ds_read_b128 a[80:83], v13 offset:4096
    v_mfma_f32_16x16x32_bf16 v[96:99], a[140:143], a[52:55], v[96:99]
    v_mfma_f32_16x16x32_bf16 v[92:95], a[140:143], a[48:51], v[92:95]
    buffer_load_dwordx4 v3, s[28:31], s60 offen offset:2048 lds
    v_mfma_f32_16x16x32_bf16 v[88:91], a[140:143], a[44:47], v[88:91]
    ds_read_b128 a[84:87], v13 offset:6144
    v_mfma_f32_16x16x32_bf16 v[84:87], a[140:143], a[40:43], v[84:87]
    ds_read_b128 a[88:91], v13 offset:8192
    v_mfma_f32_16x16x32_bf16 v[80:83], a[140:143], a[36:39], v[80:83]
    v_mfma_f32_16x16x32_bf16 v[112:115], a[144:147], a[36:39], v[112:115]
    s_add_u32 s14, s14, s8
    s_sub_u32 s14, s14, s9
    ds_read_b128 a[92:95], v13 offset:10240
    v_mfma_f32_16x16x32_bf16 v[116:119], a[144:147], a[40:43], v[116:119]
    buffer_load_dwordx4 v4, s[28:31], s60 offen offset:3072 lds
    v_mfma_f32_16x16x32_bf16 v[120:123], a[144:147], a[44:47], v[120:123]
    ds_read_b128 a[96:99], v13 offset:12288
    v_mfma_f32_16x16x32_bf16 v[124:127], a[144:147], a[48:51], v[124:127]
    s_add_u32 s14, s14, s8
    s_sub_u32 s14, s14, s9
    s_add_u32 m0, s82, 151552
    v_mfma_f32_16x16x32_bf16 v[128:131], a[144:147], a[52:55], v[128:131]
    ds_read_b128 a[100:103], v13 offset:14336
    v_mfma_f32_16x16x32_bf16 v[132:135], a[144:147], a[56:59], v[132:135]
    buffer_load_dwordx4 v5, s[28:31], s60 offen lds
    v_mfma_f32_16x16x32_bf16 v[136:139], a[144:147], a[60:63], v[136:139]
    s_add_u32 s14, s14, s8
    s_sub_u32 s14, s14, s9
    ds_read_b128 a[104:107], v13 offset:16384
    v_mfma_f32_16x16x32_bf16 v[140:143], a[144:147], a[64:67], v[140:143]
    s_nop 0
    v_mfma_f32_16x16x32_bf16 v[144:147], a[144:147], a[68:71], v[144:147]
    s_add_u32 m0, s66, 86016
    ds_read_b64_tr_b16 a[168:169], v25 offset:0
    s_add_u32 s60, s91, s49
    v_mfma_f32_16x16x32_bf16 v[180:183], a[148:151], a[68:71], v[180:183]
    s_add_u32 s14, s14, s8
    s_sub_u32 s14, s14, s9
    v_mfma_f32_16x16x32_bf16 v[176:179], a[148:151], a[64:67], v[176:179]
    buffer_load_dwordx4 v7, s[32:35], s60 offen offset:1024 lds
    v_mfma_f32_16x16x32_bf16 v[172:175], a[148:151], a[60:63], v[172:175]
    ds_read_b64_tr_b16 a[170:171], v25 offset:512
    v_mfma_f32_16x16x32_bf16 v[168:171], a[148:151], a[56:59], v[168:171]
    s_add_u32 s14, s14, s8
    s_sub_u32 s14, s14, s9
    ds_read_b64_tr_b16 a[172:173], v10 offset:2048
    v_mfma_f32_16x16x32_bf16 v[164:167], a[148:151], a[52:55], v[164:167]
    v_mfma_f32_16x16x32_bf16 v[160:163], a[148:151], a[48:51], v[160:163]
    ds_read_b64_tr_b16 a[174:175], v10 offset:2560
    v_mfma_f32_16x16x32_bf16 v[156:159], a[148:151], a[44:47], v[156:159]
    buffer_load_dwordx4 v8, s[32:35], s60 offen offset:3072 lds
    v_mfma_f32_16x16x32_bf16 v[152:155], a[148:151], a[40:43], v[152:155]
    s_add_u32 s14, s14, s8
    s_sub_u32 s14, s14, s9
    ds_read_b64_tr_b16 a[176:177], v25 offset:2048
    v_mfma_f32_16x16x32_bf16 v[148:151], a[148:151], a[36:39], v[148:151]
    v_mfma_f32_16x16x32_bf16 v[184:187], a[152:155], a[36:39], v[184:187]
    s_add_u32 s14, s14, s8
    s_sub_u32 s14, s14, s9
    ds_read_b64_tr_b16 a[178:179], v25 offset:2560
    v_mfma_f32_16x16x32_bf16 v[188:191], a[152:155], a[40:43], v[188:191]
    buffer_load_dwordx4 v6, s[32:35], s60 offen offset:0 lds
    v_mfma_f32_16x16x32_bf16 v[192:195], a[152:155], a[44:47], v[192:195]
    ds_read_b64_tr_b16 a[180:181], v10 offset:4096
    v_mfma_f32_16x16x32_bf16 v[196:199], a[152:155], a[48:51], v[196:199]
    v_mfma_f32_16x16x32_bf16 v[200:203], a[152:155], a[52:55], v[200:203]
    ds_read_b64_tr_b16 a[182:183], v10 offset:4608
    v_mfma_f32_16x16x32_bf16 v[204:207], a[152:155], a[56:59], v[204:207]
    v_mfma_f32_16x16x32_bf16 v[208:211], a[152:155], a[60:63], v[208:211]
    buffer_load_dwordx4 v27, s[32:35], s60 offen offset:2048 lds
    v_mfma_f32_16x16x32_bf16 v[212:215], a[152:155], a[64:67], v[212:215]
    ds_read_b64_tr_b16 a[184:185], v25 offset:4096
    v_mfma_f32_16x16x32_bf16 v[216:219], a[152:155], a[68:71], v[216:219]
    ds_read_b64_tr_b16 a[186:187], v25 offset:4608
    v_mfma_f32_16x16x32_bf16 v[252:255], a[156:159], a[68:71], v[252:255]
    s_add_u32 m0, s66, 90112
    s_add_u32 s59, s60, 2304
    v_mfma_f32_16x16x32_bf16 v[248:251], a[156:159], a[64:67], v[248:251]
    ds_read_b64_tr_b16 a[188:189], v12
    v_mfma_f32_16x16x32_bf16 v[244:247], a[156:159], a[60:63], v[244:247]
    buffer_load_dwordx4 v9, s[32:35], s60 offen offset:2048 lds
    v_mfma_f32_16x16x32_bf16 v[240:243], a[156:159], a[56:59], v[240:243]
    ds_read_b64_tr_b16 a[190:191], v12 offset:512
    v_mfma_f32_16x16x32_bf16 v[236:239], a[156:159], a[52:55], v[236:239]
    v_mfma_f32_16x16x32_bf16 v[232:235], a[156:159], a[48:51], v[232:235]
    v_add_u32_e64 v12, s62, v12
    v_mfma_f32_16x16x32_bf16 v[228:231], a[156:159], a[44:47], v[228:231]
    buffer_load_dwordx4 v6, s[32:35], s59 offen lds
    v_mfma_f32_16x16x32_bf16 v[224:227], a[156:159], a[40:43], v[224:227]
    v_mfma_f32_16x16x32_bf16 v[220:223], a[156:159], a[36:39], v[220:223]
    v_mfma_f32_16x16x32_bf16 a[192:195], a[160:163], a[36:39], a[192:195]
    v_mfma_f32_16x16x32_bf16 a[196:199], a[160:163], a[40:43], a[196:199]
    v_mfma_f32_16x16x32_bf16 a[200:203], a[160:163], a[44:47], a[200:203]
    buffer_load_dwordx4 v7, s[32:35], s59 offen offset:1024 lds
    v_mfma_f32_16x16x32_bf16 a[204:207], a[160:163], a[48:51], a[204:207]
    v_mfma_f32_16x16x32_bf16 a[208:211], a[160:163], a[52:55], a[208:211]
    v_mfma_f32_16x16x32_bf16 a[212:215], a[160:163], a[56:59], a[212:215]
    v_mfma_f32_16x16x32_bf16 a[216:219], a[160:163], a[60:63], a[216:219]
    v_mfma_f32_16x16x32_bf16 a[220:223], a[160:163], a[64:67], a[220:223]
    s_nop 0
    v_mfma_f32_16x16x32_bf16 a[224:227], a[160:163], a[68:71], a[224:227]
    s_waitcnt lgkmcnt(0)
    v_mfma_f32_16x16x32_bf16 v[48:51], a[164:167], a[72:75], v[48:51]
    s_waitcnt vmcnt(19)
    s_barrier
    v_mfma_f32_16x16x32_bf16 v[52:55], a[164:167], a[76:79], v[52:55]
    s_xor_b32 s91, s90, 6
    s_mul_i32 s91, s91, 221184
    s_add_u32 s91, s91, s64
    v_mfma_f32_16x16x32_bf16 v[56:59], a[164:167], a[80:83], v[56:59]
    s_mov_b64 s[8:9], 0
    s_cbranch_vccz L_skip6
    s_load_dword s9, s[16:17], 0x7000 glc
    s_load_dword s8, s[16:17], 0x5000 glc
L_skip6:
    ds_read_b64_tr_b16 a[108:109], v10 offset:28672
    v_mfma_f32_16x16x32_bf16 v[60:63], a[164:167], a[84:87], v[60:63]
    s_add_u32 m0, s66, 0
    s_add_u32 s60, s91, s48
    v_mfma_f32_16x16x32_bf16 v[64:67], a[164:167], a[88:91], v[64:67]
    buffer_load_dwordx4 v7, s[32:35], s60 offen offset:1024 lds
    v_mfma_f32_16x16x32_bf16 v[68:71], a[164:167], a[92:95], v[68:71]
    ds_read_b64_tr_b16 a[110:111], v10 offset:29184
    v_mfma_f32_16x16x32_bf16 v[72:75], a[164:167], a[96:99], v[72:75]
    ds_read_b128 a[0:3], v14 offset:0
    v_mfma_f32_16x16x32_bf16 v[76:79], a[164:167], a[100:103], v[76:79]
    v_mfma_f32_16x16x32_bf16 v[108:111], a[168:171], a[100:103], v[108:111]
    ds_read_b128 a[4:7], v14 offset:2048
    v_mfma_f32_16x16x32_bf16 v[104:107], a[168:171], a[96:99], v[104:107]
    v_mfma_f32_16x16x32_bf16 v[100:103], a[168:171], a[92:95], v[100:103]
    ds_read_b128 a[8:11], v14 offset:4096
    v_mfma_f32_16x16x32_bf16 v[96:99], a[168:171], a[88:91], v[96:99]
    buffer_load_dwordx4 v8, s[32:35], s60 offen offset:3072 lds
    v_mfma_f32_16x16x32_bf16 v[92:95], a[168:171], a[84:87], v[92:95]
    ds_read_b128 a[12:15], v14 offset:6144
    v_mfma_f32_16x16x32_bf16 v[88:91], a[168:171], a[80:83], v[88:91]
    v_mfma_f32_16x16x32_bf16 v[84:87], a[168:171], a[76:79], v[84:87]
    ds_read_b128 a[16:19], v14 offset:8192
    v_mfma_f32_16x16x32_bf16 v[80:83], a[168:171], a[72:75], v[80:83]
    v_mfma_f32_16x16x32_bf16 v[112:115], a[172:175], a[72:75], v[112:115]
    s_sub_u32 s14, s14, s9
    s_add_u32 s14, s14, s8
L_att_pad2:
    s_cbranch_execz L_att_ret0
    ds_read_b128 a[20:23], v14 offset:10240
    v_mfma_f32_16x16x32_bf16 v[116:119], a[172:175], a[76:79], v[116:119]
    v_mfma_f32_16x16x32_bf16 v[120:123], a[172:175], a[80:83], v[120:123]
    s_nop 0
    ds_read_b128 a[24:27], v14 offset:12288
    v_mfma_f32_16x16x32_bf16 v[124:127], a[172:175], a[84:87], v[124:127]
    buffer_load_dwordx4 v6, s[32:35], s60 offen offset:0 lds
    v_mfma_f32_16x16x32_bf16 v[128:131], a[172:175], a[88:91], v[128:131]
    s_sub_u32 s14, s14, s9
    s_add_u32 s14, s14, s8
    ds_read_b128 a[28:31], v14 offset:14336
    v_mfma_f32_16x16x32_bf16 v[132:135], a[172:175], a[92:95], v[132:135]
    v_mfma_f32_16x16x32_bf16 v[136:139], a[172:175], a[96:99], v[136:139]
    s_sub_u32 s14, s14, s9
    s_add_u32 s14, s14, s8
    ds_read_b128 a[32:35], v14 offset:16384
    v_mfma_f32_16x16x32_bf16 v[140:143], a[172:175], a[100:103], v[140:143]
    v_mfma_f32_16x16x32_bf16 v[144:147], a[172:175], a[104:107], v[144:147]
    ds_read_b64_tr_b16 a[112:113], v25 offset:28672
    v_mfma_f32_16x16x32_bf16 v[180:183], a[176:179], a[104:107], v[180:183]
    s_sub_u32 s14, s14, s9
    s_add_u32 s14, s14, s8
    v_mfma_f32_16x16x32_bf16 v[176:179], a[176:179], a[100:103], v[176:179]
    ds_read_b64_tr_b16 a[114:115], v25 offset:29184
    v_mfma_f32_16x16x32_bf16 v[172:175], a[176:179], a[96:99], v[172:175]
    buffer_load_dwordx4 v27, s[32:35], s60 offen offset:2048 lds
    v_mfma_f32_16x16x32_bf16 v[168:171], a[176:179], a[92:95], v[168:171]
    s_sub_u32 s14, s14, s9
    s_add_u32 s14, s14, s8
    ds_read_b64_tr_b16 a[116:117], v10 offset:30720
    v_mfma_f32_16x16x32_bf16 v[164:167], a[176:179], a[88:91], v[164:167]
    v_mfma_f32_16x16x32_bf16 v[160:163], a[176:179], a[84:87], v[160:163]
    ds_read_b64_tr_b16 a[118:119], v10 offset:31232
    v_mfma_f32_16x16x32_bf16 v[156:159], a[176:179], a[80:83], v[156:159]
    s_sub_u32 s14, s14, s9
    s_add_u32 s14, s14, s8
    v_mfma_f32_16x16x32_bf16 v[152:155], a[176:179], a[76:79], v[152:155]
    ds_read_b64_tr_b16 a[120:121], v25 offset:30720
    v_mfma_f32_16x16x32_bf16 v[148:151], a[176:179], a[72:75], v[148:151]
    s_add_u32 m0, s66, 4096
    s_add_u32 s59, s60, 2304
    v_mfma_f32_16x16x32_bf16 v[184:187], a[180:183], a[72:75], v[184:187]
    s_sub_u32 s14, s14, s9
    s_add_u32 s14, s14, s8
    ds_read_b64_tr_b16 a[122:123], v25 offset:31232
    v_mfma_f32_16x16x32_bf16 v[188:191], a[180:183], a[76:79], v[188:191]
    buffer_load_dwordx4 v9, s[32:35], s60 offen offset:2048 lds
    v_mfma_f32_16x16x32_bf16 v[192:195], a[180:183], a[80:83], v[192:195]
    ds_read_b64_tr_b16 a[124:125], v10 offset:32768
    v_mfma_f32_16x16x32_bf16 v[196:199], a[180:183], a[84:87], v[196:199]
    v_mfma_f32_16x16x32_bf16 v[200:203], a[180:183], a[88:91], v[200:203]
    ds_read_b64_tr_b16 a[126:127], v10 offset:33280
    v_mfma_f32_16x16x32_bf16 v[204:207], a[180:183], a[92:95], v[204:207]
    v_mfma_f32_16x16x32_bf16 v[208:211], a[180:183], a[96:99], v[208:211]
    ds_read_b64_tr_b16 a[128:129], v25 offset:32768
    v_mfma_f32_16x16x32_bf16 v[212:215], a[180:183], a[100:103], v[212:215]
    v_mfma_f32_16x16x32_bf16 v[216:219], a[180:183], a[104:107], v[216:219]
    ds_read_b64_tr_b16 a[130:131], v25 offset:33280
    v_mfma_f32_16x16x32_bf16 v[252:255], a[184:187], a[104:107], v[252:255]
    buffer_load_dwordx4 v6, s[32:35], s59 offen lds
    v_mfma_f32_16x16x32_bf16 v[248:251], a[184:187], a[100:103], v[248:251]
    ds_read_b64_tr_b16 a[132:133], v12
    v_mfma_f32_16x16x32_bf16 v[244:247], a[184:187], a[96:99], v[244:247]
    s_nop 0
    v_mfma_f32_16x16x32_bf16 v[240:243], a[184:187], a[92:95], v[240:243]
    s_nop 0
    ds_read_b64_tr_b16 a[134:135], v12 offset:512
    v_mfma_f32_16x16x32_bf16 v[236:239], a[184:187], a[88:91], v[236:239]
    v_mfma_f32_16x16x32_bf16 v[232:235], a[184:187], a[84:87], v[232:235]
    v_add_u32_e64 v12, s62, v12
    v_mfma_f32_16x16x32_bf16 v[228:231], a[184:187], a[80:83], v[228:231]
    v_mfma_f32_16x16x32_bf16 v[224:227], a[184:187], a[76:79], v[224:227]
    v_mfma_f32_16x16x32_bf16 v[220:223], a[184:187], a[72:75], v[220:223]
    buffer_load_dwordx4 v7, s[32:35], s59 offen offset:1024 lds
    v_mfma_f32_16x16x32_bf16 a[192:195], a[188:191], a[72:75], a[192:195]
    v_mfma_f32_16x16x32_bf16 a[196:199], a[188:191], a[76:79], a[196:199]
    v_mfma_f32_16x16x32_bf16 a[200:203], a[188:191], a[80:83], a[200:203]
    v_mfma_f32_16x16x32_bf16 a[204:207], a[188:191], a[84:87], a[204:207]
    v_mfma_f32_16x16x32_bf16 a[208:211], a[188:191], a[88:91], a[208:211]
    v_mfma_f32_16x16x32_bf16 a[212:215], a[188:191], a[92:95], a[212:215]
    s_nop 0
    v_mfma_f32_16x16x32_bf16 a[216:219], a[188:191], a[96:99], a[216:219]
    s_nop 0
    v_mfma_f32_16x16x32_bf16 a[220:223], a[188:191], a[100:103], a[220:223]
    s_nop 0
    v_mfma_f32_16x16x32_bf16 a[224:227], a[188:191], a[104:107], a[224:227]
    s_waitcnt lgkmcnt(0)
    v_mfma_f32_16x16x32_bf16 v[48:51], a[108:111], a[0:3], v[48:51]
    s_waitcnt vmcnt(14)
    s_barrier
    v_mfma_f32_16x16x32_bf16 v[52:55], a[108:111], a[4:7], v[52:55]
    s_add_u32 m0, s65, 114688
    s_xor_b32 s60, s90, 6
    s_lshl_b32 s60, s60, 7
    v_mfma_f32_16x16x32_bf16 v[56:59], a[108:111], a[8:11], v[56:59]
    s_cmp_lt_i32 s14, 0
    s_cselect_b32 s15, 17, 1
    ds_read_b64_tr_b16 a[136:137], v10 offset:57344
    v_mfma_f32_16x16x32_bf16 v[60:63], a[108:111], a[12:15], v[60:63]
    buffer_load_dwordx4 v1, s[28:31], s60 offen offset:0 lds
    v_mfma_f32_16x16x32_bf16 v[64:67], a[108:111], a[16:19], v[64:67]
    s_lshl_b32 s15, s15, s67
    ds_read_b64_tr_b16 a[138:139], v10 offset:57856
    v_mfma_f32_16x16x32_bf16 v[68:71], a[108:111], a[20:23], v[68:71]
    s_cbranch_vccz L_skip1
    s_atomic_or s15, s[94:95], 0x0
L_skip1:
    v_mfma_f32_16x16x32_bf16 v[72:75], a[108:111], a[24:27], v[72:75]
    ds_read_b128 a[36:39], v13 offset:20480
    v_mfma_f32_16x16x32_bf16 v[76:79], a[108:111], a[28:31], v[76:79]
    buffer_load_dwordx4 v2, s[28:31], s60 offen offset:1024 lds
    v_mfma_f32_16x16x32_bf16 v[108:111], a[112:115], a[28:31], v[108:111]
    ds_read_b128 a[40:43], v13 offset:22528
    v_mfma_f32_16x16x32_bf16 v[104:107], a[112:115], a[24:27], v[104:107]
    v_mfma_f32_16x16x32_bf16 v[100:103], a[112:115], a[20:23], v[100:103]
    ds_read_b128 a[44:47], v13 offset:24576
    v_mfma_f32_16x16x32_bf16 v[96:99], a[112:115], a[16:19], v[96:99]
    v_mfma_f32_16x16x32_bf16 v[92:95], a[112:115], a[12:15], v[92:95]
    buffer_load_dwordx4 v3, s[28:31], s60 offen offset:2048 lds
    v_mfma_f32_16x16x32_bf16 v[88:91], a[112:115], a[8:11], v[88:91]
    ds_read_b128 a[48:51], v13 offset:26624
    v_mfma_f32_16x16x32_bf16 v[84:87], a[112:115], a[4:7], v[84:87]
    ds_read_b128 a[52:55], v13 offset:28672
    v_mfma_f32_16x16x32_bf16 v[80:83], a[112:115], a[0:3], v[80:83]
    v_mfma_f32_16x16x32_bf16 v[112:115], a[116:119], a[0:3], v[112:115]
    ds_read_b128 a[56:59], v13 offset:30720
    v_mfma_f32_16x16x32_bf16 v[116:119], a[116:119], a[4:7], v[116:119]
    buffer_load_dwordx4 v4, s[28:31], s60 offen offset:3072 lds
    v_mfma_f32_16x16x32_bf16 v[120:123], a[116:119], a[8:11], v[120:123]
    ds_read_b128 a[60:63], v13 offset:32768
    v_mfma_f32_16x16x32_bf16 v[124:127], a[116:119], a[12:15], v[124:127]
    s_add_u32 m0, s82, 131072
    v_mfma_f32_16x16x32_bf16 v[128:131], a[116:119], a[16:19], v[128:131]
    ds_read_b128 a[64:67], v13 offset:34816
    v_mfma_f32_16x16x32_bf16 v[132:135], a[116:119], a[20:23], v[132:135]
    buffer_load_dwordx4 v5, s[28:31], s60 offen lds
    v_mfma_f32_16x16x32_bf16 v[136:139], a[116:119], a[24:27], v[136:139]
    ds_read_b128 a[68:71], v13 offset:36864
    v_mfma_f32_16x16x32_bf16 v[140:143], a[116:119], a[28:31], v[140:143]
    v_mfma_f32_16x16x32_bf16 v[144:147], a[116:119], a[32:35], v[144:147]
    s_add_u32 m0, s66, 28672
    ds_read_b64_tr_b16 a[140:141], v25 offset:57344
    s_add_u32 s60, s91, s49
    v_mfma_f32_16x16x32_bf16 v[180:183], a[120:123], a[32:35], v[180:183]
    s_nop 0
    v_mfma_f32_16x16x32_bf16 v[176:179], a[120:123], a[28:31], v[176:179]
    buffer_load_dwordx4 v7, s[32:35], s60 offen offset:1024 lds
    v_mfma_f32_16x16x32_bf16 v[172:175], a[120:123], a[24:27], v[172:175]
    ds_read_b64_tr_b16 a[142:143], v25 offset:57856
    v_mfma_f32_16x16x32_bf16 v[168:171], a[120:123], a[20:23], v[168:171]
    ds_read_b64_tr_b16 a[144:145], v10 offset:59392
    v_mfma_f32_16x16x32_bf16 v[164:167], a[120:123], a[16:19], v[164:167]
    v_mfma_f32_16x16x32_bf16 v[160:163], a[120:123], a[12:15], v[160:163]
    ds_read_b64_tr_b16 a[146:147], v10 offset:59904
    v_mfma_f32_16x16x32_bf16 v[156:159], a[120:123], a[8:11], v[156:159]
    buffer_load_dwordx4 v8, s[32:35], s60 offen offset:3072 lds
    v_mfma_f32_16x16x32_bf16 v[152:155], a[120:123], a[4:7], v[152:155]
    ds_read_b64_tr_b16 a[148:149], v25 offset:59392
    v_mfma_f32_16x16x32_bf16 v[148:151], a[120:123], a[0:3], v[148:151]
    v_mfma_f32_16x16x32_bf16 v[184:187], a[124:127], a[0:3], v[184:187]
    ds_read_b64_tr_b16 a[150:151], v25 offset:59904
    v_mfma_f32_16x16x32_bf16 v[188:191], a[124:127], a[4:7], v[188:191]
    buffer_load_dwordx4 v6, s[32:35], s60 offen offset:0 lds
    v_mfma_f32_16x16x32_bf16 v[192:195], a[124:127], a[8:11], v[192:195]
    ds_read_b64_tr_b16 a[152:153], v10 offset:61440
    v_mfma_f32_16x16x32_bf16 v[196:199], a[124:127], a[12:15], v[196:199]
    v_mfma_f32_16x16x32_bf16 v[200:203], a[124:127], a[16:19], v[200:203]
    ds_read_b64_tr_b16 a[154:155], v10 offset:61952
    v_mfma_f32_16x16x32_bf16 v[204:207], a[124:127], a[20:23], v[204:207]
    v_mfma_f32_16x16x32_bf16 v[208:211], a[124:127], a[24:27], v[208:211]
    buffer_load_dwordx4 v27, s[32:35], s60 offen offset:2048 lds
    v_mfma_f32_16x16x32_bf16 v[212:215], a[124:127], a[28:31], v[212:215]
    ds_read_b64_tr_b16 a[156:157], v25 offset:61440
    v_mfma_f32_16x16x32_bf16 v[216:219], a[124:127], a[32:35], v[216:219]
    ds_read_b64_tr_b16 a[158:159], v25 offset:61952
    v_mfma_f32_16x16x32_bf16 v[252:255], a[128:131], a[32:35], v[252:255]
    s_add_u32 m0, s66, 32768
    s_add_u32 s59, s60, 2304
    v_mfma_f32_16x16x32_bf16 v[248:251], a[128:131], a[28:31], v[248:251]
    ds_read_b64_tr_b16 a[160:161], v12
    v_mfma_f32_16x16x32_bf16 v[244:247], a[128:131], a[24:27], v[244:247]
    buffer_load_dwordx4 v9, s[32:35], s60 offen offset:2048 lds
    v_mfma_f32_16x16x32_bf16 v[240:243], a[128:131], a[20:23], v[240:243]
    ds_read_b64_tr_b16 a[162:163], v12 offset:512
    v_mfma_f32_16x16x32_bf16 v[236:239], a[128:131], a[16:19], v[236:239]
    v_mfma_f32_16x16x32_bf16 v[232:235], a[128:131], a[12:15], v[232:235]
    v_add_u32_e64 v12, s62, v12
    v_mfma_f32_16x16x32_bf16 v[228:231], a[128:131], a[8:11], v[228:231]
    buffer_load_dwordx4 v6, s[32:35], s59 offen lds
    v_mfma_f32_16x16x32_bf16 v[224:227], a[128:131], a[4:7], v[224:227]
    v_mfma_f32_16x16x32_bf16 v[220:223], a[128:131], a[0:3], v[220:223]
    v_mfma_f32_16x16x32_bf16 a[192:195], a[132:135], a[0:3], a[192:195]
    v_mfma_f32_16x16x32_bf16 a[196:199], a[132:135], a[4:7], a[196:199]
    v_mfma_f32_16x16x32_bf16 a[200:203], a[132:135], a[8:11], a[200:203]
    buffer_load_dwordx4 v7, s[32:35], s59 offen offset:1024 lds
    v_mfma_f32_16x16x32_bf16 a[204:207], a[132:135], a[12:15], a[204:207]
    v_mfma_f32_16x16x32_bf16 a[208:211], a[132:135], a[16:19], a[208:211]
    v_mfma_f32_16x16x32_bf16 a[212:215], a[132:135], a[20:23], a[212:215]
    v_mfma_f32_16x16x32_bf16 a[216:219], a[132:135], a[24:27], a[216:219]
    s_nop 0
    v_mfma_f32_16x16x32_bf16 a[220:223], a[132:135], a[28:31], a[220:223]
    s_nop 0
    v_mfma_f32_16x16x32_bf16 a[224:227], a[132:135], a[32:35], a[224:227]
    s_waitcnt lgkmcnt(0)
    v_mfma_f32_16x16x32_bf16 v[48:51], a[136:139], a[36:39], v[48:51]
    s_waitcnt vmcnt(19)
    s_barrier
    v_mfma_f32_16x16x32_bf16 v[52:55], a[136:139], a[40:43], v[52:55]
    s_xor_b32 s91, s90, 7
    s_mul_i32 s91, s91, 221184
    s_add_u32 s91, s91, s64
    v_mfma_f32_16x16x32_bf16 v[56:59], a[136:139], a[44:47], v[56:59]
    s_add_u32 m0, s66, 57344
    ds_read_b64_tr_b16 a[164:165], v11 offset:20480
    s_add_u32 s60, s91, s48
    v_mfma_f32_16x16x32_bf16 v[60:63], a[136:139], a[48:51], v[60:63]
    buffer_load_dwordx4 v7, s[32:35], s60 offen offset:1024 lds
    v_mfma_f32_16x16x32_bf16 v[64:67], a[136:139], a[52:55], v[64:67]
    s_mul_i32 s85, s56, 9216
    ds_read_b64_tr_b16 a[166:167], v11 offset:20992
    s_add_u32 s85, s85, 2048
    v_mfma_f32_16x16x32_bf16 v[68:71], a[136:139], a[56:59], v[68:71]
    v_mul_u32_u24 v34, 1152, v32
    v_lshl_add_u32 v34, v38, 4, v34
    v_mfma_f32_16x16x32_bf16 v[72:75], a[136:139], a[60:63], v[72:75]
    ds_read_b128 a[72:75], v14 offset:20480
    v_add_u32_e64 v15, s85, v34
    v_mfma_f32_16x16x32_bf16 v[76:79], a[136:139], a[64:67], v[76:79]
    v_subrev_u32 v16, 896, v15
    v_subrev_u32 v17, 1792, v15
    v_mfma_f32_16x16x32_bf16 v[108:111], a[140:143], a[64:67], v[108:111]
    ds_read_b128 a[76:79], v14 offset:22528
    v_lshrrev_b32_e64 v35, 2, v32
    v_mfma_f32_16x16x32_bf16 v[104:107], a[140:143], a[60:63], v[104:107]
    v_mul_u32_u24 v35, 36864, v35
    s_mul_i32 s85, s56, 82944
    v_mfma_f32_16x16x32_bf16 v[100:103], a[140:143], a[56:59], v[100:103]
    s_add_u32 s85, s85, 38912
    ds_read_b128 a[80:83], v14 offset:24576
    v_add3_u32 v18, v34, v35, s85
    v_mfma_f32_16x16x32_bf16 v[96:99], a[140:143], a[52:55], v[96:99]
    buffer_load_dwordx4 v8, s[32:35], s60 offen offset:3072 lds
    v_mfma_f32_16x16x32_bf16 v[92:95], a[140:143], a[48:51], v[92:95]
    ds_read_b128 a[84:87], v14 offset:26624
    v_subrev_u32 v19, 896, v18
    v_mfma_f32_16x16x32_bf16 v[88:91], a[140:143], a[44:47], v[88:91]
    v_subrev_u32 v20, 1792, v18
    s_xor_b32 s85, s67, 0
    v_mfma_f32_16x16x32_bf16 v[84:87], a[140:143], a[40:43], v[84:87]
    s_mul_i32 s85, s85, 165888
    ds_read_b128 a[88:91], v14 offset:28672
    s_add_u32 s70, s85, s64
    v_mfma_f32_16x16x32_bf16 v[80:83], a[140:143], a[36:39], v[80:83]
    s_xor_b32 s85, s67, 1
    s_mul_i32 s85, s85, 165888
    s_add_u32 s71, s85, s64
    v_mfma_f32_16x16x32_bf16 v[112:115], a[144:147], a[36:39], v[112:115]
    s_xor_b32 s85, s67, 2
    ds_read_b128 a[92:95], v14 offset:30720
    s_mul_i32 s85, s85, 165888
    v_mfma_f32_16x16x32_bf16 v[116:119], a[144:147], a[40:43], v[116:119]
    s_add_u32 s72, s85, s64
    s_xor_b32 s85, s67, 3
    s_mul_i32 s85, s85, 165888
    v_mfma_f32_16x16x32_bf16 v[120:123], a[144:147], a[44:47], v[120:123]
    s_add_u32 s73, s85, s64
    ds_read_b128 a[96:99], v14 offset:32768
    v_mfma_f32_16x16x32_bf16 v[124:127], a[144:147], a[48:51], v[124:127]
    buffer_load_dwordx4 v6, s[32:35], s60 offen offset:0 lds
    v_mfma_f32_16x16x32_bf16 v[128:131], a[144:147], a[52:55], v[128:131]
    ds_read_b128 a[100:103], v14 offset:34816
    v_mfma_f32_16x16x32_bf16 v[132:135], a[144:147], a[56:59], v[132:135]
    v_mfma_f32_16x16x32_bf16 v[136:139], a[144:147], a[60:63], v[136:139]
    ds_read_b128 a[104:107], v14 offset:36864
    v_mfma_f32_16x16x32_bf16 v[140:143], a[144:147], a[64:67], v[140:143]
    v_mfma_f32_16x16x32_bf16 v[144:147], a[144:147], a[68:71], v[144:147]
    ds_read_b64_tr_b16 a[168:169], v29 offset:20480
    v_mfma_f32_16x16x32_bf16 v[180:183], a[148:151], a[68:71], v[180:183]
    v_mfma_f32_16x16x32_bf16 v[176:179], a[148:151], a[64:67], v[176:179]
    ds_read_b64_tr_b16 a[170:171], v29 offset:20992
    v_mfma_f32_16x16x32_bf16 v[172:175], a[148:151], a[60:63], v[172:175]
    buffer_load_dwordx4 v27, s[32:35], s60 offen offset:2048 lds
    v_mfma_f32_16x16x32_bf16 v[168:171], a[148:151], a[56:59], v[168:171]
    ds_read_b64_tr_b16 a[172:173], v11 offset:22528
    v_mfma_f32_16x16x32_bf16 v[164:167], a[148:151], a[52:55], v[164:167]
    v_mfma_f32_16x16x32_bf16 v[160:163], a[148:151], a[48:51], v[160:163]
    ds_read_b64_tr_b16 a[174:175], v11 offset:23040
    v_mfma_f32_16x16x32_bf16 v[156:159], a[148:151], a[44:47], v[156:159]
    v_mfma_f32_16x16x32_bf16 v[152:155], a[148:151], a[40:43], v[152:155]
    ds_read_b64_tr_b16 a[176:177], v29 offset:22528
    v_mfma_f32_16x16x32_bf16 v[148:151], a[148:151], a[36:39], v[148:151]
    s_add_u32 m0, s66, 61440
    s_add_u32 s59, s60, 2304
    v_mfma_f32_16x16x32_bf16 v[184:187], a[152:155], a[36:39], v[184:187]
    ds_read_b64_tr_b16 a[178:179], v29 offset:23040
    v_mfma_f32_16x16x32_bf16 v[188:191], a[152:155], a[40:43], v[188:191]
    buffer_load_dwordx4 v9, s[32:35], s60 offen offset:2048 lds
    v_mfma_f32_16x16x32_bf16 v[192:195], a[152:155], a[44:47], v[192:195]
    ds_read_b64_tr_b16 a[180:181], v11 offset:24576
    v_mfma_f32_16x16x32_bf16 v[196:199], a[152:155], a[48:51], v[196:199]
    v_mfma_f32_16x16x32_bf16 v[200:203], a[152:155], a[52:55], v[200:203]
    ds_read_b64_tr_b16 a[182:183], v11 offset:25088
    v_mfma_f32_16x16x32_bf16 v[204:207], a[152:155], a[56:59], v[204:207]
    v_mfma_f32_16x16x32_bf16 v[208:211], a[152:155], a[60:63], v[208:211]
    ds_read_b64_tr_b16 a[184:185], v29 offset:24576
    v_mfma_f32_16x16x32_bf16 v[212:215], a[152:155], a[64:67], v[212:215]
    v_mfma_f32_16x16x32_bf16 v[216:219], a[152:155], a[68:71], v[216:219]
    ds_read_b64_tr_b16 a[186:187], v29 offset:25088
    v_mfma_f32_16x16x32_bf16 v[252:255], a[156:159], a[68:71], v[252:255]
    buffer_load_dwordx4 v6, s[32:35], s59 offen lds
    v_mfma_f32_16x16x32_bf16 v[248:251], a[156:159], a[64:67], v[248:251]
    ds_read_b64_tr_b16 a[188:189], v12
    v_mfma_f32_16x16x32_bf16 v[244:247], a[156:159], a[60:63], v[244:247]
    v_mfma_f32_16x16x32_bf16 v[240:243], a[156:159], a[56:59], v[240:243]
    ds_read_b64_tr_b16 a[190:191], v12 offset:512
    v_mfma_f32_16x16x32_bf16 v[236:239], a[156:159], a[52:55], v[236:239]
    v_mfma_f32_16x16x32_bf16 v[232:235], a[156:159], a[48:51], v[232:235]
    v_add_u32_e64 v12, s83, v12
    v_mfma_f32_16x16x32_bf16 v[228:231], a[156:159], a[44:47], v[228:231]
    v_mfma_f32_16x16x32_bf16 v[224:227], a[156:159], a[40:43], v[224:227]
    v_mfma_f32_16x16x32_bf16 v[220:223], a[156:159], a[36:39], v[220:223]
    buffer_load_dwordx4 v7, s[32:35], s59 offen offset:1024 lds
    v_mfma_f32_16x16x32_bf16 a[192:195], a[160:163], a[36:39], a[192:195]
    v_mfma_f32_16x16x32_bf16 a[196:199], a[160:163], a[40:43], a[196:199]
    v_mfma_f32_16x16x32_bf16 a[200:203], a[160:163], a[44:47], a[200:203]
    v_mfma_f32_16x16x32_bf16 a[204:207], a[160:163], a[48:51], a[204:207]
    v_mfma_f32_16x16x32_bf16 a[208:211], a[160:163], a[52:55], a[208:211]
    v_mfma_f32_16x16x32_bf16 a[212:215], a[160:163], a[56:59], a[212:215]
    s_nop 0
    v_mfma_f32_16x16x32_bf16 a[216:219], a[160:163], a[60:63], a[216:219]
    s_nop 0
    v_mfma_f32_16x16x32_bf16 a[220:223], a[160:163], a[64:67], a[220:223]
    s_nop 0
    v_mfma_f32_16x16x32_bf16 a[224:227], a[160:163], a[68:71], a[224:227]
    s_waitcnt lgkmcnt(0)
    v_mfma_f32_16x16x32_bf16 v[48:51], a[164:167], a[72:75], v[48:51]
    s_waitcnt vmcnt(7)
    s_barrier
    v_mfma_f32_16x16x32_bf16 v[52:55], a[164:167], a[76:79], v[52:55]
    s_add_u32 m0, s65, 135168
    s_xor_b32 s60, s90, 7
    s_lshl_b32 s60, s60, 7
    v_mfma_f32_16x16x32_bf16 v[56:59], a[164:167], a[80:83], v[56:59]
    ds_read_b64_tr_b16 a[108:109], v10 offset:0
    v_mfma_f32_16x16x32_bf16 v[60:63], a[164:167], a[84:87], v[60:63]
    buffer_load_dwordx4 v1, s[28:31], s60 offen offset:0 lds
    v_mfma_f32_16x16x32_bf16 v[64:67], a[164:167], a[88:91], v[64:67]
    ds_read_b64_tr_b16 a[110:111], v10 offset:512
    v_mfma_f32_16x16x32_bf16 v[68:71], a[164:167], a[92:95], v[68:71]
    ds_read_b128 a[0:3], v13 offset:0
    v_mfma_f32_16x16x32_bf16 v[72:75], a[164:167], a[96:99], v[72:75]
    ds_read_b128 a[4:7], v13 offset:2048
    v_mfma_f32_16x16x32_bf16 v[76:79], a[164:167], a[100:103], v[76:79]
    buffer_load_dwordx4 v2, s[28:31], s60 offen offset:1024 lds
    v_mfma_f32_16x16x32_bf16 v[108:111], a[168:171], a[100:103], v[108:111]
    ds_read_b128 a[8:11], v13 offset:4096
    v_mfma_f32_16x16x32_bf16 v[104:107], a[168:171], a[96:99], v[104:107]
    ds_read_b128 a[12:15], v13 offset:6144
    v_mfma_f32_16x16x32_bf16 v[100:103], a[168:171], a[92:95], v[100:103]
    ds_read_b128 a[16:19], v13 offset:8192
    v_mfma_f32_16x16x32_bf16 v[96:99], a[168:171], a[88:91], v[96:99]
    ds_read_b128 a[20:23], v13 offset:10240
    v_mfma_f32_16x16x32_bf16 v[92:95], a[168:171], a[84:87], v[92:95]
    buffer_load_dwordx4 v3, s[28:31], s60 offen offset:2048 lds
    v_mfma_f32_16x16x32_bf16 v[88:91], a[168:171], a[80:83], v[88:91]
    ds_read_b128 a[24:27], v13 offset:12288
    v_mfma_f32_16x16x32_bf16 v[84:87], a[168:171], a[76:79], v[84:87]
    ds_read_b128 a[28:31], v13 offset:14336
    v_mfma_f32_16x16x32_bf16 v[80:83], a[168:171], a[72:75], v[80:83]
    ds_read_b128 a[32:35], v13 offset:16384
    v_mfma_f32_16x16x32_bf16 v[112:115], a[172:175], a[72:75], v[112:115]
    s_mov_b32 s89, 0x12345
    ds_read_b64_tr_b16 a[112:113], v25 offset:0
    ds_read_b64_tr_b16 a[114:115], v25 offset:512
    v_mfma_f32_16x16x32_bf16 v[116:119], a[172:175], a[76:79], v[116:119]
    buffer_load_dwordx4 v4, s[28:31], s60 offen offset:3072 lds
    v_mfma_f32_16x16x32_bf16 v[120:123], a[172:175], a[80:83], v[120:123]
    s_mov_b32 s89, 0x12345
    ds_read_b64_tr_b16 a[116:117], v10 offset:2048
    ds_read_b64_tr_b16 a[118:119], v10 offset:2560
    v_mfma_f32_16x16x32_bf16 v[124:127], a[172:175], a[84:87], v[124:127]
    s_add_u32 m0, s82, 151552
    ds_read_b64_tr_b16 a[120:121], v25 offset:2048
    v_mfma_f32_16x16x32_bf16 v[128:131], a[172:175], a[88:91], v[128:131]
    ds_read_b64_tr_b16 a[122:123], v25 offset:2560
    v_mfma_f32_16x16x32_bf16 v[132:135], a[172:175], a[92:95], v[132:135]
    buffer_load_dwordx4 v5, s[28:31], s60 offen lds
    v_mfma_f32_16x16x32_bf16 v[136:139], a[172:175], a[96:99], v[136:139]
    s_mov_b32 s89, 0x12345
    ds_read_b64_tr_b16 a[124:125], v10 offset:4096
    ds_read_b64_tr_b16 a[126:127], v10 offset:4608
    v_mfma_f32_16x16x32_bf16 v[140:143], a[172:175], a[100:103], v[140:143]
    ds_read_b64_tr_b16 a[128:129], v25 offset:4096
    v_mfma_f32_16x16x32_bf16 v[144:147], a[172:175], a[104:107], v[144:147]
    s_add_u32 m0, s66, 86016
    ds_read_b64_tr_b16 a[130:131], v25 offset:4608
    s_add_u32 s60, s91, s49
    v_mfma_f32_16x16x32_bf16 v[180:183], a[176:179], a[104:107], v[180:183]
    s_nop 0
    v_mfma_f32_16x16x32_bf16 v[176:179], a[176:179], a[100:103], v[176:179]
    buffer_load_dwordx4 v7, s[32:35], s60 offen offset:1024 lds
    v_mfma_f32_16x16x32_bf16 v[172:175], a[176:179], a[96:99], v[172:175]
    s_mov_b32 s89, 0x12345
    ds_read_b64_tr_b16 a[132:133], v12
    ds_read_b64_tr_b16 a[134:135], v12 offset:512
    v_mfma_f32_16x16x32_bf16 v[168:171], a[176:179], a[92:95], v[168:171]
    v_add_u32_e64 v12, s62, v12
    v_mfma_f32_16x16x32_bf16 v[164:167], a[176:179], a[88:91], v[164:167]
    ds_read_b64_tr_b16 a[136:137], v10 offset:28672
    v_mfma_f32_16x16x32_bf16 v[160:163], a[176:179], a[84:87], v[160:163]
    ds_read_b64_tr_b16 a[138:139], v10 offset:29184
    v_mfma_f32_16x16x32_bf16 v[156:159], a[176:179], a[80:83], v[156:159]
    buffer_load_dwordx4 v8, s[32:35], s60 offen offset:3072 lds
    v_mfma_f32_16x16x32_bf16 v[152:155], a[176:179], a[76:79], v[152:155]
    ds_read_b128 a[36:39], v14 offset:0
    v_mfma_f32_16x16x32_bf16 v[148:151], a[176:179], a[72:75], v[148:151]
    ds_read_b128 a[40:43], v14 offset:2048
    v_mfma_f32_16x16x32_bf16 v[184:187], a[180:183], a[72:75], v[184:187]
    ds_read_b128 a[44:47], v14 offset:4096
    v_mfma_f32_16x16x32_bf16 v[188:191], a[180:183], a[76:79], v[188:191]
    buffer_load_dwordx4 v6, s[32:35], s60 offen offset:0 lds
    v_mfma_f32_16x16x32_bf16 v[192:195], a[180:183], a[80:83], v[192:195]
    ds_read_b128 a[48:51], v14 offset:6144
    v_mfma_f32_16x16x32_bf16 v[196:199], a[180:183], a[84:87], v[196:199]
    ds_read_b128 a[52:55], v14 offset:8192
    v_mfma_f32_16x16x32_bf16 v[200:203], a[180:183], a[88:91], v[200:203]
    ds_read_b128 a[56:59], v14 offset:10240
    v_mfma_f32_16x16x32_bf16 v[204:207], a[180:183], a[92:95], v[204:207]
    ds_read_b128 a[60:63], v14 offset:12288
    v_mfma_f32_16x16x32_bf16 v[208:211], a[180:183], a[96:99], v[208:211]
    buffer_load_dwordx4 v27, s[32:35], s60 offen offset:2048 lds
    v_mfma_f32_16x16x32_bf16 v[212:215], a[180:183], a[100:103], v[212:215]
    ds_read_b128 a[64:67], v14 offset:14336
    v_mfma_f32_16x16x32_bf16 v[216:219], a[180:183], a[104:107], v[216:219]
    ds_read_b128 a[68:71], v14 offset:16384
    v_mfma_f32_16x16x32_bf16 v[252:255], a[184:187], a[104:107], v[252:255]
    s_add_u32 m0, s66, 90112
    ds_read_b64_tr_b16 a[140:141], v25 offset:28672
    ds_read_b64_tr_b16 a[142:143], v25 offset:29184
    v_mfma_f32_16x16x32_bf16 v[248:251], a[184:187], a[100:103], v[248:251]
    s_add_u32 s59, s60, 2304
    ds_read_b64_tr_b16 a[144:145], v10 offset:30720
    v_mfma_f32_16x16x32_bf16 v[244:247], a[184:187], a[96:99], v[244:247]
    buffer_load_dwordx4 v9, s[32:35], s60 offen offset:2048 lds
    v_mfma_f32_16x16x32_bf16 v[240:243], a[184:187], a[92:95], v[240:243]
    s_mov_b32 s89, 0x12345
    ds_read_b64_tr_b16 a[146:147], v10 offset:31232
    ds_read_b64_tr_b16 a[148:149], v25 offset:30720
    v_mfma_f32_16x16x32_bf16 v[236:239], a[184:187], a[88:91], v[236:239]
    ds_read_b64_tr_b16 a[150:151], v25 offset:31232
    v_mfma_f32_16x16x32_bf16 v[232:235], a[184:187], a[84:87], v[232:235]
    ds_read_b64_tr_b16 a[152:153], v10 offset:32768
    v_mfma_f32_16x16x32_bf16 v[228:231], a[184:187], a[80:83], v[228:231]
    buffer_load_dwordx4 v6, s[32:35], s59 offen lds
    v_mfma_f32_16x16x32_bf16 v[224:227], a[184:187], a[76:79], v[224:227]
    ds_read_b64_tr_b16 a[154:155], v10 offset:33280
    v_mfma_f32_16x16x32_bf16 v[220:223], a[184:187], a[72:75], v[220:223]
    ds_read_b64_tr_b16 a[156:157], v25 offset:32768
    v_mfma_f32_16x16x32_bf16 a[192:195], a[188:191], a[72:75], a[192:195]
    ds_read_b64_tr_b16 a[158:159], v25 offset:33280
    v_mfma_f32_16x16x32_bf16 a[196:199], a[188:191], a[76:79], a[196:199]
    ds_read_b64_tr_b16 a[160:161], v12
    v_mfma_f32_16x16x32_bf16 a[200:203], a[188:191], a[80:83], a[200:203]
    buffer_load_dwordx4 v7, s[32:35], s59 offen offset:1024 lds
    v_mfma_f32_16x16x32_bf16 a[204:207], a[188:191], a[84:87], a[204:207]
    ds_read_b64_tr_b16 a[162:163], v12 offset:512
    v_add_u32_e64 v12, s62, v12
    v_mfma_f32_16x16x32_bf16 a[208:211], a[188:191], a[88:91], a[208:211]
    v_mfma_f32_16x16x32_bf16 a[212:215], a[188:191], a[92:95], a[212:215]
    s_nop 0
    v_mfma_f32_16x16x32_bf16 a[216:219], a[188:191], a[96:99], a[216:219]
    s_nop 0
    v_mfma_f32_16x16x32_bf16 a[220:223], a[188:191], a[100:103], a[220:223]
    s_nop 0
    v_mfma_f32_16x16x32_bf16 a[224:227], a[188:191], a[104:107], a[224:227]
    s_waitcnt lgkmcnt(0)
    v_mfma_f32_16x16x32_bf16 v[48:51], a[108:111], a[0:3], v[48:51]
    s_waitcnt vmcnt(7)
    s_barrier
    v_mfma_f32_16x16x32_bf16 v[52:55], a[108:111], a[4:7], v[52:55]
    s_add_u32 m0, s65, 114688
    s_add_u32 s60, 0, 1024
    v_mfma_f32_16x16x32_bf16 v[56:59], a[108:111], a[8:11], v[56:59]
    ds_read_b64_tr_b16 a[164:165], v10 offset:57344
    v_mfma_f32_16x16x32_bf16 v[60:63], a[108:111], a[12:15], v[60:63]
    buffer_load_dwordx4 v1, s[28:31], s60 offen offset:0 lds
    v_mfma_f32_16x16x32_bf16 v[64:67], a[108:111], a[16:19], v[64:67]
    s_getpc_b64 s[10:11]
L_att_pc2:
    s_sub_u32 s10, s10, L_att_pc2-L_att_body
    s_subb_u32 s11, s11, 0
    v_mfma_f32_16x16x32_bf16 v[68:71], a[108:111], a[20:23], v[68:71]
    ds_read_b64_tr_b16 a[166:167], v10 offset:57856
    v_mfma_f32_16x16x32_bf16 v[72:75], a[108:111], a[24:27], v[72:75]
    ds_read_b128 a[72:75], v13 offset:20480
    v_mfma_f32_16x16x32_bf16 v[76:79], a[108:111], a[28:31], v[76:79]
    buffer_load_dwordx4 v2, s[28:31], s60 offen offset:1024 lds
    v_mfma_f32_16x16x32_bf16 v[108:111], a[112:115], a[28:31], v[108:111]
    ds_read_b128 a[76:79], v13 offset:22528
    v_mfma_f32_16x16x32_bf16 v[104:107], a[112:115], a[24:27], v[104:107]
    v_mfma_f32_16x16x32_bf16 v[100:103], a[112:115], a[20:23], v[100:103]
    ds_read_b128 a[80:83], v13 offset:24576
    v_mfma_f32_16x16x32_bf16 v[96:99], a[112:115], a[16:19], v[96:99]
    buffer_load_dwordx4 v3, s[28:31], s60 offen offset:2048 lds
    v_mfma_f32_16x16x32_bf16 v[92:95], a[112:115], a[12:15], v[92:95]
    ds_read_b128 a[84:87], v13 offset:26624
    v_mfma_f32_16x16x32_bf16 v[88:91], a[112:115], a[8:11], v[88:91]
    v_mfma_f32_16x16x32_bf16 v[84:87], a[112:115], a[4:7], v[84:87]
    ds_read_b128 a[88:91], v13 offset:28672
    v_mfma_f32_16x16x32_bf16 v[80:83], a[112:115], a[0:3], v[80:83]
    buffer_load_dwordx4 v4, s[28:31], s60 offen offset:3072 lds
    v_mfma_f32_16x16x32_bf16 v[112:115], a[116:119], a[0:3], v[112:115]
    ds_read_b128 a[92:95], v13 offset:30720
    v_mfma_f32_16x16x32_bf16 v[116:119], a[116:119], a[4:7], v[116:119]
    s_nop 0
    v_mfma_f32_16x16x32_bf16 v[120:123], a[116:119], a[8:11], v[120:123]
    s_add_u32 m0, s82, 131072
    ds_read_b128 a[96:99], v13 offset:32768
    v_mfma_f32_16x16x32_bf16 v[124:127], a[116:119], a[12:15], v[124:127]
    global_load_dword a255, v39, s[10:11]
    v_mfma_f32_16x16x32_bf16 v[128:131], a[116:119], a[16:19], v[128:131]
    s_mov_b64 s[52:53], s[18:19]
    ds_read_b128 a[100:103], v13 offset:34816
    s_mov_b32 s54, 1152
    v_mfma_f32_16x16x32_bf16 v[132:135], a[116:119], a[20:23], v[132:135]
    s_mov_b32 s55, 0x20000
    v_lshlrev_b32_e64 v46, 7, v0
    v_mfma_f32_16x16x32_bf16 v[136:139], a[116:119], a[24:27], v[136:139]
    ds_read_b128 a[104:107], v13 offset:36864
    v_mfma_f32_16x16x32_bf16 v[140:143], a[116:119], a[28:31], v[140:143]
    buffer_load_dwordx4 v5, s[28:31], s60 offen lds
    v_mfma_f32_16x16x32_bf16 v[144:147], a[116:119], a[32:35], v[144:147]
    s_add_u32 s91, s64, 1769472
    ds_read_b64_tr_b16 a[168:169], v25 offset:57344
    s_add_u32 m0, s66, 0
    v_mfma_f32_16x16x32_bf16 v[180:183], a[120:123], a[32:35], v[180:183]
    s_add_u32 s60, s91, s48
    v_mfma_f32_16x16x32_bf16 v[176:179], a[120:123], a[28:31], v[176:179]
    ds_read_b64_tr_b16 a[170:171], v25 offset:57856
    v_mfma_f32_16x16x32_bf16 v[172:175], a[120:123], a[24:27], v[172:175]
    buffer_load_dwordx4 v7, s[32:35], s60 offen offset:1024 lds
    v_mfma_f32_16x16x32_bf16 v[168:171], a[120:123], a[20:23], v[168:171]
    ds_read_b64_tr_b16 a[172:173], v10 offset:59392
    v_mfma_f32_16x16x32_bf16 v[164:167], a[120:123], a[16:19], v[164:167]
    v_mfma_f32_16x16x32_bf16 v[160:163], a[120:123], a[12:15], v[160:163]
    ds_read_b64_tr_b16 a[174:175], v10 offset:59904
    v_mfma_f32_16x16x32_bf16 v[156:159], a[120:123], a[8:11], v[156:159]
L_att_pad3:
    s_cbranch_execz L_att_ret0
    buffer_load_dwordx4 v8, s[32:35], s60 offen offset:3072 lds
    v_mfma_f32_16x16x32_bf16 v[152:155], a[120:123], a[4:7], v[152:155]
    s_nop 0
    ds_read_b64_tr_b16 a[176:177], v25 offset:59392
    v_mfma_f32_16x16x32_bf16 v[148:151], a[120:123], a[0:3], v[148:151]
    v_mfma_f32_16x16x32_bf16 v[184:187], a[124:127], a[0:3], v[184:187]
    ds_read_b64_tr_b16 a[178:179], v25 offset:59904
    v_mfma_f32_16x16x32_bf16 v[188:191], a[124:127], a[4:7], v[188:191]
    buffer_load_dwordx4 v6, s[32:35], s60 offen offset:0 lds
    v_mfma_f32_16x16x32_bf16 v[192:195], a[124:127], a[8:11], v[192:195]
    ds_read_b64_tr_b16 a[180:181], v10 offset:61440
    v_mfma_f32_16x16x32_bf16 v[196:199], a[124:127], a[12:15], v[196:199]
    v_mfma_f32_16x16x32_bf16 v[200:203], a[124:127], a[16:19], v[200:203]
    ds_read_b64_tr_b16 a[182:183], v10 offset:61952
    v_mfma_f32_16x16x32_bf16 v[204:207], a[124:127], a[20:23], v[204:207]
    buffer_load_dwordx4 v27, s[32:35], s60 offen offset:2048 lds
    v_mfma_f32_16x16x32_bf16 v[208:211], a[124:127], a[24:27], v[208:211]
    s_add_u32 m0, s66, 4096
    ds_read_b64_tr_b16 a[184:185], v25 offset:61440
    s_add_u32 s59, s60, 2304
    v_mfma_f32_16x16x32_bf16 v[212:215], a[124:127], a[28:31], v[212:215]
    v_mfma_f32_16x16x32_bf16 v[216:219], a[124:127], a[32:35], v[216:219]
    ds_read_b64_tr_b16 a[186:187], v25 offset:61952
    v_mfma_f32_16x16x32_bf16 v[252:255], a[128:131], a[32:35], v[252:255]
    buffer_load_dwordx4 v9, s[32:35], s60 offen offset:2048 lds
    v_mfma_f32_16x16x32_bf16 v[248:251], a[128:131], a[28:31], v[248:251]
    ds_read_b64_tr_b16 a[188:189], v12
    v_mfma_f32_16x16x32_bf16 v[244:247], a[128:131], a[24:27], v[244:247]
    v_mfma_f32_16x16x32_bf16 v[240:243], a[128:131], a[20:23], v[240:243]
    ds_read_b64_tr_b16 a[190:191], v12 offset:512
    v_mfma_f32_16x16x32_bf16 v[236:239], a[128:131], a[16:19], v[236:239]
    buffer_load_dwordx4 v6, s[32:35], s59 offen lds
    v_mfma_f32_16x16x32_bf16 v[232:235], a[128:131], a[12:15], v[232:235]
    v_add_u32_e64 v12, s62, v12
    v_mfma_f32_16x16x32_bf16 v[228:231], a[128:131], a[8:11], v[228:231]
    v_mfma_f32_16x16x32_bf16 v[224:227], a[128:131], a[4:7], v[224:227]
    v_mfma_f32_16x16x32_bf16 v[220:223], a[128:131], a[0:3], v[220:223]
    buffer_load_dwordx4 v7, s[32:35], s59 offen offset:1024 lds
    v_mfma_f32_16x16x32_bf16 a[192:195], a[132:135], a[0:3], a[192:195]
    s_add_u32 m0, s66, 28672
    s_add_u32 s60, s91, s49
    v_mfma_f32_16x16x32_bf16 a[196:199], a[132:135], a[4:7], a[196:199]
    v_mfma_f32_16x16x32_bf16 a[200:203], a[132:135], a[8:11], a[200:203]
    s_nop 0
    v_mfma_f32_16x16x32_bf16 a[204:207], a[132:135], a[12:15], a[204:207]
    buffer_load_dwordx4 v7, s[32:35], s60 offen offset:1024 lds
    v_mfma_f32_16x16x32_bf16 a[208:211], a[132:135], a[16:19], a[208:211]
    v_mfma_f32_16x16x32_bf16 a[212:215], a[132:135], a[20:23], a[212:215]
    v_mfma_f32_16x16x32_bf16 a[216:219], a[132:135], a[24:27], a[216:219]
    s_nop 0
    v_mfma_f32_16x16x32_bf16 a[220:223], a[132:135], a[28:31], a[220:223]
    buffer_load_dword a255, v46, s[52:55], 0 offen
    v_mfma_f32_16x16x32_bf16 a[224:227], a[132:135], a[32:35], a[224:227]
    s_waitcnt lgkmcnt(0)
    v_mfma_f32_16x16x32_bf16 v[48:51], a[136:139], a[36:39], v[48:51]
    s_waitcnt vmcnt(15)
    s_barrier
    v_mfma_f32_16x16x32_bf16 v[52:55], a[136:139], a[40:43], v[52:55]
    s_load_dword s97, s[94:95], 0x0
    v_mfma_f32_16x16x32_bf16 v[56:59], a[136:139], a[44:47], v[56:59]
    ds_read_b64_tr_b16 a[108:109], v11 offset:20480
    v_mfma_f32_16x16x32_bf16 v[60:63], a[136:139], a[48:51], v[60:63]
    buffer_load_dwordx4 v8, s[32:35], s60 offen offset:3072 lds
    v_mfma_f32_16x16x32_bf16 v[64:67], a[136:139], a[52:55], v[64:67]
    s_mul_i32 s85, s68, 20736
    ds_read_b64_tr_b16 a[110:111], v11 offset:20992
    s_add_u32 s85, s85, 2048
    v_mfma_f32_16x16x32_bf16 v[68:71], a[136:139], a[56:59], v[68:71]
    v_min_u32_e64 v22, 53, v0
    v_mul_u32_u24_e64 v21, 43, v22
    v_mfma_f32_16x16x32_bf16 v[72:75], a[136:139], a[60:63], v[72:75]
    ds_read_b128 a[0:3], v14 offset:20480
    v_lshrrev_b32_e64 v21, 7, v21
    v_mfma_f32_16x16x32_bf16 v[76:79], a[136:139], a[64:67], v[76:79]
    v_mul_u32_u24 v21, 768, v21
    v_lshl_add_u32 v21, v22, 7, v21
    v_mfma_f32_16x16x32_bf16 v[108:111], a[140:143], a[64:67], v[108:111]
    ds_read_b128 a[4:7], v14 offset:22528
    v_add_u32_e64 v21, s85, v21
    v_mfma_f32_16x16x32_bf16 v[104:107], a[140:143], a[60:63], v[104:107]
    v_mfma_f32_16x16x32_bf16 v[100:103], a[140:143], a[56:59], v[100:103]
    ds_read_b128 a[8:11], v14 offset:24576
    v_mfma_f32_16x16x32_bf16 v[96:99], a[140:143], a[52:55], v[96:99]
    v_mfma_f32_16x16x32_bf16 v[92:95], a[140:143], a[48:51], v[92:95]
    buffer_load_dwordx4 v6, s[32:35], s60 offen offset:0 lds
    v_mfma_f32_16x16x32_bf16 v[88:91], a[140:143], a[44:47], v[88:91]
    ds_read_b128 a[12:15], v14 offset:26624
    v_mfma_f32_16x16x32_bf16 v[84:87], a[140:143], a[40:43], v[84:87]
    ds_read_b128 a[16:19], v14 offset:28672
    v_mfma_f32_16x16x32_bf16 v[80:83], a[140:143], a[36:39], v[80:83]
    v_mfma_f32_16x16x32_bf16 v[112:115], a[144:147], a[36:39], v[112:115]
    ds_read_b128 a[20:23], v14 offset:30720
    v_mfma_f32_16x16x32_bf16 v[116:119], a[144:147], a[40:43], v[116:119]
    v_mfma_f32_16x16x32_bf16 v[120:123], a[144:147], a[44:47], v[120:123]
    ds_read_b128 a[24:27], v14 offset:32768
    v_mfma_f32_16x16x32_bf16 v[124:127], a[144:147], a[48:51], v[124:127]
    v_mfma_f32_16x16x32_bf16 v[128:131], a[144:147], a[52:55], v[128:131]
    ds_read_b128 a[28:31], v14 offset:34816
    v_mfma_f32_16x16x32_bf16 v[132:135], a[144:147], a[56:59], v[132:135]
    buffer_load_dwordx4 v27, s[32:35], s60 offen offset:2048 lds
    v_mfma_f32_16x16x32_bf16 v[136:139], a[144:147], a[60:63], v[136:139]
    ds_read_b128 a[32:35], v14 offset:36864
    v_mfma_f32_16x16x32_bf16 v[140:143], a[144:147], a[64:67], v[140:143]
    v_mfma_f32_16x16x32_bf16 v[144:147], a[144:147], a[68:71], v[144:147]
    ds_read_b64_tr_b16 a[112:113], v29 offset:20480
    v_mfma_f32_16x16x32_bf16 v[180:183], a[148:151], a[68:71], v[180:183]
    v_mfma_f32_16x16x32_bf16 v[176:179], a[148:151], a[64:67], v[176:179]
    ds_read_b64_tr_b16 a[114:115], v29 offset:20992
    v_mfma_f32_16x16x32_bf16 v[172:175], a[148:151], a[60:63], v[172:175]
    v_mfma_f32_16x16x32_bf16 v[168:171], a[148:151], a[56:59], v[168:171]
    ds_read_b64_tr_b16 a[116:117], v11 offset:22528
    v_mfma_f32_16x16x32_bf16 v[164:167], a[148:151], a[52:55], v[164:167]
    s_add_u32 m0, s66, 32768
    s_add_u32 s59, s60, 2304
    v_mfma_f32_16x16x32_bf16 v[160:163], a[148:151], a[48:51], v[160:163]
    ds_read_b64_tr_b16 a[118:119], v11 offset:23040
    v_mfma_f32_16x16x32_bf16 v[156:159], a[148:151], a[44:47], v[156:159]
    buffer_load_dwordx4 v9, s[32:35], s60 offen offset:2048 lds
    v_mfma_f32_16x16x32_bf16 v[152:155], a[148:151], a[40:43], v[152:155]
    ds_read_b64_tr_b16 a[120:121], v29 offset:22528
    v_mfma_f32_16x16x32_bf16 v[148:151], a[148:151], a[36:39], v[148:151]
    v_mfma_f32_16x16x32_bf16 v[184:187], a[152:155], a[36:39], v[184:187]
    ds_read_b64_tr_b16 a[122:123], v29 offset:23040
    v_mfma_f32_16x16x32_bf16 v[188:191], a[152:155], a[40:43], v[188:191]
    v_mfma_f32_16x16x32_bf16 v[192:195], a[152:155], a[44:47], v[192:195]
    ds_read_b64_tr_b16 a[124:125], v11 offset:24576
    v_mfma_f32_16x16x32_bf16 v[196:199], a[152:155], a[48:51], v[196:199]
    v_mfma_f32_16x16x32_bf16 v[200:203], a[152:155], a[52:55], v[200:203]
    ds_read_b64_tr_b16 a[126:127], v11 offset:25088
    v_mfma_f32_16x16x32_bf16 v[204:207], a[152:155], a[56:59], v[204:207]
    v_mfma_f32_16x16x32_bf16 v[208:211], a[152:155], a[60:63], v[208:211]
    buffer_load_dwordx4 v6, s[32:35], s59 offen lds
    v_mfma_f32_16x16x32_bf16 v[212:215], a[152:155], a[64:67], v[212:215]
    ds_read_b64_tr_b16 a[128:129], v29 offset:24576
    v_mfma_f32_16x16x32_bf16 v[216:219], a[152:155], a[68:71], v[216:219]
    ds_read_b64_tr_b16 a[130:131], v29 offset:25088
    v_mfma_f32_16x16x32_bf16 v[252:255], a[156:159], a[68:71], v[252:255]
    v_mfma_f32_16x16x32_bf16 v[248:251], a[156:159], a[64:67], v[248:251]
    ds_read_b64_tr_b16 a[132:133], v12
    v_mfma_f32_16x16x32_bf16 v[244:247], a[156:159], a[60:63], v[244:247]
    v_mfma_f32_16x16x32_bf16 v[240:243], a[156:159], a[56:59], v[240:243]
    ds_read_b64_tr_b16 a[134:135], v12 offset:512
    v_mfma_f32_16x16x32_bf16 v[236:239], a[156:159], a[52:55], v[236:239]
    v_mfma_f32_16x16x32_bf16 v[232:235], a[156:159], a[48:51], v[232:235]
    v_add_u32_e64 v12, s83, v12
    v_mfma_f32_16x16x32_bf16 v[228:231], a[156:159], a[44:47], v[228:231]
    buffer_load_dwordx4 v7, s[32:35], s59 offen offset:1024 lds
    v_mfma_f32_16x16x32_bf16 v[224:227], a[156:159], a[40:43], v[224:227]
    v_mfma_f32_16x16x32_bf16 v[220:223], a[156:159], a[36:39], v[220:223]
    v_mfma_f32_16x16x32_bf16 a[192:195], a[160:163], a[36:39], a[192:195]
    v_mfma_f32_16x16x32_bf16 a[196:199], a[160:163], a[40:43], a[196:199]
    v_mfma_f32_16x16x32_bf16 a[200:203], a[160:163], a[44:47], a[200:203]
    v_mfma_f32_16x16x32_bf16 a[204:207], a[160:163], a[48:51], a[204:207]
    v_mfma_f32_16x16x32_bf16 a[208:211], a[160:163], a[52:55], a[208:211]
    v_mfma_f32_16x16x32_bf16 a[212:215], a[160:163], a[56:59], a[212:215]
    v_mfma_f32_16x16x32_bf16 a[216:219], a[160:163], a[60:63], a[216:219]
    v_mfma_f32_16x16x32_bf16 a[220:223], a[160:163], a[64:67], a[220:223]
    v_mfma_f32_16x16x32_bf16 a[224:227], a[160:163], a[68:71], a[224:227]
    s_waitcnt lgkmcnt(0)
    s_waitcnt lgkmcnt(0)
    s_andn2_b32 s89, 15, s97
    s_cbranch_scc1 L_att_spin0
L_att_spin0r:
    v_mfma_f32_16x16x32_bf16 v[48:51], a[164:167], a[72:75], v[48:51]
    s_waitcnt vmcnt(8)
    s_barrier
    v_mfma_f32_16x16x32_bf16 v[52:55], a[164:167], a[76:79], v[52:55]
    v_mfma_f32_16x16x32_bf16 v[56:59], a[164:167], a[80:83], v[56:59]
    ds_read_b64_tr_b16 a[136:137], v10 offset:0
    v_mfma_f32_16x16x32_bf16 v[60:63], a[164:167], a[84:87], v[60:63]
    v_mfma_f32_16x16x32_bf16 v[64:67], a[164:167], a[88:91], v[64:67]
    s_lshr_b32 s85, s56, 1
    ds_read_b64_tr_b16 a[138:139], v10 offset:512
    s_mul_i32 s85, s85, 8192
    v_mfma_f32_16x16x32_bf16 v[68:71], a[164:167], a[92:95], v[68:71]
    s_lshl_b32 s3, s56, 12
    s_add_u32 s3, s3, s85
    s_add_u32 s3, s3, s80
    v_mfma_f32_16x16x32_bf16 v[72:75], a[164:167], a[96:99], v[72:75]
    s_bfe_u32 s85, s97, 0x10004
    ds_read_b128 a[36:39], v13 offset:0
    s_lshl_b32 s85, s85, 13
    v_mfma_f32_16x16x32_bf16 v[76:79], a[164:167], a[100:103], v[76:79]
    s_add_u32 s79, s85, s80
    s_add_u32 s79, s79, 1572864
    s_add_u32 s85, s85, s3
    v_mfma_f32_16x16x32_bf16 v[108:111], a[168:171], a[100:103], v[108:111]
    s_add_u32 s0, s85, 0
    ds_read_b128 a[40:43], v13 offset:2048
    s_bfe_u32 s85, s97, 0x10005
    v_mfma_f32_16x16x32_bf16 v[104:107], a[168:171], a[96:99], v[104:107]
    s_lshl_b32 s85, s85, 13
    s_add_u32 s85, s85, s3
    s_add_u32 s1, s85, 2097152
    v_mfma_f32_16x16x32_bf16 v[100:103], a[168:171], a[92:95], v[100:103]
    s_bfe_u32 s85, s97, 0x10006
    ds_read_b128 a[44:47], v13 offset:4096
    s_lshl_b32 s85, s85, 13
    v_mfma_f32_16x16x32_bf16 v[96:99], a[168:171], a[88:91], v[96:99]
    s_add_u32 s85, s85, s3
    s_add_u32 s61, s85, 4194304
    s_bfe_u32 s85, s97, 0x10007
    v_mfma_f32_16x16x32_bf16 v[92:95], a[168:171], a[84:87], v[92:95]
    s_lshl_b32 s85, s85, 13
    ds_read_b128 a[48:51], v13 offset:6144
    s_add_u32 s4, s85, s80
    v_mfma_f32_16x16x32_bf16 v[88:91], a[168:171], a[80:83], v[88:91]
    s_add_u32 s4, s4, 6291456
    s_add_u32 s85, s85, s3
    s_add_u32 s5, s85, 6815744
    s_nop 0
    v_mfma_f32_16x16x32_bf16 v[84:87], a[168:171], a[76:79], v[84:87]
    s_add_u32 s92, s26, s79
    s_addc_u32 s93, s27, 0
    ds_read_b128 a[52:55], v13 offset:8192
    v_mfma_f32_16x16x32_bf16 v[80:83], a[168:171], a[72:75], v[80:83]
    v_and_b32 v40, 15, v0
    v_lshrrev_b32 v41, 4, v0
    v_mfma_f32_16x16x32_bf16 v[112:115], a[172:175], a[72:75], v[112:115]
    ds_read_b128 a[56:59], v13 offset:10240
    v_mul_u32_u24 v30, 576, v41
    v_mfma_f32_16x16x32_bf16 v[116:119], a[172:175], a[76:79], v[116:119]
    v_lshl_add_u32 v30, v40, 3, v30
    s_sub_u32 s17, s56, s67
    v_mfma_f32_16x16x32_bf16 v[120:123], a[172:175], a[80:83], v[120:123]
    s_and_b32 s17, s17, 3
    ds_read_b128 a[60:63], v13 offset:12288
    s_mul_i32 s85, s17, 2304
    v_mfma_f32_16x16x32_bf16 v[124:127], a[172:175], a[84:87], v[124:127]
    v_add_u32_e64 v30, s85, v30
    v_add_u32 v31, 64512, v30
    v_mfma_f32_16x16x32_bf16 v[128:131], a[172:175], a[88:91], v[128:131]
    ds_read_b128 a[64:67], v13 offset:14336
    v_lshrrev_b32_e64 v42, 3, v40
    v_mfma_f32_16x16x32_bf16 v[132:135], a[172:175], a[92:95], v[132:135]
    v_mul_u32_u24 v42, 64448, v42
    v_add_u32_e64 v32, v30, v42
    v_mfma_f32_16x16x32_bf16 v[136:139], a[172:175], a[96:99], v[136:139]
    s_mul_i32 s85, s56, 9
    ds_read_b128 a[68:71], v13 offset:16384
    s_add_u32 s85, s85, 8
    v_mfma_f32_16x16x32_bf16 v[140:143], a[172:175], a[100:103], v[140:143]
    s_min_u32 s85, s85, 27
    s_sub_u32 s85, s85, s17
    s_mul_i32 s85, s85, 2304
    v_mfma_f32_16x16x32_bf16 v[144:147], a[172:175], a[104:107], v[144:147]
    ds_read_b64_tr_b16 a[140:141], v25 offset:0
    v_add_u32_e64 v33, s85, v30
    v_mfma_f32_16x16x32_bf16 v[180:183], a[176:179], a[104:107], v[180:183]
    v_add_u32_e64 v34, s85, v31
    v_add_u32_e64 v35, s85, v32
    v_mfma_f32_16x16x32_bf16 v[176:179], a[176:179], a[100:103], v[176:179]
    s_mul_i32 s85, s56, 5184
    ds_read_b64_tr_b16 a[142:143], v25 offset:512
    v_lshl_add_u32 v36, v0, 3, s85
    v_mfma_f32_16x16x32_bf16 v[172:175], a[176:179], a[96:99], v[172:175]
    v_add_u32 v37, 64512, v36
    v_and_b32_e64 v42, 3, v0
    v_mfma_f32_16x16x32_bf16 v[168:171], a[176:179], a[92:95], v[168:171]
    ds_read_b64_tr_b16 a[144:145], v10 offset:2048
    v_lshl_add_u32 v42, v41, 2, v42
    v_mfma_f32_16x16x32_bf16 v[164:167], a[176:179], a[88:91], v[164:167]
    v_bfe_u32 v43, v0, 2, 2
    v_lshl_add_u32 v42, v42, 2, v43
    v_mfma_f32_16x16x32_bf16 v[160:163], a[176:179], a[84:87], v[160:163]
    ds_read_b64_tr_b16 a[146:147], v10 offset:2560
    v_lshl_add_u32 v38, v42, 3, s85
    v_mfma_f32_16x16x32_bf16 v[156:159], a[176:179], a[80:83], v[156:159]
    v_add_u32 v39, 64512, v38
    s_add_u32 s85, s56, 1
    v_mfma_f32_16x16x32_bf16 v[152:155], a[176:179], a[76:79], v[152:155]
    s_and_b32 s85, s85, 4
    ds_read_b64_tr_b16 a[148:149], v25 offset:2048
    s_lshl_b32 s85, s85, 7
    v_mfma_f32_16x16x32_bf16 v[148:151], a[176:179], a[72:75], v[148:151]
    s_sub_u32 s85, 162816, s85
    v_lshl_add_u32 v46, v40, 3, s85
    s_lshl_b32 s85, s57, 6
    v_mfma_f32_16x16x32_bf16 v[184:187], a[180:183], a[72:75], v[184:187]
    ds_read_b64_tr_b16 a[150:151], v25 offset:2560
    v_add_u32_e64 v42, s85, v0
    v_mfma_f32_16x16x32_bf16 v[188:191], a[180:183], a[76:79], v[188:191]
    v_mov_b32 v43, 0xf1800000
    v_cmp_gt_u32 s[8:9], 8, v42
    v_mfma_f32_16x16x32_bf16 v[192:195], a[180:183], a[80:83], v[192:195]
    ds_read_b64_tr_b16 a[152:153], v10 offset:4096
    v_cmp_gt_u32 s[10:11], 4, v42
    v_mfma_f32_16x16x32_bf16 v[196:199], a[180:183], a[84:87], v[196:199]
    v_cndmask_b32 v2, 0, v43, s[8:9]
    v_cndmask_b32 v3, 0, v43, s[8:9]
    v_mfma_f32_16x16x32_bf16 v[200:203], a[180:183], a[88:91], v[200:203]
    ds_read_b64_tr_b16 a[154:155], v10 offset:4608
    v_cndmask_b32 v4, 0, v43, s[8:9]
    v_mfma_f32_16x16x32_bf16 v[204:207], a[180:183], a[92:95], v[204:207]
    v_cndmask_b32 v5, 0, v43, s[8:9]
    v_cndmask_b32 v6, 0, v43, s[10:11]
    v_mfma_f32_16x16x32_bf16 v[208:211], a[180:183], a[96:99], v[208:211]
    ds_read_b64_tr_b16 a[156:157], v25 offset:4096
    v_cndmask_b32 v7, 0, v43, s[10:11]
    v_mfma_f32_16x16x32_bf16 v[212:215], a[180:183], a[100:103], v[212:215]
    v_cndmask_b32 v8, 0, v43, s[10:11]
    v_cndmask_b32 v9, 0, v43, s[10:11]
    v_mfma_f32_16x16x32_bf16 v[216:219], a[180:183], a[104:107], v[216:219]
    ds_read_b64_tr_b16 a[158:159], v25 offset:4608
    v_lshrrev_b32_e64 v44, 4, v0
    v_mfma_f32_16x16x32_bf16 v[252:255], a[184:187], a[104:107], v[252:255]
    v_mul_u32_u24 v44, 3072, v44
    v_and_b32_e64 v45, 3, v0
    v_mfma_f32_16x16x32_bf16 v[248:251], a[184:187], a[100:103], v[248:251]
    ds_read_b64_tr_b16 a[160:161], v12
    v_lshl_add_u32 v44, v45, 3, v44
    v_mfma_f32_16x16x32_bf16 v[244:247], a[184:187], a[96:99], v[244:247]
    v_bfe_u32 v45, v0, 2, 2
    v_lshl_add_u32 v44, v45, 7, v44
    v_mfma_f32_16x16x32_bf16 v[240:243], a[184:187], a[92:95], v[240:243]
    ds_read_b64_tr_b16 a[162:163], v12 offset:512
    v_bfe_u32 v45, v0, 3, 2
    v_mfma_f32_16x16x32_bf16 v[236:239], a[184:187], a[88:91], v[236:239]
    s_add_u32 s85, s67, 0
    s_and_b32 s40, s85, 3
    v_xor_b32 v1, s40, v45
    v_mfma_f32_16x16x32_bf16 v[232:235], a[184:187], a[84:87], v[232:235]
    s_lshr_b32 s85, s85, 2
    v_add_u32_e64 v12, s62, v12
    s_lshl_b32 s85, s85, 10
    v_mfma_f32_16x16x32_bf16 v[228:231], a[184:187], a[80:83], v[228:231]
    s_nop 0
    v_lshl_add_u32 v1, v1, 5, v44
    v_add_u32_e64 v1, s85, v1
    v_mfma_f32_16x16x32_bf16 v[224:227], a[184:187], a[76:79], v[224:227]
    s_add_u32 s85, s67, 1
    s_and_b32 s40, s85, 3
    v_xor_b32 v22, s40, v45
    v_mfma_f32_16x16x32_bf16 v[220:223], a[184:187], a[72:75], v[220:223]
    s_lshr_b32 s85, s85, 2
    s_lshl_b32 s85, s85, 10
    v_lshl_add_u32 v22, v22, 5, v44
    v_mfma_f32_16x16x32_bf16 a[192:195], a[188:191], a[72:75], a[192:195]
    v_add_u32_e64 v22, s85, v22
    s_add_u32 s85, s67, 2
    v_mfma_f32_16x16x32_bf16 a[196:199], a[188:191], a[76:79], a[196:199]
    s_and_b32 s40, s85, 3
    v_xor_b32 v23, s40, v45
    s_lshr_b32 s85, s85, 2
    v_mfma_f32_16x16x32_bf16 a[200:203], a[188:191], a[80:83], a[200:203]
    s_lshl_b32 s85, s85, 10
    v_lshl_add_u32 v23, v23, 5, v44
    v_add_u32_e64 v23, s85, v23
    v_mfma_f32_16x16x32_bf16 a[204:207], a[188:191], a[84:87], a[204:207]
    s_add_u32 s85, s67, 3
    s_and_b32 s40, s85, 3
    v_xor_b32_e64 v27, s40, v45
    v_mfma_f32_16x16x32_bf16 a[208:211], a[188:191], a[88:91], a[208:211]
    s_lshr_b32 s85, s85, 2
    s_lshl_b32 s85, s85, 10
    v_lshl_add_u32 v27, v27, 5, v44
    v_mfma_f32_16x16x32_bf16 a[212:215], a[188:191], a[92:95], a[212:215]
    v_add_u32_e64 v27, s85, v27
    v_mfma_f32_16x16x32_bf16 a[216:219], a[188:191], a[96:99], a[216:219]
    v_mfma_f32_16x16x32_bf16 a[220:223], a[188:191], a[100:103], a[220:223]
    s_nop 0
    v_mfma_f32_16x16x32_bf16 a[224:227], a[188:191], a[104:107], a[224:227]
    s_waitcnt lgkmcnt(0)
    v_mfma_f32_16x16x32_bf16 v[48:51], a[108:111], a[0:3], v[48:51]
    s_waitcnt vmcnt(0)
    s_barrier
    v_mfma_f32_16x16x32_bf16 v[48:51], a[136:139], a[36:39], v[48:51]
    s_min_u32 s17, s56, 1
    ds_read_b64_tr_b16 a[164:165], v10 offset:28672
    s_lshl_b32 s17, s17, 31
    v_mfma_f32_16x16x32_bf16 v[52:55], a[136:139], a[40:43], v[52:55]
    buffer_load_dword a255, v21, s[36:39], s64 offen
    v_mfma_f32_16x16x32_bf16 v[52:55], a[108:111], a[4:7], v[52:55]
    s_lshl_b32 s16, s67, 9
    ds_read_b64_tr_b16 a[166:167], v10 offset:29184
    s_add_u32 s16, s16, s79
    v_mfma_f32_16x16x32_bf16 v[56:59], a[108:111], a[8:11], v[56:59]
    s_add_u32 s16, s16, 65536
    ds_read_b128 a[72:75], v14 offset:0
    s_mov_b32 s8, 0x11111111
    v_mfma_f32_16x16x32_bf16 v[56:59], a[136:139], a[44:47], v[56:59]
    s_mov_b32 s9, s8
    ds_read_b128 a[76:79], v14 offset:2048
    s_mov_b32 s10, 0x33333333
    v_mfma_f32_16x16x32_bf16 v[60:63], a[136:139], a[48:51], v[60:63]
    s_mov_b32 s11, s10
    ds_read_b128 a[80:83], v14 offset:4096
    s_mov_b32 s12, 0x77777777
    v_mfma_f32_16x16x32_bf16 v[60:63], a[108:111], a[12:15], v[60:63]
    s_mov_b32 s13, s12
    ds_read_b128 a[84:87], v14 offset:6144
    v_mov_b32 v40, 0xffff0000
    v_mfma_f32_16x16x32_bf16 v[64:67], a[108:111], a[16:19], v[64:67]
    s_nop 0
    ds_read_b128 a[88:91], v14 offset:8192
    v_mov_b32 v41, 0xffff
    v_mfma_f32_16x16x32_bf16 v[64:67], a[136:139], a[52:55], v[64:67]
    ds_read_b128 a[92:95], v14 offset:10240
    v_cndmask_b32 v43, 0, v40, s[8:9]
    v_mfma_f32_16x16x32_bf16 v[68:71], a[136:139], a[56:59], v[68:71]
    ds_read_b128 a[96:99], v14 offset:12288
    v_cndmask_b32 v26, 0, v41, s[10:11]
    v_mfma_f32_16x16x32_bf16 v[68:71], a[108:111], a[20:23], v[68:71]
    ds_read_b128 a[100:103], v14 offset:14336
    v_cndmask_b32 v40, 0, v40, s[12:13]
    v_mfma_f32_16x16x32_bf16 v[72:75], a[108:111], a[24:27], v[72:75]
    ds_read_b128 a[104:107], v14 offset:16384
    v_or_b32_e64 v26, v26, v40
    v_mfma_f32_16x16x32_bf16 v[72:75], a[136:139], a[60:63], v[72:75]
    s_mov_b32 s14, 0x3eae1a93
    ds_read_b64_tr_b16 a[168:169], v25 offset:28672
    ds_read_b64_tr_b16 a[170:171], v25 offset:29184
    v_mfma_f32_16x16x32_bf16 v[76:79], a[136:139], a[64:67], v[76:79]
    s_mov_b32 s15, s14
    s_nop 0
    ds_read_b64_tr_b16 a[172:173], v10 offset:30720
    ds_read_b64_tr_b16 a[174:175], v10 offset:31232
    v_mfma_f32_16x16x32_bf16 v[76:79], a[108:111], a[28:31], v[76:79]
    s_mov_b32 s89, 0x12345
    ds_read_b64_tr_b16 a[176:177], v25 offset:30720
    ds_read_b64_tr_b16 a[178:179], v25 offset:31232
    v_mfma_f32_16x16x32_bf16 v[80:83], a[112:115], a[0:3], v[80:83]
    s_mov_b32 s89, 0x12345
    ds_read_b64_tr_b16 a[180:181], v10 offset:32768
    ds_read_b64_tr_b16 a[182:183], v10 offset:33280
    v_mfma_f32_16x16x32_bf16 v[80:83], a[140:143], a[36:39], v[80:83]
    s_mov_b32 s89, 0x12345
    ds_read_b64_tr_b16 a[184:185], v25 offset:32768
    ds_read_b64_tr_b16 a[186:187], v25 offset:33280
    v_mfma_f32_16x16x32_bf16 v[84:87], a[140:143], a[40:43], v[84:87]
    s_mov_b32 s89, 0x12345
    ds_read_b64_tr_b16 a[188:189], v12
    ds_read_b64_tr_b16 a[190:191], v12 offset:512
    v_mfma_f32_16x16x32_bf16 v[84:87], a[112:115], a[4:7], v[84:87]
    v_lshrrev_b32 v40, 3, v0
    v_and_b32 v41, 7, v0
    v_mfma_f32_16x16x32_bf16 v[88:91], a[112:115], a[8:11], v[88:91]
    v_lshlrev_b32_e64 v41, 4, v41
    v_lshrrev_b32_e64 v42, 5, v0
    v_mfma_f32_16x16x32_bf16 v[88:91], a[140:143], a[44:47], v[88:91]
    s_nop 0
    v_lshl_add_u32 v42, v42, 13, v41
    s_lshl_b32 s59, s67, 2
    v_mfma_f32_16x16x32_bf16 v[92:95], a[140:143], a[48:51], v[92:95]
    s_add_u32 s59, s59, s56
    s_lshl_b32 s63, s59, 7
    s_add_u32 s63, s63, s4
    v_mfma_f32_16x16x32_bf16 v[92:95], a[112:115], a[12:15], v[92:95]
    s_add_u32 s63, s63, 262144
    s_lshl_b32 s62, s59, 14
    s_add_u32 s62, s62, s4
    s_waitcnt lgkmcnt(2)
    v_mfma_f32_16x16x32_bf16 v[48:51], a[164:167], a[72:75], v[48:51]
    s_waitcnt lgkmcnt(0)
    s_barrier
    v_lshl_add_u32 v10, v40, 10, v41
    v_mfma_f32_16x16x32_bf16 v[52:55], a[164:167], a[76:79], v[52:55]
    v_lshl_add_u32 v11, v40, 11, v42
    v_and_or_b32 v29, v0, 8, v41
    v_mfma_f32_16x16x32_bf16 v[56:59], a[164:167], a[80:83], v[56:59]
    v_lshrrev_b32_e64 v40, 4, v0
    v_lshl_add_u32 v29, v40, 8, v29
    v_mfma_f32_16x16x32_bf16 v[60:63], a[164:167], a[84:87], v[60:63]
    v_lshlrev_b32_e64 v25, 4, v0
    v_and_b32 v24, 0x3ff, v24
    v_mfma_f32_16x16x32_bf16 v[64:67], a[164:167], a[88:91], v[64:67]
    v_lshlrev_b32_e64 v13, 3, v0
    v_add_u32 v12, 162304, v13
    v_mfma_f32_16x16x32_bf16 v[68:71], a[164:167], a[92:95], v[68:71]
    v_add_u32_e64 v13, s17, v13
    v_mov_b32_e64 v14, v43
    v_mfma_f32_16x16x32_bf16 v[72:75], a[164:167], a[96:99], v[72:75]
    v_cvt_pk_bf16_f32 v40, v48, v49
    v_cvt_pk_bf16_f32 v41, v50, v51
    v_mfma_f32_16x16x32_bf16 v[76:79], a[164:167], a[100:103], v[76:79]
    ds_write_b64 v30, v[40:41] offset:64
    v_mfma_f32_16x16x32_bf16 v[80:83], a[168:171], a[72:75], v[80:83]
    v_cvt_pk_bf16_f32 v42, v52, v53
    v_cvt_pk_bf16_f32 v43, v54, v55
    v_mfma_f32_16x16x32_bf16 v[84:87], a[168:171], a[76:79], v[84:87]
    ds_write_b64 v30, v[42:43] offset:192
    v_mfma_f32_16x16x32_bf16 v[88:91], a[168:171], a[80:83], v[88:91]
    v_cvt_pk_bf16_f32 v44, v56, v57
    v_cvt_pk_bf16_f32 v45, v58, v59
    v_mfma_f32_16x16x32_bf16 v[92:95], a[168:171], a[84:87], v[92:95]
    ds_write_b64 v30, v[44:45] offset:320
    v_mfma_f32_16x16x32_bf16 v[96:99], a[112:115], a[16:19], v[96:99]
    v_cvt_pk_bf16_f32 v40, v60, v61
    v_cvt_pk_bf16_f32 v41, v62, v63
    v_mfma_f32_16x16x32_bf16 v[96:99], a[140:143], a[52:55], v[96:99]
    ds_write_b64 v30, v[40:41] offset:448
    v_mfma_f32_16x16x32_bf16 v[96:99], a[168:171], a[88:91], v[96:99]
    v_cvt_pk_bf16_f32 v42, v64, v65
    v_cvt_pk_bf16_f32 v43, v66, v67
    v_mfma_f32_16x16x32_bf16 v[100:103], a[168:171], a[92:95], v[100:103]
    ds_write_b64 v31, v[42:43] offset:64
    v_mfma_f32_16x16x32_bf16 v[100:103], a[140:143], a[56:59], v[100:103]
    s_lshl_b32 s6, s56, 11
    v_cvt_pk_bf16_f32 v44, v68, v69
    v_cvt_pk_bf16_f32 v45, v70, v71
    v_mfma_f32_16x16x32_bf16 v[100:103], a[112:115], a[20:23], v[100:103]
    s_add_u32 s6, s6, s4
    ds_write_b64 v31, v[44:45] offset:192
    v_mfma_f32_16x16x32_bf16 v[104:107], a[112:115], a[24:27], v[104:107]
    s_sub_u32 s7, s5, 262144
    v_cvt_pk_bf16_f32 v40, v72, v73
    v_cvt_pk_bf16_f32 v41, v74, v75
    v_mfma_f32_16x16x32_bf16 v[104:107], a[140:143], a[60:63], v[104:107]
    s_and_b32 s85, s67, 1
    ds_write_b64 v31, v[40:41] offset:320
    v_mfma_f32_16x16x32_bf16 v[104:107], a[168:171], a[96:99], v[104:107]
    s_lshl_b32 s40, s85, 13
    v_cvt_pk_bf16_f32 v42, v76, v77
    v_cvt_pk_bf16_f32 v43, v78, v79
    v_mfma_f32_16x16x32_bf16 v[108:111], a[168:171], a[100:103], v[108:111]
    s_sub_u32 s41, 12288, s40
    ds_write_b64 v31, v[42:43] offset:448
    v_mfma_f32_16x16x32_bf16 v[108:111], a[140:143], a[64:67], v[108:111]
    s_add_u32 s40, s40, 4096
    v_cvt_pk_bf16_f32 v44, v80, v81
    v_cvt_pk_bf16_f32 v45, v82, v83
    v_mfma_f32_16x16x32_bf16 v[108:111], a[112:115], a[28:31], v[108:111]
    s_mul_i32 s42, s67, 73728
    ds_write_b64 v30, v[44:45] offset:9280
    v_mfma_f32_16x16x32_bf16 v[112:115], a[116:119], a[0:3], v[112:115]
    s_lshl_b32 s85, s85, 12
    v_cvt_pk_bf16_f32 v40, v84, v85
    v_cvt_pk_bf16_f32 v41, v86, v87
    v_mfma_f32_16x16x32_bf16 v[112:115], a[144:147], a[36:39], v[112:115]
    s_sub_u32 s42, s42, s85
    ds_write_b64 v30, v[40:41] offset:9408
    v_mfma_f32_16x16x32_bf16 v[112:115], a[172:175], a[72:75], v[112:115]
    s_lshl_b32 s85, s56, 10
    v_cvt_pk_bf16_f32 v42, v88, v89
    v_cvt_pk_bf16_f32 v43, v90, v91
    v_mfma_f32_16x16x32_bf16 v[116:119], a[172:175], a[76:79], v[116:119]
    s_add_u32 s42, s42, s85
    ds_write_b64 v30, v[42:43] offset:9536
    v_mfma_f32_16x16x32_bf16 v[116:119], a[144:147], a[40:43], v[116:119]
    s_add_u32 s42, s42, s4
    v_cvt_pk_bf16_f32 v44, v92, v93
    s_nop 0
    v_cvt_pk_bf16_f32 v45, v94, v95
    v_mfma_f32_16x16x32_bf16 v[116:119], a[116:119], a[4:7], v[116:119]
    s_add_u32 s42, s42, 524288
    ds_write_b64 v30, v[44:45] offset:9664
    v_mfma_f32_16x16x32_bf16 v[120:123], a[116:119], a[8:11], v[120:123]
    s_xor_b32 s85, s67, 0
    v_cvt_pk_bf16_f32 v40, v96, v97
    v_cvt_pk_bf16_f32 v41, v98, v99
    s_nop 0
    v_mfma_f32_16x16x32_bf16 v[120:123], a[144:147], a[44:47], v[120:123]
    s_lshl_b32 s85, s85, 16
    ds_write_b64 v31, v[40:41] offset:9280
    v_mfma_f32_16x16x32_bf16 v[120:123], a[172:175], a[80:83], v[120:123]
    s_add_u32 s74, s85, s6
    v_cvt_pk_bf16_f32 v42, v100, v101
    v_cvt_pk_bf16_f32 v43, v102, v103
    v_mfma_f32_16x16x32_bf16 v[124:127], a[172:175], a[84:87], v[124:127]
    s_xor_b32 s85, s67, 1
    ds_write_b64 v31, v[42:43] offset:9408
    v_mfma_f32_16x16x32_bf16 v[124:127], a[144:147], a[48:51], v[124:127]
    s_lshl_b32 s85, s85, 16
    v_cvt_pk_bf16_f32 v44, v104, v105
    v_cvt_pk_bf16_f32 v45, v106, v107
L_att_pad4:
    s_cbranch_execz L_att_ret0
    v_mfma_f32_16x16x32_bf16 v[124:127], a[116:119], a[12:15], v[124:127]
    s_add_u32 s75, s85, s6
    ds_write_b64 v31, v[44:45] offset:9536
    v_mfma_f32_16x16x32_bf16 v[128:131], a[116:119], a[16:19], v[128:131]
    s_xor_b32 s85, s67, 2
    v_cvt_pk_bf16_f32 v40, v108, v109
    v_cvt_pk_bf16_f32 v41, v110, v111
    v_mfma_f32_16x16x32_bf16 v[128:131], a[144:147], a[52:55], v[128:131]
    s_lshl_b32 s85, s85, 16
    ds_write_b64 v31, v[40:41] offset:9664
    v_mfma_f32_16x16x32_bf16 v[128:131], a[172:175], a[88:91], v[128:131]
    s_add_u32 s76, s85, s6
    v_cvt_pk_bf16_f32 v42, v112, v113
    v_cvt_pk_bf16_f32 v43, v114, v115
    v_mfma_f32_16x16x32_bf16 v[132:135], a[172:175], a[92:95], v[132:135]
    s_xor_b32 s85, s67, 3
    ds_write_b64 v30, v[42:43] offset:20800
    v_mfma_f32_16x16x32_bf16 v[132:135], a[144:147], a[56:59], v[132:135]
    s_lshl_b32 s85, s85, 16
    v_cvt_pk_bf16_f32 v44, v116, v117
    v_cvt_pk_bf16_f32 v45, v118, v119
    v_mfma_f32_16x16x32_bf16 v[132:135], a[116:119], a[20:23], v[132:135]
    s_add_u32 s77, s85, s6
    ds_write_b64 v30, v[44:45] offset:20928
    v_mfma_f32_16x16x32_bf16 a[192:195], a[132:135], a[0:3], a[192:195]
    v_cvt_pk_bf16_f32 v40, v120, v121
    v_cvt_pk_bf16_f32 v41, v122, v123
    v_mfma_f32_16x16x32_bf16 a[192:195], a[160:163], a[36:39], a[192:195]
    ds_write_b64 v30, v[40:41] offset:21056
    v_mfma_f32_16x16x32_bf16 a[192:195], a[188:191], a[72:75], a[192:195]
    v_cvt_pk_bf16_f32 v42, v124, v125
    v_cvt_pk_bf16_f32 v43, v126, v127
    v_mfma_f32_16x16x32_bf16 v[136:139], a[172:175], a[96:99], v[136:139]
    ds_write_b64 v30, v[42:43] offset:21184
    v_mfma_f32_16x16x32_bf16 v[136:139], a[144:147], a[60:63], v[136:139]
    v_cvt_pk_bf16_f32 v44, v128, v129
    v_cvt_pk_bf16_f32 v45, v130, v131
    v_mfma_f32_16x16x32_bf16 v[136:139], a[116:119], a[24:27], v[136:139]
    ds_write_b64 v31, v[44:45] offset:20800
    v_mfma_f32_16x16x32_bf16 v[140:143], a[116:119], a[28:31], v[140:143]
    v_cvt_pk_bf16_f32 v40, v132, v133
    v_cvt_pk_bf16_f32 v41, v134, v135
    v_mfma_f32_16x16x32_bf16 v[140:143], a[144:147], a[64:67], v[140:143]
    ds_write_b64 v31, v[40:41] offset:20928
    v_mfma_f32_16x16x32_bf16 v[140:143], a[172:175], a[100:103], v[140:143]
    v_accvgpr_read_b32 v48, a192
    v_accvgpr_read_b32 v49, a193
    v_mfma_f32_16x16x32_bf16 v[144:147], a[172:175], a[104:107], v[144:147]
    v_accvgpr_read_b32 v50, a194
    v_accvgpr_read_b32 v51, a195
    v_mfma_f32_16x16x32_bf16 v[144:147], a[144:147], a[68:71], v[144:147]
    v_cvt_pk_bf16_f32 v42, v48, v49
    v_cvt_pk_bf16_f32 v43, v50, v51
    v_mfma_f32_16x16x32_bf16 v[144:147], a[116:119], a[32:35], v[144:147]
    ds_write_b64 v33, v[42:43] offset:64
    v_mfma_f32_16x16x32_bf16 a[196:199], a[132:135], a[4:7], a[196:199]
    v_cvt_pk_bf16_f32 v44, v136, v137
    v_cvt_pk_bf16_f32 v45, v138, v139
    v_mfma_f32_16x16x32_bf16 a[196:199], a[160:163], a[40:43], a[196:199]
    ds_write_b64 v31, v[44:45] offset:21056
    v_mfma_f32_16x16x32_bf16 a[196:199], a[188:191], a[76:79], a[196:199]
    v_cvt_pk_bf16_f32 v40, v140, v141
    v_cvt_pk_bf16_f32 v41, v142, v143
    v_mfma_f32_16x16x32_bf16 v[148:151], a[176:179], a[72:75], v[148:151]
    ds_write_b64 v31, v[40:41] offset:21184
    v_mfma_f32_16x16x32_bf16 v[148:151], a[148:151], a[36:39], v[148:151]
    v_cvt_pk_bf16_f32 v42, v144, v145
    v_cvt_pk_bf16_f32 v43, v146, v147
    v_mfma_f32_16x16x32_bf16 v[148:151], a[120:123], a[0:3], v[148:151]
    ds_write_b64 v32, v[42:43] offset:20736
    v_mfma_f32_16x16x32_bf16 v[152:155], a[120:123], a[4:7], v[152:155]
    v_accvgpr_read_b32 v52, a196
    v_accvgpr_read_b32 v53, a197
    v_mfma_f32_16x16x32_bf16 v[152:155], a[148:151], a[40:43], v[152:155]
    v_accvgpr_read_b32 v54, a198
    v_accvgpr_read_b32 v55, a199
    v_mfma_f32_16x16x32_bf16 v[152:155], a[176:179], a[76:79], v[152:155]
    v_cvt_pk_bf16_f32 v44, v52, v53
    v_cvt_pk_bf16_f32 v45, v54, v55
    v_mfma_f32_16x16x32_bf16 v[156:159], a[176:179], a[80:83], v[156:159]
    ds_write_b64 v33, v[44:45] offset:192
    v_mfma_f32_16x16x32_bf16 v[156:159], a[148:151], a[44:47], v[156:159]
    v_cvt_pk_bf16_f32 v40, v148, v149
    v_cvt_pk_bf16_f32 v41, v150, v151
    v_mfma_f32_16x16x32_bf16 v[156:159], a[120:123], a[8:11], v[156:159]
    ds_write_b64 v30, v[40:41] offset:30016
    v_mfma_f32_16x16x32_bf16 a[200:203], a[132:135], a[8:11], a[200:203]
    s_add_u32 m0, s69, 135936
    v_cvt_pk_bf16_f32 v42, v152, v153
    v_cvt_pk_bf16_f32 v43, v154, v155
    v_mfma_f32_16x16x32_bf16 a[200:203], a[160:163], a[44:47], a[200:203]
    ds_write_b64 v30, v[42:43] offset:30144
    v_mfma_f32_16x16x32_bf16 a[200:203], a[188:191], a[80:83], a[200:203]
    v_mfma_f32_16x16x32_bf16 v[160:163], a[176:179], a[84:87], v[160:163]
    v_cvt_pk_bf16_f32 v44, v156, v157
    v_cvt_pk_bf16_f32 v45, v158, v159
    v_mfma_f32_16x16x32_bf16 v[160:163], a[148:151], a[48:51], v[160:163]
    ds_write_b64 v30, v[44:45] offset:30272
    v_mfma_f32_16x16x32_bf16 v[160:163], a[120:123], a[12:15], v[160:163]
    s_nop 0
    v_mfma_f32_16x16x32_bf16 v[164:167], a[120:123], a[16:19], v[164:167]
    s_add_u32 s60, s70, 0
    v_accvgpr_read_b32 v56, a200
    v_accvgpr_read_b32 v57, a201
    v_mfma_f32_16x16x32_bf16 v[164:167], a[148:151], a[52:55], v[164:167]
    v_accvgpr_read_b32 v58, a202
    v_accvgpr_read_b32 v59, a203
    v_mfma_f32_16x16x32_bf16 v[164:167], a[176:179], a[88:91], v[164:167]
    v_cvt_pk_bf16_f32 v40, v56, v57
    v_cvt_pk_bf16_f32 v41, v58, v59
    v_mfma_f32_16x16x32_bf16 v[168:171], a[176:179], a[92:95], v[168:171]
    ds_write_b64 v33, v[40:41] offset:320
    v_mfma_f32_16x16x32_bf16 v[168:171], a[148:151], a[56:59], v[168:171]
    v_cvt_pk_bf16_f32 v42, v160, v161
    v_cvt_pk_bf16_f32 v43, v162, v163
    v_mfma_f32_16x16x32_bf16 v[168:171], a[120:123], a[20:23], v[168:171]
    ds_write_b64 v30, v[42:43] offset:30400
    v_mfma_f32_16x16x32_bf16 a[204:207], a[132:135], a[12:15], a[204:207]
    buffer_load_dwordx4 v15, s[36:39], s60 offen offset:0 lds
    v_mfma_f32_16x16x32_bf16 a[204:207], a[160:163], a[48:51], a[204:207]
    v_cvt_pk_bf16_f32 v44, v164, v165
    v_cvt_pk_bf16_f32 v45, v166, v167
    v_mfma_f32_16x16x32_bf16 a[204:207], a[188:191], a[84:87], a[204:207]
    ds_write_b64 v31, v[44:45] offset:30016
    v_mfma_f32_16x16x32_bf16 v[172:175], a[176:179], a[96:99], v[172:175]
    v_cvt_pk_bf16_f32 v40, v168, v169
    v_cvt_pk_bf16_f32 v41, v170, v171
    v_mfma_f32_16x16x32_bf16 v[172:175], a[148:151], a[60:63], v[172:175]
    ds_write_b64 v31, v[40:41] offset:30144
    v_mfma_f32_16x16x32_bf16 v[172:175], a[120:123], a[24:27], v[172:175]
    v_mfma_f32_16x16x32_bf16 v[176:179], a[120:123], a[28:31], v[176:179]
    buffer_load_dwordx4 v16, s[36:39], s60 offen offset:1024 lds
    v_mfma_f32_16x16x32_bf16 v[176:179], a[148:151], a[64:67], v[176:179]
    v_accvgpr_read_b32 v60, a204
    v_accvgpr_read_b32 v61, a205
    v_mfma_f32_16x16x32_bf16 v[176:179], a[176:179], a[100:103], v[176:179]
    v_accvgpr_read_b32 v62, a206
    v_accvgpr_read_b32 v63, a207
    v_mfma_f32_16x16x32_bf16 v[180:183], a[176:179], a[104:107], v[180:183]
    v_cvt_pk_bf16_f32 v42, v60, v61
    v_cvt_pk_bf16_f32 v43, v62, v63
    v_mfma_f32_16x16x32_bf16 v[180:183], a[148:151], a[68:71], v[180:183]
    ds_write_b64 v33, v[42:43] offset:448
    v_mfma_f32_16x16x32_bf16 v[180:183], a[120:123], a[32:35], v[180:183]
    v_cvt_pk_bf16_f32 v44, v172, v173
    v_cvt_pk_bf16_f32 v45, v174, v175
    v_mfma_f32_16x16x32_bf16 a[208:211], a[132:135], a[16:19], a[208:211]
    buffer_load_dwordx4 v17, s[36:39], s60 offen offset:2048 lds
    v_mfma_f32_16x16x32_bf16 a[208:211], a[160:163], a[52:55], a[208:211]
    ds_write_b64 v31, v[44:45] offset:30272
    v_mfma_f32_16x16x32_bf16 a[208:211], a[188:191], a[88:91], a[208:211]
    v_cvt_pk_bf16_f32 v40, v176, v177
    v_cvt_pk_bf16_f32 v41, v178, v179
    v_mfma_f32_16x16x32_bf16 v[184:187], a[180:183], a[72:75], v[184:187]
    ds_write_b64 v31, v[40:41] offset:30400
    v_mfma_f32_16x16x32_bf16 v[184:187], a[152:155], a[36:39], v[184:187]
    v_cvt_pk_bf16_f32 v42, v180, v181
    v_cvt_pk_bf16_f32 v43, v182, v183
    v_mfma_f32_16x16x32_bf16 v[184:187], a[124:127], a[0:3], v[184:187]
    ds_write_b64 v32, v[42:43] offset:29952
    v_mfma_f32_16x16x32_bf16 v[188:191], a[124:127], a[4:7], v[188:191]
    s_add_u32 m0, s69, 148224
    v_mfma_f32_16x16x32_bf16 v[188:191], a[152:155], a[40:43], v[188:191]
    ds_write2_b32 v46, a192, a208 offset0:0 offset1:1
    v_mfma_f32_16x16x32_bf16 v[188:191], a[180:183], a[76:79], v[188:191]
    v_accvgpr_read_b32 v64, a208
    v_accvgpr_read_b32 v65, a209
    v_mfma_f32_16x16x32_bf16 v[192:195], a[180:183], a[80:83], v[192:195]
    v_accvgpr_read_b32 v66, a210
    v_accvgpr_read_b32 v67, a211
    v_mfma_f32_16x16x32_bf16 v[192:195], a[152:155], a[44:47], v[192:195]
    v_cvt_pk_bf16_f32 v44, v64, v65
    v_cvt_pk_bf16_f32 v45, v66, v67
    v_mfma_f32_16x16x32_bf16 v[192:195], a[124:127], a[8:11], v[192:195]
    ds_write_b64 v34, v[44:45] offset:64
    v_mfma_f32_16x16x32_bf16 a[212:215], a[132:135], a[20:23], a[212:215]
    s_add_u32 s60, s70, 41472
    v_cvt_pk_bf16_f32 v40, v184, v185
    v_cvt_pk_bf16_f32 v41, v186, v187
    v_mfma_f32_16x16x32_bf16 a[212:215], a[160:163], a[56:59], a[212:215]
    ds_write_b64 v30, v[40:41] offset:41536
    v_mfma_f32_16x16x32_bf16 a[212:215], a[188:191], a[92:95], a[212:215]
    v_cvt_pk_bf16_f32 v42, v188, v189
    v_cvt_pk_bf16_f32 v43, v190, v191
    v_mfma_f32_16x16x32_bf16 v[196:199], a[180:183], a[84:87], v[196:199]
    ds_write_b64 v30, v[42:43] offset:41664
    v_mfma_f32_16x16x32_bf16 v[196:199], a[152:155], a[48:51], v[196:199]
    v_cvt_pk_bf16_f32 v44, v192, v193
    v_cvt_pk_bf16_f32 v45, v194, v195
    v_mfma_f32_16x16x32_bf16 v[196:199], a[124:127], a[12:15], v[196:199]
    ds_write_b64 v30, v[44:45] offset:41792
    v_mfma_f32_16x16x32_bf16 v[200:203], a[124:127], a[16:19], v[200:203]
    buffer_load_dwordx4 v15, s[36:39], s60 offen offset:0 lds
    v_mfma_f32_16x16x32_bf16 v[200:203], a[152:155], a[52:55], v[200:203]
    ds_write2_b32 v46, a196, a212 offset0:32 offset1:33
    v_mfma_f32_16x16x32_bf16 v[200:203], a[180:183], a[88:91], v[200:203]
    v_accvgpr_read_b32 v68, a212
    v_accvgpr_read_b32 v69, a213
    v_mfma_f32_16x16x32_bf16 v[204:207], a[180:183], a[92:95], v[204:207]
    v_accvgpr_read_b32 v70, a214
    v_accvgpr_read_b32 v71, a215
    v_mfma_f32_16x16x32_bf16 v[204:207], a[152:155], a[56:59], v[204:207]
    v_cvt_pk_bf16_f32 v40, v68, v69
    v_cvt_pk_bf16_f32 v41, v70, v71
    v_mfma_f32_16x16x32_bf16 v[204:207], a[124:127], a[20:23], v[204:207]
    ds_write_b64 v34, v[40:41] offset:192
    v_mfma_f32_16x16x32_bf16 a[216:219], a[132:135], a[24:27], a[216:219]
    buffer_load_dwordx4 v16, s[36:39], s60 offen offset:1024 lds
    v_mfma_f32_16x16x32_bf16 a[216:219], a[160:163], a[60:63], a[216:219]
    v_cvt_pk_bf16_f32 v42, v196, v197
    v_cvt_pk_bf16_f32 v43, v198, v199
    v_mfma_f32_16x16x32_bf16 a[216:219], a[188:191], a[96:99], a[216:219]
    ds_write_b64 v30, v[42:43] offset:41920
    v_mfma_f32_16x16x32_bf16 v[208:211], a[180:183], a[96:99], v[208:211]
    v_cvt_pk_bf16_f32 v44, v200, v201
    v_cvt_pk_bf16_f32 v45, v202, v203
    v_mfma_f32_16x16x32_bf16 v[208:211], a[152:155], a[60:63], v[208:211]
    ds_write_b64 v31, v[44:45] offset:41536
    v_mfma_f32_16x16x32_bf16 v[208:211], a[124:127], a[24:27], v[208:211]
    v_cvt_pk_bf16_f32 v40, v204, v205
    v_cvt_pk_bf16_f32 v41, v206, v207
    v_mfma_f32_16x16x32_bf16 v[212:215], a[124:127], a[28:31], v[212:215]
    buffer_load_dwordx4 v17, s[36:39], s60 offen offset:2048 lds
    v_mfma_f32_16x16x32_bf16 v[212:215], a[152:155], a[64:67], v[212:215]
    ds_write_b64 v31, v[40:41] offset:41664
    v_mfma_f32_16x16x32_bf16 v[212:215], a[180:183], a[100:103], v[212:215]
    v_mfma_f32_16x16x32_bf16 v[216:219], a[180:183], a[104:107], v[216:219]
    ds_write2_b32 v46, a200, a216 offset0:64 offset1:65
    v_mfma_f32_16x16x32_bf16 v[216:219], a[152:155], a[68:71], v[216:219]
    v_accvgpr_read_b32 v72, a216
    v_accvgpr_read_b32 v73, a217
    v_mfma_f32_16x16x32_bf16 v[216:219], a[124:127], a[32:35], v[216:219]
    v_accvgpr_read_b32 v74, a218
    v_accvgpr_read_b32 v75, a219
    v_mfma_f32_16x16x32_bf16 a[220:223], a[132:135], a[28:31], a[220:223]
    v_cvt_pk_bf16_f32 v42, v72, v73
    v_cvt_pk_bf16_f32 v43, v74, v75
    v_mfma_f32_16x16x32_bf16 a[220:223], a[160:163], a[64:67], a[220:223]
    ds_write_b64 v34, v[42:43] offset:320
    v_mfma_f32_16x16x32_bf16 a[220:223], a[188:191], a[100:103], a[220:223]
    v_cvt_pk_bf16_f32 v44, v208, v209
    v_cvt_pk_bf16_f32 v45, v210, v211
    v_mfma_f32_16x16x32_bf16 v[220:223], a[184:187], a[72:75], v[220:223]
    ds_write_b64 v31, v[44:45] offset:41792
    v_mfma_f32_16x16x32_bf16 v[220:223], a[156:159], a[36:39], v[220:223]
    v_cvt_pk_bf16_f32 v40, v212, v213
    v_cvt_pk_bf16_f32 v41, v214, v215
    v_mfma_f32_16x16x32_bf16 v[220:223], a[128:131], a[0:3], v[220:223]
    ds_write_b64 v31, v[40:41] offset:41920
    v_mfma_f32_16x16x32_bf16 v[224:227], a[128:131], a[4:7], v[224:227]
    v_cvt_pk_bf16_f32 v42, v216, v217
    v_cvt_pk_bf16_f32 v43, v218, v219
    v_mfma_f32_16x16x32_bf16 v[224:227], a[156:159], a[40:43], v[224:227]
    ds_write_b64 v32, v[42:43] offset:41472
    v_mfma_f32_16x16x32_bf16 v[224:227], a[184:187], a[76:79], v[224:227]
    v_mfma_f32_16x16x32_bf16 v[228:231], a[184:187], a[80:83], v[228:231]
    ds_write2_b32 v46, a204, a220 offset0:96 offset1:97
    v_mfma_f32_16x16x32_bf16 v[228:231], a[156:159], a[44:47], v[228:231]
    v_accvgpr_read_b32 v76, a220
    v_accvgpr_read_b32 v77, a221
    v_mfma_f32_16x16x32_bf16 v[228:231], a[128:131], a[8:11], v[228:231]
    v_accvgpr_read_b32 v78, a222
    v_accvgpr_read_b32 v79, a223
    v_mfma_f32_16x16x32_bf16 a[224:227], a[132:135], a[32:35], a[224:227]
    v_cvt_pk_bf16_f32 v44, v76, v77
    v_cvt_pk_bf16_f32 v45, v78, v79
    v_mfma_f32_16x16x32_bf16 a[224:227], a[160:163], a[68:71], a[224:227]
    ds_write_b64 v34, v[44:45] offset:448
    v_mfma_f32_16x16x32_bf16 a[224:227], a[188:191], a[104:107], a[224:227]
    v_cvt_pk_bf16_f32 v40, v220, v221
    v_cvt_pk_bf16_f32 v41, v222, v223
    v_mfma_f32_16x16x32_bf16 v[232:235], a[184:187], a[84:87], v[232:235]
    ds_write_b64 v30, v[40:41] offset:50752
    v_mfma_f32_16x16x32_bf16 v[232:235], a[156:159], a[48:51], v[232:235]
    v_cvt_pk_bf16_f32 v42, v224, v225
    v_cvt_pk_bf16_f32 v43, v226, v227
    v_mfma_f32_16x16x32_bf16 v[232:235], a[128:131], a[12:15], v[232:235]
    ds_write_b64 v30, v[42:43] offset:50880
    v_mfma_f32_16x16x32_bf16 v[236:239], a[128:131], a[16:19], v[236:239]
    v_cvt_pk_bf16_f32 v44, v228, v229
    v_cvt_pk_bf16_f32 v45, v230, v231
    v_mfma_f32_16x16x32_bf16 v[236:239], a[156:159], a[52:55], v[236:239]
    ds_write_b64 v30, v[44:45] offset:51008
    v_mfma_f32_16x16x32_bf16 v[236:239], a[184:187], a[88:91], v[236:239]
    s_nop 0
    v_accvgpr_read_b32 v80, a224
    v_accvgpr_read_b32 v81, a225
    v_mfma_f32_16x16x32_bf16 v[240:243], a[184:187], a[92:95], v[240:243]
    s_nop 0
    v_accvgpr_read_b32 v82, a226
    v_accvgpr_read_b32 v83, a227
    v_mfma_f32_16x16x32_bf16 v[240:243], a[156:159], a[56:59], v[240:243]
    v_cvt_pk_bf16_f32 v40, v80, v81
    v_cvt_pk_bf16_f32 v41, v82, v83
    v_mfma_f32_16x16x32_bf16 v[240:243], a[128:131], a[20:23], v[240:243]
    ds_write_b64 v35, v[40:41] offset:0
    v_mfma_f32_16x16x32_bf16 v[244:247], a[128:131], a[24:27], v[244:247]
    v_cvt_pk_bf16_f32 v42, v232, v233
    v_cvt_pk_bf16_f32 v43, v234, v235
    v_mfma_f32_16x16x32_bf16 v[244:247], a[156:159], a[60:63], v[244:247]
    ds_write_b64 v30, v[42:43] offset:51136
    v_mfma_f32_16x16x32_bf16 v[244:247], a[184:187], a[96:99], v[244:247]
    v_cvt_pk_bf16_f32 v44, v236, v237
    v_cvt_pk_bf16_f32 v45, v238, v239
    v_mfma_f32_16x16x32_bf16 v[248:251], a[184:187], a[100:103], v[248:251]
    ds_write_b64 v31, v[44:45] offset:50752
    v_mfma_f32_16x16x32_bf16 v[248:251], a[156:159], a[64:67], v[248:251]
    v_cvt_pk_bf16_f32 v40, v240, v241
    v_cvt_pk_bf16_f32 v41, v242, v243
    v_mfma_f32_16x16x32_bf16 v[248:251], a[128:131], a[28:31], v[248:251]
    ds_write_b64 v31, v[40:41] offset:50880
    v_mfma_f32_16x16x32_bf16 v[252:255], a[128:131], a[32:35], v[252:255]
    v_cvt_pk_bf16_f32 v42, v244, v245
    v_cvt_pk_bf16_f32 v43, v246, v247
    v_mfma_f32_16x16x32_bf16 v[252:255], a[156:159], a[68:71], v[252:255]
    ds_write_b64 v31, v[42:43] offset:51008
    v_mfma_f32_16x16x32_bf16 v[252:255], a[184:187], a[104:107], v[252:255]
    s_nop 0
    v_cvt_pk_bf16_f32 v44, v248, v249
    v_cvt_pk_bf16_f32 v45, v250, v251
    ds_write_b64 v31, v[44:45] offset:51136
    s_nop 3
    v_cvt_pk_bf16_f32 v40, v252, v253
    v_cvt_pk_bf16_f32 v41, v254, v255
    ds_write_b64 v32, v[40:41] offset:50688
    v_mov_b32 v145, 0
    v_mov_b32 v146, 0
    v_mov_b32 v149, 0
    v_mov_b32 v150, 0
    s_waitcnt lgkmcnt(0)
    s_barrier
    ds_read_b64 v[112:113], v36 offset:20736
    ds_read_b64 v[114:115], v36 offset:20768
    ds_read_b64 v[116:117], v36 offset:20800
    ds_read_b64 v[118:119], v36 offset:64
    ds_read_b64 v[120:121], v36 offset:21312
    ds_read_b64 v[122:123], v36 offset:21344
    ds_read_b64 v[124:125], v36 offset:21376
    ds_read_b64 v[126:127], v36 offset:640
    ds_read_b64 v[128:129], v36 offset:21888
    ds_read_b64 v[130:131], v36 offset:21920
    ds_read_b64 v[132:133], v36 offset:21952
    ds_read_b64 v[134:135], v36 offset:1216
    s_waitcnt lgkmcnt(8)
    v_mfma_f32_4x4x4_16b_bf16 v[48:51], v[112:113], v[118:119], v[2:5]
    ds_read_b64 v[136:137], v36 offset:22464
    v_mfma_f32_4x4x4_16b_bf16 v[52:55], v[114:115], v[118:119], v[6:9]
    ds_read_b64 v[138:139], v36 offset:22496
    v_mfma_f32_4x4x4_16b_bf16 v[56:59], v[116:117], v[118:119], 0
    s_waitcnt lgkmcnt(4)
    ds_read_b64 v[140:141], v36 offset:22528
    ds_read_b64 v[142:143], v36 offset:1792
    v_mfma_f32_4x4x4_16b_bf16 v[48:51], v[120:121], v[126:127], v[48:51]
    ds_read_b64 v[112:113], v36 offset:23040
    v_mfma_f32_4x4x4_16b_bf16 v[52:55], v[122:123], v[126:127], v[52:55]
    ds_read_b64 v[114:115], v36 offset:23072
    v_mfma_f32_4x4x4_16b_bf16 v[56:59], v[124:125], v[126:127], v[56:59]
    s_waitcnt lgkmcnt(3)
    s_nop 0
    ds_read_b64 v[116:117], v36 offset:23104
    ds_read_b32 v144, v36 offset:2368
    ds_read_b32 v147, v36 offset:2372
    v_mfma_f32_4x4x4_16b_bf16 v[48:51], v[128:129], v[134:135], v[48:51]
    ds_read_b64 v[120:121], v36 offset:23616
    v_mfma_f32_4x4x4_16b_bf16 v[52:55], v[130:131], v[134:135], v[52:55]
    ds_read_b64 v[122:123], v36 offset:23648
    v_mfma_f32_4x4x4_16b_bf16 v[56:59], v[132:133], v[134:135], v[56:59]
    s_waitcnt lgkmcnt(4)
    ds_read_b64 v[124:125], v36 offset:23680
    ds_read_b64 v[126:127], v36 offset:2944
    v_mfma_f32_4x4x4_16b_bf16 v[48:51], v[136:137], v[142:143], v[48:51]
    ds_read_b64 v[128:129], v36 offset:24192
    v_mfma_f32_4x4x4_16b_bf16 v[52:55], v[138:139], v[142:143], v[52:55]
    ds_read_b64 v[130:131], v36 offset:24224
    v_mfma_f32_4x4x4_16b_bf16 v[56:59], v[140:141], v[142:143], v[56:59]
    s_waitcnt lgkmcnt(4)
    ds_read_b64 v[132:133], v36 offset:24256
    ds_read_b64 v[134:135], v36 offset:3520
    v_mfma_f32_4x4x4_16b_bf16 v[48:51], v[112:113], v[144:145], v[48:51]
    ds_read_b64 v[136:137], v36 offset:24768
    v_mfma_f32_4x4x4_16b_bf16 v[52:55], v[114:115], v[144:145], v[52:55]
    ds_read_b64 v[138:139], v36 offset:24800
    v_mfma_f32_4x4x4_16b_bf16 v[56:59], v[116:117], v[144:145], v[56:59]
    ds_read_b64 v[140:141], v36 offset:24832
    v_mfma_f32_4x4x4_16b_bf16 v[60:63], v[112:113], v[146:147], v[2:5]
    ds_read_b64 v[142:143], v36 offset:4096
    v_mfma_f32_4x4x4_16b_bf16 v[64:67], v[114:115], v[146:147], v[6:9]
    v_mfma_f32_4x4x4_16b_bf16 v[68:71], v[116:117], v[146:147], 0
    s_waitcnt lgkmcnt(4)
    v_mfma_f32_4x4x4_16b_bf16 v[60:63], v[120:121], v[126:127], v[60:63]
    ds_read_b64 v[112:113], v36 offset:25344
    v_mfma_f32_4x4x4_16b_bf16 v[64:67], v[122:123], v[126:127], v[64:67]
    s_nop 0
    ds_read_b64 v[114:115], v36 offset:25376
    v_mfma_f32_4x4x4_16b_bf16 v[68:71], v[124:125], v[126:127], v[68:71]
    ds_read_b64 v[116:117], v36 offset:25408
    ds_read_b64 v[118:119], v36 offset:4672
    v_mfma_f32_4x4x4_16b_bf16 v[60:63], v[128:129], v[134:135], v[60:63]
    ds_read_b64 v[120:121], v37 offset:20736
    v_mfma_f32_4x4x4_16b_bf16 v[64:67], v[130:131], v[134:135], v[64:67]
    ds_read_b64 v[122:123], v37 offset:20768
    v_mfma_f32_4x4x4_16b_bf16 v[68:71], v[132:133], v[134:135], v[68:71]
    s_waitcnt lgkmcnt(4)
    ds_read_b64 v[124:125], v37 offset:20800
    ds_read_b64 v[126:127], v37 offset:64
    v_mfma_f32_4x4x4_16b_bf16 v[60:63], v[136:137], v[142:143], v[60:63]
    ds_read_b64 v[128:129], v37 offset:21312
    v_mfma_f32_4x4x4_16b_bf16 v[64:67], v[138:139], v[142:143], v[64:67]
    ds_read_b64 v[130:131], v37 offset:21344
    v_mfma_f32_4x4x4_16b_bf16 v[68:71], v[140:141], v[142:143], v[68:71]
    s_waitcnt lgkmcnt(4)
    ds_read_b64 v[132:133], v37 offset:21376
    ds_read_b64 v[134:135], v37 offset:640
    v_mfma_f32_4x4x4_16b_bf16 v[60:63], v[112:113], v[118:119], v[60:63]
    ds_read_b64 v[136:137], v37 offset:21888
    v_mfma_f32_4x4x4_16b_bf16 v[64:67], v[114:115], v[118:119], v[64:67]
    ds_read_b64 v[138:139], v37 offset:21920
    v_mfma_f32_4x4x4_16b_bf16 v[68:71], v[116:117], v[118:119], v[68:71]
    s_waitcnt lgkmcnt(4)
    ds_read_b64 v[140:141], v37 offset:21952
    ds_read_b64 v[142:143], v37 offset:1216
    v_mfma_f32_4x4x4_16b_bf16 v[72:75], v[120:121], v[126:127], v[2:5]
    ds_read_b64 v[112:113], v37 offset:22464
    v_mfma_f32_4x4x4_16b_bf16 v[76:79], v[122:123], v[126:127], v[6:9]
    ds_read_b64 v[114:115], v37 offset:22496
    v_mfma_f32_4x4x4_16b_bf16 v[80:83], v[124:125], v[126:127], 0
    s_waitcnt lgkmcnt(4)
    ds_read_b64 v[116:117], v37 offset:22528
    ds_read_b64 v[118:119], v37 offset:1792
    v_mfma_f32_4x4x4_16b_bf16 v[72:75], v[128:129], v[134:135], v[72:75]
    ds_read_b64 v[120:121], v37 offset:23040
    v_mfma_f32_4x4x4_16b_bf16 v[76:79], v[130:131], v[134:135], v[76:79]
    ds_read_b64 v[122:123], v37 offset:23072
    v_mfma_f32_4x4x4_16b_bf16 v[80:83], v[132:133], v[134:135], v[80:83]
    s_waitcnt lgkmcnt(3)
    s_nop 0
    ds_read_b64 v[124:125], v37 offset:23104
    ds_read_b32 v148, v37 offset:2368
    ds_read_b32 v151, v37 offset:2372
    v_mfma_f32_4x4x4_16b_bf16 v[72:75], v[136:137], v[142:143], v[72:75]
    ds_read_b64 v[128:129], v37 offset:23616
    v_mfma_f32_4x4x4_16b_bf16 v[76:79], v[138:139], v[142:143], v[76:79]
    ds_read_b64 v[130:131], v37 offset:23648
    v_mfma_f32_4x4x4_16b_bf16 v[80:83], v[140:141], v[142:143], v[80:83]
    s_waitcnt lgkmcnt(4)
    ds_read_b64 v[132:133], v37 offset:23680
    ds_read_b64 v[134:135], v37 offset:2944
    v_mfma_f32_4x4x4_16b_bf16 v[72:75], v[112:113], v[118:119], v[72:75]
    ds_read_b64 v[136:137], v37 offset:24192
    v_mfma_f32_4x4x4_16b_bf16 v[76:79], v[114:115], v[118:119], v[76:79]
    ds_read_b64 v[138:139], v37 offset:24224
    v_mfma_f32_4x4x4_16b_bf16 v[80:83], v[116:117], v[118:119], v[80:83]
    s_waitcnt lgkmcnt(4)
    ds_read_b64 v[140:141], v37 offset:24256
    ds_read_b64 v[142:143], v37 offset:3520
    v_mfma_f32_4x4x4_16b_bf16 v[72:75], v[120:121], v[148:149], v[72:75]
    ds_read_b64 v[112:113], v37 offset:24768
    v_mfma_f32_4x4x4_16b_bf16 v[76:79], v[122:123], v[148:149], v[76:79]
    ds_read_b64 v[114:115], v37 offset:24800
    v_mfma_f32_4x4x4_16b_bf16 v[80:83], v[124:125], v[148:149], v[80:83]
    ds_read_b64 v[116:117], v37 offset:24832
    v_mfma_f32_4x4x4_16b_bf16 v[84:87], v[120:121], v[150:151], v[2:5]
    ds_read_b64 v[118:119], v37 offset:4096
    v_mfma_f32_4x4x4_16b_bf16 v[88:91], v[122:123], v[150:151], v[6:9]
    v_mfma_f32_4x4x4_16b_bf16 v[92:95], v[124:125], v[150:151], 0
    s_waitcnt lgkmcnt(4)
    v_mfma_f32_4x4x4_16b_bf16 v[84:87], v[128:129], v[134:135], v[84:87]
    ds_read_b64 v[120:121], v37 offset:25344
    v_mfma_f32_4x4x4_16b_bf16 v[88:91], v[130:131], v[134:135], v[88:91]
    s_nop 0
    ds_read_b64 v[122:123], v37 offset:25376
    v_mfma_f32_4x4x4_16b_bf16 v[92:95], v[132:133], v[134:135], v[92:95]
    ds_read_b64 v[124:125], v37 offset:25408
    ds_read_b64 v[126:127], v37 offset:4672
    v_mfma_f32_4x4x4_16b_bf16 v[84:87], v[136:137], v[142:143], v[84:87]
    ds_read_b64 v[96:97], v12
    v_mfma_f32_4x4x4_16b_bf16 v[88:91], v[138:139], v[142:143], v[88:91]
    ds_read_b64_tr_b16 a[0:1], v38 offset:41472
    v_mfma_f32_4x4x4_16b_bf16 v[92:95], v[140:141], v[142:143], v[92:95]
    s_waitcnt lgkmcnt(5)
    ds_read_b64_tr_b16 a[2:3], v39 offset:41472
    v_mfma_f32_4x4x4_16b_bf16 v[84:87], v[112:113], v[118:119], v[84:87]
    ds_read_b64_tr_b16 a[4:5], v38 offset:41504
    v_mfma_f32_4x4x4_16b_bf16 v[88:91], v[114:115], v[118:119], v[88:91]
    ds_read_b64_tr_b16 a[6:7], v39 offset:41504
    v_mfma_f32_4x4x4_16b_bf16 v[92:95], v[116:117], v[118:119], v[92:95]
    s_waitcnt lgkmcnt(4)
    ds_read_b64_tr_b16 a[8:9], v38 offset:41536
    v_mfma_f32_4x4x4_16b_bf16 v[84:87], v[120:121], v[126:127], v[84:87]
    ds_read_b64_tr_b16 a[10:11], v39 offset:41536
    v_mfma_f32_4x4x4_16b_bf16 v[88:91], v[122:123], v[126:127], v[88:91]
    ds_read_b64_tr_b16 a[12:13], v38 offset:42048
    v_mfma_f32_4x4x4_16b_bf16 v[92:95], v[124:125], v[126:127], v[92:95]
    ds_read_b64_tr_b16 a[14:15], v39 offset:42048
    ds_read_b64_tr_b16 a[16:17], v38 offset:42080
    s_nop 0
    ds_read_b64_tr_b16 a[18:19], v39 offset:42080
    ds_read_b64_tr_b16 a[20:21], v38 offset:42112
    ds_read_b64_tr_b16 a[22:23], v39 offset:42112
    s_barrier
    v_mul_f32 v96, 0xbfb8aa3b, v96
    v_mul_f32 v97, 0xbfb8aa3b, v97
    v_exp_f32 v96, v96
    v_exp_f32 v97, v97
    v_cndmask_b32 v57, v57, v49, s[8:9]
    v_cndmask_b32 v69, v69, v61, s[8:9]
    v_cndmask_b32 v81, v81, v73, s[8:9]
    v_cndmask_b32 v93, v93, v85, s[8:9]
    s_add_u32 m0, s69, 768
    s_add_u32 s60, s70, 82944
    buffer_load_dwordx4 v15, s[36:39], s60 offen offset:0 lds
    v_add_f32 v96, 1.0, v96
    v_add_f32 v97, 1.0, v97
    v_rcp_f32 v98, v96
    v_rcp_f32 v99, v97
    v_cndmask_b32 v58, v58, v50, s[10:11]
    v_cndmask_b32 v70, v70, v62, s[10:11]
    v_cndmask_b32 v82, v82, v74, s[10:11]
    v_cndmask_b32 v94, v94, v86, s[10:11]
    buffer_load_dwordx4 v16, s[36:39], s60 offen offset:1024 lds
    v_sub_f32 v96, 1.0, v98
    v_sub_f32 v97, 1.0, v99
    v_cndmask_b32 v59, v59, v51, s[12:13]
    v_cndmask_b32 v71, v71, v63, s[12:13]
    v_cndmask_b32 v83, v83, v75, s[12:13]
    v_cndmask_b32 v95, v95, v87, s[12:13]
    v_max3_f32 v48, v52, v53, v54
    v_max3_f32 v60, v64, v65, v66
    buffer_load_dwordx4 v17, s[36:39], s60 offen offset:2048 lds
    v_max3_f32 v72, v76, v77, v78
    v_max3_f32 v84, v88, v89, v90
    v_max3_f32 v48, v48, v55, v56
    v_max3_f32 v60, v60, v67, v68
    v_max3_f32 v72, v72, v79, v80
    v_max3_f32 v84, v84, v91, v92
    v_max3_f32 v48, v48, v57, v58
L_att_pad5:
    s_cbranch_execz L_att_ret1
    v_max3_f32 v60, v60, v69, v70
    s_add_u32 m0, s69, 13056
    s_add_u32 s60, s70, 124416
    s_nop 0
    buffer_load_dwordx4 v15, s[36:39], s60 offen offset:0 lds
    v_max3_f32 v72, v72, v81, v82
    v_max3_f32 v84, v84, v93, v94
    v_max_f32 v48, v48, v59
    v_max_f32 v60, v60, v71
    v_max_f32 v72, v72, v83
    v_max_f32 v84, v84, v95
    v_mul_f32 v48, s14, v48
    v_mul_f32 v60, s14, v60
    buffer_load_dwordx4 v16, s[36:39], s60 offen offset:1024 lds
    v_mul_f32 v72, s14, v72
    v_mul_f32 v84, s14, v84
    v_pk_fma_f32 v[52:53], v[52:53], s[14:15], v[48:49] op_sel_hi:[1,1,0] neg_lo:[0,0,1] neg_hi:[0,0,1]
    v_pk_fma_f32 v[54:55], v[54:55], s[14:15], v[48:49] op_sel_hi:[1,1,0] neg_lo:[0,0,1] neg_hi:[0,0,1]
    v_pk_fma_f32 v[56:57], v[56:57], s[14:15], v[48:49] op_sel_hi:[1,1,0] neg_lo:[0,0,1] neg_hi:[0,0,1]
    v_pk_fma_f32 v[58:59], v[58:59], s[14:15], v[48:49] op_sel_hi:[1,1,0] neg_lo:[0,0,1] neg_hi:[0,0,1]
    v_pk_fma_f32 v[64:65], v[64:65], s[14:15], v[60:61] op_sel_hi:[1,1,0] neg_lo:[0,0,1] neg_hi:[0,0,1]
    v_pk_fma_f32 v[66:67], v[66:67], s[14:15], v[60:61] op_sel_hi:[1,1,0] neg_lo:[0,0,1] neg_hi:[0,0,1]
    buffer_load_dwordx4 v17, s[36:39], s60 offen offset:2048 lds
    v_pk_fma_f32 v[68:69], v[68:69], s[14:15], v[60:61] op_sel_hi:[1,1,0] neg_lo:[0,0,1] neg_hi:[0,0,1]
    v_pk_fma_f32 v[70:71], v[70:71], s[14:15], v[60:61] op_sel_hi:[1,1,0] neg_lo:[0,0,1] neg_hi:[0,0,1]
    v_pk_fma_f32 v[76:77], v[76:77], s[14:15], v[72:73] op_sel_hi:[1,1,0] neg_lo:[0,0,1] neg_hi:[0,0,1]
    v_pk_fma_f32 v[78:79], v[78:79], s[14:15], v[72:73] op_sel_hi:[1,1,0] neg_lo:[0,0,1] neg_hi:[0,0,1]
    v_pk_fma_f32 v[80:81], v[80:81], s[14:15], v[72:73] op_sel_hi:[1,1,0] neg_lo:[0,0,1] neg_hi:[0,0,1]
    v_pk_fma_f32 v[82:83], v[82:83], s[14:15], v[72:73] op_sel_hi:[1,1,0] neg_lo:[0,0,1] neg_hi:[0,0,1]
    v_pk_fma_f32 v[88:89], v[88:89], s[14:15], v[84:85] op_sel_hi:[1,1,0] neg_lo:[0,0,1] neg_hi:[0,0,1]
    v_pk_fma_f32 v[90:91], v[90:91], s[14:15], v[84:85] op_sel_hi:[1,1,0] neg_lo:[0,0,1] neg_hi:[0,0,1]
    s_add_u32 m0, s69, 25344
    s_add_u32 s60, s71, 0
    buffer_load_dwordx4 v15, s[36:39], s60 offen offset:0 lds
    v_pk_fma_f32 v[92:93], v[92:93], s[14:15], v[84:85] op_sel_hi:[1,1,0] neg_lo:[0,0,1] neg_hi:[0,0,1]
    v_pk_fma_f32 v[94:95], v[94:95], s[14:15], v[84:85] op_sel_hi:[1,1,0] neg_lo:[0,0,1] neg_hi:[0,0,1]
    v_exp_f32 v52, v52
    v_exp_f32 v53, v53
    v_exp_f32 v54, v54
    v_exp_f32 v55, v55
    v_exp_f32 v56, v56
    v_exp_f32 v57, v57
    buffer_load_dwordx4 v16, s[36:39], s60 offen offset:1024 lds
    v_exp_f32 v58, v58
    v_exp_f32 v59, v59
    v_exp_f32 v64, v64
    v_exp_f32 v65, v65
    v_exp_f32 v66, v66
    v_exp_f32 v67, v67
    v_exp_f32 v68, v68
    v_exp_f32_e64 v69, v69
    buffer_load_dwordx4 v17, s[36:39], s60 offen offset:2048 lds
    v_exp_f32 v70, v70
    v_exp_f32 v71, v71
    v_exp_f32 v76, v76
    v_exp_f32 v77, v77
    v_exp_f32 v78, v78
    v_exp_f32 v79, v79
    v_exp_f32 v80, v80
    v_exp_f32 v81, v81
    s_add_u32 m0, s69, 62208
    s_add_u32 s60, s71, 41472
    buffer_load_dwordx4 v15, s[36:39], s60 offen offset:0 lds
    v_exp_f32 v82, v82
    v_exp_f32 v83, v83
    v_exp_f32 v88, v88
    v_exp_f32 v89, v89
    v_exp_f32 v90, v90
    v_exp_f32 v91, v91
    v_exp_f32 v92, v92
    v_exp_f32 v93, v93
    buffer_load_dwordx4 v16, s[36:39], s60 offen offset:1024 lds
    v_exp_f32 v94, v94
    v_exp_f32 v95, v95
    v_pk_add_f32 v[48:49], v[52:53], v[54:55]
    v_pk_add_f32 v[50:51], v[56:57], v[58:59]
    v_pk_add_f32 v[60:61], v[64:65], v[66:67]
    v_pk_add_f32 v[62:63], v[68:69], v[70:71]
    v_pk_add_f32 v[72:73], v[76:77], v[78:79]
    v_pk_add_f32 v[74:75], v[80:81], v[82:83]
    buffer_load_dwordx4 v17, s[36:39], s60 offen offset:2048 lds
    v_pk_add_f32 v[84:85], v[88:89], v[90:91]
    v_pk_add_f32 v[86:87], v[92:93], v[94:95]
    v_pk_add_f32 v[48:49], v[48:49], v[50:51]
    v_pk_add_f32 v[60:61], v[60:61], v[62:63]
    v_pk_add_f32 v[72:73], v[72:73], v[74:75]
    v_pk_add_f32 v[84:85], v[84:85], v[86:87]
    v_add_f32 v48, v48, v49
    v_add_f32 v60, v60, v61
    s_add_u32 m0, s69, 74496
    s_add_u32 s60, s71, 82944
    buffer_load_dwordx4 v15, s[36:39], s60 offen offset:0 lds
    v_add_f32 v72, v72, v73
    v_add_f32 v84, v84, v85
    v_rcp_f32 v48, v48
    v_rcp_f32 v60, v60
    v_rcp_f32 v72, v72
    v_rcp_f32 v84, v84
    v_mul_f32 v48, v48, v98
    v_mul_f32 v60, v60, v98
    buffer_load_dwordx4 v16, s[36:39], s60 offen offset:1024 lds
    v_mul_f32 v72, v72, v99
    v_mul_f32 v84, v84, v99
    v_pk_mul_f32 v[52:53], v[52:53], v[48:49] op_sel_hi:[1,0]
    v_pk_mul_f32 v[54:55], v[54:55], v[48:49] op_sel_hi:[1,0]
    v_pk_mul_f32 v[56:57], v[56:57], v[48:49] op_sel_hi:[1,0]
    v_pk_mul_f32 v[58:59], v[58:59], v[48:49] op_sel_hi:[1,0]
    v_pk_mul_f32 v[64:65], v[64:65], v[60:61] op_sel_hi:[1,0]
    v_pk_mul_f32 v[66:67], v[66:67], v[60:61] op_sel_hi:[1,0]
    buffer_load_dwordx4 v17, s[36:39], s60 offen offset:2048 lds
    v_pk_mul_f32 v[68:69], v[68:69], v[60:61] op_sel_hi:[1,0]
    v_pk_mul_f32 v[70:71], v[70:71], v[60:61] op_sel_hi:[1,0]
    v_pk_mul_f32 v[76:77], v[76:77], v[72:73] op_sel_hi:[1,0]
    v_pk_mul_f32 v[78:79], v[78:79], v[72:73] op_sel_hi:[1,0]
    v_pk_mul_f32 v[80:81], v[80:81], v[72:73] op_sel_hi:[1,0]
    v_pk_mul_f32 v[82:83], v[82:83], v[72:73] op_sel_hi:[1,0]
    v_pk_mul_f32 v[88:89], v[88:89], v[84:85] op_sel_hi:[1,0]
    v_pk_mul_f32 v[90:91], v[90:91], v[84:85] op_sel_hi:[1,0]
    s_add_u32 m0, s69, 86784
    s_add_u32 s60, s71, 124416
    buffer_load_dwordx4 v15, s[36:39], s60 offen offset:0 lds
    v_pk_mul_f32 v[92:93], v[92:93], v[84:85] op_sel_hi:[1,0]
    v_pk_mul_f32 v[94:95], v[94:95], v[84:85] op_sel_hi:[1,0]
    v_cvt_pk_bf16_f32 v52, v52, v53
    v_cvt_pk_bf16_f32 v53, v54, v55
    v_cvt_pk_bf16_f32 v56, v56, v57
    v_cvt_pk_bf16_f32 v57, v58, v59
    v_cvt_pk_bf16_f32 v64, v64, v65
    v_cvt_pk_bf16_f32 v65, v66, v67
    buffer_load_dwordx4 v16, s[36:39], s60 offen offset:1024 lds
    v_cvt_pk_bf16_f32 v68, v68, v69
    v_cvt_pk_bf16_f32 v69, v70, v71
    v_cvt_pk_bf16_f32 v76, v76, v77
    v_cvt_pk_bf16_f32 v77, v78, v79
    v_cvt_pk_bf16_f32 v80, v80, v81
    v_cvt_pk_bf16_f32 v81, v82, v83
    v_cvt_pk_bf16_f32 v88, v88, v89
    v_cvt_pk_bf16_f32 v89, v90, v91
    buffer_load_dwordx4 v17, s[36:39], s60 offen offset:2048 lds
    v_cvt_pk_bf16_f32 v92, v92, v93
    v_cvt_pk_bf16_f32 v93, v94, v95
    v_and_b32_e64 v48, v14, v56
    v_bfi_b32 v56, v14, 0, v56
    v_and_b32 v49, v26, v57
    v_bfi_b32 v57, v26, 0, v57
    v_and_b32 v60, v14, v68
    v_bfi_b32 v68, v14, 0, v68
    buffer_store_dwordx2 v[96:97], v13, s[44:47], s16 offen sc1
    v_and_b32 v61, v26, v69
    v_bfi_b32 v69, v26, 0, v69
    v_and_b32 v72, v14, v80
    v_bfi_b32 v80, v14, 0, v80
    v_and_b32_e64 v73, v26, v81
    v_bfi_b32 v81, v26, 0, v81
    v_and_b32_e64 v84, v14, v92
    v_bfi_b32 v92, v14, 0, v92
    v_and_b32 v85, v26, v93
    v_bfi_b32 v93, v26, 0, v93
    s_waitcnt lgkmcnt(4)
    v_mfma_f32_4x4x4_16b_bf16 v[100:103], a[0:1], v[48:49], 0
    ds_read_b64_tr_b16 a[24:25], v38 offset:42624
    v_mfma_f32_4x4x4_16b_bf16 v[104:107], a[2:3], v[72:73], 0
    ds_read_b64_tr_b16 a[26:27], v39 offset:42624
    v_mfma_f32_4x4x4_16b_bf16 v[100:103], a[4:5], v[52:53], v[100:103]
    ds_read_b64_tr_b16 a[28:29], v38 offset:42656
    v_mfma_f32_4x4x4_16b_bf16 v[104:107], a[6:7], v[76:77], v[104:107]
    ds_read_b64_tr_b16 a[30:31], v39 offset:42656
    v_mfma_f32_4x4x4_16b_bf16 v[100:103], a[8:9], v[56:57], v[100:103]
    ds_read_b64_tr_b16 a[32:33], v38 offset:42688
    v_mfma_f32_4x4x4_16b_bf16 v[104:107], a[10:11], v[80:81], v[104:107]
    ds_read_b64_tr_b16 a[34:35], v39 offset:42688
    v_mfma_f32_4x4x4_16b_bf16 v[108:111], a[12:13], v[48:49], 0
    ds_read_b64_tr_b16 a[36:37], v38 offset:43200
    v_mfma_f32_4x4x4_16b_bf16 v[112:115], a[14:15], v[72:73], 0
    s_waitcnt lgkmcnt(4)
    ds_read_b64_tr_b16 a[38:39], v39 offset:43200
    v_mfma_f32_4x4x4_16b_bf16 v[108:111], a[16:17], v[52:53], v[108:111]
    s_nop 0
    ds_read_b64_tr_b16 a[40:41], v38 offset:43232
    v_mfma_f32_4x4x4_16b_bf16 v[112:115], a[18:19], v[76:77], v[112:115]
    ds_read_b64_tr_b16 a[42:43], v39 offset:43232
    v_mfma_f32_4x4x4_16b_bf16 v[108:111], a[20:21], v[56:57], v[108:111]
    ds_read_b64_tr_b16 a[44:45], v38 offset:43264
    v_mfma_f32_4x4x4_16b_bf16 v[112:115], a[22:23], v[80:81], v[112:115]
    ds_read_b64_tr_b16 a[46:47], v39 offset:43264
    v_mfma_f32_4x4x4_16b_bf16 v[116:119], a[24:25], v[48:49], 0
    ds_read_b64_tr_b16 a[48:49], v38 offset:43776
    v_mfma_f32_4x4x4_16b_bf16 v[120:123], a[26:27], v[72:73], 0
    ds_read_b64_tr_b16 a[50:51], v39 offset:43776
    v_mfma_f32_4x4x4_16b_bf16 v[116:119], a[28:29], v[52:53], v[116:119]
    s_waitcnt lgkmcnt(4)
    ds_read_b64_tr_b16 a[52:53], v38 offset:43808
    v_mfma_f32_4x4x4_16b_bf16 v[120:123], a[30:31], v[76:77], v[120:123]
    ds_read_b64_tr_b16 a[54:55], v39 offset:43808
    s_nop 0
    v_mfma_f32_4x4x4_16b_bf16 v[116:119], a[32:33], v[56:57], v[116:119]
    ds_read_b64_tr_b16 a[56:57], v38 offset:43840
    v_mfma_f32_4x4x4_16b_bf16 v[120:123], a[34:35], v[80:81], v[120:123]
    ds_read_b64_tr_b16 a[58:59], v39 offset:43840
    v_mfma_f32_4x4x4_16b_bf16 v[124:127], a[36:37], v[48:49], 0
    ds_read_b64_tr_b16 a[60:61], v38 offset:44352
    v_mfma_f32_4x4x4_16b_bf16 v[128:131], a[38:39], v[72:73], 0
    ds_read_b64_tr_b16 a[62:63], v39 offset:44352
    s_nop 0
    v_mfma_f32_4x4x4_16b_bf16 v[124:127], a[40:41], v[52:53], v[124:127]
    ds_read_b64_tr_b16 a[64:65], v38 offset:44384
    v_mfma_f32_4x4x4_16b_bf16 v[128:131], a[42:43], v[76:77], v[128:131]
    s_waitcnt lgkmcnt(4)
    ds_read_b64_tr_b16 a[66:67], v39 offset:44384
    v_mfma_f32_4x4x4_16b_bf16 v[124:127], a[44:45], v[56:57], v[124:127]
    ds_read_b64_tr_b16 a[68:69], v38 offset:44416
    v_mfma_f32_4x4x4_16b_bf16 v[128:131], a[46:47], v[80:81], v[128:131]
    ds_read_b64_tr_b16 a[70:71], v39 offset:44416
    v_mfma_f32_4x4x4_16b_bf16 v[132:135], a[48:49], v[48:49], 0
    ds_read_b64_tr_b16 a[72:73], v38 offset:44928
    v_mfma_f32_4x4x4_16b_bf16 v[136:139], a[50:51], v[72:73], 0
    ds_read_b64_tr_b16 a[74:75], v39 offset:44928
    v_mfma_f32_4x4x4_16b_bf16 v[140:143], a[48:49], v[60:61], 0
    ds_read_b64_tr_b16 a[76:77], v38 offset:44960
    v_mfma_f32_4x4x4_16b_bf16 v[144:147], a[50:51], v[84:85], 0
    ds_read_b64_tr_b16 a[78:79], v39 offset:44960
    v_mfma_f32_4x4x4_16b_bf16 v[132:135], a[52:53], v[52:53], v[132:135]
    ds_read_b64_tr_b16 a[80:81], v38 offset:44992
    v_mfma_f32_4x4x4_16b_bf16 v[136:139], a[54:55], v[76:77], v[136:139]
    ds_read_b64_tr_b16 a[82:83], v39 offset:44992
    v_mfma_f32_4x4x4_16b_bf16 v[140:143], a[52:53], v[64:65], v[140:143]
    ds_read_b64_tr_b16 a[84:85], v38 offset:45504
    v_mfma_f32_4x4x4_16b_bf16 v[144:147], a[54:55], v[88:89], v[144:147]
    ds_read_b64_tr_b16 a[86:87], v39 offset:45504
    v_mfma_f32_4x4x4_16b_bf16 v[132:135], a[56:57], v[56:57], v[132:135]
    s_waitcnt lgkmcnt(4)
    ds_read_b64_tr_b16 a[88:89], v38 offset:45536
    s_nop 0
    v_mfma_f32_4x4x4_16b_bf16 v[136:139], a[58:59], v[80:81], v[136:139]
    ds_read_b64_tr_b16 a[90:91], v39 offset:45536
    v_mfma_f32_4x4x4_16b_bf16 v[140:143], a[56:57], v[68:69], v[140:143]
    ds_read_b64_tr_b16 a[92:93], v38 offset:45568
    v_mfma_f32_4x4x4_16b_bf16 v[144:147], a[58:59], v[92:93], v[144:147]
    ds_read_b64_tr_b16 a[94:95], v39 offset:45568
    v_mfma_f32_4x4x4_16b_bf16 v[148:151], a[60:61], v[60:61], 0
    ds_read_b64_tr_b16 a[96:97], v38 offset:46080
    v_mfma_f32_4x4x4_16b_bf16 v[152:155], a[62:63], v[84:85], 0
    ds_read_b64_tr_b16 a[98:99], v39 offset:46080
    v_mfma_f32_4x4x4_16b_bf16 v[148:151], a[64:65], v[64:65], v[148:151]
    ds_read_b64_tr_b16 a[100:101], v38 offset:46112
    v_mfma_f32_4x4x4_16b_bf16 v[152:155], a[66:67], v[88:89], v[152:155]
    ds_read_b64_tr_b16 a[102:103], v39 offset:46112
    v_mfma_f32_4x4x4_16b_bf16 v[148:151], a[68:69], v[68:69], v[148:151]
    ds_read_b64_tr_b16 a[104:105], v38 offset:46144
    v_mfma_f32_4x4x4_16b_bf16 v[152:155], a[70:71], v[92:93], v[152:155]
    ds_read_b64_tr_b16 a[106:107], v39 offset:46144
    v_cvt_pk_bf16_f32 v192, v100, v101
    v_mfma_f32_4x4x4_16b_bf16 v[156:159], a[72:73], v[60:61], 0
    v_cvt_pk_bf16_f32 v193, v102, v103
    v_mfma_f32_4x4x4_16b_bf16 v[160:163], a[74:75], v[84:85], 0
    v_cvt_pk_bf16_f32 v194, v108, v109
    v_mfma_f32_4x4x4_16b_bf16 v[156:159], a[76:77], v[64:65], v[156:159]
    v_cvt_pk_bf16_f32 v195, v110, v111
    v_mfma_f32_4x4x4_16b_bf16 v[160:163], a[78:79], v[88:89], v[160:163]
    buffer_store_dwordx4 v[192:195], v10, s[44:47], s62 offen offset:0 sc1
    v_cvt_pk_bf16_f32 v208, v104, v105
    s_waitcnt lgkmcnt(4)
    v_mfma_f32_4x4x4_16b_bf16 v[156:159], a[80:81], v[68:69], v[156:159]
    v_cvt_pk_bf16_f32 v209, v106, v107
    v_mfma_f32_4x4x4_16b_bf16 v[160:163], a[82:83], v[92:93], v[160:163]
    s_nop 0
    v_cvt_pk_bf16_f32 v210, v112, v113
    v_mfma_f32_4x4x4_16b_bf16 v[164:167], a[84:85], v[60:61], 0
    v_cvt_pk_bf16_f32 v211, v114, v115
    v_mfma_f32_4x4x4_16b_bf16 v[168:171], a[86:87], v[84:85], 0
    buffer_store_dwordx4 v[208:211], v10, s[44:47], s62 offen offset:128 sc1
    v_cvt_pk_bf16_f32 v196, v116, v117
    v_mfma_f32_4x4x4_16b_bf16 v[164:167], a[88:89], v[64:65], v[164:167]
    v_cvt_pk_bf16_f32 v197, v118, v119
    v_mfma_f32_4x4x4_16b_bf16 v[168:171], a[90:91], v[88:89], v[168:171]
    v_cvt_pk_bf16_f32 v198, v124, v125
    v_mfma_f32_4x4x4_16b_bf16 v[164:167], a[92:93], v[68:69], v[164:167]
    v_cvt_pk_bf16_f32 v199, v126, v127
    v_mfma_f32_4x4x4_16b_bf16 v[168:171], a[94:95], v[92:93], v[168:171]
    buffer_store_dwordx4 v[196:199], v10, s[44:47], s62 offen offset:256 sc1
    v_cvt_pk_bf16_f32 v212, v120, v121
    v_mfma_f32_4x4x4_16b_bf16 v[172:175], a[96:97], v[60:61], 0
    v_cvt_pk_bf16_f32 v213, v122, v123
    v_mfma_f32_4x4x4_16b_bf16 v[176:179], a[98:99], v[84:85], 0
    s_waitcnt lgkmcnt(3)
    v_cvt_pk_bf16_f32 v214, v128, v129
    v_mfma_f32_4x4x4_16b_bf16 v[172:175], a[100:101], v[64:65], v[172:175]
    s_waitcnt lgkmcnt(2)
    v_cvt_pk_bf16_f32 v215, v130, v131
    v_mfma_f32_4x4x4_16b_bf16 v[176:179], a[102:103], v[88:89], v[176:179]
    buffer_store_dwordx4 v[212:215], v10, s[44:47], s62 offen offset:384 sc1
    v_cvt_pk_bf16_f32 v200, v132, v133
    s_waitcnt lgkmcnt(1)
    v_mfma_f32_4x4x4_16b_bf16 v[172:175], a[104:105], v[68:69], v[172:175]
    s_waitcnt lgkmcnt(0)
    v_cvt_pk_bf16_f32 v201, v142, v143
    v_mfma_f32_4x4x4_16b_bf16 v[176:179], a[106:107], v[92:93], v[176:179]
    v_cvt_pk_bf16_f32 v202, v148, v149
    v_cvt_pk_bf16_f32 v203, v150, v151
    s_barrier
    s_nop 0
    buffer_store_dwordx4 v[200:203], v10, s[44:47], s62 offen offset:512 sc1
    v_cvt_pk_bf16_f32 v216, v136, v137
    v_cvt_pk_bf16_f32 v217, v146, v147
    v_cvt_pk_bf16_f32 v218, v152, v153
    v_cvt_pk_bf16_f32 v219, v154, v155
    buffer_store_dwordx4 v[216:219], v10, s[44:47], s62 offen offset:640 sc1
    v_cvt_pk_bf16_f32 v204, v156, v157
    v_cvt_pk_bf16_f32 v205, v158, v159
    v_cvt_pk_bf16_f32 v206, v164, v165
    v_cvt_pk_bf16_f32 v207, v166, v167
    buffer_store_dwordx4 v[204:207], v10, s[44:47], s62 offen offset:768 sc1
    v_cvt_pk_bf16_f32 v220, v160, v161
    v_cvt_pk_bf16_f32 v221, v162, v163
    v_cvt_pk_bf16_f32 v222, v168, v169
    v_cvt_pk_bf16_f32 v223, v170, v171
    buffer_store_dwordx4 v[220:223], v10, s[44:47], s62 offen offset:896 sc1
    v_cvt_pk_bf16_f32 v224, v172, v173
    v_cvt_pk_bf16_f32 v225, v174, v175
    v_cvt_pk_bf16_f32 v226, v176, v177
    v_cvt_pk_bf16_f32 v227, v178, v179
    buffer_store_dwordx4 v[224:227], v11, s[44:47], s63 offen sc1
    s_add_u32 m0, s69, 37632
    s_add_u32 s60, s72, 0
    buffer_load_dwordx4 v15, s[36:39], s60 offen offset:0 lds
    s_nop 0
    buffer_load_dwordx4 v16, s[36:39], s60 offen offset:1024 lds
    buffer_load_dwordx4 v17, s[36:39], s60 offen offset:2048 lds
    s_add_u32 m0, s69, 49920
    s_add_u32 s60, s72, 41472
    buffer_load_dwordx4 v15, s[36:39], s60 offen offset:0 lds
    buffer_load_dwordx4 v16, s[36:39], s60 offen offset:1024 lds
    buffer_load_dwordx4 v17, s[36:39], s60 offen offset:2048 lds
    s_add_u32 m0, s69, 99072
    s_add_u32 s60, s72, 82944
    buffer_load_dwordx4 v15, s[36:39], s60 offen offset:0 lds
    buffer_load_dwordx4 v16, s[36:39], s60 offen offset:1024 lds
    buffer_load_dwordx4 v17, s[36:39], s60 offen offset:2048 lds
    v_add_u32 v160, 0x10000, v1
    v_add_u32 v161, 0x20000, v1
    v_add_u32 v162, 0x10000, v22
    v_add_u32 v163, 0x20000, v22
    v_add_u32 v164, 0x10000, v23
    v_add_u32 v165, 0x20000, v23
    v_add_u32 v166, 0x10000, v27
    v_add_u32 v167, 0x20000, v27
    s_waitcnt lgkmcnt(0)
    s_waitcnt vmcnt(9)
    s_barrier
    s_cbranch_vccz L_skip7
    s_atomic_add s96, s[92:93], 0x900
L_skip7:
    s_add_u32 s59, s74, 0
    s_nop 0
    buffer_load_dwordx4 a[0:3], v25, s[44:47], s59 offen offset:0 sc1
    buffer_load_dwordx4 a[4:7], v25, s[44:47], s59 offen offset:1024 sc1
    s_add_u32 s59, s74, 16384
    buffer_load_dwordx4 a[8:11], v25, s[44:47], s59 offen offset:0 sc1
    buffer_load_dwordx4 a[12:15], v25, s[44:47], s59 offen offset:1024 sc1
    s_add_u32 s59, s74, 32768
    buffer_load_dwordx4 a[16:19], v25, s[44:47], s59 offen offset:0 sc1
    buffer_load_dwordx4 a[20:23], v25, s[44:47], s59 offen offset:1024 sc1
    s_add_u32 s59, s74, 49152
    buffer_load_dwordx4 a[24:27], v25, s[44:47], s59 offen offset:0 sc1
    buffer_load_dwordx4 a[28:31], v25, s[44:47], s59 offen offset:1024 sc1
    s_cbranch_vccz L_skip8
    s_mov_b32 s97, 0
    s_atomic_add s97, s[92:93], 0x900 glc
L_skip8:
    ds_read_b64_tr_b16 v[176:177], v161 offset:4864
    ds_read_b64_tr_b16 v[178:179], v161 offset:5376
    ds_read_b64_tr_b16 v[180:181], v161 offset:17152
    ds_read_b64_tr_b16 v[182:183], v161 offset:17664
    ds_read_b64_tr_b16 v[184:185], v163 offset:4864
    ds_read_b64_tr_b16 v[186:187], v163 offset:5376
    ds_read_b64_tr_b16 v[188:189], v163 offset:17152
    ds_read_b64_tr_b16 v[190:191], v163 offset:17664
    ds_read_b64_tr_b16 v[192:193], v165 offset:4864
    ds_read_b64_tr_b16 v[194:195], v165 offset:5376
    ds_read_b64_tr_b16 v[196:197], v165 offset:17152
    ds_read_b64_tr_b16 v[198:199], v165 offset:17664
    s_and_b32 s85, s57, 7
    v_lshrrev_b32 v31, 1, v0
    v_min_u32_e64 v31, 9, v31
    v_add_u32_e64 v31, s85, v31
    v_subrev_u32_e64 v2, 9, v31
    v_min_u32 v31, v31, v2
    v_and_b32 v2, 1, v0
    v_lshlrev_b32_e64 v2, 4, v2
    v_lshl_add_u32 v31, v31, 7, v2
    s_lshl_b32 s85, s56, 5
    v_add_u32_e64 v31, s85, v31
    s_mov_b64 s[48:49], s[22:23]
    s_mov_b32 s50, 2359296
    s_mov_b32 s51, 0x20000
    s_mul_i32 s68, s57, 147456
    s_lshl_b32 s82, s56, 5
    s_add_u32 s68, s68, s82
    s_lshr_b32 s82, s58, 2
    s_lshl_b32 s82, s82, 5
    s_and_b32 s83, s58, 1
    s_lshl_b32 s83, s83, 3
    s_add_u32 s82, s82, s83
    s_bfe_u32 s83, s58, 0x10001
    s_add_u32 s82, s82, s83
    v_bfe_u32 v208, v0, 4, 1
    v_lshl_add_u32 v208, v208, 4, s82
    v_and_b32 v209, 3, v0
    v_lshl_add_u32 v209, v209, 1, v208
    v_lshlrev_b32 v221, 2, v209
    v_bfe_u32 v214, v0, 1, 3
    v_and_b32_e64 v215, 1, v0
    v_lshlrev_b32 v215, 4, v215
    s_movk_i32 s83, 0x3f80
    v_lshlrev_b32 v215, v215, s83
    s_add_u32 s83, s79, 65536
    v_cmp_eq_u32 s[8:9], 0, v214
    v_cmp_eq_u32 s[10:11], 1, v214
    v_cmp_eq_u32 s[12:13], 2, v214
    v_cmp_eq_u32 s[14:15], 3, v214
    v_cndmask_b32 v208, 0, v215, s[8:9]
    v_cndmask_b32 v209, 0, v215, s[10:11]
    v_cndmask_b32 v210, 0, v215, s[12:13]
    v_cndmask_b32 v211, 0, v215, s[14:15]
    v_cmp_eq_u32 s[8:9], 4, v214
    v_cmp_eq_u32 s[10:11], 5, v214
    v_cmp_eq_u32 s[12:13], 6, v214
    v_cmp_eq_u32 s[14:15], 7, v214
    v_cndmask_b32 v212, 0, v215, s[8:9]
    v_cndmask_b32 v213, 0, v215, s[10:11]
    v_cndmask_b32 v214, 0, v215, s[12:13]
    v_cndmask_b32 v215, 0, v215, s[14:15]
    s_add_u32 s43, s65, 62208
    v_lshrrev_b32 v244, 5, v0
    v_bfe_u32 v245, v0, 2, 2
    v_lshl_add_u32 v225, v245, 3, s43
    v_lshl_add_u32 v225, v244, 5, v225
    s_waitcnt vmcnt(7) lgkmcnt(4)
    v_mfma_f32_16x16x32_bf16 v[64:67], v[176:179], a[0:3], 0
    s_add_u32 m0, s69, 111360
    ds_read_b64_tr_b16 v[200:201], v167 offset:4864
    s_add_u32 s60, s72, 124416
    s_waitcnt vmcnt(5)
    v_mfma_f32_16x16x32_bf16 v[64:67], v[180:183], a[8:11], v[64:67]
    buffer_load_dwordx4 v15, s[36:39], s60 offen offset:0 lds
    v_mfma_f32_16x16x32_bf16 v[68:71], v[176:179], a[4:7], 0
    s_nop 0
    ds_read_b64_tr_b16 v[202:203], v167 offset:5376
    s_waitcnt vmcnt(5)
    v_mfma_f32_16x16x32_bf16 v[68:71], v[180:183], a[12:15], v[68:71]
    s_nop 0
    ds_read_b64_tr_b16 v[204:205], v167 offset:17152
    v_mfma_f32_16x16x32_bf16 v[72:75], v[184:187], a[0:3], 0
    ds_read_b64_tr_b16 v[206:207], v167 offset:17664
    v_mfma_f32_16x16x32_bf16 v[72:75], v[188:191], a[8:11], v[72:75]
    buffer_load_dwordx4 v16, s[36:39], s60 offen offset:1024 lds
    v_mfma_f32_16x16x32_bf16 v[76:79], v[184:187], a[4:7], 0
    s_waitcnt lgkmcnt(4)
    ds_read_b64_tr_b16 v[176:177], v161 offset:5888
    v_mfma_f32_16x16x32_bf16 v[76:79], v[188:191], a[12:15], v[76:79]
    s_nop 0
    ds_read_b64_tr_b16 v[178:179], v161 offset:6400
    v_mfma_f32_16x16x32_bf16 v[80:83], v[192:195], a[0:3], 0
    s_nop 0
    ds_read_b64_tr_b16 v[180:181], v161 offset:18176
    v_mfma_f32_16x16x32_bf16 v[80:83], v[196:199], a[8:11], v[80:83]
    buffer_load_dwordx4 v17, s[36:39], s60 offen offset:2048 lds
    v_mfma_f32_16x16x32_bf16 v[84:87], v[192:195], a[4:7], 0
    s_waitcnt lgkmcnt(3)
    ds_read_b64_tr_b16 v[182:183], v161 offset:18688
    ds_read_b64_tr_b16 v[184:185], v163 offset:5888
    v_mfma_f32_16x16x32_bf16 v[84:87], v[196:199], a[12:15], v[84:87]
    s_add_u32 m0, s69, 123648
    ds_read_b64_tr_b16 v[186:187], v163 offset:6400
    s_add_u32 s60, s73, 0
    v_mfma_f32_16x16x32_bf16 v[88:91], v[200:203], a[0:3], 0
    s_nop 0
    ds_read_b64_tr_b16 v[188:189], v163 offset:18176
    v_mfma_f32_16x16x32_bf16 v[88:91], v[204:207], a[8:11], v[88:91]
    s_waitcnt lgkmcnt(0)
    s_andn2_b32 s89, s100, s97
    s_cbranch_scc1 L_att_spin1
L_att_spin1r:
    v_mfma_f32_16x16x32_bf16 v[92:95], v[200:203], a[4:7], 0
    s_barrier
    ds_read_b64_tr_b16 v[190:191], v163 offset:18688
    ds_read_b64_tr_b16 v[192:193], v165 offset:5888
    v_mfma_f32_16x16x32_bf16 v[92:95], v[204:207], a[12:15], v[92:95]
    buffer_load_dwordx4 v15, s[36:39], s60 offen offset:0 lds
    v_mfma_f32_16x16x32_bf16 v[96:99], v[176:179], a[0:3], 0
    s_add_u32 s59, s75, 0
    ds_read_b64_tr_b16 v[194:195], v165 offset:6400
    ds_read_b64_tr_b16 v[196:197], v165 offset:18176
    v_mfma_f32_16x16x32_bf16 v[96:99], v[180:183], a[8:11], v[96:99]
    ds_read_b64_tr_b16 v[198:199], v165 offset:18688
    v_mfma_f32_16x16x32_bf16 v[100:103], v[176:179], a[4:7], 0
    s_waitcnt lgkmcnt(4)
    ds_read_b64_tr_b16 v[200:201], v167 offset:5888
    v_mfma_f32_16x16x32_bf16 v[100:103], v[180:183], a[12:15], v[100:103]
    buffer_load_dwordx4 a[32:35], v25, s[44:47], s59 offen offset:0 sc1
    v_mfma_f32_16x16x32_bf16 v[104:107], v[184:187], a[0:3], 0
    s_mov_b32 s89, 0x12345
    ds_read_b64_tr_b16 v[202:203], v167 offset:6400
    ds_read_b64_tr_b16 v[204:205], v167 offset:18176
    v_mfma_f32_16x16x32_bf16 v[104:107], v[188:191], a[8:11], v[104:107]
    s_nop 0
    ds_read_b64_tr_b16 v[206:207], v167 offset:18688
    v_mfma_f32_16x16x32_bf16 v[108:111], v[184:187], a[4:7], 0
    s_waitcnt lgkmcnt(4)
    ds_read_b64_tr_b16 v[176:177], v161 offset:6912
    v_mfma_f32_16x16x32_bf16 v[108:111], v[188:191], a[12:15], v[108:111]
    buffer_load_dwordx4 a[36:39], v25, s[44:47], s59 offen offset:1024 sc1
    v_mfma_f32_16x16x32_bf16 v[112:115], v[192:195], a[0:3], 0
    s_add_u32 s59, s75, 16384
    ds_read_b64_tr_b16 v[178:179], v161 offset:7424
    ds_read_b64_tr_b16 v[180:181], v161 offset:19200
    v_mfma_f32_16x16x32_bf16 v[112:115], v[196:199], a[8:11], v[112:115]
    s_nop 0
    ds_read_b64_tr_b16 v[182:183], v161 offset:19712
    v_mfma_f32_16x16x32_bf16 v[116:119], v[192:195], a[4:7], 0
    s_waitcnt lgkmcnt(4)
    ds_read_b64_tr_b16 v[184:185], v1 offset:768
    v_mfma_f32_16x16x32_bf16 v[116:119], v[196:199], a[12:15], v[116:119]
    buffer_load_dwordx4 a[40:43], v25, s[44:47], s59 offen offset:0 sc1
    v_mfma_f32_16x16x32_bf16 v[120:123], v[200:203], a[0:3], 0
    s_nop 0
    ds_read_b64_tr_b16 v[186:187], v1 offset:1280
    ds_read_b64_tr_b16 v[188:189], v1 offset:13056
    v_mfma_f32_16x16x32_bf16 v[120:123], v[204:207], a[8:11], v[120:123]
    ds_read_b64_tr_b16 v[190:191], v1 offset:13568
    v_mfma_f32_16x16x32_bf16 v[124:127], v[200:203], a[4:7], 0
    s_waitcnt lgkmcnt(4)
    ds_read_b64_tr_b16 v[192:193], v22 offset:768
    v_mfma_f32_16x16x32_bf16 v[124:127], v[204:207], a[12:15], v[124:127]
    buffer_load_dwordx4 a[44:47], v25, s[44:47], s59 offen offset:1024 sc1
    v_mfma_f32_16x16x32_bf16 v[128:131], v[176:179], a[0:3], 0
    s_add_u32 s59, s75, 32768
    ds_read_b64_tr_b16 v[194:195], v22 offset:1280
    ds_read_b64_tr_b16 v[196:197], v22 offset:13056
    v_mfma_f32_16x16x32_bf16 v[128:131], v[180:183], a[8:11], v[128:131]
    ds_read_b64_tr_b16 v[198:199], v22 offset:13568
    v_mfma_f32_16x16x32_bf16 v[132:135], v[176:179], a[4:7], 0
    s_waitcnt lgkmcnt(4)
    ds_read_b64_tr_b16 v[200:201], v23 offset:768
    v_mfma_f32_16x16x32_bf16 v[132:135], v[180:183], a[12:15], v[132:135]
    buffer_load_dwordx4 a[48:51], v25, s[44:47], s59 offen offset:0 sc1
    s_waitcnt vmcnt(12)
    v_mfma_f32_16x16x32_bf16 v[64:67], v[184:187], a[16:19], v[64:67]
    s_nop 0
    ds_read_b64_tr_b16 v[202:203], v23 offset:1280
    ds_read_b64_tr_b16 v[204:205], v23 offset:13056
    s_waitcnt vmcnt(10)
    v_mfma_f32_16x16x32_bf16 v[64:67], v[188:191], a[24:27], v[64:67]
    ds_read_b64_tr_b16 v[206:207], v23 offset:13568
    s_waitcnt vmcnt(9)
    v_mfma_f32_16x16x32_bf16 v[68:71], v[188:191], a[28:31], v[68:71]
    s_waitcnt lgkmcnt(4)
    ds_read_b64_tr_b16 v[176:177], v27 offset:768
    v_mfma_f32_16x16x32_bf16 v[68:71], v[184:187], a[20:23], v[68:71]
    buffer_load_dwordx4 a[52:55], v25, s[44:47], s59 offen offset:1024 sc1
    v_mfma_f32_16x16x32_bf16 v[72:75], v[192:195], a[16:19], v[72:75]
    s_barrier
    ds_read_b64_tr_b16 v[178:179], v27 offset:1280
    s_nop 0
    v_mfma_f32_16x16x32_bf16 v[72:75], v[196:199], a[24:27], v[72:75]
    s_add_u32 s59, s75, 49152
    ds_read_b64_tr_b16 v[180:181], v27 offset:13056
    ds_read_b64_tr_b16 v[182:183], v27 offset:13568
    v_mfma_f32_16x16x32_bf16 v[76:79], v[196:199], a[28:31], v[76:79]
    s_waitcnt lgkmcnt(4)
    s_nop 0
    ds_read_b64_tr_b16 v[184:185], v1 offset:1792
    v_mfma_f32_16x16x32_bf16 v[76:79], v[192:195], a[20:23], v[76:79]
    buffer_load_dwordx4 a[56:59], v25, s[44:47], s59 offen offset:0 sc1
    v_mfma_f32_16x16x32_bf16 v[80:83], v[200:203], a[16:19], v[80:83]
    s_mov_b32 s89, 0x12345
    ds_read_b64_tr_b16 v[186:187], v1 offset:2304
    ds_read_b64_tr_b16 v[188:189], v1 offset:14080
    v_mfma_f32_16x16x32_bf16 v[80:83], v[204:207], a[24:27], v[80:83]
    s_nop 0
    ds_read_b64_tr_b16 v[190:191], v1 offset:14592
    v_mfma_f32_16x16x32_bf16 v[84:87], v[204:207], a[28:31], v[84:87]
    s_waitcnt lgkmcnt(4)
    ds_read_b64_tr_b16 v[192:193], v22 offset:1792
L_att_pad6:
    s_cbranch_execz L_att_ret1
    s_nop 0
    v_mfma_f32_16x16x32_bf16 v[84:87], v[200:203], a[20:23], v[84:87]
    buffer_load_dwordx4 a[60:63], v25, s[44:47], s59 offen offset:1024 sc1
    v_mfma_f32_16x16x32_bf16 v[88:91], v[176:179], a[16:19], v[88:91]
    s_mov_b32 s89, 0x12345
    ds_read_b64_tr_b16 v[194:195], v22 offset:2304
    ds_read_b64_tr_b16 v[196:197], v22 offset:14080
    v_mfma_f32_16x16x32_bf16 v[88:91], v[180:183], a[24:27], v[88:91]
    ds_read_b64_tr_b16 v[198:199], v22 offset:14592
    v_mfma_f32_16x16x32_bf16 v[92:95], v[180:183], a[28:31], v[92:95]
    s_waitcnt lgkmcnt(4)
    ds_read_b64_tr_b16 v[200:201], v23 offset:1792
    v_mfma_f32_16x16x32_bf16 v[92:95], v[176:179], a[20:23], v[92:95]
    buffer_load_dwordx4 v16, s[36:39], s60 offen offset:1024 lds
    v_mfma_f32_16x16x32_bf16 v[96:99], v[184:187], a[16:19], v[96:99]
    s_add_u32 s59, s76, 0
    ds_read_b64_tr_b16 v[202:203], v23 offset:2304
    ds_read_b64_tr_b16 v[204:205], v23 offset:14080
    v_mfma_f32_16x16x32_bf16 v[96:99], v[188:191], a[24:27], v[96:99]
    s_nop 0
    ds_read_b64_tr_b16 v[206:207], v23 offset:14592
    v_mfma_f32_16x16x32_bf16 v[100:103], v[188:191], a[28:31], v[100:103]
    s_waitcnt lgkmcnt(4)
    ds_read_b64_tr_b16 v[176:177], v27 offset:1792
    v_mfma_f32_16x16x32_bf16 v[100:103], v[184:187], a[20:23], v[100:103]
    buffer_load_dwordx4 a[64:67], v25, s[44:47], s59 offen offset:0 sc1
    v_mfma_f32_16x16x32_bf16 v[104:107], v[192:195], a[16:19], v[104:107]
    s_mov_b32 s89, 0x12345
    ds_read_b64_tr_b16 v[178:179], v27 offset:2304
    ds_read_b64_tr_b16 v[180:181], v27 offset:14080
    v_mfma_f32_16x16x32_bf16 v[104:107], v[196:199], a[24:27], v[104:107]
    s_nop 0
    ds_read_b64_tr_b16 v[182:183], v27 offset:14592
    v_mfma_f32_16x16x32_bf16 v[108:111], v[196:199], a[28:31], v[108:111]
    s_waitcnt lgkmcnt(4)
    ds_read_b64_tr_b16 v[184:185], v1 offset:2816
    v_mfma_f32_16x16x32_bf16 v[108:111], v[192:195], a[20:23], v[108:111]
    buffer_load_dwordx4 a[68:71], v25, s[44:47], s59 offen offset:1024 sc1
    v_mfma_f32_16x16x32_bf16 v[112:115], v[200:203], a[16:19], v[112:115]
    s_mov_b32 s89, 0x12345
    ds_read_b64_tr_b16 v[186:187], v1 offset:3328
    ds_read_b64_tr_b16 v[188:189], v1 offset:15104
    v_mfma_f32_16x16x32_bf16 v[112:115], v[204:207], a[24:27], v[112:115]
    s_nop 0
    ds_read_b64_tr_b16 v[190:191], v1 offset:15616
    v_mfma_f32_16x16x32_bf16 v[116:119], v[204:207], a[28:31], v[116:119]
    s_waitcnt lgkmcnt(4)
    ds_read_b64_tr_b16 v[192:193], v1 offset:25344
    v_mfma_f32_16x16x32_bf16 v[116:119], v[200:203], a[20:23], v[116:119]
    buffer_load_dwordx4 v17, s[36:39], s60 offen offset:2048 lds
    v_mfma_f32_16x16x32_bf16 v[120:123], v[176:179], a[16:19], v[120:123]
    s_add_u32 s59, s76, 16384
    ds_read_b64_tr_b16 v[194:195], v1 offset:25856
    ds_read_b64_tr_b16 v[196:197], v1 offset:62208
    v_mfma_f32_16x16x32_bf16 v[120:123], v[180:183], a[24:27], v[120:123]
    s_add_u32 m0, s69, 135936
    ds_read_b64_tr_b16 v[198:199], v1 offset:62720
    s_add_u32 s60, s73, 41472
    v_mfma_f32_16x16x32_bf16 v[124:127], v[180:183], a[28:31], v[124:127]
    s_waitcnt lgkmcnt(4)
    s_nop 0
    ds_read_b64_tr_b16 v[200:201], v22 offset:25344
    v_mfma_f32_16x16x32_bf16 v[124:127], v[176:179], a[20:23], v[124:127]
    buffer_load_dwordx4 a[72:75], v25, s[44:47], s59 offen offset:0 sc1
    v_mfma_f32_16x16x32_bf16 v[128:131], v[184:187], a[16:19], v[128:131]
    s_cbranch_vccz L_skip9
    s_mov_b32 s97, 0
    s_atomic_add s97, s[92:93], 0x100 glc
L_skip9:
    ds_read_b64_tr_b16 v[202:203], v22 offset:25856
    v_mfma_f32_16x16x32_bf16 v[128:131], v[188:191], a[24:27], v[128:131]
    s_mov_b32 s89, 0x12345
    ds_read_b64_tr_b16 v[204:205], v22 offset:62208
    ds_read_b64_tr_b16 v[206:207], v22 offset:62720
    v_mfma_f32_16x16x32_bf16 v[132:135], v[188:191], a[28:31], v[132:135]
    s_waitcnt lgkmcnt(4)
    ds_read_b64_tr_b16 v[176:177], v23 offset:25344
    v_mfma_f32_16x16x32_bf16 v[132:135], v[184:187], a[20:23], v[132:135]
    buffer_load_dwordx4 a[76:79], v25, s[44:47], s59 offen offset:1024 sc1
    s_waitcnt vmcnt(13)
    v_mfma_f32_16x16x32_bf16 v[64:67], v[192:195], a[32:35], v[64:67]
    s_nop 0
    ds_read_b64_tr_b16 v[178:179], v23 offset:25856
    ds_read_b64_tr_b16 v[180:181], v23 offset:62208
    s_waitcnt vmcnt(11)
    v_mfma_f32_16x16x32_bf16 v[64:67], v[196:199], a[40:43], v[64:67]
    ds_read_b64_tr_b16 v[182:183], v23 offset:62720
    s_waitcnt vmcnt(10)
    v_mfma_f32_16x16x32_bf16 v[68:71], v[196:199], a[44:47], v[68:71]
    s_waitcnt lgkmcnt(4)
    ds_read_b64_tr_b16 v[184:185], v27 offset:25344
    v_mfma_f32_16x16x32_bf16 v[68:71], v[192:195], a[36:39], v[68:71]
    buffer_load_dwordx4 v15, s[36:39], s60 offen offset:0 lds
    v_mfma_f32_16x16x32_bf16 v[72:75], v[200:203], a[32:35], v[72:75]
    s_nop 0
    s_barrier
    ds_read_b64_tr_b16 v[186:187], v27 offset:25856
    v_mfma_f32_16x16x32_bf16 v[72:75], v[204:207], a[40:43], v[72:75]
    s_add_u32 s59, s76, 32768
    ds_read_b64_tr_b16 v[188:189], v27 offset:62208
    ds_read_b64_tr_b16 v[190:191], v27 offset:62720
    v_mfma_f32_16x16x32_bf16 v[76:79], v[204:207], a[44:47], v[76:79]
    s_waitcnt lgkmcnt(4)
    s_nop 0
    ds_read_b64_tr_b16 v[192:193], v1 offset:26368
    v_mfma_f32_16x16x32_bf16 v[76:79], v[200:203], a[36:39], v[76:79]
    buffer_load_dwordx4 a[80:83], v25, s[44:47], s59 offen offset:0 sc1
    v_mfma_f32_16x16x32_bf16 v[80:83], v[176:179], a[32:35], v[80:83]
    s_mov_b32 s89, 0x12345
    ds_read_b64_tr_b16 v[194:195], v1 offset:26880
    ds_read_b64_tr_b16 v[196:197], v1 offset:63232
    v_mfma_f32_16x16x32_bf16 v[80:83], v[180:183], a[40:43], v[80:83]
    s_nop 0
    ds_read_b64_tr_b16 v[198:199], v1 offset:63744
    v_mfma_f32_16x16x32_bf16 v[84:87], v[180:183], a[44:47], v[84:87]
    s_waitcnt lgkmcnt(4)
    ds_read_b64_tr_b16 v[200:201], v22 offset:26368
    v_mfma_f32_16x16x32_bf16 v[84:87], v[176:179], a[36:39], v[84:87]
    buffer_load_dwordx4 a[84:87], v25, s[44:47], s59 offen offset:1024 sc1
    v_mfma_f32_16x16x32_bf16 v[88:91], v[184:187], a[32:35], v[88:91]
    s_mov_b32 s89, 0x12345
    ds_read_b64_tr_b16 v[202:203], v22 offset:26880
    ds_read_b64_tr_b16 v[204:205], v22 offset:63232
    v_mfma_f32_16x16x32_bf16 v[88:91], v[188:191], a[40:43], v[88:91]
    s_nop 0
    ds_read_b64_tr_b16 v[206:207], v22 offset:63744
    v_mfma_f32_16x16x32_bf16 v[92:95], v[188:191], a[44:47], v[92:95]
    s_waitcnt lgkmcnt(4)
    ds_read_b64_tr_b16 v[176:177], v23 offset:26368
    v_mfma_f32_16x16x32_bf16 v[92:95], v[184:187], a[36:39], v[92:95]
    buffer_load_dwordx4 v16, s[36:39], s60 offen offset:1024 lds
    v_mfma_f32_16x16x32_bf16 v[96:99], v[192:195], a[32:35], v[96:99]
    s_add_u32 s59, s76, 49152
    ds_read_b64_tr_b16 v[178:179], v23 offset:26880
    ds_read_b64_tr_b16 v[180:181], v23 offset:63232
    v_mfma_f32_16x16x32_bf16 v[96:99], v[196:199], a[40:43], v[96:99]
    s_nop 0
    ds_read_b64_tr_b16 v[182:183], v23 offset:63744
    v_mfma_f32_16x16x32_bf16 v[100:103], v[196:199], a[44:47], v[100:103]
    s_waitcnt lgkmcnt(4)
    ds_read_b64_tr_b16 v[184:185], v27 offset:26368
    v_mfma_f32_16x16x32_bf16 v[100:103], v[192:195], a[36:39], v[100:103]
    buffer_load_dwordx4 a[88:91], v25, s[44:47], s59 offen offset:0 sc1
    v_mfma_f32_16x16x32_bf16 v[104:107], v[200:203], a[32:35], v[104:107]
    s_mov_b32 s89, 0x12345
    ds_read_b64_tr_b16 v[186:187], v27 offset:26880
    ds_read_b64_tr_b16 v[188:189], v27 offset:63232
    v_mfma_f32_16x16x32_bf16 v[104:107], v[204:207], a[40:43], v[104:107]
    s_nop 0
    ds_read_b64_tr_b16 v[190:191], v27 offset:63744
    v_mfma_f32_16x16x32_bf16 v[108:111], v[204:207], a[44:47], v[108:111]
    s_waitcnt lgkmcnt(4)
    ds_read_b64_tr_b16 v[192:193], v1 offset:27392
    v_mfma_f32_16x16x32_bf16 v[108:111], v[200:203], a[36:39], v[108:111]
    buffer_load_dwordx4 a[92:95], v25, s[44:47], s59 offen offset:1024 sc1
    v_mfma_f32_16x16x32_bf16 v[112:115], v[176:179], a[32:35], v[112:115]
    s_mov_b32 s89, 0x12345
    ds_read_b64_tr_b16 v[194:195], v1 offset:27904
    ds_read_b64_tr_b16 v[196:197], v1 offset:64256
    v_mfma_f32_16x16x32_bf16 v[112:115], v[180:183], a[40:43], v[112:115]
    ds_read_b64_tr_b16 v[198:199], v1 offset:64768
    v_mfma_f32_16x16x32_bf16 v[116:119], v[180:183], a[44:47], v[116:119]
    s_waitcnt lgkmcnt(4)
    ds_read_b64_tr_b16 v[200:201], v160 offset:8960
    v_mfma_f32_16x16x32_bf16 v[116:119], v[176:179], a[36:39], v[116:119]
    buffer_load_dwordx4 v17, s[36:39], s60 offen offset:2048 lds
    v_mfma_f32_16x16x32_bf16 v[120:123], v[184:187], a[32:35], v[120:123]
    s_add_u32 s59, s77, 0
    ds_read_b64_tr_b16 v[202:203], v160 offset:9472
    ds_read_b64_tr_b16 v[204:205], v160 offset:21248
    v_mfma_f32_16x16x32_bf16 v[120:123], v[188:191], a[40:43], v[120:123]
    s_add_u32 m0, s69, 148224
    ds_read_b64_tr_b16 v[206:207], v160 offset:21760
    s_add_u32 s60, s73, 82944
    v_mfma_f32_16x16x32_bf16 v[124:127], v[188:191], a[44:47], v[124:127]
    s_waitcnt lgkmcnt(4)
    ds_read_b64_tr_b16 v[176:177], v162 offset:8960
    s_nop 0
    v_mfma_f32_16x16x32_bf16 v[124:127], v[184:187], a[36:39], v[124:127]
    buffer_load_dwordx4 a[96:99], v25, s[44:47], s59 offen offset:0 sc1
    v_mfma_f32_16x16x32_bf16 v[128:131], v[192:195], a[32:35], v[128:131]
    s_mov_b32 s89, 0x12345
    ds_read_b64_tr_b16 v[178:179], v162 offset:9472
    ds_read_b64_tr_b16 v[180:181], v162 offset:21248
    v_mfma_f32_16x16x32_bf16 v[128:131], v[196:199], a[40:43], v[128:131]
    s_nop 0
    ds_read_b64_tr_b16 v[182:183], v162 offset:21760
    v_mfma_f32_16x16x32_bf16 v[132:135], v[196:199], a[44:47], v[132:135]
    s_waitcnt lgkmcnt(4)
    ds_read_b64_tr_b16 v[184:185], v164 offset:8960
    v_mfma_f32_16x16x32_bf16 v[132:135], v[192:195], a[36:39], v[132:135]
    buffer_load_dwordx4 a[100:103], v25, s[44:47], s59 offen offset:1024 sc1
    s_waitcnt vmcnt(18)
    v_mfma_f32_16x16x32_bf16 v[64:67], v[200:203], a[48:51], v[64:67]
    s_nop 0
    ds_read_b64_tr_b16 v[186:187], v164 offset:9472
    ds_read_b64_tr_b16 v[188:189], v164 offset:21248
    s_waitcnt vmcnt(16)
    v_mfma_f32_16x16x32_bf16 v[64:67], v[204:207], a[56:59], v[64:67]
    s_nop 0
    ds_read_b64_tr_b16 v[190:191], v164 offset:21760
    s_waitcnt vmcnt(15)
    v_mfma_f32_16x16x32_bf16 v[68:71], v[204:207], a[60:63], v[68:71]
    s_waitcnt lgkmcnt(4)
    ds_read_b64_tr_b16 v[192:193], v166 offset:8960
    v_mfma_f32_16x16x32_bf16 v[68:71], v[200:203], a[52:55], v[68:71]
    s_waitcnt lgkmcnt(0)
    s_andn2_b32 s89, s99, s97
    s_cbranch_scc1 L_att_spin2
L_att_spin2r:
    v_mfma_f32_16x16x32_bf16 v[72:75], v[176:179], a[48:51], v[72:75]
    s_barrier
    ds_read_b64_tr_b16 v[194:195], v166 offset:9472
    v_mfma_f32_16x16x32_bf16 v[72:75], v[180:183], a[56:59], v[72:75]
    buffer_load_dwordx4 v15, s[36:39], s60 offen offset:0 lds
    ds_read_b64_tr_b16 v[196:197], v166 offset:21248
    v_mfma_f32_16x16x32_bf16 v[76:79], v[180:183], a[60:63], v[76:79]
    ds_read_b64_tr_b16 v[198:199], v166 offset:21760
    ds_read_b64_tr_b16 v[200:201], v160 offset:9984
    v_mfma_f32_16x16x32_bf16 v[76:79], v[176:179], a[52:55], v[76:79]
    s_add_u32 s59, s77, 16384
    ds_read_b64_tr_b16 v[202:203], v160 offset:10496
    s_add_u32 s66, s0, 0
    v_mfma_f32_16x16x32_bf16 v[80:83], v[184:187], a[48:51], v[80:83]
    ds_read_b64_tr_b16 v[204:205], v160 offset:22272
    v_mfma_f32_16x16x32_bf16 v[80:83], v[188:191], a[56:59], v[80:83]
    buffer_load_dwordx4 a[104:107], v25, s[44:47], s59 offen offset:0 sc1
    v_mfma_f32_16x16x32_bf16 v[84:87], v[188:191], a[60:63], v[84:87]
    s_waitcnt lgkmcnt(3)
    ds_read_b64_tr_b16 v[206:207], v160 offset:22784
    ds_read_b64_tr_b16 v[176:177], v162 offset:9984
    v_mfma_f32_16x16x32_bf16 v[84:87], v[184:187], a[52:55], v[84:87]
    ds_read_b64_tr_b16 v[178:179], v162 offset:10496
    v_mfma_f32_16x16x32_bf16 v[88:91], v[192:195], a[48:51], v[88:91]
    ds_read_b64_tr_b16 v[180:181], v162 offset:22272
    v_mfma_f32_16x16x32_bf16 v[88:91], v[196:199], a[56:59], v[88:91]
    buffer_load_dwordx4 a[108:111], v25, s[44:47], s59 offen offset:1024 sc1
    v_mfma_f32_16x16x32_bf16 v[92:95], v[196:199], a[60:63], v[92:95]
    s_waitcnt lgkmcnt(3)
    ds_read_b64_tr_b16 v[182:183], v162 offset:22784
    ds_read_b64_tr_b16 v[184:185], v164 offset:9984
    v_mfma_f32_16x16x32_bf16 v[92:95], v[192:195], a[52:55], v[92:95]
    s_add_u32 s59, s77, 32768
    ds_read_b64_tr_b16 v[186:187], v164 offset:10496
    v_mfma_f32_16x16x32_bf16 v[96:99], v[200:203], a[48:51], v[96:99]
    ds_read_b64_tr_b16 v[188:189], v164 offset:22272
    v_mfma_f32_16x16x32_bf16 v[96:99], v[204:207], a[56:59], v[96:99]
    buffer_load_dwordx4 a[112:115], v25, s[44:47], s59 offen offset:0 sc1
    v_mfma_f32_16x16x32_bf16 v[100:103], v[204:207], a[60:63], v[100:103]
    s_waitcnt lgkmcnt(3)
    ds_read_b64_tr_b16 v[190:191], v164 offset:22784
    ds_read_b64_tr_b16 v[192:193], v166 offset:9984
    v_mfma_f32_16x16x32_bf16 v[100:103], v[200:203], a[52:55], v[100:103]
    ds_read_b64_tr_b16 v[194:195], v166 offset:10496
    v_mfma_f32_16x16x32_bf16 v[104:107], v[176:179], a[48:51], v[104:107]
    ds_read_b64_tr_b16 v[196:197], v166 offset:22272
    v_mfma_f32_16x16x32_bf16 v[104:107], v[180:183], a[56:59], v[104:107]
    buffer_load_dwordx4 a[116:119], v25, s[44:47], s59 offen offset:1024 sc1
    v_mfma_f32_16x16x32_bf16 v[108:111], v[180:183], a[60:63], v[108:111]
    s_waitcnt lgkmcnt(3)
    ds_read_b64_tr_b16 v[198:199], v166 offset:22784
    ds_read_b64_tr_b16 v[200:201], v160 offset:11008
    v_mfma_f32_16x16x32_bf16 v[108:111], v[176:179], a[52:55], v[108:111]
    s_nop 0
    ds_read_b64_tr_b16 v[202:203], v160 offset:11520
    s_nop 0
    v_mfma_f32_16x16x32_bf16 v[112:115], v[184:187], a[48:51], v[112:115]
    s_nop 0
    ds_read_b64_tr_b16 v[204:205], v160 offset:23296
    s_nop 0
    v_mfma_f32_16x16x32_bf16 v[112:115], v[188:191], a[56:59], v[112:115]
    buffer_load_dwordx4 v16, s[36:39], s60 offen offset:1024 lds
    v_mfma_f32_16x16x32_bf16 v[116:119], v[188:191], a[60:63], v[116:119]
    s_waitcnt lgkmcnt(3)
    ds_read_b64_tr_b16 v[206:207], v160 offset:23808
    ds_read_b64_tr_b16 v[176:177], v1 offset:37632
    v_mfma_f32_16x16x32_bf16 v[116:119], v[184:187], a[52:55], v[116:119]
    s_add_u32 s59, s77, 49152
    ds_read_b64_tr_b16 v[178:179], v1 offset:38144
    v_mfma_f32_16x16x32_bf16 v[120:123], v[192:195], a[48:51], v[120:123]
    s_nop 0
    ds_read_b64_tr_b16 v[180:181], v1 offset:49920
    v_mfma_f32_16x16x32_bf16 v[120:123], v[196:199], a[56:59], v[120:123]
    buffer_load_dwordx4 a[120:123], v25, s[44:47], s59 offen offset:0 sc1
    v_mfma_f32_16x16x32_bf16 v[124:127], v[196:199], a[60:63], v[124:127]
    s_waitcnt lgkmcnt(3)
    ds_read_b64_tr_b16 v[182:183], v1 offset:50432
    ds_read_b64_tr_b16 v[184:185], v22 offset:37632
    v_mfma_f32_16x16x32_bf16 v[124:127], v[192:195], a[52:55], v[124:127]
    ds_read_b64_tr_b16 v[186:187], v22 offset:38144
    v_mfma_f32_16x16x32_bf16 v[128:131], v[200:203], a[48:51], v[128:131]
    ds_read_b64_tr_b16 v[188:189], v22 offset:49920
    v_mfma_f32_16x16x32_bf16 v[128:131], v[204:207], a[56:59], v[128:131]
    buffer_load_dwordx4 a[124:127], v25, s[44:47], s59 offen offset:1024 sc1
    v_mfma_f32_16x16x32_bf16 v[132:135], v[204:207], a[60:63], v[132:135]
    s_waitcnt lgkmcnt(3)
    ds_read_b64_tr_b16 v[190:191], v22 offset:50432
    ds_read_b64_tr_b16 v[192:193], v23 offset:37632
    v_mfma_f32_16x16x32_bf16 v[132:135], v[200:203], a[52:55], v[132:135]
    s_nop 0
    ds_read_b64_tr_b16 v[194:195], v23 offset:38144
    s_waitcnt vmcnt(21)
    v_mfma_f32_16x16x32_bf16 v[64:67], v[176:179], a[64:67], v[64:67]
    ds_read_b64_tr_b16 v[196:197], v23 offset:49920
    s_waitcnt vmcnt(18)
    v_mfma_f32_16x16x32_bf16 v[64:67], v[180:183], a[72:75], v[64:67]
    buffer_load_dwordx4 v17, s[36:39], s60 offen offset:2048 lds
    s_waitcnt vmcnt(18)
    v_mfma_f32_16x16x32_bf16 v[68:71], v[180:183], a[76:79], v[68:71]
    s_waitcnt lgkmcnt(3)
    ds_read_b64_tr_b16 v[198:199], v23 offset:50432
    ds_read_b64_tr_b16 v[200:201], v27 offset:37632
    v_mfma_f32_16x16x32_bf16 v[68:71], v[176:179], a[68:71], v[68:71]
    s_add_u32 m0, s69, 768
    ds_read_b64_tr_b16 v[202:203], v27 offset:38144
    s_add_u32 s60, s73, 124416
    v_mfma_f32_16x16x32_bf16 v[72:75], v[184:187], a[64:67], v[72:75]
    s_barrier
    s_nop 0
    ds_read_b64_tr_b16 v[204:205], v27 offset:49920
    v_mfma_f32_16x16x32_bf16 v[72:75], v[188:191], a[72:75], v[72:75]
    buffer_load_dwordx2 a[128:129], v29, s[44:47], s7 offen offset:0 sc1
    v_mfma_f32_16x16x32_bf16 v[76:79], v[188:191], a[76:79], v[76:79]
    s_waitcnt lgkmcnt(3)
    ds_read_b64_tr_b16 v[206:207], v27 offset:50432
    ds_read_b64_tr_b16 v[176:177], v1 offset:38656
    v_mfma_f32_16x16x32_bf16 v[76:79], v[184:187], a[68:71], v[76:79]
    s_nop 0
    ds_read_b64_tr_b16 v[178:179], v1 offset:39168
    v_mfma_f32_16x16x32_bf16 v[80:83], v[192:195], a[64:67], v[80:83]
    s_nop 0
    ds_read_b64_tr_b16 v[180:181], v1 offset:50944
    v_mfma_f32_16x16x32_bf16 v[80:83], v[196:199], a[72:75], v[80:83]
    buffer_load_dwordx2 a[130:131], v29, s[44:47], s7 offen offset:128 sc1
    v_mfma_f32_16x16x32_bf16 v[84:87], v[196:199], a[76:79], v[84:87]
    s_waitcnt lgkmcnt(3)
    ds_read_b64_tr_b16 v[182:183], v1 offset:51456
    ds_read_b64_tr_b16 v[184:185], v22 offset:38656
    v_mfma_f32_16x16x32_bf16 v[84:87], v[192:195], a[68:71], v[84:87]
    ds_read_b64_tr_b16 v[186:187], v22 offset:39168
    v_mfma_f32_16x16x32_bf16 v[88:91], v[200:203], a[64:67], v[88:91]
    ds_read_b64_tr_b16 v[188:189], v22 offset:50944
    v_mfma_f32_16x16x32_bf16 v[88:91], v[204:207], a[72:75], v[88:91]
    buffer_load_dwordx4 v15, s[36:39], s60 offen offset:0 lds
    v_mfma_f32_16x16x32_bf16 v[92:95], v[204:207], a[76:79], v[92:95]
    s_waitcnt lgkmcnt(3)
    ds_read_b64_tr_b16 v[190:191], v22 offset:51456
    ds_read_b64_tr_b16 v[192:193], v23 offset:38656
    v_mfma_f32_16x16x32_bf16 v[92:95], v[200:203], a[68:71], v[92:95]
    s_nop 0
    ds_read_b64_tr_b16 v[194:195], v23 offset:39168
    v_mfma_f32_16x16x32_bf16 v[96:99], v[176:179], a[64:67], v[96:99]
    s_nop 0
    ds_read_b64_tr_b16 v[196:197], v23 offset:50944
    v_mfma_f32_16x16x32_bf16 v[96:99], v[180:183], a[72:75], v[96:99]
    buffer_load_dwordx2 a[132:133], v29, s[44:47], s7 offen offset:2048 sc1
    v_mfma_f32_16x16x32_bf16 v[100:103], v[180:183], a[76:79], v[100:103]
    s_waitcnt lgkmcnt(3)
    ds_read_b64_tr_b16 v[198:199], v23 offset:51456
    ds_read_b64_tr_b16 v[200:201], v27 offset:38656
    v_mfma_f32_16x16x32_bf16 v[100:103], v[176:179], a[68:71], v[100:103]
    ds_read_b64_tr_b16 v[202:203], v27 offset:39168
    v_mfma_f32_16x16x32_bf16 v[104:107], v[184:187], a[64:67], v[104:107]
    ds_read_b64_tr_b16 v[204:205], v27 offset:50944
    v_mfma_f32_16x16x32_bf16 v[104:107], v[188:191], a[72:75], v[104:107]
    buffer_load_dwordx2 a[134:135], v29, s[44:47], s7 offen offset:2176 sc1
    v_mfma_f32_16x16x32_bf16 v[108:111], v[188:191], a[76:79], v[108:111]
    s_waitcnt lgkmcnt(3)
    ds_read_b64_tr_b16 v[206:207], v27 offset:51456
    ds_read_b64_tr_b16 v[176:177], v1 offset:39680
    v_mfma_f32_16x16x32_bf16 v[108:111], v[184:187], a[68:71], v[108:111]
    s_nop 0
    ds_read_b64_tr_b16 v[178:179], v1 offset:40192
    v_mfma_f32_16x16x32_bf16 v[112:115], v[192:195], a[64:67], v[112:115]
    s_nop 0
    ds_read_b64_tr_b16 v[180:181], v1 offset:51968
    v_mfma_f32_16x16x32_bf16 v[112:115], v[196:199], a[72:75], v[112:115]
    buffer_load_dwordx4 v16, s[36:39], s60 offen offset:1024 lds
    v_mfma_f32_16x16x32_bf16 v[116:119], v[196:199], a[76:79], v[116:119]
    s_waitcnt lgkmcnt(3)
    ds_read_b64_tr_b16 v[182:183], v1 offset:52480
    ds_read_b64_tr_b16 v[184:185], v160 offset:33536
    v_mfma_f32_16x16x32_bf16 v[116:119], v[192:195], a[68:71], v[116:119]
    ds_read_b64_tr_b16 v[186:187], v160 offset:34048
    v_mfma_f32_16x16x32_bf16 v[120:123], v[200:203], a[64:67], v[120:123]
    ds_read_b64_tr_b16 v[188:189], v160 offset:45824
    v_mfma_f32_16x16x32_bf16 v[120:123], v[204:207], a[72:75], v[120:123]
    buffer_load_dwordx2 a[136:137], v29, s[44:47], s7 offen offset:1024 sc1
    v_mfma_f32_16x16x32_bf16 v[124:127], v[204:207], a[76:79], v[124:127]
    s_waitcnt lgkmcnt(3)
    ds_read_b64_tr_b16 v[190:191], v160 offset:46336
    ds_read_b64_tr_b16 v[192:193], v162 offset:33536
    v_mfma_f32_16x16x32_bf16 v[124:127], v[200:203], a[68:71], v[124:127]
    s_nop 0
    ds_read_b64_tr_b16 v[194:195], v162 offset:34048
    v_mfma_f32_16x16x32_bf16 v[128:131], v[176:179], a[64:67], v[128:131]
    s_cbranch_vccz L_skip10
    s_mov_b32 s97, 0
    s_atomic_add s97, s[92:93], 0x300 glc
L_skip10:
    ds_read_b64_tr_b16 v[196:197], v162 offset:45824
    v_mfma_f32_16x16x32_bf16 v[128:131], v[180:183], a[72:75], v[128:131]
    buffer_load_dwordx2 a[138:139], v29, s[44:47], s7 offen offset:1152 sc1
    v_mfma_f32_16x16x32_bf16 v[132:135], v[180:183], a[76:79], v[132:135]
    s_waitcnt lgkmcnt(3)
    ds_read_b64_tr_b16 v[198:199], v162 offset:46336
    ds_read_b64_tr_b16 v[200:201], v164 offset:33536
    v_mfma_f32_16x16x32_bf16 v[132:135], v[176:179], a[68:71], v[132:135]
    s_nop 0
    ds_read_b64_tr_b16 v[202:203], v164 offset:34048
    s_waitcnt vmcnt(24)
    v_mfma_f32_16x16x32_bf16 v[64:67], v[184:187], a[80:83], v[64:67]
    ds_read_b64_tr_b16 v[204:205], v164 offset:45824
    s_waitcnt vmcnt(21)
    v_mfma_f32_16x16x32_bf16 v[64:67], v[188:191], a[88:91], v[64:67]
    buffer_load_dwordx4 v17, s[36:39], s60 offen offset:2048 lds
    s_waitcnt vmcnt(21)
    v_mfma_f32_16x16x32_bf16 v[68:71], v[188:191], a[92:95], v[68:71]
    s_waitcnt lgkmcnt(3)
    ds_read_b64_tr_b16 v[206:207], v164 offset:46336
    ds_read_b64_tr_b16 v[176:177], v166 offset:33536
    v_mfma_f32_16x16x32_bf16 v[68:71], v[184:187], a[84:87], v[68:71]
    s_add_u32 m0, s69, 13056
    ds_read_b64_tr_b16 v[178:179], v166 offset:34048
    s_add_u32 s60, s64, 0
    v_mfma_f32_16x16x32_bf16 v[72:75], v[192:195], a[80:83], v[72:75]
    s_waitcnt vmcnt(20)
    s_barrier
    ds_read_b64_tr_b16 v[180:181], v166 offset:45824
    v_mfma_f32_16x16x32_bf16 v[72:75], v[196:199], a[88:91], v[72:75]
    buffer_load_dwordx2 a[140:141], v29, s[44:47], s7 offen offset:3072 sc1
    v_mfma_f32_16x16x32_bf16 v[76:79], v[196:199], a[92:95], v[76:79]
    s_waitcnt lgkmcnt(3)
    ds_read_b64_tr_b16 v[182:183], v166 offset:46336
    ds_read_b64_tr_b16 v[184:185], v160 offset:34560
    v_mfma_f32_16x16x32_bf16 v[76:79], v[192:195], a[84:87], v[76:79]
    ds_read_b64_tr_b16 v[186:187], v160 offset:35072
    v_mfma_f32_16x16x32_bf16 v[80:83], v[200:203], a[80:83], v[80:83]
    ds_read_b64_tr_b16 v[188:189], v160 offset:46848
    v_mfma_f32_16x16x32_bf16 v[80:83], v[204:207], a[88:91], v[80:83]
    buffer_load_dwordx2 a[142:143], v29, s[44:47], s7 offen offset:3200 sc1
    v_mfma_f32_16x16x32_bf16 v[84:87], v[204:207], a[92:95], v[84:87]
    s_waitcnt lgkmcnt(3)
    ds_read_b64_tr_b16 v[190:191], v160 offset:47360
    ds_read_b64_tr_b16 v[192:193], v162 offset:34560
    v_mfma_f32_16x16x32_bf16 v[84:87], v[200:203], a[84:87], v[84:87]
    ds_read_b64_tr_b16 v[194:195], v162 offset:35072
    v_mfma_f32_16x16x32_bf16 v[88:91], v[176:179], a[80:83], v[88:91]
    ds_read_b64_tr_b16 v[196:197], v162 offset:46848
    v_mfma_f32_16x16x32_bf16 v[88:91], v[180:183], a[88:91], v[88:91]
    buffer_load_dwordx4 v18, s[36:39], s60 offen offset:0 lds
    v_mfma_f32_16x16x32_bf16 v[92:95], v[180:183], a[92:95], v[92:95]
    s_waitcnt lgkmcnt(3)
    ds_read_b64_tr_b16 v[198:199], v162 offset:47360
    ds_read_b64_tr_b16 v[200:201], v164 offset:34560
    v_mfma_f32_16x16x32_bf16 v[92:95], v[176:179], a[84:87], v[92:95]
    ds_read_b64_tr_b16 v[202:203], v164 offset:35072
    v_mfma_f32_16x16x32_bf16 v[96:99], v[184:187], a[80:83], v[96:99]
    ds_read_b64_tr_b16 v[204:205], v164 offset:46848
    v_mfma_f32_16x16x32_bf16 v[96:99], v[188:191], a[88:91], v[96:99]
    buffer_load_dwordx4 v19, s[36:39], s60 offen offset:1024 lds
    v_mfma_f32_16x16x32_bf16 v[100:103], v[188:191], a[92:95], v[100:103]
    s_waitcnt lgkmcnt(3)
    ds_read_b64_tr_b16 v[206:207], v164 offset:47360
    ds_read_b64_tr_b16 v[176:177], v166 offset:34560
    v_mfma_f32_16x16x32_bf16 v[100:103], v[184:187], a[84:87], v[100:103]
    s_nop 0
    ds_read_b64_tr_b16 v[178:179], v166 offset:35072
    v_mfma_f32_16x16x32_bf16 v[104:107], v[192:195], a[80:83], v[104:107]
    s_nop 0
    ds_read_b64_tr_b16 v[180:181], v166 offset:46848
    v_mfma_f32_16x16x32_bf16 v[104:107], v[196:199], a[88:91], v[104:107]
    buffer_load_dwordx4 v20, s[36:39], s60 offen offset:2048 lds
    v_mfma_f32_16x16x32_bf16 v[108:111], v[196:199], a[92:95], v[108:111]
    s_waitcnt lgkmcnt(3)
    ds_read_b64_tr_b16 v[182:183], v166 offset:47360
    ds_read_b64_tr_b16 v[184:185], v160 offset:35584
    v_mfma_f32_16x16x32_bf16 v[108:111], v[192:195], a[84:87], v[108:111]
    s_add_u32 m0, s69, 25344
    ds_read_b64_tr_b16 v[186:187], v160 offset:36096
    s_add_u32 s60, s64, 331776
    v_mfma_f32_16x16x32_bf16 v[112:115], v[200:203], a[80:83], v[112:115]
    s_nop 0
    ds_read_b64_tr_b16 v[188:189], v160 offset:47872
    v_mfma_f32_16x16x32_bf16 v[112:115], v[204:207], a[88:91], v[112:115]
    buffer_load_dwordx4 v18, s[36:39], s60 offen offset:0 lds
    v_mfma_f32_16x16x32_bf16 v[116:119], v[204:207], a[92:95], v[116:119]
    s_waitcnt lgkmcnt(3)
    ds_read_b64_tr_b16 v[190:191], v160 offset:48384
    ds_read_b64_tr_b16 v[192:193], v160 offset:58112
    v_mfma_f32_16x16x32_bf16 v[116:119], v[200:203], a[84:87], v[116:119]
    ds_read_b64_tr_b16 v[194:195], v160 offset:58624
    v_mfma_f32_16x16x32_bf16 v[120:123], v[176:179], a[80:83], v[120:123]
    ds_read_b64_tr_b16 v[196:197], v161 offset:4864
    v_mfma_f32_16x16x32_bf16 v[120:123], v[180:183], a[88:91], v[120:123]
    buffer_load_dwordx4 v19, s[36:39], s60 offen offset:1024 lds
    v_mfma_f32_16x16x32_bf16 v[124:127], v[180:183], a[92:95], v[124:127]
    s_waitcnt lgkmcnt(3)
    ds_read_b64_tr_b16 v[198:199], v161 offset:5376
    ds_read_b64_tr_b16 v[200:201], v162 offset:58112
    v_mfma_f32_16x16x32_bf16 v[124:127], v[176:179], a[84:87], v[124:127]
    s_nop 0
    ds_read_b64_tr_b16 v[202:203], v162 offset:58624
    s_nop 0
    v_mfma_f32_16x16x32_bf16 v[128:131], v[184:187], a[80:83], v[128:131]
    s_nop 0
    ds_read_b64_tr_b16 v[204:205], v163 offset:4864
    s_nop 0
    v_mfma_f32_16x16x32_bf16 v[128:131], v[188:191], a[88:91], v[128:131]
    buffer_load_dwordx4 v20, s[36:39], s60 offen offset:2048 lds
    v_mfma_f32_16x16x32_bf16 v[132:135], v[188:191], a[92:95], v[132:135]
    s_waitcnt lgkmcnt(3)
    ds_read_b64_tr_b16 v[206:207], v163 offset:5376
    ds_read_b64_tr_b16 v[176:177], v164 offset:58112
    v_mfma_f32_16x16x32_bf16 v[132:135], v[184:187], a[84:87], v[132:135]
    s_add_u32 m0, s65, 62208
    ds_read_b64_tr_b16 v[178:179], v164 offset:58624
    s_waitcnt vmcnt(27)
    v_mfma_f32_16x16x32_bf16 v[64:67], v[192:195], a[96:99], v[64:67]
    s_nop 0
    ds_read_b64_tr_b16 v[180:181], v165 offset:4864
    s_waitcnt vmcnt(24)
    v_mfma_f32_16x16x32_bf16 v[64:67], v[196:199], a[104:107], v[64:67]
    buffer_load_dwordx4 v31, s[52:55], 0 offen lds
    s_waitcnt vmcnt(24)
    v_mfma_f32_16x16x32_bf16 v[68:71], v[196:199], a[108:111], v[68:71]
    s_waitcnt lgkmcnt(3)
    ds_read_b64_tr_b16 v[182:183], v165 offset:5376
    ds_read_b64_tr_b16 v[184:185], v166 offset:58112
    v_mfma_f32_16x16x32_bf16 v[68:71], v[192:195], a[100:103], v[68:71]
    s_waitcnt lgkmcnt(0)
    s_andn2_b32 s89, s99, s97
    s_cbranch_scc1 L_att_spin3
L_att_spin3r:
    v_mfma_f32_16x16x32_bf16 v[72:75], v[200:203], a[96:99], v[72:75]
    s_waitcnt vmcnt(9)
    s_barrier
    ds_read_b64_tr_b16 v[186:187], v166 offset:58624
    v_mfma_f32_16x16x32_bf16 v[72:75], v[204:207], a[104:107], v[72:75]
    buffer_load_dword v58, v221, s[44:47], s83 offen sc1
    ds_read_b64_tr_b16 v[188:189], v167 offset:4864
    v_mfma_f32_16x16x32_bf16 v[76:79], v[204:207], a[108:111], v[76:79]
    s_nop 0
    ds_read_b64_tr_b16 v[190:191], v167 offset:5376
    ds_read_b64_tr_b16 v[192:193], v160 offset:59136
    v_mfma_f32_16x16x32_bf16 v[76:79], v[200:203], a[100:103], v[76:79]
    s_nop 0
    ds_read_b64_tr_b16 v[194:195], v160 offset:59648
    v_mfma_f32_16x16x32_bf16 v[80:83], v[176:179], a[96:99], v[80:83]
    s_nop 0
    ds_read_b64_tr_b16 v[196:197], v161 offset:5888
    v_mfma_f32_16x16x32_bf16 v[80:83], v[180:183], a[104:107], v[80:83]
    buffer_load_dwordx4 a[144:147], v28, s[44:47], s66 offen sc1
    v_mfma_f32_16x16x32_bf16 v[84:87], v[180:183], a[108:111], v[84:87]
    s_waitcnt lgkmcnt(3)
    ds_read_b64_tr_b16 v[198:199], v161 offset:6400
    ds_read_b64_tr_b16 v[200:201], v162 offset:59136
    v_mfma_f32_16x16x32_bf16 v[84:87], v[176:179], a[100:103], v[84:87]
    s_add_u32 s66, s0, 131072
    ds_read_b64_tr_b16 v[202:203], v162 offset:59648
    v_mfma_f32_16x16x32_bf16 v[88:91], v[184:187], a[96:99], v[88:91]
    ds_read_b64_tr_b16 v[204:205], v163 offset:5888
    v_mfma_f32_16x16x32_bf16 v[88:91], v[188:191], a[104:107], v[88:91]
    buffer_load_dwordx4 a[148:151], v28, s[44:47], s66 offen sc1
    s_nop 0
    v_mfma_f32_16x16x32_bf16 v[92:95], v[188:191], a[108:111], v[92:95]
    s_waitcnt lgkmcnt(3)
    ds_read_b64_tr_b16 v[206:207], v163 offset:6400
    ds_read_b64_tr_b16 v[176:177], v164 offset:59136
    v_mfma_f32_16x16x32_bf16 v[92:95], v[184:187], a[100:103], v[92:95]
    s_add_u32 s66, s0, 262144
    ds_read_b64_tr_b16 v[178:179], v164 offset:59648
    v_mfma_f32_16x16x32_bf16 v[96:99], v[192:195], a[96:99], v[96:99]
    ds_read_b64_tr_b16 v[180:181], v165 offset:5888
    v_mfma_f32_16x16x32_bf16 v[96:99], v[196:199], a[104:107], v[96:99]
    buffer_load_dwordx4 a[152:155], v28, s[44:47], s66 offen sc1
    v_mfma_f32_16x16x32_bf16 v[100:103], v[196:199], a[108:111], v[100:103]
L_att_pad7:
    s_cbranch_execz L_att_ret1
    s_waitcnt lgkmcnt(3)
    ds_read_b64_tr_b16 v[182:183], v165 offset:6400
    ds_read_b64_tr_b16 v[184:185], v166 offset:59136
    v_mfma_f32_16x16x32_bf16 v[100:103], v[192:195], a[100:103], v[100:103]
    s_add_u32 s66, s0, 524288
    ds_read_b64_tr_b16 v[186:187], v166 offset:59648
    v_mfma_f32_16x16x32_bf16 v[104:107], v[200:203], a[96:99], v[104:107]
    s_nop 0
    ds_read_b64_tr_b16 v[188:189], v167 offset:5888
    v_mfma_f32_16x16x32_bf16 v[104:107], v[204:207], a[104:107], v[104:107]
    buffer_load_dwordx4 a[156:159], v28, s[44:47], s66 offen sc1
    v_mfma_f32_16x16x32_bf16 v[108:111], v[204:207], a[108:111], v[108:111]
    s_waitcnt lgkmcnt(3)
    ds_read_b64_tr_b16 v[190:191], v167 offset:6400
    ds_read_b64_tr_b16 v[192:193], v160 offset:60160
    v_mfma_f32_16x16x32_bf16 v[108:111], v[200:203], a[100:103], v[108:111]
    s_add_u32 s66, s0, 655360
    ds_read_b64_tr_b16 v[194:195], v160 offset:60672
    v_mfma_f32_16x16x32_bf16 v[112:115], v[176:179], a[96:99], v[112:115]
    s_nop 0
    ds_read_b64_tr_b16 v[196:197], v161 offset:6912
    v_mfma_f32_16x16x32_bf16 v[112:115], v[180:183], a[104:107], v[112:115]
    buffer_load_dwordx4 a[160:163], v28, s[44:47], s66 offen sc1
    v_mfma_f32_16x16x32_bf16 v[116:119], v[180:183], a[108:111], v[116:119]
    s_waitcnt lgkmcnt(3)
    ds_read_b64_tr_b16 v[198:199], v161 offset:7424
    ds_read_b64_tr_b16 v[200:201], v161 offset:17152
    v_mfma_f32_16x16x32_bf16 v[116:119], v[176:179], a[100:103], v[116:119]
    s_add_u32 s66, s0, 786432
    ds_read_b64_tr_b16 v[202:203], v161 offset:17664
    v_mfma_f32_16x16x32_bf16 v[120:123], v[184:187], a[96:99], v[120:123]
    ds_read_b64_tr_b16 v[204:205], v1 offset:768
    v_mfma_f32_16x16x32_bf16 v[120:123], v[188:191], a[104:107], v[120:123]
    buffer_load_dwordx4 a[164:167], v28, s[44:47], s66 offen sc1
    v_mfma_f32_16x16x32_bf16 v[124:127], v[188:191], a[108:111], v[124:127]
    s_waitcnt lgkmcnt(3)
    ds_read_b64_tr_b16 v[206:207], v1 offset:1280
    ds_read_b64_tr_b16 v[176:177], v163 offset:17152
    s_nop 0
    v_mfma_f32_16x16x32_bf16 v[124:127], v[184:187], a[100:103], v[124:127]
    s_add_u32 s66, s0, 1048576
    ds_read_b64_tr_b16 v[178:179], v163 offset:17664
    v_mfma_f32_16x16x32_bf16 v[128:131], v[192:195], a[96:99], v[128:131]
    ds_read_b64_tr_b16 v[180:181], v22 offset:768
    v_mfma_f32_16x16x32_bf16 v[128:131], v[196:199], a[104:107], v[128:131]
    buffer_load_dwordx4 a[168:171], v28, s[44:47], s66 offen sc1
    v_mfma_f32_16x16x32_bf16 v[132:135], v[196:199], a[108:111], v[132:135]
    s_waitcnt lgkmcnt(3)
    ds_read_b64_tr_b16 v[182:183], v22 offset:1280
    ds_read_b64_tr_b16 v[184:185], v165 offset:17152
    v_mfma_f32_16x16x32_bf16 v[132:135], v[192:195], a[100:103], v[132:135]
    s_nop 0
    s_add_u32 s66, s0, 1179648
    ds_read_b64_tr_b16 v[186:187], v165 offset:17664
    s_nop 0
    v_mfma_f32_16x16x32_bf16 v[64:67], v[200:203], a[112:115], v[64:67]
    s_nop 0
    ds_read_b64_tr_b16 v[188:189], v23 offset:768
    v_mfma_f32_16x16x32_bf16 v[64:67], v[204:207], a[120:123], v[64:67]
    buffer_load_dwordx4 a[172:175], v28, s[44:47], s66 offen sc1
    v_mfma_f32_16x16x32_bf16 v[68:71], v[204:207], a[124:127], v[68:71]
    s_waitcnt lgkmcnt(3)
    ds_read_b64_tr_b16 v[190:191], v23 offset:1280
    ds_read_b64_tr_b16 v[192:193], v167 offset:17152
    v_mfma_f32_16x16x32_bf16 v[68:71], v[200:203], a[116:119], v[68:71]
    s_nop 0
    s_add_u32 s66, s0, 1310720
    ds_read_b64_tr_b16 v[194:195], v167 offset:17664
    v_mfma_f32_16x16x32_bf16 v[72:75], v[176:179], a[112:115], v[72:75]
    s_waitcnt vmcnt(10)
    s_barrier
    ds_read_b64_tr_b16 v[196:197], v27 offset:768
    v_mfma_f32_16x16x32_bf16 v[72:75], v[180:183], a[120:123], v[72:75]
    buffer_load_dwordx4 a[176:179], v28, s[44:47], s66 offen sc1
    v_mfma_f32_16x16x32_bf16 v[76:79], v[180:183], a[124:127], v[76:79]
    s_waitcnt lgkmcnt(3)
    ds_read_b64_tr_b16 v[198:199], v27 offset:1280
    ds_read_b64_tr_b16 v[200:201], v161 offset:18176
    v_mfma_f32_16x16x32_bf16 v[76:79], v[176:179], a[116:119], v[76:79]
    s_add_u32 s66, s1, 0
    ds_read_b64_tr_b16 v[202:203], v161 offset:18688
    v_mfma_f32_16x16x32_bf16 v[80:83], v[184:187], a[112:115], v[80:83]
    s_nop 0
    ds_read_b64_tr_b16 v[204:205], v1 offset:1792
    v_mfma_f32_16x16x32_bf16 v[80:83], v[188:191], a[120:123], v[80:83]
    buffer_load_dwordx4 a[180:183], v28, s[44:47], s66 offen sc1
    v_mfma_f32_16x16x32_bf16 v[84:87], v[188:191], a[124:127], v[84:87]
    s_waitcnt lgkmcnt(3)
    ds_read_b64_tr_b16 v[206:207], v1 offset:2304
    ds_read_b64_tr_b16 v[176:177], v163 offset:18176
    v_mfma_f32_16x16x32_bf16 v[84:87], v[184:187], a[116:119], v[84:87]
    s_add_u32 s66, s1, 131072
    ds_read_b64_tr_b16 v[178:179], v163 offset:18688
    v_mfma_f32_16x16x32_bf16 v[88:91], v[192:195], a[112:115], v[88:91]
    ds_read_b64_tr_b16 v[180:181], v22 offset:1792
    v_mfma_f32_16x16x32_bf16 v[88:91], v[196:199], a[120:123], v[88:91]
    buffer_load_dwordx4 a[184:187], v28, s[44:47], s66 offen sc1
    v_mfma_f32_16x16x32_bf16 v[92:95], v[196:199], a[124:127], v[92:95]
    s_waitcnt lgkmcnt(3)
    ds_read_b64_tr_b16 v[182:183], v22 offset:2304
    ds_read_b64_tr_b16 v[184:185], v165 offset:18176
    s_nop 0
    v_mfma_f32_16x16x32_bf16 v[92:95], v[192:195], a[116:119], v[92:95]
    s_add_u32 s66, s1, 262144
    ds_read_b64_tr_b16 v[186:187], v165 offset:18688
    v_mfma_f32_16x16x32_bf16 v[96:99], v[200:203], a[112:115], v[96:99]
    ds_read_b64_tr_b16 v[188:189], v23 offset:1792
    v_mfma_f32_16x16x32_bf16 v[96:99], v[204:207], a[120:123], v[96:99]
    buffer_load_dwordx4 a[188:191], v28, s[44:47], s66 offen sc1
    v_mfma_f32_16x16x32_bf16 v[100:103], v[204:207], a[124:127], v[100:103]
    s_waitcnt lgkmcnt(3)
    ds_read_b64_tr_b16 v[190:191], v23 offset:2304
    ds_read_b64_tr_b16 v[192:193], v167 offset:18176
    v_mfma_f32_16x16x32_bf16 v[100:103], v[200:203], a[116:119], v[100:103]
    s_nop 0
    ds_read_b64_tr_b16 v[194:195], v167 offset:18688
    v_mfma_f32_16x16x32_bf16 v[104:107], v[176:179], a[112:115], v[104:107]
    ds_read_b64_tr_b16 v[196:197], v27 offset:1792
    v_mfma_f32_16x16x32_bf16 v[104:107], v[180:183], a[120:123], v[104:107]
    s_nop 0
    ds_read_b64_tr_b16 v[198:199], v27 offset:2304
    v_mfma_f32_16x16x32_bf16 v[108:111], v[180:183], a[124:127], v[108:111]
    s_waitcnt lgkmcnt(4)
    ds_read_b64_tr_b16 v[200:201], v161 offset:19200
    v_mfma_f32_16x16x32_bf16 v[108:111], v[176:179], a[116:119], v[108:111]
    ds_read_b64_tr_b16 v[202:203], v161 offset:19712
    v_mfma_f32_16x16x32_bf16 v[112:115], v[184:187], a[112:115], v[112:115]
    ds_read_b64_tr_b16 v[204:205], v1 offset:2816
    v_mfma_f32_16x16x32_bf16 v[112:115], v[188:191], a[120:123], v[112:115]
    s_nop 0
    ds_read_b64_tr_b16 v[206:207], v1 offset:3328
    v_mfma_f32_16x16x32_bf16 v[116:119], v[188:191], a[124:127], v[116:119]
    s_waitcnt lgkmcnt(4)
    ds_read_b64_tr_b16 v[176:177], v1 offset:13056
    v_mfma_f32_16x16x32_bf16 v[116:119], v[184:187], a[116:119], v[116:119]
    ds_read_b64_tr_b16 v[178:179], v1 offset:13568
    v_mfma_f32_16x16x32_bf16 v[120:123], v[192:195], a[112:115], v[120:123]
    ds_read_b64_tr_b16 v[180:181], v1 offset:25344
    v_mfma_f32_16x16x32_bf16 v[120:123], v[196:199], a[120:123], v[120:123]
    ds_read_b64_tr_b16 v[182:183], v1 offset:25856
    v_mfma_f32_16x16x32_bf16 v[124:127], v[196:199], a[124:127], v[124:127]
    s_waitcnt lgkmcnt(4)
    ds_read_b64_tr_b16 v[184:185], v22 offset:13056
    v_mfma_f32_16x16x32_bf16 v[124:127], v[192:195], a[116:119], v[124:127]
    s_nop 0
    ds_read_b64_tr_b16 v[186:187], v22 offset:13568
    v_mfma_f32_16x16x32_bf16 v[128:131], v[200:203], a[112:115], v[128:131]
    ds_read_b64_tr_b16 v[188:189], v22 offset:25344
    v_mfma_f32_16x16x32_bf16 v[128:131], v[204:207], a[120:123], v[128:131]
    ds_read_b64_tr_b16 v[190:191], v22 offset:25856
    v_mfma_f32_16x16x32_bf16 v[132:135], v[204:207], a[124:127], v[132:135]
    s_waitcnt lgkmcnt(4)
    ds_read_b64_tr_b16 v[192:193], v23 offset:13056
    v_mfma_f32_16x16x32_bf16 v[132:135], v[200:203], a[116:119], v[132:135]
    s_nop 0
    ds_read_b64_tr_b16 v[194:195], v23 offset:13568
    v_mfma_f32_16x16x32_bf16 v[64:67], v[176:179], a[128:131], v[64:67]
    ds_read_b64_tr_b16 v[196:197], v23 offset:25344
    v_mfma_f32_16x16x32_bf16 v[64:67], v[180:183], a[136:139], v[64:67]
    s_nop 0
    ds_read_b64_tr_b16 v[198:199], v23 offset:25856
    v_mfma_f32_16x16x32_bf16 v[68:71], v[180:183], a[140:143], v[68:71]
    s_waitcnt lgkmcnt(4)
    ds_read_b64_tr_b16 v[200:201], v27 offset:13056
    v_mfma_f32_16x16x32_bf16 v[68:71], v[176:179], a[132:135], v[68:71]
    ds_read_b64_tr_b16 v[202:203], v27 offset:13568
    v_mfma_f32_16x16x32_bf16 v[72:75], v[184:187], a[128:131], v[72:75]
    ds_read_b64_tr_b16 v[204:205], v27 offset:25344
    v_mfma_f32_16x16x32_bf16 v[72:75], v[188:191], a[136:139], v[72:75]
    s_nop 0
    ds_read_b64_tr_b16 v[206:207], v27 offset:25856
    v_mfma_f32_16x16x32_bf16 v[76:79], v[188:191], a[140:143], v[76:79]
    s_waitcnt lgkmcnt(4)
    ds_read_b64_tr_b16 v[176:177], v1 offset:14080
    v_mfma_f32_16x16x32_bf16 v[76:79], v[184:187], a[132:135], v[76:79]
    ds_read_b64_tr_b16 v[178:179], v1 offset:14592
    v_cvt_pk_bf16_f32 v32, v64, v65
    v_mfma_f32_16x16x32_bf16 v[80:83], v[192:195], a[128:131], v[80:83]
    ds_read_b64_tr_b16 v[180:181], v1 offset:26368
    v_cvt_pk_bf16_f32 v33, v66, v67
    v_mfma_f32_16x16x32_bf16 v[80:83], v[196:199], a[136:139], v[80:83]
    s_nop 0
    ds_read_b64_tr_b16 v[182:183], v1 offset:26880
    v_cvt_pk_bf16_f32 v34, v68, v69
    v_mfma_f32_16x16x32_bf16 v[84:87], v[196:199], a[140:143], v[84:87]
    s_waitcnt lgkmcnt(4)
    ds_read_b64_tr_b16 v[184:185], v22 offset:14080
    v_cvt_pk_bf16_f32 v35, v70, v71
    v_mfma_f32_16x16x32_bf16 v[84:87], v[192:195], a[132:135], v[84:87]
    buffer_store_dwordx4 v[32:35], v24, s[44:47], s42 offen sc1
    v_mfma_f32_16x16x32_bf16 v[88:91], v[200:203], a[128:131], v[88:91]
    s_add_u32 s42, s42, s40
    ds_read_b64_tr_b16 v[186:187], v22 offset:14592
    ds_read_b64_tr_b16 v[188:189], v22 offset:26368
    v_mfma_f32_16x16x32_bf16 v[88:91], v[204:207], a[136:139], v[88:91]
    ds_read_b64_tr_b16 v[190:191], v22 offset:26880
    v_cvt_pk_bf16_f32 v36, v72, v73
    v_mfma_f32_16x16x32_bf16 v[92:95], v[204:207], a[140:143], v[92:95]
    s_waitcnt lgkmcnt(4)
    ds_read_b64_tr_b16 v[192:193], v23 offset:14080
    v_cvt_pk_bf16_f32 v37, v74, v75
    v_mfma_f32_16x16x32_bf16 v[92:95], v[200:203], a[132:135], v[92:95]
    ds_read_b64_tr_b16 v[194:195], v23 offset:14592
    v_cvt_pk_bf16_f32 v38, v76, v77
    v_mfma_f32_16x16x32_bf16 v[96:99], v[176:179], a[128:131], v[96:99]
    ds_read_b64_tr_b16 v[196:197], v23 offset:26368
    v_cvt_pk_bf16_f32 v39, v78, v79
    v_mfma_f32_16x16x32_bf16 v[96:99], v[180:183], a[136:139], v[96:99]
    buffer_store_dwordx4 v[36:39], v24, s[44:47], s42 offen sc1
    v_mfma_f32_16x16x32_bf16 v[100:103], v[180:183], a[140:143], v[100:103]
    s_waitcnt lgkmcnt(3)
    ds_read_b64_tr_b16 v[198:199], v23 offset:26880
    ds_read_b64_tr_b16 v[200:201], v27 offset:14080
    v_mfma_f32_16x16x32_bf16 v[100:103], v[176:179], a[132:135], v[100:103]
    s_add_u32 s42, s42, s41
    ds_read_b64_tr_b16 v[202:203], v27 offset:14592
    v_cvt_pk_bf16_f32 v40, v80, v81
    v_mfma_f32_16x16x32_bf16 v[104:107], v[184:187], a[128:131], v[104:107]
    ds_read_b64_tr_b16 v[204:205], v27 offset:26368
    v_cvt_pk_bf16_f32 v41, v82, v83
    v_mfma_f32_16x16x32_bf16 v[104:107], v[188:191], a[136:139], v[104:107]
    ds_read_b64_tr_b16 v[206:207], v27 offset:26880
    v_cvt_pk_bf16_f32 v42, v84, v85
    v_mfma_f32_16x16x32_bf16 v[108:111], v[188:191], a[140:143], v[108:111]
    s_waitcnt lgkmcnt(4)
    ds_read_b64_tr_b16 v[176:177], v1 offset:15104
    v_cvt_pk_bf16_f32 v43, v86, v87
    v_mfma_f32_16x16x32_bf16 v[108:111], v[184:187], a[132:135], v[108:111]
    buffer_store_dwordx4 v[40:43], v24, s[44:47], s42 offen sc1
    v_mfma_f32_16x16x32_bf16 v[112:115], v[192:195], a[128:131], v[112:115]
    s_add_u32 s42, s42, s40
    ds_read_b64_tr_b16 v[178:179], v1 offset:15616
    ds_read_b64_tr_b16 v[180:181], v1 offset:27392
    v_mfma_f32_16x16x32_bf16 v[112:115], v[196:199], a[136:139], v[112:115]
    ds_read_b64_tr_b16 v[182:183], v1 offset:27904
    v_cvt_pk_bf16_f32 v44, v88, v89
    v_mfma_f32_16x16x32_bf16 v[116:119], v[196:199], a[140:143], v[116:119]
    s_waitcnt lgkmcnt(4)
    v_cvt_pk_bf16_f32 v45, v90, v91
    v_cvt_pk_bf16_f32 v46, v92, v93
    v_mfma_f32_16x16x32_bf16 v[116:119], v[192:195], a[132:135], v[116:119]
    s_nop 0
    v_cvt_pk_bf16_f32 v47, v94, v95
    v_mfma_f32_16x16x32_bf16 v[120:123], v[200:203], a[128:131], v[120:123]
    buffer_store_dwordx4 v[44:47], v24, s[44:47], s42 offen sc1
    v_mfma_f32_16x16x32_bf16 v[120:123], v[204:207], a[136:139], v[120:123]
    s_add_u32 s42, s42, s41
    v_cvt_pk_bf16_f32 v32, v96, v97
    v_cvt_pk_bf16_f32 v33, v98, v99
    v_mfma_f32_16x16x32_bf16 v[124:127], v[204:207], a[140:143], v[124:127]
    s_waitcnt lgkmcnt(0)
    v_cvt_pk_bf16_f32 v34, v100, v101
    v_cvt_pk_bf16_f32 v35, v102, v103
    v_mfma_f32_16x16x32_bf16 v[124:127], v[200:203], a[132:135], v[124:127]
    s_nop 0
    v_mfma_f32_16x16x32_bf16 v[128:131], v[176:179], a[128:131], v[128:131]
    buffer_store_dwordx4 v[32:35], v24, s[44:47], s42 offen sc1
    v_mfma_f32_16x16x32_bf16 v[128:131], v[180:183], a[136:139], v[128:131]
    s_add_u32 s42, s42, s40
    v_cvt_pk_bf16_f32 v36, v104, v105
    v_cvt_pk_bf16_f32 v37, v106, v107
    v_mfma_f32_16x16x32_bf16 v[132:135], v[180:183], a[140:143], v[132:135]
    v_cvt_pk_bf16_f32 v38, v108, v109
    v_cvt_pk_bf16_f32 v39, v110, v111
    v_mfma_f32_16x16x32_bf16 v[132:135], v[176:179], a[132:135], v[132:135]
    buffer_store_dwordx4 v[36:39], v24, s[44:47], s42 offen sc1
    s_add_u32 s42, s42, s41
    v_cvt_pk_bf16_f32 v40, v112, v113
    v_cvt_pk_bf16_f32 v41, v114, v115
    v_cvt_pk_bf16_f32 v42, v116, v117
    v_cvt_pk_bf16_f32 v43, v118, v119
    buffer_store_dwordx4 v[40:43], v24, s[44:47], s42 offen sc1
    s_add_u32 s42, s42, s40
    v_cvt_pk_bf16_f32 v44, v120, v121
    v_cvt_pk_bf16_f32 v45, v122, v123
    v_cvt_pk_bf16_f32 v46, v124, v125
    v_cvt_pk_bf16_f32 v47, v126, v127
    buffer_store_dwordx4 v[44:47], v24, s[44:47], s42 offen sc1
    s_add_u32 s42, s42, s41
    v_cvt_pk_bf16_f32 v32, v128, v129
    v_cvt_pk_bf16_f32 v33, v130, v131
    s_nop 0
    v_cvt_pk_bf16_f32 v34, v132, v133
    v_cvt_pk_bf16_f32 v35, v134, v135
    buffer_store_dwordx4 v[32:35], v24, s[44:47], s42 offen sc1
    s_cbranch_vccz L_skip11
    s_mov_b32 s70, 0
    s_atomic_add s70, s[92:93], 0x500 glc
L_skip11:
    s_waitcnt vmcnt(22)
    ds_read_b64 v[48:49], v225 offset:0
    ds_read_b64 v[50:51], v225 offset:64
    s_nop 0
    ds_read_b64 v[52:53], v225 offset:128
    ds_read_b64 v[54:55], v225 offset:192
    ds_read_b64 v[56:57], v225 offset:256
    s_lshl_b32 s43, s58, 8
    v_and_b32 v246, 15, v0
    v_lshl_add_u32 v246, v246, 4, s43
    s_and_b32 s43, s57, 7
    v_lshrrev_b32 v247, 4, v0
    v_add_u32 v248, s43, v247
    v_subrev_u32 v249, 9, v248
    v_min_u32_e64 v248, v248, v249
    v_lshl_add_u32 v227, v248, 15, v246
    v_add_u32 v248, 4, v248
    v_subrev_u32 v249, 9, v248
    v_min_u32 v248, v248, v249
    v_lshl_add_u32 v228, v248, 15, v246
    v_add_u32 v248, 4, v248
    v_subrev_u32 v249, 9, v248
    v_min_u32 v248, v248, v249
    v_lshl_add_u32 v229, v248, 15, v246
    v_min_u32_e64 v249, 1, v247
    v_lshl_add_u32 v229, v249, 31, v229
    v_bfe_u32 v249, v0, 3, 1
    v_sub_u32_e64 v249, v247, v249
    v_cmp_eq_u32 s[8:9], 0, v249
    v_cmp_eq_u32 s[10:11], 2, v249
    v_and_b32 v250, 3, v0
    s_waitcnt lgkmcnt(0)
    s_waitcnt vmcnt(0)
    s_barrier
    s_cbranch_vccz L_skip12
    s_atomic_add s96, s[92:93], 0xa00
L_skip12:
    s_andn2_b32 s89, s99, s70
    s_cbranch_scc1 L_att_spin4
L_att_spin4r:
    s_cbranch_vccz L_skip13
    s_mov_b32 s72, 0
    s_atomic_add s72, s[92:93], 0x600 glc
L_skip13:
    s_barrier
    s_add_u32 s60, s1, 524288
    buffer_load_dwordx4 a[192:195], v28, s[44:47], s60 offen sc1
    s_add_u32 s60, s1, 655360
    buffer_load_dwordx4 a[196:199], v28, s[44:47], s60 offen sc1
    s_add_u32 s60, s1, 786432
    buffer_load_dwordx4 a[200:203], v28, s[44:47], s60 offen sc1
    s_add_u32 s60, s1, 1048576
    buffer_load_dwordx4 a[204:207], v28, s[44:47], s60 offen sc1
    s_add_u32 s60, s1, 1179648
    buffer_load_dwordx4 a[208:211], v28, s[44:47], s60 offen sc1
    s_add_u32 s60, s1, 1310720
    buffer_load_dwordx4 a[212:215], v28, s[44:47], s60 offen sc1
    v_lshl_add_u32 v226, v250, 2, v245
    v_and_or_b32 v226, v0, 48, v226
    v_lshlrev_b32 v226, 2, v226
    v_or_b32 v249, v208, v212
    v_cndmask_b32 v230, 0, v249, s[8:9]
    v_cndmask_b32 v234, 0, v249, s[10:11]
    v_or_b32 v249, v209, v213
    v_cndmask_b32 v231, 0, v249, s[8:9]
    v_cndmask_b32 v235, 0, v249, s[10:11]
    v_or_b32 v249, v210, v214
    v_cndmask_b32 v232, 0, v249, s[8:9]
    v_cndmask_b32 v236, 0, v249, s[10:11]
    v_or_b32_e64 v249, v211, v215
    v_cndmask_b32 v233, 0, v249, s[8:9]
    v_cndmask_b32 v237, 0, v249, s[10:11]
    v_mul_u32_u24 v246, 288, v221
    v_lshl_add_u32 v246, v245, 3, v246
    v_sub_u32 v249, v245, v250
    v_mul_i32_i24 v249, 2296, v249
    v_add_u32 v247, v246, v249
    v_lshl_add_u32 v246, v244, 31, v246
    v_add_u32 v248, s43, v244
    v_lshl_add_u32 v238, v248, 7, v247
    v_add_u32 v248, 2, v248
    v_subrev_u32 v249, 9, v248
    v_min_u32 v248, v248, v249
    v_lshl_add_u32 v239, v248, 7, v247
    v_add_u32 v248, 2, v248
    v_subrev_u32 v249, 9, v248
    v_min_u32 v248, v248, v249
    v_lshl_add_u32 v240, v248, 7, v247
    v_add_u32 v248, 2, v248
    v_subrev_u32 v249, 9, v248
    v_min_u32 v248, v248, v249
    v_lshl_add_u32 v241, v248, 7, v247
    v_add_u32_e64 v248, 2, v248
    v_subrev_u32_e64 v249, 9, v248
    v_min_u32_e64 v248, v248, v249
    v_lshl_add_u32 v242, v248, 7, v246
    v_lshlrev_b32_e64 v136, 16, v48
    v_and_b32 v137, 0xffff0000, v48
    v_lshlrev_b32_e64 v138, 16, v49
    v_and_b32 v139, 0xffff0000, v49
    v_lshlrev_b32_e64 v140, 16, v50
    v_and_b32 v141, 0xffff0000, v50
    v_lshlrev_b32_e64 v142, 16, v51
    v_and_b32 v143, 0xffff0000, v51
    v_lshlrev_b32 v144, 16, v52
    v_and_b32 v145, 0xffff0000, v52
    v_lshlrev_b32 v146, 16, v53
    v_and_b32 v147, 0xffff0000, v53
    v_lshlrev_b32 v148, 16, v54
    v_and_b32 v149, 0xffff0000, v54
    v_lshlrev_b32 v150, 16, v55
    v_and_b32 v151, 0xffff0000, v55
    v_lshlrev_b32 v152, 16, v56
    v_and_b32 v153, 0xffff0000, v56
    v_lshlrev_b32 v154, 16, v57
    v_and_b32 v155, 0xffff0000, v57
    v_mfma_f32_16x16x32_bf16 v[136:139], v[208:211], a[144:147], v[136:139]
    v_mfma_f32_16x16x32_bf16 v[136:139], v[208:211], a[148:151], v[136:139]
    v_mfma_f32_16x16x32_bf16 v[136:139], v[208:211], a[152:155], v[136:139]
    v_mfma_f32_16x16x32_bf16 v[136:139], v[212:215], a[156:159], v[136:139]
    v_mfma_f32_16x16x32_bf16 v[136:139], v[212:215], a[160:163], v[136:139]
    v_mfma_f32_16x16x32_bf16 v[136:139], v[212:215], a[164:167], v[136:139]
    v_mfma_f32_16x16x32_bf16 v[140:143], v[208:211], a[168:171], v[140:143]
    v_mfma_f32_16x16x32_bf16 v[140:143], v[208:211], a[172:175], v[140:143]
    v_mfma_f32_16x16x32_bf16 v[140:143], v[208:211], a[176:179], v[140:143]
    v_mfma_f32_16x16x32_bf16 v[140:143], v[212:215], a[180:183], v[140:143]
    v_mfma_f32_16x16x32_bf16 v[140:143], v[212:215], a[184:187], v[140:143]
    v_mfma_f32_16x16x32_bf16 v[140:143], v[212:215], a[188:191], v[140:143]
    s_nop 1
    v_mul_f32 v136, v58, v136
    v_mul_f32 v137, v58, v137
    v_mul_f32 v138, v58, v138
    v_mul_f32 v139, v58, v139
    s_nop 1
    v_mul_f32 v140, v58, v140
    v_mul_f32 v141, v58, v141
    v_mul_f32_e64 v142, v58, v142
    v_mul_f32 v143, v58, v143
    s_waitcnt lgkmcnt(0)
    s_andn2_b32 s89, s99, s72
    s_cbranch_scc1 L_att_spin5
L_att_spin5r:
    s_cbranch_vccz L_skip14
    s_mov_b32 s70, 0
    s_atomic_add s70, s[92:93], 0xa00 glc
L_skip14:
    s_barrier
    s_add_u32 s60, s61, 0
    buffer_load_dwordx4 a[216:219], v28, s[44:47], s60 offen sc1
    s_add_u32 s60, s61, 131072
    buffer_load_dwordx4 a[220:223], v28, s[44:47], s60 offen sc1
    s_add_u32 s60, s61, 262144
    buffer_load_dwordx4 a[224:227], v28, s[44:47], s60 offen sc1
    s_waitcnt vmcnt(8)
    v_mfma_f32_16x16x32_bf16 v[144:147], v[208:211], a[192:195], v[144:147]
    s_waitcnt vmcnt(7)
    v_mfma_f32_16x16x32_bf16 v[144:147], v[208:211], a[196:199], v[144:147]
    s_waitcnt vmcnt(6)
    v_mfma_f32_16x16x32_bf16 v[144:147], v[208:211], a[200:203], v[144:147]
    s_waitcnt vmcnt(5)
    v_mfma_f32_16x16x32_bf16 v[144:147], v[212:215], a[204:207], v[144:147]
    s_waitcnt vmcnt(4)
    v_mfma_f32_16x16x32_bf16 v[144:147], v[212:215], a[208:211], v[144:147]
    s_waitcnt vmcnt(3)
    v_mfma_f32_16x16x32_bf16 v[144:147], v[212:215], a[212:215], v[144:147]
    s_nop 7
    v_mul_f32 v144, v58, v144
    v_mul_f32 v145, v58, v145
    v_mul_f32 v146, v58, v146
    v_mul_f32_e64 v147, v58, v147
    s_waitcnt lgkmcnt(0)
    s_andn2_b32 s89, s100, s70
    s_cbranch_scc1 L_att_spin6
L_att_spin6r:
    s_cbranch_vccz L_skip15
    s_mov_b32 s72, 0
    s_atomic_add s72, s[92:93], 0x700 glc
L_skip15:
    s_barrier
    buffer_load_dwordx4 a[0:3], v227, s[44:47], s5 offen sc1
    buffer_load_dwordx4 a[4:7], v228, s[44:47], s5 offen sc1
    buffer_load_dwordx4 a[8:11], v229, s[44:47], s5 offen sc1
    s_waitcnt vmcnt(5)
    v_mfma_f32_16x16x32_bf16 v[148:151], v[208:211], a[216:219], v[148:151]
    s_waitcnt vmcnt(4)
    v_mfma_f32_16x16x32_bf16 v[148:151], v[208:211], a[220:223], v[148:151]
    s_waitcnt vmcnt(3)
    s_nop 0
    v_mfma_f32_16x16x32_bf16 v[148:151], v[208:211], a[224:227], v[148:151]
    s_waitcnt lgkmcnt(0)
    s_andn2_b32 s89, s99, s72
    s_cbranch_scc1 L_att_spin7
L_att_spin7r:
    s_cbranch_vccz L_skip16
    s_mov_b32 s70, 0
    s_atomic_add s70, s[92:93], 0x800 glc
L_skip16:
    s_barrier
    s_add_u32 s60, s61, 524288
    buffer_load_dwordx4 a[228:231], v28, s[44:47], s60 offen sc1
    s_add_u32 s60, s61, 655360
    buffer_load_dwordx4 a[232:235], v28, s[44:47], s60 offen sc1
    s_add_u32 s60, s61, 786432
    buffer_load_dwordx4 a[236:239], v28, s[44:47], s60 offen sc1
    s_waitcnt vmcnt(5)
    v_mfma_f32_16x16x32_bf16 v[136:139], v[230:233], a[0:3], v[136:139]
    v_mfma_f32_16x16x32_bf16 v[140:143], v[234:237], a[0:3], v[140:143]
    s_waitcnt vmcnt(4)
    v_mfma_f32_16x16x32_bf16 v[144:147], v[230:233], a[4:7], v[144:147]
    s_waitcnt vmcnt(3)
    v_mfma_f32_16x16x32_bf16 v[48:51], v[230:233], a[8:11], 0
    s_nop 2
    v_cvt_pk_bf16_f32 v244, v136, v137
    v_cvt_pk_bf16_f32 v245, v138, v139
    v_cvt_pk_bf16_f32 v246, v140, v141
    v_cvt_pk_bf16_f32 v247, v142, v143
    v_cvt_pk_bf16_f32 v248, v144, v145
    v_cvt_pk_bf16_f32 v249, v146, v147
    ds_bpermute_b32 v244, v226, v244
    ds_bpermute_b32 v245, v226, v245
    ds_bpermute_b32 v246, v226, v246
    ds_bpermute_b32 v247, v226, v247
    ds_bpermute_b32 v248, v226, v248
    ds_bpermute_b32 v249, v226, v249
    s_waitcnt lgkmcnt(0)
    s_andn2_b32 s89, s99, s70
    s_cbranch_scc1 L_att_spin8
L_att_spin8r:
    s_barrier
    s_add_u32 s60, s61, 1048576
    buffer_load_dwordx4 a[240:243], v28, s[44:47], s60 offen sc1
    s_add_u32 s60, s61, 1179648
    buffer_load_dwordx4 a[244:247], v28, s[44:47], s60 offen sc1
    s_add_u32 s60, s61, 1310720
    buffer_load_dwordx4 a[248:251], v28, s[44:47], s60 offen sc1
    buffer_store_dwordx2 v[244:245], v238, s[48:51], s68 offen
    buffer_store_dwordx2 v[246:247], v239, s[48:51], s68 offen
    buffer_store_dwordx2 v[248:249], v240, s[48:51], s68 offen
    s_waitcnt vmcnt(8)
    v_mfma_f32_16x16x32_bf16 v[148:151], v[212:215], a[228:231], v[148:151]
    s_waitcnt vmcnt(7)
    v_mfma_f32_16x16x32_bf16 v[148:151], v[212:215], a[232:235], v[148:151]
    s_waitcnt vmcnt(6)
    v_mfma_f32_16x16x32_bf16 v[148:151], v[212:215], a[236:239], v[148:151]
    s_nop 7
    v_mul_f32_e64 v148, v58, v148
    v_mul_f32_e64 v149, v58, v149
    v_mul_f32_e64 v150, v58, v150
    v_mul_f32_e64 v151, v58, v151
    s_nop 1
    v_mfma_f32_16x16x32_bf16 v[148:151], v[234:237], a[4:7], v[148:151]
    s_nop 7
    v_cvt_pk_bf16_f32 v250, v148, v149
    v_cvt_pk_bf16_f32 v251, v150, v151
    ds_bpermute_b32 v250, v226, v250
    ds_bpermute_b32 v251, v226, v251
    s_waitcnt lgkmcnt(0)
    buffer_store_dwordx2 v[250:251], v241, s[48:51], s68 offen
    s_waitcnt vmcnt(6)
    v_mfma_f32_16x16x32_bf16 v[152:155], v[208:211], a[240:243], v[152:155]
    s_nop 0
    s_waitcnt vmcnt(5)
    v_mfma_f32_16x16x32_bf16 v[152:155], v[208:211], a[244:247], v[152:155]
    s_waitcnt vmcnt(4)
    v_mfma_f32_16x16x32_bf16 v[152:155], v[208:211], a[248:251], v[152:155]
    s_nop 7
    v_fma_f32 v152, v152, v58, v48
    v_fma_f32 v153, v153, v58, v49
    v_fma_f32 v154, v154, v58, v50
    v_fma_f32 v155, v155, v58, v51
    v_cvt_pk_bf16_f32 v252, v152, v153
    v_cvt_pk_bf16_f32 v253, v154, v155
    buffer_store_dwordx2 v[252:253], v242, s[48:51], s68 offen
    s_endpgm
L_att_spin0:
    v_mov_b32 v46, 0
    global_load_dword v46, v46, s[94:95] sc1
    s_waitcnt vmcnt(0)
    v_readfirstlane_b32 s97, v46
    s_sub_u32 s81, s81, 1
    s_waitcnt lgkmcnt(0)
    s_cmp_lt_i32 s81, 0
    s_cbranch_scc1 L_att_spin0r
    s_andn2_b32 s89, 15, s97
    s_cbranch_scc1 L_att_spin0
    s_branch L_att_spin0r
L_att_spin1:
    s_mov_b32 s97, 0
    s_atomic_add s97, s[92:93], 0x900 glc
    s_sub_u32 s81, s81, 1
    s_waitcnt lgkmcnt(0)
    s_cmp_lt_i32 s81, 0
    s_cbranch_scc1 L_att_spin1r
    s_andn2_b32 s89, s100, s97
    s_cbranch_scc1 L_att_spin1
    s_branch L_att_spin1r
L_att_spin2:
    s_mov_b32 s97, 0
    s_atomic_add s97, s[92:93], 0x100 glc
    s_sub_u32 s81, s81, 1
    s_waitcnt lgkmcnt(0)
    s_cmp_lt_i32 s81, 0
    s_cbranch_scc1 L_att_spin2r
    s_andn2_b32 s89, s99, s97
    s_cbranch_scc1 L_att_spin2
    s_branch L_att_spin2r
L_att_spin3:
    s_mov_b32 s97, 0
    s_atomic_add s97, s[92:93], 0x300 glc
    s_sub_u32 s81, s81, 1
    s_waitcnt lgkmcnt(0)
    s_cmp_lt_i32 s81, 0
    s_cbranch_scc1 L_att_spin3r
    s_andn2_b32 s89, s99, s97
    s_cbranch_scc1 L_att_spin3
    s_branch L_att_spin3r
L_att_spin4:
    s_mov_b32 s70, 0
    s_atomic_add s70, s[92:93], 0x500 glc
    s_sub_u32 s81, s81, 1
    s_waitcnt lgkmcnt(0)
    s_cmp_lt_i32 s81, 0
    s_cbranch_scc1 L_att_spin4r
    s_andn2_b32 s89, s99, s70
    s_cbranch_scc1 L_att_spin4
    s_branch L_att_spin4r
L_att_spin5:
    s_mov_b32 s72, 0
    s_atomic_add s72, s[92:93], 0x600 glc
    s_sub_u32 s81, s81, 1
    s_waitcnt lgkmcnt(0)
    s_cmp_lt_i32 s81, 0
    s_cbranch_scc1 L_att_spin5r
    s_andn2_b32 s89, s99, s72
    s_cbranch_scc1 L_att_spin5
    s_branch L_att_spin5r
L_att_spin6:
    s_mov_b32 s70, 0
    s_atomic_add s70, s[92:93], 0xa00 glc
    s_sub_u32 s81, s81, 1
    s_waitcnt lgkmcnt(0)
    s_cmp_lt_i32 s81, 0
    s_cbranch_scc1 L_att_spin6r
    s_andn2_b32 s89, s100, s70
    s_cbranch_scc1 L_att_spin6
    s_branch L_att_spin6r
L_att_spin7:
    s_mov_b32 s72, 0
    s_atomic_add s72, s[92:93], 0x700 glc
    s_sub_u32 s81, s81, 1
    s_waitcnt lgkmcnt(0)
    s_cmp_lt_i32 s81, 0
    s_cbranch_scc1 L_att_spin7r
    s_andn2_b32 s89, s99, s72
    s_cbranch_scc1 L_att_spin7
    s_branch L_att_spin7r
L_att_spin8:
    s_mov_b32 s70, 0
L_att_pad8:
    s_cbranch_execz L_att_ret1
    s_atomic_add s70, s[92:93], 0x800 glc
    s_sub_u32 s81, s81, 1
    s_waitcnt lgkmcnt(0)
    s_cmp_lt_i32 s81, 0
    s_cbranch_scc1 L_att_spin8r
    s_andn2_b32 s89, s99, s70
    s_cbranch_scc1 L_att_spin8
    s_branch L_att_spin8r
.p2align 12
.section .rodata,"a"
.p2align 6
.amdhsa_kernel gated_mix__sliding_local_dilated__dense_activation_squared_relu__prompt_kernel
  .amdhsa_next_free_vgpr 512
  .amdhsa_next_free_sgpr 102
  .amdhsa_accum_offset 256
  .amdhsa_group_segment_fixed_size 0
  .amdhsa_kernarg_size 96
  .amdhsa_user_sgpr_count 2
  .amdhsa_user_sgpr_kernarg_segment_ptr 1
  .amdhsa_system_sgpr_workgroup_id_x 1
.end_amdhsa_kernel
```
